```python
import torch

def _softmax(x, axis=-1):
    return torch.softmax(x, dim=axis)
def _gelu(x):
    return torch.nn.functional.gelu(x, approximate="tanh")
def _silu(x):
    return torch.nn.functional.silu(x)
def _sigmoid(x):
    return torch.sigmoid(x)
def _layernorm(x, axis=-1, eps=1e-5):
    m = x.mean(dim=axis, keepdim=True)
    v = x.var(dim=axis, keepdim=True, unbiased=False)
    return (x - m) / torch.sqrt(v + eps)
def _scatter_add(tgt, idx, src, axis=0):
    return tgt.clone().index_add_(axis, idx, src)
def _segment_sum(src, seg, n):
    out = torch.zeros((n,) + src.shape[1:], dtype=src.dtype)
    return out.index_add_(0, seg, src)
def _pad(x, pw):
    flat = tuple(v for pair in reversed(pw) for v in pair)
    return torch.nn.functional.pad(x, flat)

kernel_name = 'sequential_preLN__compressed_kv_cla__glu_gated_swiglu__prompt'

def setup_inputs():

    _w = (lambda a: (lambda t: t.to(torch.bfloat16) if t.is_floating_point() else t)(torch.as_tensor(a)))
    def _A_setup():
        B, H, Sq, Sk, D, M = 1, 16, 2048, 2048, 256, 448
        Dc = 4 * D
        return {
            "x": _w((lambda *s: torch.randn(*s, dtype=torch.bfloat16) * 0.05)(B, Sq, M)),
            "c_kv": _w((lambda *s: torch.randn(*s, dtype=torch.bfloat16) * 0.4)(B, Sk, Dc)),
            "w_q": _w((lambda *s: torch.randn(*s, dtype=torch.bfloat16) * 1.6)(M, H, D) * (M ** -0.5)),
            "w_uk": _w((lambda *s: torch.randn(*s, dtype=torch.bfloat16) * 1.6)(Dc, H, D) * (Dc ** -0.5)),
            "w_uv": _w((lambda *s: torch.randn(*s, dtype=torch.bfloat16) * 0.4)(Dc, H, D) * (Dc ** -0.5)),
            "w_o": _w((lambda *s: torch.randn(*s, dtype=torch.bfloat16) * 0.4)(H, D, M) * ((H * D) ** -0.5)),
        }
    _A_in = _A_setup()

    def _B_setup():
        B, S, D, F = 1, 2048, 448, 1792
        return {
            "x": _w((lambda *s: torch.randn(*s, dtype=torch.bfloat16) * 0.05)(B, S, D)),
            "w1": _w((lambda *s: torch.randn(*s, dtype=torch.bfloat16) * 0.2)(D, F) * (2.0 / D) ** 0.5),
            "w3": _w((lambda *s: torch.randn(*s, dtype=torch.bfloat16) * 0.2)(D, F) * (2.0 / D) ** 0.5),
            "w2": _w((lambda *s: torch.randn(*s, dtype=torch.bfloat16) * 0.2)(F, D) * (2.0 / F) ** 0.5),
        }
    _B_in = _B_setup()

    return {
        "A_x": _A_in["x"],
        "A_c_kv": _A_in["c_kv"],
        "A_w_q": _A_in["w_q"],
        "A_w_uk": _A_in["w_uk"],
        "A_w_uv": _A_in["w_uv"],
        "A_w_o": _A_in["w_o"],
        "B_x": _B_in["x"],
        "B_w1": _B_in["w1"],
        "B_w3": _B_in["w3"],
        "B_w2": _B_in["w2"],
    }

def reference(A_x, A_c_kv, A_w_q, A_w_uk, A_w_uv, A_w_o, B_x, B_w1, B_w3, B_w2):
    def _A_ref(x, c_kv, w_q, w_uk, w_uv, w_o):
        B, Sq, M = x.shape[0], x.shape[1], x.shape[2]
        Sk = c_kv.shape[1]
        H, D = w_q.shape[1], w_q.shape[2]
        q = torch.einsum("bqm,mhd->bhqd", x, w_q)
        k = torch.einsum("bkc,chd->bhkd", c_kv, w_uk)
        v = torch.einsum("bkc,chd->bhkd", c_kv, w_uv)
        scores = torch.einsum("bhqd,bhkd->bhqk", q, k) * (D ** -0.5)
        off = Sk - Sq
        qi = torch.arange(Sq)[:, None]
        kj = torch.arange(Sk)[None, :]
        cmask = kj <= (qi + off)
        scores = torch.where(cmask[None, None], scores, -1e9)
        p = _softmax(scores, axis=-1)
        ctx = torch.einsum("bhqk,bhkd->bhqd", p, v)
        return torch.einsum("bhqd,hdm->bqm", ctx, w_o)

    def _B_ref(x, w1, w3, w2):
        gate = torch.einsum("bsd,df->bsf", x, w1)
        up = torch.einsum("bsd,df->bsf", x, w3)
        h = _silu(gate) * up
        out = torch.einsum("bsf,fd->bsd", h, w2)
        return out

    x = A_x
    h = x + _A_ref(_layernorm(x, axis=-1), A_c_kv, A_w_q, A_w_uk, A_w_uv, A_w_o)
    h2 = h + _B_ref(_layernorm(h, axis=-1), B_w1, B_w3, B_w2)
    return h2
```

```asm
; @launch grid=(256,1,1) block=(256,1,1) lds=163840
.amdgcn_target "amdgcn-amd-amdhsa--gfx950"
.text
.globl sequential_preLN__compressed_kv_cla__glu_gated_swiglu__prompt_kernel
.p2align 8
.type sequential_preLN__compressed_kv_cla__glu_gated_swiglu__prompt_kernel,@function
sequential_preLN__compressed_kv_cla__glu_gated_swiglu__prompt_kernel:
M_begin:
    s_cmp_ge_u32 s2, 256
    s_cbranch_scc1 M_end

    s_load_dwordx16 s[40:55], s[0:1], 0
    s_load_dwordx8 s[56:63], s[0:1], 64
    s_load_dwordx2 s[64:65], s[0:1], 96
    v_lshrrev_b32 v5, 6, v0
    v_and_b32 v2, 63, v0
    v_readfirstlane_b32 s66, v5
    v_lshlrev_b32 v1, 4, v2
    s_and_b32 s67, s2, 7
    s_lshr_b32 s68, s2, 3
    s_and_b32 s3, s68, 1
    s_lshl_b32 s30, s67, 1
    s_add_u32 s30, s30, s3
    s_bfe_u32 s28, s68, 0x10001
    s_lshr_b32 s27, s68, 2

    s_getpc_b64 s[20:21]
M_pc0:
    s_sub_u32 s20, s20, M_pc0-M_begin
    s_subb_u32 s21, s21, 0
    s_mov_b32 s22, M_codeend-M_begin
    s_mov_b32 s23, 0x00020000
    s_lshl_b32 s24, s68, 2
    s_add_u32 s24, s24, s66
    s_lshl_b32 s24, s24, 10
    buffer_load_dword v8, v1, s[20:23], s24 offen
    v_lshrrev_b32 v9, 3, v2
    v_lshrrev_b32 v10, 4, v2
    v_and_b32 v11, 7, v2
    s_lshl_b32 s3, s66, 6
    v_add_u32 v9, s3, v9
    v_lshlrev_b32 v9, 11, v9
    v_xor_b32 v12, v11, v10
    v_xor_b32 v13, 4, v12
    v_lshl_add_u32 v12, v12, 4, v9
    v_lshl_add_u32 v13, v13, 4, v9
    v_add_u32 v232, 0, v12
    v_add_u32 v233, 15360, v13
    v_add_u32 v234, 30720, v12
    v_add_u32 v235, 46080, v13
    v_add_u32 v236, 65536, v12
    v_add_u32 v237, 80896, v13
    v_add_u32 v238, 96256, v12
    v_add_u32 v239, 111616, v13
    v_lshrrev_b32 v9, 5, v2
    v_and_b32 v11, 31, v2
    s_and_b32 s3, s66, 1
    s_lshl_b32 s3, s3, 3
    s_lshl_b32 s38, s66, 3
    v_add_u32 v12, 0, v9
    v_and_b32 v13, 3, v12
    v_lshlrev_b32 v13, 1, v13
    v_or_b32 v13, s3, v13
    v_xor_b32 v13, v13, v11
    v_add_u32 v12, s38, v12
    v_lshlrev_b32 v12, 13, v12
    v_lshl_add_u32 v12, v13, 4, v12
    v_subrev_u32 v240, 0, v12
    v_add_u32 v12, 2, v9
    v_and_b32 v13, 3, v12
    v_lshlrev_b32 v13, 1, v13
    v_or_b32 v13, s3, v13
    v_xor_b32 v13, v13, v11
    v_add_u32 v12, s38, v12
    v_lshlrev_b32 v12, 13, v12
    v_lshl_add_u32 v12, v13, 4, v12
    v_subrev_u32 v241, 1024, v12
    v_add_u32 v12, 4, v9
    v_and_b32 v13, 3, v12
    v_lshlrev_b32 v13, 1, v13
    v_or_b32 v13, s3, v13
    v_xor_b32 v13, v13, v11
    v_add_u32 v12, s38, v12
    v_lshlrev_b32 v12, 13, v12
    v_lshl_add_u32 v12, v13, 4, v12
    v_subrev_u32 v242, 2048, v12
    v_add_u32 v12, 6, v9
    v_and_b32 v13, 3, v12
    v_lshlrev_b32 v13, 1, v13
    v_or_b32 v13, s3, v13
    v_xor_b32 v13, v13, v11
    v_add_u32 v12, s38, v12
    v_lshlrev_b32 v12, 13, v12
    v_lshl_add_u32 v12, v13, 4, v12
    v_subrev_u32 v243, 3072, v12

    s_mov_b32 s20, 0
    s_mov_b32 s21, 0
    s_mov_b32 s22, 65536
    s_lshl_b32 s37, s66, 13
    s_add_u32 s29, s37, 4096
    s_lshl_b32 s24, s66, 12
    s_waitcnt lgkmcnt(0)
    s_lshl_b32 s3, s27, 19
    s_add_u32 s4, s42, s3
    s_addc_u32 s5, s43, 0
    s_mov_b32 s6, 524288
    s_mov_b32 s7, 0x00020000
    s_cmp_eq_u32 s28, 0
    s_cselect_b32 s8, s46, s48
    s_cselect_b32 s9, s47, s49
    s_lshl_b32 s3, s30, 9
    s_add_u32 s8, s8, s3
    s_addc_u32 s9, s9, 0
    s_sub_u32 s10, 8388608, s3
    s_mov_b32 s11, 0x00020000

    s_mov_b32 s72, s40
    s_mov_b32 s73, s41
    s_mov_b32 s74, 1835008
    s_mov_b32 s75, 0x00020000
    s_lshl_b32 s3, s2, 2
    s_add_u32 s3, s3, s66
    s_mul_i32 s3, s3, 1792
    v_cmp_gt_u32 vcc, 56, v2
    v_mov_b32 v12, 0x7fffffff
    s_nop 0
    v_cndmask_b32 v12, v12, v1, vcc
    buffer_load_dwordx4 v[160:163], v12, s[72:75], s3 offen
    buffer_load_dwordx4 v[164:167], v12, s[72:75], s3 offen offset:896
    s_add_u32 m0, s22, s37
    s_nop 0
    buffer_load_dwordx4 v232, s[4:7], s21 offen offset:0 lds
    buffer_load_dwordx4 v233, s[4:7], s21 offen offset:1024 lds
    buffer_load_dwordx4 v234, s[4:7], s21 offen offset:2048 lds
    buffer_load_dwordx4 v235, s[4:7], s21 offen offset:3072 lds
    s_add_u32 m0, s24, 0
    s_nop 0
    buffer_load_dwordx4 v240, s[8:11], s20 offen offset:0 nt lds
    buffer_load_dwordx4 v241, s[8:11], s20 offen offset:1024 nt lds
    buffer_load_dwordx4 v242, s[8:11], s20 offen offset:2048 nt lds
    buffer_load_dwordx4 v243, s[8:11], s20 offen offset:3072 nt lds
    s_add_u32 s20, s20, 262144
    s_add_u32 m0, s22, s29
    s_nop 0
    buffer_load_dwordx4 v236, s[4:7], s21 offen offset:0 lds
    buffer_load_dwordx4 v237, s[4:7], s21 offen offset:1024 lds
    buffer_load_dwordx4 v238, s[4:7], s21 offen offset:2048 lds
    buffer_load_dwordx4 v239, s[4:7], s21 offen offset:3072 lds
    s_add_u32 s21, s21, 128
    s_add_u32 s22, s22, 32768
    s_cmp_eq_u32 s22, 163840
    s_cselect_b32 s22, 65536, s22
    s_mov_b32 s12, s64
    s_mov_b32 s13, s65
    s_mov_b32 s14, 268435456
    s_mov_b32 s15, 0x00020000
    v_and_b32 v11, 15, v2
    v_lshrrev_b32 v12, 2, v11
    v_and_b32 v13, 1, v10
    v_lshl_or_b32 v13, v13, 2, v12
    v_lshl_add_u32 v12, v10, 3, v12
    v_lshlrev_b32 v12, 9, v12
    v_and_b32 v14, 3, v11
    v_lshl_add_u32 v12, v14, 3, v12
    s_and_b32 s3, s66, 1
    s_lshl_b32 s3, s3, 8
    v_add_u32 v12, s3, v12
    v_xor_b32 v14, 0, v13
    v_lshl_add_u32 v244, v14, 5, v12
    v_xor_b32 v14, 1, v13
    v_lshl_add_u32 v245, v14, 5, v12
    v_xor_b32 v14, 2, v13
    v_lshl_add_u32 v246, v14, 5, v12
    v_xor_b32 v14, 3, v13
    v_lshl_add_u32 v247, v14, 5, v12
    v_xor_b32 v14, 4, v13
    v_lshl_add_u32 v248, v14, 5, v12
    v_xor_b32 v14, 5, v13
    v_lshl_add_u32 v249, v14, 5, v12
    v_xor_b32 v14, 6, v13
    v_lshl_add_u32 v250, v14, 5, v12
    v_xor_b32 v14, 7, v13
    v_lshl_add_u32 v251, v14, 5, v12
    v_lshrrev_b32 v12, 1, v11
    v_xor_b32 v12, v12, v10
    v_lshlrev_b32 v12, 4, v12
    v_lshl_add_u32 v12, v11, 7, v12
    s_lshr_b32 s3, s66, 1
    s_lshl_b32 s3, s3, 14
    v_add_u32 v252, s3, v12
    v_xor_b32 v253, 64, v252
    s_mov_b32 s25, 65536
    v_add_u32 v254, s25, v252
    v_add_u32 v255, s25, v253
    v_lshlrev_b32 v28, 2, v10
    v_lshlrev_b32 v29, 3, v11
    v_and_b32 v12, 3, v11
    v_lshlrev_b32 v12, 5, v12
    v_lshrrev_b32 v11, 2, v11
    v_lshl_add_u32 v30, v11, 3, v12
    s_mov_b32 s0, s49
    s_lshr_b32 s49, s68, 1
    s_lshl_b32 s49, s49, 2
    s_add_u32 s49, s49, s66
    s_mov_b32 s16, s62
    s_mov_b32 s17, s63
    s_mov_b32 s18, 256
    s_mov_b32 s19, 0x00020000
    s_mov_b32 s64, s60
    s_mov_b32 s65, s61
    s_lshr_b32 s71, s49, 2
    s_and_b32 s72, s49, 3
    s_lshl_b32 s92, s71, 18
    s_lshl_b32 s73, s30, 9
    s_add_u32 s92, s92, s73
    s_lshl_b32 s73, s72, 7
    s_add_u32 s92, s92, s73
    s_mul_i32 s95, s30, 229376
    s_lshl_b32 s73, s49, 12
    s_add_u32 s95, s95, s73
    s_add_u32 s95, s95, 35651584
    s_lshl_b32 s70, s30, 3
    s_add_u32 s70, s70, s49
    s_add_u32 s70, s70, 184
    s_mul_i32 s71, s70, 9363
    s_lshr_b32 s71, s71, 16
    s_mul_i32 s72, s71, 7
    s_sub_u32 s72, s70, s72
    s_mul_i32 s73, s71, 28672
    s_lshl_b32 s74, s72, 7
    s_add_u32 s73, s73, s74
    s_mul_i32 s74, s72, 229376
    s_bfe_u32 s72, s71, 0x10001
    s_mul_i32 s72, s72, 114688
    s_add_u32 s74, s74, s72
    s_and_b32 s72, s71, 1
    s_lshr_b32 s71, s71, 2
    s_lshl_b32 s71, s71, 1
    s_add_u32 s71, s71, s72
    s_lshl_b32 s71, s71, 12
    s_add_u32 s74, s74, s71
    s_add_u32 s74, s74, 48234496
    s_mov_b32 s82, 3670016
    s_mov_b32 s69, 8192
    s_cmp_ge_u32 s49, 56
    s_cselect_b32 s80, s58, s44
    s_cselect_b32 s81, s59, s45
    s_cmp_ge_u32 s49, 56
    s_cselect_b32 s82, 1605632, s82
    s_cselect_b32 s69, 896, s69
    s_cmp_ge_u32 s49, 56
    s_cselect_b32 s92, s73, s92
    s_cselect_b32 s95, s74, s95
    s_cselect_b64 vcc, -1, 0
    s_mov_b32 s83, 0x00020000
    v_mul_lo_u32 v25, v28, s69
    v_cndmask_b32 v24, v30, v29, vcc
    v_add_u32 v25, v25, v24
    s_getpc_b64 s[44:45]
M_pc1:
    s_sub_u32 s44, s44, M_pc1-M_begin
    s_subb_u32 s45, s45, 0
    s_mov_b32 s46, M_codeend-M_begin
    s_mov_b32 s47, 0x00020000
    s_lshl_b32 s48, s68, 2
    s_add_u32 s48, s48, s66
    s_lshl_b32 s48, s48, 10
    s_add_u32 m0, s24, 16384
    s_nop 0
    buffer_load_dwordx4 v240, s[8:11], s20 offen offset:0 nt lds
    buffer_load_dwordx4 v241, s[8:11], s20 offen offset:1024 nt lds
    buffer_load_dwordx4 v242, s[8:11], s20 offen offset:2048 nt lds
    buffer_load_dwordx4 v243, s[8:11], s20 offen offset:3072 nt lds
    s_add_u32 s20, s20, 262144
    s_add_u32 m0, s22, s37
    s_nop 0
    buffer_load_dwordx4 v232, s[4:7], s21 offen offset:0 lds
    buffer_load_dwordx4 v233, s[4:7], s21 offen offset:1024 lds
    buffer_load_dwordx4 v234, s[4:7], s21 offen offset:2048 lds
    buffer_load_dwordx4 v235, s[4:7], s21 offen offset:3072 lds
    s_add_u32 m0, s22, s29
    s_nop 0
    buffer_load_dwordx4 v236, s[4:7], s21 offen offset:0 lds
    buffer_load_dwordx4 v237, s[4:7], s21 offen offset:1024 lds
    buffer_load_dwordx4 v238, s[4:7], s21 offen offset:2048 lds
    buffer_load_dwordx4 v239, s[4:7], s21 offen offset:3072 lds
    s_add_u32 s21, s21, 128
    s_add_u32 s22, s22, 32768
    s_cmp_eq_u32 s22, 163840
    s_cselect_b32 s22, 65536, s22
    s_add_u32 m0, s24, 32768
    s_nop 0
    buffer_load_dwordx4 v240, s[8:11], s20 offen offset:0 nt lds
    buffer_load_dwordx4 v241, s[8:11], s20 offen offset:1024 nt lds
    buffer_load_dwordx4 v242, s[8:11], s20 offen offset:2048 nt lds
    buffer_load_dwordx4 v243, s[8:11], s20 offen offset:3072 nt lds
    s_add_u32 s20, s20, 262144
    s_waitcnt vmcnt(16)
    s_barrier
    ds_read_b64_tr_b16 v[64:65], v244 offset:0
    ds_read_b64_tr_b16 v[66:67], v244 offset:2048
    ds_read_b128 v[32:35], v254 offset:0
    ds_read_b64_tr_b16 v[68:69], v245 offset:0
    ds_read_b64_tr_b16 v[70:71], v245 offset:2048
    ds_read_b128 v[36:39], v254 offset:2048
    ds_read_b64_tr_b16 v[72:73], v246 offset:0
    ds_read_b64_tr_b16 v[74:75], v246 offset:2048
    ds_read_b128 v[40:43], v254 offset:4096
    ds_read_b64_tr_b16 v[76:77], v247 offset:0
    ds_read_b64_tr_b16 v[78:79], v247 offset:2048
    ds_read_b128 v[44:47], v254 offset:6144
    ds_read_b64_tr_b16 v[80:81], v248 offset:0
    ds_read_b64_tr_b16 v[82:83], v248 offset:2048
    ds_read_b128 v[48:51], v254 offset:8192
    ds_read_b64_tr_b16 v[84:85], v249 offset:0
    ds_read_b64_tr_b16 v[86:87], v249 offset:2048
    ds_read_b128 v[52:55], v254 offset:10240
    ds_read_b64_tr_b16 v[88:89], v250 offset:0
    ds_read_b64_tr_b16 v[90:91], v250 offset:2048
    ds_read_b128 v[56:59], v254 offset:12288
    ds_read_b64_tr_b16 v[92:93], v251 offset:0
    ds_read_b64_tr_b16 v[94:95], v251 offset:2048
    ds_read_b128 v[60:63], v254 offset:14336
    s_cmp_eq_u32 s28, 0
    s_cbranch_scc0 G_V
G_K:
    s_waitcnt vmcnt(12) lgkmcnt(0)
    s_barrier
    v_mfma_f32_16x16x32_bf16 a[0:3], v[64:67], v[32:35], 0
    v_mfma_f32_16x16x32_bf16 a[4:7], v[68:71], v[32:35], 0
    v_mfma_f32_16x16x32_bf16 a[8:11], v[72:75], v[32:35], 0
    v_mfma_f32_16x16x32_bf16 a[12:15], v[76:79], v[32:35], 0
    ds_read_b64_tr_b16 v[128:129], v244 offset:16384
    s_add_u32 m0, s24, 49152
    v_mfma_f32_16x16x32_bf16 a[16:19], v[80:83], v[32:35], 0
    buffer_load_dwordx4 v240, s[8:11], s20 offen offset:0 nt lds
    v_mfma_f32_16x16x32_bf16 a[20:23], v[84:87], v[32:35], 0
    ds_read_b64_tr_b16 v[130:131], v244 offset:18432
    v_mov_b32 v12, 0x3f803f80
    v_mfma_f32_16x16x32_bf16 a[24:27], v[88:91], v[32:35], 0
    v_dot2_f32_bf16 v14, v160, v12, 0
    v_dot2_f32_bf16 v16, v160, v160, 0
    v_mfma_f32_16x16x32_bf16 a[28:31], v[92:95], v[32:35], 0
    ds_read_b128 v[96:99], v255 offset:0
    v_dot2_f32_bf16 v15, v164, v12, 0
    v_mfma_f32_16x16x32_bf16 a[60:63], v[92:95], v[36:39], 0
    buffer_load_dwordx4 v241, s[8:11], s20 offen offset:1024 nt lds
    v_mfma_f32_16x16x32_bf16 a[56:59], v[88:91], v[36:39], 0
    ds_read_b64_tr_b16 v[132:133], v245 offset:16384
    v_dot2_f32_bf16 v17, v164, v164, 0
    v_mfma_f32_16x16x32_bf16 a[52:55], v[84:87], v[36:39], 0
    v_dot2_f32_bf16 v14, v161, v12, v14
    v_dot2_f32_bf16 v16, v161, v161, v16
    v_mfma_f32_16x16x32_bf16 a[48:51], v[80:83], v[36:39], 0
    ds_read_b64_tr_b16 v[134:135], v245 offset:18432
    v_dot2_f32_bf16 v15, v165, v12, v15
    v_mfma_f32_16x16x32_bf16 a[44:47], v[76:79], v[36:39], 0
    buffer_load_dwordx4 v242, s[8:11], s20 offen offset:2048 nt lds
    v_mfma_f32_16x16x32_bf16 a[40:43], v[72:75], v[36:39], 0
    ds_read_b128 v[100:103], v255 offset:2048
    v_dot2_f32_bf16 v17, v165, v165, v17
    v_mfma_f32_16x16x32_bf16 a[36:39], v[68:71], v[36:39], 0
    v_dot2_f32_bf16 v14, v162, v12, v14
    v_dot2_f32_bf16 v16, v162, v162, v16
    v_mfma_f32_16x16x32_bf16 a[32:35], v[64:67], v[36:39], 0
    ds_read_b64_tr_b16 v[136:137], v246 offset:16384
    v_dot2_f32_bf16 v15, v166, v12, v15
    v_mfma_f32_16x16x32_bf16 a[64:67], v[64:67], v[40:43], 0
    buffer_load_dwordx4 v243, s[8:11], s20 offen offset:3072 nt lds
    v_mfma_f32_16x16x32_bf16 a[68:71], v[68:71], v[40:43], 0
    ds_read_b64_tr_b16 v[138:139], v246 offset:18432
    s_add_u32 s20, s20, 262144
    v_mfma_f32_16x16x32_bf16 a[72:75], v[72:75], v[40:43], 0
    v_dot2_f32_bf16 v17, v166, v166, v17
    v_dot2_f32_bf16 v14, v163, v12, v14
    v_mfma_f32_16x16x32_bf16 a[76:79], v[76:79], v[40:43], 0
    ds_read_b128 v[104:107], v255 offset:4096
    v_dot2_f32_bf16 v16, v163, v163, v16
    v_mfma_f32_16x16x32_bf16 a[80:83], v[80:83], v[40:43], 0
    v_dot2_f32_bf16 v15, v167, v12, v15
    v_dot2_f32_bf16 v17, v167, v167, v17
    v_mfma_f32_16x16x32_bf16 a[84:87], v[84:87], v[40:43], 0
    ds_read_b64_tr_b16 v[140:141], v247 offset:16384
    s_add_u32 m0, s22, s37
    v_mfma_f32_16x16x32_bf16 a[88:91], v[88:91], v[40:43], 0
    buffer_load_dwordx4 v232, s[4:7], s21 offen offset:0 lds
    v_mfma_f32_16x16x32_bf16 a[92:95], v[92:95], v[40:43], 0
    ds_read_b64_tr_b16 v[142:143], v247 offset:18432
    v_and_b32 v9, 3, v2
    v_mfma_f32_16x16x32_bf16 a[124:127], v[92:95], v[44:47], 0
    v_and_b32 v10, 60, v2
    v_and_b32 v11, 1, v9
    v_mfma_f32_16x16x32_bf16 a[120:123], v[88:91], v[44:47], 0
    ds_read_b128 v[108:111], v255 offset:6144
    v_add_f32_dpp v14, v14, v14 row_ror:1 row_mask:0xf bank_mask:0xf
    v_mfma_f32_16x16x32_bf16 a[116:119], v[84:87], v[44:47], 0
    buffer_load_dwordx4 v233, s[4:7], s21 offen offset:1024 lds
    v_mfma_f32_16x16x32_bf16 a[112:115], v[80:83], v[44:47], 0
    ds_read_b64_tr_b16 v[144:145], v248 offset:16384
    v_add_f32_dpp v15, v15, v15 row_ror:1 row_mask:0xf bank_mask:0xf
    v_mfma_f32_16x16x32_bf16 a[108:111], v[76:79], v[44:47], 0
    v_add_f32_dpp v16, v16, v16 row_ror:1 row_mask:0xf bank_mask:0xf
    v_add_f32_dpp v17, v17, v17 row_ror:1 row_mask:0xf bank_mask:0xf
    v_mfma_f32_16x16x32_bf16 a[104:107], v[72:75], v[44:47], 0
    ds_read_b64_tr_b16 v[146:147], v248 offset:18432
    v_add_f32_dpp v14, v14, v14 row_ror:2 row_mask:0xf bank_mask:0xf
    v_mfma_f32_16x16x32_bf16 a[100:103], v[68:71], v[44:47], 0
    buffer_load_dwordx4 v234, s[4:7], s21 offen offset:2048 lds
    v_mfma_f32_16x16x32_bf16 a[96:99], v[64:67], v[44:47], 0
    ds_read_b128 v[112:115], v255 offset:8192
    v_add_f32_dpp v15, v15, v15 row_ror:2 row_mask:0xf bank_mask:0xf
    v_mfma_f32_16x16x32_bf16 a[128:131], v[64:67], v[48:51], 0
    v_add_f32_dpp v16, v16, v16 row_ror:2 row_mask:0xf bank_mask:0xf
    v_add_f32_dpp v17, v17, v17 row_ror:2 row_mask:0xf bank_mask:0xf
    v_mfma_f32_16x16x32_bf16 a[132:135], v[68:71], v[48:51], 0
    ds_read_b64_tr_b16 v[148:149], v249 offset:16384
    v_add_f32_dpp v14, v14, v14 row_ror:4 row_mask:0xf bank_mask:0xf
    v_mfma_f32_16x16x32_bf16 a[136:139], v[72:75], v[48:51], 0
    buffer_load_dwordx4 v235, s[4:7], s21 offen offset:3072 lds
    v_mfma_f32_16x16x32_bf16 a[140:143], v[76:79], v[48:51], 0
    ds_read_b64_tr_b16 v[150:151], v249 offset:18432
    v_add_f32_dpp v15, v15, v15 row_ror:4 row_mask:0xf bank_mask:0xf
    v_mfma_f32_16x16x32_bf16 a[144:147], v[80:83], v[48:51], 0
    v_add_f32_dpp v16, v16, v16 row_ror:4 row_mask:0xf bank_mask:0xf
    v_add_f32_dpp v17, v17, v17 row_ror:4 row_mask:0xf bank_mask:0xf
    v_mfma_f32_16x16x32_bf16 a[148:151], v[84:87], v[48:51], 0
    ds_read_b128 v[116:119], v255 offset:10240
    v_add_f32_dpp v14, v14, v14 row_ror:8 row_mask:0xf bank_mask:0xf
    v_mfma_f32_16x16x32_bf16 a[152:155], v[88:91], v[48:51], 0
    v_add_f32_dpp v15, v15, v15 row_ror:8 row_mask:0xf bank_mask:0xf
    v_add_f32_dpp v16, v16, v16 row_ror:8 row_mask:0xf bank_mask:0xf
    v_mfma_f32_16x16x32_bf16 a[156:159], v[92:95], v[48:51], 0
    ds_read_b64_tr_b16 v[152:153], v250 offset:16384
    s_add_u32 m0, s22, s29
    v_mfma_f32_16x16x32_bf16 a[188:191], v[92:95], v[52:55], 0
    buffer_load_dwordx4 v236, s[4:7], s21 offen offset:0 lds
    v_mfma_f32_16x16x32_bf16 a[184:187], v[88:91], v[52:55], 0
    ds_read_b64_tr_b16 v[154:155], v250 offset:18432
    v_add_f32_dpp v17, v17, v17 row_ror:8 row_mask:0xf bank_mask:0xf
    v_mfma_f32_16x16x32_bf16 a[180:183], v[84:87], v[52:55], 0
    s_bfe_u32 s31, s68, 0x30001
    s_lshr_b32 s32, s68, 4
    v_mfma_f32_16x16x32_bf16 a[176:179], v[80:83], v[52:55], 0
    ds_read_b128 v[120:123], v255 offset:12288
    s_sub_u32 s3, 15, s31
    v_mfma_f32_16x16x32_bf16 a[172:175], v[76:79], v[52:55], 0
    buffer_load_dwordx4 v237, s[4:7], s21 offen offset:1024 lds
    v_mfma_f32_16x16x32_bf16 a[168:171], v[72:75], v[52:55], 0
    ds_read_b64_tr_b16 v[156:157], v251 offset:16384
    v_mfma_f32_16x16x32_bf16 a[164:167], v[68:71], v[52:55], 0
    s_cmp_eq_u32 s32, 1
    s_cselect_b32 s33, s3, s31
    v_mfma_f32_16x16x32_bf16 a[160:163], v[64:67], v[52:55], 0
    ds_read_b64_tr_b16 v[158:159], v251 offset:18432
    s_mul_i32 s34, s30, 2181376
    v_mfma_f32_16x16x32_bf16 a[192:195], v[64:67], v[56:59], 0
    buffer_load_dwordx4 v238, s[4:7], s21 offen offset:2048 lds
    v_mfma_f32_16x16x32_bf16 a[196:199], v[68:71], v[56:59], 0
    ds_read_b128 v[124:127], v255 offset:14336
    s_add_u32 s34, s34, 117440512
    v_mfma_f32_16x16x32_bf16 a[200:203], v[72:75], v[56:59], 0
    s_mul_i32 s3, s27, 272384
    s_add_u32 s34, s34, s3
    v_mfma_f32_16x16x32_bf16 a[204:207], v[76:79], v[56:59], 0
    s_lshr_b32 s3, s66, 1
    s_mul_i32 s3, s3, 136192
    v_mfma_f32_16x16x32_bf16 a[208:211], v[80:83], v[56:59], 0
    buffer_load_dwordx4 v239, s[4:7], s21 offen offset:3072 lds
    v_mfma_f32_16x16x32_bf16 a[212:215], v[84:87], v[56:59], 0
    s_add_u32 s21, s21, 128
    s_add_u32 s22, s22, 32768
    v_mfma_f32_16x16x32_bf16 a[216:219], v[88:91], v[56:59], 0
    s_cmp_eq_u32 s22, 163840
    s_cselect_b32 s22, 65536, s22
    v_mfma_f32_16x16x32_bf16 a[220:223], v[92:95], v[56:59], 0
    s_add_u32 s34, s34, s3
    s_lshl_b32 s3, s28, 14
    v_mfma_f32_16x16x32_bf16 a[252:255], v[92:95], v[60:63], 0
    s_add_u32 s34, s34, s3
    v_cmp_eq_u32 vcc, 0, v0
    v_mfma_f32_16x16x32_bf16 a[248:251], v[88:91], v[60:63], 0
    v_mov_b32 v31, 268435456
    s_and_b32 s79, s68, 7
    v_mfma_f32_16x16x32_bf16 a[244:247], v[84:87], v[60:63], 0
    v_cndmask_b32 v31, v31, 0, vcc
    s_add_u32 s79, s79, 18
    v_mfma_f32_16x16x32_bf16 a[240:243], v[80:83], v[60:63], 0
    s_mov_b32 s78, 268435456
    s_lshl_b32 s79, s79, 18
    v_mfma_f32_16x16x32_bf16 a[236:239], v[76:79], v[60:63], 0
    s_mov_b32 s76, 0x05040100
    s_mov_b32 s77, 0x07060302
    v_mfma_f32_16x16x32_bf16 a[232:235], v[72:75], v[60:63], 0
    v_add_u32 v4, s24, v1
    v_mfma_f32_16x16x32_bf16 a[228:231], v[68:71], v[60:63], 0
    v_mfma_f32_16x16x32_bf16 a[224:227], v[64:67], v[60:63], 0
    s_waitcnt vmcnt(12) lgkmcnt(0)
    s_barrier
    v_mfma_f32_16x16x32_bf16 a[0:3], v[128:131], v[96:99], a[0:3]
    s_add_u32 s25, s25, 32768
    v_mfma_f32_16x16x32_bf16 a[4:7], v[132:135], v[96:99], a[4:7]
    s_cmp_eq_u32 s25, 163840
    s_cselect_b32 s25, 65536, s25
    v_mfma_f32_16x16x32_bf16 a[8:11], v[136:139], v[96:99], a[8:11]
    v_mfma_f32_16x16x32_bf16 a[12:15], v[140:143], v[96:99], a[12:15]
    ds_read_b64_tr_b16 v[64:65], v244 offset:32768
    s_add_u32 m0, s24, 0
    v_mfma_f32_16x16x32_bf16 a[16:19], v[144:147], v[96:99], a[16:19]
    buffer_load_dwordx4 v240, s[8:11], s20 offen offset:0 nt lds
    v_mfma_f32_16x16x32_bf16 a[20:23], v[148:151], v[96:99], a[20:23]
    v_add_u32 v254, s25, v252
    ds_read_b64_tr_b16 v[66:67], v244 offset:34816
    v_mfma_f32_16x16x32_bf16 a[24:27], v[152:155], v[96:99], a[24:27]
    v_add_u32 v255, s25, v253
    s_and_b32 s71, s49, 7
    v_mfma_f32_16x16x32_bf16 a[28:31], v[156:159], v[96:99], a[28:31]
    ds_read_b128 v[32:35], v254 offset:0
    s_lshr_b32 s72, s49, 3
    v_mfma_f32_16x16x32_bf16 a[60:63], v[156:159], v[100:103], a[60:63]
    buffer_load_dwordx4 v241, s[8:11], s20 offen offset:1024 nt lds
    v_mfma_f32_16x16x32_bf16 a[56:59], v[152:155], v[100:103], a[56:59]
    ds_read_b64_tr_b16 v[68:69], v245 offset:32768
    s_mul_i32 s96, s30, 229376
    v_mfma_f32_16x16x32_bf16 a[52:55], v[148:151], v[100:103], a[52:55]
    s_mul_i32 s73, s71, 28672
    s_add_u32 s93, s96, s73
    v_mfma_f32_16x16x32_bf16 a[48:51], v[144:147], v[100:103], a[48:51]
    ds_read_b64_tr_b16 v[70:71], v245 offset:34816
    s_lshl_b32 s73, s72, 7
    v_mfma_f32_16x16x32_bf16 a[44:47], v[140:143], v[100:103], a[44:47]
    buffer_load_dwordx4 v242, s[8:11], s20 offen offset:2048 nt lds
    v_mfma_f32_16x16x32_bf16 a[40:43], v[136:139], v[100:103], a[40:43]
    ds_read_b128 v[36:39], v254 offset:2048
    s_add_u32 s93, s93, s73
    v_mfma_f32_16x16x32_bf16 a[36:39], v[132:135], v[100:103], a[36:39]
    s_xor_b32 s73, s72, s30
    v_mfma_f32_16x16x32_bf16 a[32:35], v[128:131], v[100:103], a[32:35]
    ds_read_b64_tr_b16 v[72:73], v246 offset:32768
    v_mfma_f32_16x16x32_bf16 a[64:67], v[128:131], v[104:107], a[64:67]
    buffer_load_dwordx4 v243, s[8:11], s20 offen offset:3072 nt lds
    v_mfma_f32_16x16x32_bf16 a[68:71], v[132:135], v[104:107], a[68:71]
    ds_read_b64_tr_b16 v[74:75], v246 offset:34816
    s_add_u32 s20, s20, 262144
    v_mfma_f32_16x16x32_bf16 a[72:75], v[136:139], v[104:107], a[72:75]
    s_bitcmp1_b32 s73, 0
    s_cselect_b32 s73, 0, 4
    v_mfma_f32_16x16x32_bf16 a[76:79], v[140:143], v[104:107], a[76:79]
    ds_read_b128 v[40:43], v254 offset:4096
    v_mfma_f32_16x16x32_bf16 a[80:83], v[144:147], v[104:107], a[80:83]
    s_cmp_eq_u32 s72, 6
    s_cselect_b32 s73, 0, s73
    v_mfma_f32_16x16x32_bf16 a[84:87], v[148:151], v[104:107], a[84:87]
    ds_read_b64_tr_b16 v[76:77], v247 offset:32768
    s_add_u32 m0, s24, 16384
    v_mfma_f32_16x16x32_bf16 a[88:91], v[152:155], v[104:107], a[88:91]
    buffer_load_dwordx4 v240, s[8:11], s20 offen offset:0 nt lds
    v_mfma_f32_16x16x32_bf16 a[92:95], v[156:159], v[104:107], a[92:95]
    ds_read_b64_tr_b16 v[78:79], v247 offset:34816
    s_lshr_b32 s74, s72, 1
    v_mfma_f32_16x16x32_bf16 a[124:127], v[156:159], v[108:111], a[124:127]
    s_add_u32 s73, s73, s74
    s_lshl_b32 s73, s73, 3
    v_mfma_f32_16x16x32_bf16 a[120:123], v[152:155], v[108:111], a[120:123]
    ds_read_b128 v[44:47], v254 offset:6144
    s_add_u32 s73, s73, s71
    v_mfma_f32_16x16x32_bf16 a[116:119], v[148:151], v[108:111], a[116:119]
    buffer_load_dwordx4 v241, s[8:11], s20 offen offset:1024 nt lds
    v_mfma_f32_16x16x32_bf16 a[112:115], v[144:147], v[108:111], a[112:115]
    ds_read_b64_tr_b16 v[80:81], v248 offset:32768
    s_lshl_b32 s73, s73, 12
    v_mfma_f32_16x16x32_bf16 a[108:111], v[140:143], v[108:111], a[108:111]
    s_add_u32 s96, s96, s73
    s_add_u32 s96, s96, 39845888
    v_mfma_f32_16x16x32_bf16 a[104:107], v[136:139], v[108:111], a[104:107]
    ds_read_b64_tr_b16 v[82:83], v248 offset:34816
    s_lshl_b32 s70, s30, 3
    v_mfma_f32_16x16x32_bf16 a[100:103], v[132:135], v[108:111], a[100:103]
    buffer_load_dwordx4 v242, s[8:11], s20 offen offset:2048 nt lds
    v_mfma_f32_16x16x32_bf16 a[96:99], v[128:131], v[108:111], a[96:99]
    ds_read_b128 v[48:51], v254 offset:8192
    s_add_u32 s70, s70, s49
    v_mfma_f32_16x16x32_bf16 a[128:131], v[128:131], v[112:115], a[128:131]
    s_add_u32 s70, s70, 312
    s_mul_i32 s71, s70, 9363
    v_mfma_f32_16x16x32_bf16 a[132:135], v[132:135], v[112:115], a[132:135]
    ds_read_b64_tr_b16 v[84:85], v249 offset:32768
    s_lshr_b32 s71, s71, 16
    v_mfma_f32_16x16x32_bf16 a[136:139], v[136:139], v[112:115], a[136:139]
    buffer_load_dwordx4 v243, s[8:11], s20 offen offset:3072 nt lds
    v_mfma_f32_16x16x32_bf16 a[140:143], v[140:143], v[112:115], a[140:143]
    ds_read_b64_tr_b16 v[86:87], v249 offset:34816
    s_add_u32 s20, s20, 262144
    v_mfma_f32_16x16x32_bf16 a[144:147], v[144:147], v[112:115], a[144:147]
    s_mul_i32 s72, s71, 7
    s_sub_u32 s72, s70, s72
    v_mfma_f32_16x16x32_bf16 a[148:151], v[148:151], v[112:115], a[148:151]
    ds_read_b128 v[52:55], v254 offset:10240
    s_mul_i32 s73, s71, 28672
    v_mfma_f32_16x16x32_bf16 a[152:155], v[152:155], v[112:115], a[152:155]
    s_lshl_b32 s74, s72, 7
    s_add_u32 s73, s73, s74
    v_mfma_f32_16x16x32_bf16 a[156:159], v[156:159], v[112:115], a[156:159]
    ds_read_b64_tr_b16 v[88:89], v250 offset:32768
    s_add_u32 m0, s22, s37
    v_mfma_f32_16x16x32_bf16 a[188:191], v[156:159], v[116:119], a[188:191]
    buffer_load_dwordx4 v232, s[4:7], s21 offen offset:0 lds
    v_mfma_f32_16x16x32_bf16 a[184:187], v[152:155], v[116:119], a[184:187]
    ds_read_b64_tr_b16 v[90:91], v250 offset:34816
    s_mul_i32 s74, s72, 229376
    v_mfma_f32_16x16x32_bf16 a[180:183], v[148:151], v[116:119], a[180:183]
    s_bfe_u32 s72, s71, 0x10001
    s_mul_i32 s72, s72, 114688
    v_mfma_f32_16x16x32_bf16 a[176:179], v[144:147], v[116:119], a[176:179]
    ds_read_b128 v[56:59], v254 offset:12288
    s_add_u32 s74, s74, s72
    v_mfma_f32_16x16x32_bf16 a[172:175], v[140:143], v[116:119], a[172:175]
    buffer_load_dwordx4 v233, s[4:7], s21 offen offset:1024 lds
    v_mfma_f32_16x16x32_bf16 a[168:171], v[136:139], v[116:119], a[168:171]
    ds_read_b64_tr_b16 v[92:93], v251 offset:32768
    s_and_b32 s72, s71, 1
    v_mfma_f32_16x16x32_bf16 a[164:167], v[132:135], v[116:119], a[164:167]
    s_lshr_b32 s71, s71, 2
    s_lshl_b32 s71, s71, 1
    v_mfma_f32_16x16x32_bf16 a[160:163], v[128:131], v[116:119], a[160:163]
    ds_read_b64_tr_b16 v[94:95], v251 offset:34816
    s_add_u32 s71, s71, s72
    v_mfma_f32_16x16x32_bf16 a[192:195], v[128:131], v[120:123], a[192:195]
    buffer_load_dwordx4 v234, s[4:7], s21 offen offset:2048 lds
    v_mfma_f32_16x16x32_bf16 a[196:199], v[132:135], v[120:123], a[196:199]
    ds_read_b128 v[60:63], v254 offset:14336
    s_lshl_b32 s71, s71, 12
    v_mfma_f32_16x16x32_bf16 a[200:203], v[136:139], v[120:123], a[200:203]
    s_add_u32 s74, s74, s71
    s_add_u32 s74, s74, 48234496
    v_mfma_f32_16x16x32_bf16 a[204:207], v[140:143], v[120:123], a[204:207]
    s_cmp_ge_u32 s70, 392
    s_cselect_b32 s73, 0, s73
    s_cselect_b32 s74, 268435456, s74
    v_mfma_f32_16x16x32_bf16 a[208:211], v[144:147], v[120:123], a[208:211]
    buffer_load_dwordx4 v235, s[4:7], s21 offen offset:3072 lds
    v_mfma_f32_16x16x32_bf16 a[212:215], v[148:151], v[120:123], a[212:215]
    s_mov_b32 s86, 3670016
    s_mov_b32 s98, 896
    v_mfma_f32_16x16x32_bf16 a[216:219], v[152:155], v[120:123], a[216:219]
    s_cmp_ge_u32 s49, 56
    s_cselect_b32 s84, s58, s50
    s_cselect_b32 s85, s59, s51
    v_mfma_f32_16x16x32_bf16 a[220:223], v[156:159], v[120:123], a[220:223]
    s_cmp_ge_u32 s49, 56
    s_cselect_b32 s86, 1605632, s86
    s_cselect_b32 s98, 896, s98
    v_mfma_f32_16x16x32_bf16 a[252:255], v[156:159], v[124:127], a[252:255]
    s_cmp_ge_u32 s49, 56
    s_cselect_b32 s93, s73, s93
    s_cselect_b32 s96, s74, s96
    s_cselect_b64 vcc, -1, 0
    v_mfma_f32_16x16x32_bf16 a[248:251], v[152:155], v[124:127], a[248:251]
    s_mov_b32 s87, 0x00020000
    v_mul_lo_u32 v26, v28, s98
    v_mfma_f32_16x16x32_bf16 a[244:247], v[148:151], v[124:127], a[244:247]
    v_cndmask_b32 v24, v30, v29, vcc
    v_add_u32 v26, v26, v24
    v_mfma_f32_16x16x32_bf16 a[240:243], v[144:147], v[124:127], a[240:243]
    v_mov_b32 v12, v14
    v_mov_b32 v13, v15
    v_mfma_f32_16x16x32_bf16 a[236:239], v[140:143], v[124:127], a[236:239]
    s_nop 0
    v_permlane16_swap_b32 v14, v12
    v_mfma_f32_16x16x32_bf16 a[232:235], v[136:139], v[124:127], a[232:235]
    v_permlane16_swap_b32 v15, v13
    s_nop 0
    v_mfma_f32_16x16x32_bf16 a[228:231], v[132:135], v[124:127], a[228:231]
    v_add_f32 v14, v14, v12
    v_add_f32 v15, v15, v13
    v_mfma_f32_16x16x32_bf16 a[224:227], v[128:131], v[124:127], a[224:227]
    s_waitcnt vmcnt(20) lgkmcnt(0)
    s_barrier
    v_mfma_f32_16x16x32_bf16 a[0:3], v[64:67], v[32:35], a[0:3]
    v_mfma_f32_16x16x32_bf16 a[4:7], v[68:71], v[32:35], a[4:7]
    v_mfma_f32_16x16x32_bf16 a[8:11], v[72:75], v[32:35], a[8:11]
    v_mfma_f32_16x16x32_bf16 a[12:15], v[76:79], v[32:35], a[12:15]
    ds_read_b64_tr_b16 v[128:129], v244 offset:49152
    s_add_u32 m0, s24, 32768
    v_mfma_f32_16x16x32_bf16 a[16:19], v[80:83], v[32:35], a[16:19]
    buffer_load_dwordx4 v240, s[8:11], s20 offen offset:0 nt lds
    v_mfma_f32_16x16x32_bf16 a[20:23], v[84:87], v[32:35], a[20:23]
    ds_read_b64_tr_b16 v[130:131], v244 offset:51200
    v_mov_b32 v12, v14
    v_mfma_f32_16x16x32_bf16 a[24:27], v[88:91], v[32:35], a[24:27]
    v_mov_b32 v13, v15
    s_nop 0
    v_mfma_f32_16x16x32_bf16 a[28:31], v[92:95], v[32:35], a[28:31]
    ds_read_b128 v[96:99], v255 offset:0
    v_permlane32_swap_b32 v14, v12
    v_mfma_f32_16x16x32_bf16 a[60:63], v[92:95], v[36:39], a[60:63]
    v_permlane32_swap_b32 v15, v13
    s_nop 0
    v_mfma_f32_16x16x32_bf16 a[56:59], v[88:91], v[36:39], a[56:59]
    ds_read_b64_tr_b16 v[132:133], v245 offset:49152
    v_add_f32 v14, v14, v12
    v_mfma_f32_16x16x32_bf16 a[52:55], v[84:87], v[36:39], a[52:55]
    buffer_load_dwordx4 v241, s[8:11], s20 offen offset:1024 nt lds
    v_mfma_f32_16x16x32_bf16 a[48:51], v[80:83], v[36:39], a[48:51]
    ds_read_b64_tr_b16 v[134:135], v245 offset:51200
    v_add_f32 v15, v15, v13
    v_mfma_f32_16x16x32_bf16 a[44:47], v[76:79], v[36:39], a[44:47]
    v_mov_b32 v12, v16
    v_mov_b32 v13, v17
    v_mfma_f32_16x16x32_bf16 a[40:43], v[72:75], v[36:39], a[40:43]
    ds_read_b128 v[100:103], v255 offset:2048
    s_nop 0
    v_mfma_f32_16x16x32_bf16 a[36:39], v[68:71], v[36:39], a[36:39]
    v_permlane16_swap_b32 v16, v12
    v_permlane16_swap_b32 v17, v13
    v_mfma_f32_16x16x32_bf16 a[32:35], v[64:67], v[36:39], a[32:35]
    ds_read_b64_tr_b16 v[136:137], v246 offset:49152
    s_nop 0
    v_mfma_f32_16x16x32_bf16 a[64:67], v[64:67], v[40:43], a[64:67]
    buffer_load_dwordx4 v242, s[8:11], s20 offen offset:2048 nt lds
    v_mfma_f32_16x16x32_bf16 a[68:71], v[68:71], v[40:43], a[68:71]
    ds_read_b64_tr_b16 v[138:139], v246 offset:51200
    v_add_f32 v16, v16, v12
    v_mfma_f32_16x16x32_bf16 a[72:75], v[72:75], v[40:43], a[72:75]
    v_add_f32 v17, v17, v13
    v_mov_b32 v12, v16
    v_mfma_f32_16x16x32_bf16 a[76:79], v[76:79], v[40:43], a[76:79]
    ds_read_b128 v[104:107], v255 offset:4096
    v_mov_b32 v13, v17
    v_mfma_f32_16x16x32_bf16 a[80:83], v[80:83], v[40:43], a[80:83]
    s_nop 0
    v_permlane32_swap_b32 v16, v12
    v_mfma_f32_16x16x32_bf16 a[84:87], v[84:87], v[40:43], a[84:87]
    ds_read_b64_tr_b16 v[140:141], v247 offset:49152
    v_permlane32_swap_b32 v17, v13
    v_mfma_f32_16x16x32_bf16 a[88:91], v[88:91], v[40:43], a[88:91]
    buffer_load_dwordx4 v243, s[8:11], s20 offen offset:3072 nt lds
    v_mfma_f32_16x16x32_bf16 a[92:95], v[92:95], v[40:43], a[92:95]
    ds_read_b64_tr_b16 v[142:143], v247 offset:51200
    s_add_u32 s20, s20, 262144
    v_mfma_f32_16x16x32_bf16 a[124:127], v[92:95], v[44:47], a[124:127]
    s_nop 0
    v_add_f32 v16, v16, v12
    v_mfma_f32_16x16x32_bf16 a[120:123], v[88:91], v[44:47], a[120:123]
    ds_read_b128 v[108:111], v255 offset:6144
    v_add_f32 v17, v17, v13
    v_mfma_f32_16x16x32_bf16 a[116:119], v[84:87], v[44:47], a[116:119]
    v_mul_f32 v14, 0x3b124925, v14
    v_mul_f32 v16, 0x3b124925, v16
    v_mfma_f32_16x16x32_bf16 a[112:115], v[80:83], v[44:47], a[112:115]
    ds_read_b64_tr_b16 v[144:145], v248 offset:49152
    v_fma_f32 v16, -v14, v14, v16
    v_mfma_f32_16x16x32_bf16 a[108:111], v[76:79], v[44:47], a[108:111]
    v_max_f32 v16, 0, v16
    v_add_f32 v16, 0x3727c5ac, v16
    v_mfma_f32_16x16x32_bf16 a[104:107], v[72:75], v[44:47], a[104:107]
    ds_read_b64_tr_b16 v[146:147], v248 offset:51200
    v_rsq_f32 v16, v16
    v_mfma_f32_16x16x32_bf16 a[100:103], v[68:71], v[44:47], a[100:103]
    v_mul_f32 v15, 0x3b124925, v15
    v_mul_f32 v17, 0x3b124925, v17
    v_mfma_f32_16x16x32_bf16 a[96:99], v[64:67], v[44:47], a[96:99]
    ds_read_b128 v[112:115], v255 offset:8192
    s_add_u32 m0, s22, s29
    v_mfma_f32_16x16x32_bf16 a[128:131], v[64:67], v[48:51], a[128:131]
    buffer_load_dwordx4 v236, s[4:7], s21 offen offset:0 lds
    v_mfma_f32_16x16x32_bf16 a[132:135], v[68:71], v[48:51], a[132:135]
    ds_read_b64_tr_b16 v[148:149], v249 offset:49152
    v_fma_f32 v17, -v15, v15, v17
    v_mfma_f32_16x16x32_bf16 a[136:139], v[72:75], v[48:51], a[136:139]
    v_max_f32 v17, 0, v17
    v_add_f32 v17, 0x3727c5ac, v17
    v_mfma_f32_16x16x32_bf16 a[140:143], v[76:79], v[48:51], a[140:143]
    ds_read_b64_tr_b16 v[150:151], v249 offset:51200
    v_rsq_f32 v17, v17
    v_mfma_f32_16x16x32_bf16 a[144:147], v[80:83], v[48:51], a[144:147]
    v_lshl_add_u32 v10, v11, 1, v10
    v_mul_f32 v16, 0x3db8aa3b, v16
    v_mfma_f32_16x16x32_bf16 a[148:151], v[84:87], v[48:51], a[148:151]
    ds_read_b128 v[116:119], v255 offset:10240
    v_mul_f32 v14, v14, v16
    v_mfma_f32_16x16x32_bf16 a[152:155], v[88:91], v[48:51], a[152:155]
    buffer_load_dwordx4 v237, s[4:7], s21 offen offset:1024 lds
    v_mfma_f32_16x16x32_bf16 a[156:159], v[92:95], v[48:51], a[156:159]
    ds_read_b64_tr_b16 v[152:153], v250 offset:49152
    v_mul_f32 v17, 0x3db8aa3b, v17
    v_mfma_f32_16x16x32_bf16 a[188:191], v[92:95], v[52:55], a[188:191]
    v_mul_f32 v15, v15, v17
    s_lshl_b32 s75, s30, 6
    v_mfma_f32_16x16x32_bf16 a[184:187], v[88:91], v[52:55], a[184:187]
    ds_read_b64_tr_b16 v[154:155], v250 offset:51200
    s_add_u32 s75, s75, s49
    v_mfma_f32_16x16x32_bf16 a[180:183], v[84:87], v[52:55], a[180:183]
    s_cmp_ge_u32 s75, 392
    s_cselect_b32 s54, s56, s54
    s_cselect_b32 s55, s57, s55
    s_cselect_b32 s73, 392, 0
    s_cselect_b32 s97, 4096, 0
    v_mfma_f32_16x16x32_bf16 a[176:179], v[80:83], v[52:55], a[176:179]
    ds_read_b128 v[120:123], v255 offset:12288
    s_sub_u32 s70, s75, s73
    v_mfma_f32_16x16x32_bf16 a[172:175], v[76:79], v[52:55], a[172:175]
    buffer_load_dwordx4 v238, s[4:7], s21 offen offset:2048 lds
    v_mfma_f32_16x16x32_bf16 a[168:171], v[72:75], v[52:55], a[168:171]
    ds_read_b64_tr_b16 v[156:157], v251 offset:49152
    s_lshr_b32 s71, s70, 2
    v_mfma_f32_16x16x32_bf16 a[164:167], v[68:71], v[52:55], a[164:167]
    s_mul_i32 s71, s71, 9363
    s_lshr_b32 s71, s71, 16
    v_mfma_f32_16x16x32_bf16 a[160:163], v[64:67], v[52:55], a[160:163]
    ds_read_b64_tr_b16 v[158:159], v251 offset:51200
    s_mul_i32 s72, s71, 28
    v_mfma_f32_16x16x32_bf16 a[192:195], v[64:67], v[56:59], a[192:195]
    s_sub_u32 s72, s70, s72
    s_mul_i32 s94, s71, 114688
    v_mfma_f32_16x16x32_bf16 a[196:199], v[68:71], v[56:59], a[196:199]
    ds_read_b128 v[124:127], v255 offset:14336
    s_lshl_b32 s73, s72, 7
    v_mfma_f32_16x16x32_bf16 a[200:203], v[72:75], v[56:59], a[200:203]
    buffer_load_dwordx4 v239, s[4:7], s21 offen offset:3072 lds
    v_mfma_f32_16x16x32_bf16 a[204:207], v[76:79], v[56:59], a[204:207]
    s_add_u32 s21, s21, 128
    s_add_u32 s22, s22, 32768
    v_mfma_f32_16x16x32_bf16 a[208:211], v[80:83], v[56:59], a[208:211]
    s_cmp_eq_u32 s22, 163840
    s_cselect_b32 s22, 65536, s22
    v_mfma_f32_16x16x32_bf16 a[212:215], v[84:87], v[56:59], a[212:215]
    s_add_u32 s94, s94, s73
    s_mul_i32 s73, s72, 114688
    v_mfma_f32_16x16x32_bf16 a[216:219], v[88:91], v[56:59], a[216:219]
    s_add_u32 s97, s97, s73
    s_lshl_b32 s73, s71, 13
    v_mfma_f32_16x16x32_bf16 a[220:223], v[92:95], v[56:59], a[220:223]
    s_add_u32 s97, s97, s73
    s_add_u32 s97, s97, 44040192
    v_mfma_f32_16x16x32_bf16 a[252:255], v[92:95], v[60:63], a[252:255]
    s_sub_u32 s70, s75, 784
    s_max_i32 s70, s70, 0
    v_mfma_f32_16x16x32_bf16 a[248:251], v[88:91], v[60:63], a[248:251]
    s_mul_i32 s71, s70, 9363
    s_lshr_b32 s71, s71, 16
    v_mfma_f32_16x16x32_bf16 a[244:247], v[84:87], v[60:63], a[244:247]
    s_mul_i32 s72, s71, 7
    s_sub_u32 s72, s70, s72
    v_mfma_f32_16x16x32_bf16 a[240:243], v[80:83], v[60:63], a[240:243]
    s_mul_i32 s73, s71, 28672
    s_lshl_b32 s74, s72, 7
    v_mfma_f32_16x16x32_bf16 a[236:239], v[76:79], v[60:63], a[236:239]
    s_add_u32 s73, s73, s74
    s_mul_i32 s74, s72, 229376
    v_mfma_f32_16x16x32_bf16 a[232:235], v[72:75], v[60:63], a[232:235]
    s_bfe_u32 s72, s71, 0x10001
    v_mfma_f32_16x16x32_bf16 a[228:231], v[68:71], v[60:63], a[228:231]
    v_mfma_f32_16x16x32_bf16 a[224:227], v[64:67], v[60:63], a[224:227]
    s_waitcnt vmcnt(16) lgkmcnt(0)
    s_barrier
    v_mfma_f32_16x16x32_bf16 a[0:3], v[128:131], v[96:99], a[0:3]
    s_add_u32 s25, s25, 32768
    v_mfma_f32_16x16x32_bf16 a[4:7], v[132:135], v[96:99], a[4:7]
    s_cmp_eq_u32 s25, 163840
    s_cselect_b32 s25, 65536, s25
    v_mfma_f32_16x16x32_bf16 a[8:11], v[136:139], v[96:99], a[8:11]
    v_mfma_f32_16x16x32_bf16 a[12:15], v[140:143], v[96:99], a[12:15]
    ds_read_b64_tr_b16 v[64:65], v244 offset:0
    s_add_u32 m0, s24, 49152
    v_mfma_f32_16x16x32_bf16 a[16:19], v[144:147], v[96:99], a[16:19]
    buffer_load_dwordx4 v240, s[8:11], s20 offen offset:0 nt lds
    v_mfma_f32_16x16x32_bf16 a[20:23], v[148:151], v[96:99], a[20:23]
    v_add_u32 v254, s25, v252
    ds_read_b64_tr_b16 v[66:67], v244 offset:2048
    v_mfma_f32_16x16x32_bf16 a[24:27], v[152:155], v[96:99], a[24:27]
    v_add_u32 v255, s25, v253
    v_lshrrev_b32 v9, 1, v9
    v_mfma_f32_16x16x32_bf16 a[28:31], v[156:159], v[96:99], a[28:31]
    ds_read_b128 v[32:35], v254 offset:0
    v_mul_u32_u24 v11, 4682, v10
    v_mfma_f32_16x16x32_bf16 a[60:63], v[156:159], v[100:103], a[60:63]
    v_lshrrev_b32 v11, 16, v11
    v_min_u32 v11, 3, v11
    v_mfma_f32_16x16x32_bf16 a[56:59], v[152:155], v[100:103], a[56:59]
    ds_read_b64_tr_b16 v[68:69], v245 offset:0
    v_mul_u32_u24 v11, 6176, v11
    v_mfma_f32_16x16x32_bf16 a[52:55], v[148:151], v[100:103], a[52:55]
    buffer_load_dwordx4 v241, s[8:11], s20 offen offset:1024 nt lds
    v_mfma_f32_16x16x32_bf16 a[48:51], v[144:147], v[100:103], a[48:51]
    ds_read_b64_tr_b16 v[70:71], v245 offset:2048
    v_mul_u32_u24 v10, 144, v10
    v_mfma_f32_16x16x32_bf16 a[44:47], v[140:143], v[100:103], a[44:47]
    v_add_u32 v18, v10, v11
    v_lshl_add_u32 v18, v9, 3, v18
    v_mfma_f32_16x16x32_bf16 a[40:43], v[136:139], v[100:103], a[40:43]
    ds_read_b128 v[36:39], v254 offset:2048
    s_lshl_b32 s3, s66, 5
    v_mfma_f32_16x16x32_bf16 a[36:39], v[132:135], v[100:103], a[36:39]
    s_add_u32 s3, s3, 102400
    v_add_u32 v18, s3, v18
    v_mfma_f32_16x16x32_bf16 a[32:35], v[128:131], v[100:103], a[32:35]
    ds_read_b64_tr_b16 v[72:73], v246 offset:0
    v_lshlrev_b32 v12, 16, v160
    v_mfma_f32_16x16x32_bf16 a[64:67], v[128:131], v[104:107], a[64:67]
    buffer_load_dwordx4 v242, s[8:11], s20 offen offset:2048 nt lds
    v_mfma_f32_16x16x32_bf16 a[68:71], v[132:135], v[104:107], a[68:71]
    ds_read_b64_tr_b16 v[74:75], v246 offset:2048
    v_and_b32 v13, 0xffff0000, v160
    v_mfma_f32_16x16x32_bf16 a[72:75], v[136:139], v[104:107], a[72:75]
    v_fma_f32 v12, v12, v16, -v14
    v_fma_f32 v13, v13, v16, -v14
    v_mfma_f32_16x16x32_bf16 a[76:79], v[140:143], v[104:107], a[76:79]
    ds_read_b128 v[40:43], v254 offset:4096
    v_cvt_pk_bf16_f32 v160, v12, v13
    v_mfma_f32_16x16x32_bf16 a[80:83], v[144:147], v[104:107], a[80:83]
    v_lshlrev_b32 v12, 16, v161
    v_and_b32 v13, 0xffff0000, v161
    v_mfma_f32_16x16x32_bf16 a[84:87], v[148:151], v[104:107], a[84:87]
    ds_read_b64_tr_b16 v[76:77], v247 offset:0
    v_fma_f32 v12, v12, v16, -v14
    v_mfma_f32_16x16x32_bf16 a[88:91], v[152:155], v[104:107], a[88:91]
    buffer_load_dwordx4 v243, s[8:11], s20 offen offset:3072 nt lds
    v_mfma_f32_16x16x32_bf16 a[92:95], v[156:159], v[104:107], a[92:95]
    ds_read_b64_tr_b16 v[78:79], v247 offset:2048
    s_add_u32 s20, s20, 262144
    v_mfma_f32_16x16x32_bf16 a[124:127], v[156:159], v[108:111], a[124:127]
    v_fma_f32 v13, v13, v16, -v14
    v_cvt_pk_bf16_f32 v161, v12, v13
    v_mfma_f32_16x16x32_bf16 a[120:123], v[152:155], v[108:111], a[120:123]
    ds_read_b128 v[44:47], v254 offset:6144
    v_lshlrev_b32 v12, 16, v162
    v_mfma_f32_16x16x32_bf16 a[116:119], v[148:151], v[108:111], a[116:119]
    v_and_b32 v13, 0xffff0000, v162
    v_fma_f32 v12, v12, v16, -v14
    v_mfma_f32_16x16x32_bf16 a[112:115], v[144:147], v[108:111], a[112:115]
    ds_read_b64_tr_b16 v[80:81], v248 offset:0
    v_fma_f32 v13, v13, v16, -v14
    v_mfma_f32_16x16x32_bf16 a[108:111], v[140:143], v[108:111], a[108:111]
    v_cvt_pk_bf16_f32 v162, v12, v13
    v_lshlrev_b32 v12, 16, v163
    v_mfma_f32_16x16x32_bf16 a[104:107], v[136:139], v[108:111], a[104:107]
    ds_read_b64_tr_b16 v[82:83], v248 offset:2048
    v_and_b32 v13, 0xffff0000, v163
    v_mfma_f32_16x16x32_bf16 a[100:103], v[132:135], v[108:111], a[100:103]
    v_fma_f32 v12, v12, v16, -v14
    v_fma_f32 v13, v13, v16, -v14
    v_mfma_f32_16x16x32_bf16 a[96:99], v[128:131], v[108:111], a[96:99]
    ds_read_b128 v[48:51], v254 offset:8192
    s_add_u32 m0, s22, s37
    v_mfma_f32_16x16x32_bf16 a[128:131], v[128:131], v[112:115], a[128:131]
    buffer_load_dwordx4 v232, s[4:7], s21 offen offset:0 lds
    v_mfma_f32_16x16x32_bf16 a[132:135], v[132:135], v[112:115], a[132:135]
    ds_read_b64_tr_b16 v[84:85], v249 offset:0
    v_cvt_pk_bf16_f32 v163, v12, v13
    v_mfma_f32_16x16x32_bf16 a[136:139], v[136:139], v[112:115], a[136:139]
    ds_write_b64 v18, v[160:161] offset:0
    ds_write_b64 v18, v[162:163] offset:144
    v_mfma_f32_16x16x32_bf16 a[140:143], v[140:143], v[112:115], a[140:143]
    ds_read_b64_tr_b16 v[86:87], v249 offset:2048
    v_lshlrev_b32 v12, 16, v164
    v_mfma_f32_16x16x32_bf16 a[144:147], v[144:147], v[112:115], a[144:147]
    v_and_b32 v13, 0xffff0000, v164
    v_fma_f32 v12, v12, v17, -v15
    v_mfma_f32_16x16x32_bf16 a[148:151], v[148:151], v[112:115], a[148:151]
    ds_read_b128 v[52:55], v254 offset:10240
    v_fma_f32 v13, v13, v17, -v15
    v_mfma_f32_16x16x32_bf16 a[152:155], v[152:155], v[112:115], a[152:155]
    buffer_load_dwordx4 v233, s[4:7], s21 offen offset:1024 lds
    v_mfma_f32_16x16x32_bf16 a[156:159], v[156:159], v[112:115], a[156:159]
    ds_read_b64_tr_b16 v[88:89], v250 offset:0
    v_cvt_pk_bf16_f32 v164, v12, v13
    v_mfma_f32_16x16x32_bf16 a[188:191], v[156:159], v[116:119], a[188:191]
    v_lshlrev_b32 v12, 16, v165
    v_and_b32 v13, 0xffff0000, v165
    v_mfma_f32_16x16x32_bf16 a[184:187], v[152:155], v[116:119], a[184:187]
    ds_read_b64_tr_b16 v[90:91], v250 offset:2048
    v_fma_f32 v12, v12, v17, -v15
    v_mfma_f32_16x16x32_bf16 a[180:183], v[148:151], v[116:119], a[180:183]
    v_fma_f32 v13, v13, v17, -v15
    v_mfma_f32_16x16x32_bf16 a[176:179], v[144:147], v[116:119], a[176:179]
    ds_read_b128 v[56:59], v254 offset:12288
    v_cvt_pk_bf16_f32 v165, v12, v13
    v_mfma_f32_16x16x32_bf16 a[172:175], v[140:143], v[116:119], a[172:175]
    buffer_load_dwordx4 v234, s[4:7], s21 offen offset:2048 lds
    v_mfma_f32_16x16x32_bf16 a[168:171], v[136:139], v[116:119], a[168:171]
    ds_read_b64_tr_b16 v[92:93], v251 offset:0
    v_lshlrev_b32 v12, 16, v166
    v_mfma_f32_16x16x32_bf16 a[164:167], v[132:135], v[116:119], a[164:167]
    v_and_b32 v13, 0xffff0000, v166
    v_fma_f32 v12, v12, v17, -v15
    v_mfma_f32_16x16x32_bf16 a[160:163], v[128:131], v[116:119], a[160:163]
    ds_read_b64_tr_b16 v[94:95], v251 offset:2048
    v_fma_f32 v13, v13, v17, -v15
    v_mfma_f32_16x16x32_bf16 a[192:195], v[128:131], v[120:123], a[192:195]
    v_cvt_pk_bf16_f32 v166, v12, v13
    v_mfma_f32_16x16x32_bf16 a[196:199], v[132:135], v[120:123], a[196:199]
    ds_read_b128 v[60:63], v254 offset:14336
    v_lshlrev_b32 v12, 16, v167
    v_mfma_f32_16x16x32_bf16 a[200:203], v[136:139], v[120:123], a[200:203]
    buffer_load_dwordx4 v235, s[4:7], s21 offen offset:3072 lds
    v_mfma_f32_16x16x32_bf16 a[204:207], v[140:143], v[120:123], a[204:207]
    v_and_b32 v13, 0xffff0000, v167
    v_fma_f32 v12, v12, v17, -v15
    v_mfma_f32_16x16x32_bf16 a[208:211], v[144:147], v[120:123], a[208:211]
    v_fma_f32 v13, v13, v17, -v15
    v_mfma_f32_16x16x32_bf16 a[212:215], v[148:151], v[120:123], a[212:215]
    v_cvt_pk_bf16_f32 v167, v12, v13
    v_mfma_f32_16x16x32_bf16 a[216:219], v[152:155], v[120:123], a[216:219]
    ds_write_b64 v18, v[164:165] offset:16
    v_mfma_f32_16x16x32_bf16 a[220:223], v[156:159], v[120:123], a[220:223]
    ds_write_b64 v18, v[166:167] offset:160
    v_mfma_f32_16x16x32_bf16 a[252:255], v[156:159], v[124:127], a[252:255]
    v_lshrrev_b32 v11, 3, v2
    v_mfma_f32_16x16x32_bf16 a[248:251], v[152:155], v[124:127], a[248:251]
    v_add_lshl_u32 v11, v11, v2, 4
    v_mfma_f32_16x16x32_bf16 a[244:247], v[148:151], v[124:127], a[244:247]
    v_add_u32 v11, s29, v11
    v_mfma_f32_16x16x32_bf16 a[240:243], v[144:147], v[124:127], a[240:243]
    v_add_u32 v11, 98304, v11
    v_mfma_f32_16x16x32_bf16 a[236:239], v[140:143], v[124:127], a[236:239]
    v_mfma_f32_16x16x32_bf16 a[232:235], v[136:139], v[124:127], a[232:235]
    v_mfma_f32_16x16x32_bf16 a[228:231], v[132:135], v[124:127], a[228:231]
    v_mfma_f32_16x16x32_bf16 a[224:227], v[128:131], v[124:127], a[224:227]
    s_waitcnt vmcnt(20) lgkmcnt(0)
    s_barrier
    v_mfma_f32_16x16x32_bf16 a[0:3], v[64:67], v[32:35], a[0:3]
    ds_read_b128 v[160:163], v11
    ds_read_b128 v[164:167], v11 offset:1152
    v_mfma_f32_16x16x32_bf16 a[4:7], v[68:71], v[32:35], a[4:7]
    v_mfma_f32_16x16x32_bf16 a[8:11], v[72:75], v[32:35], a[8:11]
    v_mfma_f32_16x16x32_bf16 a[12:15], v[76:79], v[32:35], a[12:15]
    ds_read_b64_tr_b16 v[128:129], v244 offset:16384
    s_add_u32 m0, s24, 0
    v_mfma_f32_16x16x32_bf16 a[16:19], v[80:83], v[32:35], a[16:19]
    buffer_load_dwordx4 v240, s[8:11], s20 offen offset:0 nt lds
    v_mfma_f32_16x16x32_bf16 a[20:23], v[84:87], v[32:35], a[20:23]
    ds_read_b64_tr_b16 v[130:131], v244 offset:18432
    v_mfma_f32_16x16x32_bf16 a[24:27], v[88:91], v[32:35], a[24:27]
    v_mfma_f32_16x16x32_bf16 a[28:31], v[92:95], v[32:35], a[28:31]
    ds_read_b128 v[96:99], v255 offset:0
    v_mfma_f32_16x16x32_bf16 a[60:63], v[92:95], v[36:39], a[60:63]
    v_mfma_f32_16x16x32_bf16 a[56:59], v[88:91], v[36:39], a[56:59]
    ds_read_b64_tr_b16 v[132:133], v245 offset:16384
    v_mfma_f32_16x16x32_bf16 a[52:55], v[84:87], v[36:39], a[52:55]
    buffer_load_dwordx4 v241, s[8:11], s20 offen offset:1024 nt lds
    v_mfma_f32_16x16x32_bf16 a[48:51], v[80:83], v[36:39], a[48:51]
    ds_read_b64_tr_b16 v[134:135], v245 offset:18432
    v_mfma_f32_16x16x32_bf16 a[44:47], v[76:79], v[36:39], a[44:47]
    s_waitcnt lgkmcnt(5)
    v_mfma_f32_16x16x32_bf16 a[40:43], v[72:75], v[36:39], a[40:43]
    ds_read_b128 v[100:103], v255 offset:2048
    v_lshrrev_b32 v9, 3, v2
    v_mfma_f32_16x16x32_bf16 a[36:39], v[68:71], v[36:39], a[36:39]
    v_lshlrev_b32 v9, 8, v9
    v_and_b32 v10, 7, v2
    v_mfma_f32_16x16x32_bf16 a[32:35], v[64:67], v[36:39], a[32:35]
    ds_read_b64_tr_b16 v[136:137], v246 offset:16384
    v_lshl_add_u32 v9, v10, 4, v9
    v_mfma_f32_16x16x32_bf16 a[64:67], v[64:67], v[40:43], a[64:67]
    buffer_load_dwordx4 v242, s[8:11], s20 offen offset:2048 nt lds
    v_mfma_f32_16x16x32_bf16 a[68:71], v[68:71], v[40:43], a[68:71]
    ds_read_b64_tr_b16 v[138:139], v246 offset:18432
    v_cmp_gt_u32 vcc, 48, v2
    v_mfma_f32_16x16x32_bf16 a[72:75], v[72:75], v[40:43], a[72:75]
    v_mov_b32 v10, 268435456
    s_lshr_b32 s36, s2, 1
    v_mfma_f32_16x16x32_bf16 a[76:79], v[76:79], v[40:43], a[76:79]
    ds_read_b128 v[104:107], v255 offset:4096
    s_mul_i32 s36, s36, 14336
    v_mfma_f32_16x16x32_bf16 a[80:83], v[80:83], v[40:43], a[80:83]
    v_cndmask_b32 v10, v10, v9, vcc
    s_and_b32 s3, s2, 1
    v_mfma_f32_16x16x32_bf16 a[84:87], v[84:87], v[40:43], a[84:87]
    ds_read_b64_tr_b16 v[140:141], v247 offset:16384
    s_lshl_b32 s3, s3, 7
    v_mfma_f32_16x16x32_bf16 a[88:91], v[88:91], v[40:43], a[88:91]
    buffer_load_dwordx4 v243, s[8:11], s20 offen offset:3072 nt lds
    v_mfma_f32_16x16x32_bf16 a[92:95], v[92:95], v[40:43], a[92:95]
    ds_read_b64_tr_b16 v[142:143], v247 offset:18432
    s_add_u32 s20, s20, 262144
    v_mfma_f32_16x16x32_bf16 a[124:127], v[92:95], v[44:47], a[124:127]
    s_add_u32 s36, s36, s3
    s_mul_i32 s3, s66, 3584
    v_mfma_f32_16x16x32_bf16 a[120:123], v[88:91], v[44:47], a[120:123]
    ds_read_b128 v[108:111], v255 offset:6144
    s_add_u32 s36, s36, s3
    v_mfma_f32_16x16x32_bf16 a[116:119], v[84:87], v[44:47], a[116:119]
    s_add_u32 s36, s36, 33554432
    v_mfma_f32_16x16x32_bf16 a[112:115], v[80:83], v[44:47], a[112:115]
    ds_read_b64_tr_b16 v[144:145], v248 offset:16384
    buffer_store_dwordx4 v[160:163], v9, s[12:15], s36 offen sc1
    v_mfma_f32_16x16x32_bf16 a[108:111], v[76:79], v[44:47], a[108:111]
    v_mfma_f32_16x16x32_bf16 a[104:107], v[72:75], v[44:47], a[104:107]
    ds_read_b64_tr_b16 v[146:147], v248 offset:18432
    buffer_store_dwordx4 v[164:167], v10, s[12:15], s36 offen offset:2048 sc1
    v_mfma_f32_16x16x32_bf16 a[100:103], v[68:71], v[44:47], a[100:103]
    s_getreg_b32 s39, hwreg(HW_REG_XCC_ID, 0, 4)
    s_mul_i32 s3, s2, 384
    v_mfma_f32_16x16x32_bf16 a[96:99], v[64:67], v[44:47], a[96:99]
    ds_read_b128 v[112:115], v255 offset:8192
    s_add_u32 m0, s22, s29
    v_mfma_f32_16x16x32_bf16 a[128:131], v[64:67], v[48:51], a[128:131]
    buffer_load_dwordx4 v236, s[4:7], s21 offen offset:0 lds
    v_mfma_f32_16x16x32_bf16 a[132:135], v[68:71], v[48:51], a[132:135]
    ds_read_b64_tr_b16 v[148:149], v249 offset:16384
    s_add_u32 s39, s39, 1
    v_mfma_f32_16x16x32_bf16 a[136:139], v[72:75], v[48:51], a[136:139]
    s_add_u32 s3, s3, 111149056
    v_cmp_gt_u32 vcc, 16, v0
    v_mfma_f32_16x16x32_bf16 a[140:143], v[76:79], v[48:51], a[140:143]
    ds_read_b64_tr_b16 v[150:151], v249 offset:18432
    v_mov_b32 v9, 268435456
    v_mfma_f32_16x16x32_bf16 a[144:147], v[80:83], v[48:51], a[144:147]
    v_mov_b32 v12, 0
    v_mfma_f32_16x16x32_bf16 a[148:151], v[84:87], v[48:51], a[148:151]
    ds_read_b128 v[116:119], v255 offset:10240
    v_cndmask_b32 v9, v9, v1, vcc
    v_mfma_f32_16x16x32_bf16 a[152:155], v[88:91], v[48:51], a[152:155]
    buffer_load_dwordx4 v237, s[4:7], s21 offen offset:1024 lds
    v_mfma_f32_16x16x32_bf16 a[156:159], v[92:95], v[48:51], a[156:159]
    ds_read_b64_tr_b16 v[152:153], v250 offset:16384
    v_mov_b32 v13, 0
    v_mfma_f32_16x16x32_bf16 a[188:191], v[92:95], v[52:55], a[188:191]
    v_mov_b32 v14, 0
    v_mov_b32 v15, 0
    v_mfma_f32_16x16x32_bf16 a[184:187], v[88:91], v[52:55], a[184:187]
    ds_read_b64_tr_b16 v[154:155], v250 offset:18432
    v_writelane_b32 v12, s39, 0
    v_mfma_f32_16x16x32_bf16 a[180:183], v[84:87], v[52:55], a[180:183]
    buffer_store_dwordx4 v[12:15], v9, s[12:15], s3 offen sc1
    v_mfma_f32_16x16x32_bf16 a[176:179], v[80:83], v[52:55], a[176:179]
    ds_read_b128 v[120:123], v255 offset:12288
    s_lshl_b32 s3, s2, 2
    v_mfma_f32_16x16x32_bf16 a[172:175], v[76:79], v[52:55], a[172:175]
    buffer_load_dwordx4 v238, s[4:7], s21 offen offset:2048 lds
    v_mfma_f32_16x16x32_bf16 a[168:171], v[72:75], v[52:55], a[168:171]
    ds_read_b64_tr_b16 v[156:157], v251 offset:16384
    s_add_u32 s3, s3, 111280128
    v_mfma_f32_16x16x32_bf16 a[164:167], v[68:71], v[52:55], a[164:167]
    buffer_store_dword v13, v31, s[12:15], s3 offen sc1
    s_mul_i32 s72, s72, 114688
    v_mfma_f32_16x16x32_bf16 a[160:163], v[64:67], v[52:55], a[160:163]
    ds_read_b64_tr_b16 v[158:159], v251 offset:18432
    s_add_u32 s74, s74, s72
    v_mfma_f32_16x16x32_bf16 a[192:195], v[64:67], v[56:59], a[192:195]
    v_mfma_f32_16x16x32_bf16 a[196:199], v[68:71], v[56:59], a[196:199]
    ds_read_b128 v[124:127], v255 offset:14336
    s_and_b32 s72, s71, 1
    v_mfma_f32_16x16x32_bf16 a[200:203], v[72:75], v[56:59], a[200:203]
    buffer_load_dwordx4 v239, s[4:7], s21 offen offset:3072 lds
    v_mfma_f32_16x16x32_bf16 a[204:207], v[76:79], v[56:59], a[204:207]
    s_add_u32 s21, s21, 128
    s_add_u32 s22, s22, 32768
    v_mfma_f32_16x16x32_bf16 a[208:211], v[80:83], v[56:59], a[208:211]
    s_cmp_eq_u32 s22, 163840
    s_cselect_b32 s22, 65536, s22
    v_mfma_f32_16x16x32_bf16 a[212:215], v[84:87], v[56:59], a[212:215]
    s_lshr_b32 s71, s71, 2
    s_lshl_b32 s71, s71, 1
    v_mfma_f32_16x16x32_bf16 a[216:219], v[88:91], v[56:59], a[216:219]
    s_add_u32 s71, s71, s72
    s_lshl_b32 s71, s71, 12
    v_mfma_f32_16x16x32_bf16 a[220:223], v[92:95], v[56:59], a[220:223]
    s_add_u32 s74, s74, s71
    s_add_u32 s74, s74, 48234496
    v_mfma_f32_16x16x32_bf16 a[252:255], v[92:95], v[60:63], a[252:255]
    s_mov_b32 s90, 1605632
    v_mfma_f32_16x16x32_bf16 a[248:251], v[88:91], v[60:63], a[248:251]
    s_mov_b32 s99, 3584
    v_mfma_f32_16x16x32_bf16 a[244:247], v[84:87], v[60:63], a[244:247]
    s_cmp_ge_u32 s75, 784
    s_cselect_b32 s88, s58, s54
    s_cselect_b32 s89, s59, s55
    v_mfma_f32_16x16x32_bf16 a[240:243], v[80:83], v[60:63], a[240:243]
    v_mfma_f32_16x16x32_bf16 a[236:239], v[76:79], v[60:63], a[236:239]
    v_mfma_f32_16x16x32_bf16 a[232:235], v[72:75], v[60:63], a[232:235]
    v_mfma_f32_16x16x32_bf16 a[228:231], v[68:71], v[60:63], a[228:231]
    v_mfma_f32_16x16x32_bf16 a[224:227], v[64:67], v[60:63], a[224:227]
    s_waitcnt vmcnt(20) lgkmcnt(0)
    s_barrier
    v_mfma_f32_16x16x32_bf16 a[0:3], v[128:131], v[96:99], a[0:3]
    s_add_u32 s25, s25, 32768
    v_mfma_f32_16x16x32_bf16 a[4:7], v[132:135], v[96:99], a[4:7]
    s_cmp_eq_u32 s25, 163840
    s_cselect_b32 s25, 65536, s25
    v_mfma_f32_16x16x32_bf16 a[8:11], v[136:139], v[96:99], a[8:11]
    v_mfma_f32_16x16x32_bf16 a[12:15], v[140:143], v[96:99], a[12:15]
    ds_read_b64_tr_b16 v[64:65], v244 offset:32768
    s_add_u32 m0, s24, 16384
    v_mfma_f32_16x16x32_bf16 a[16:19], v[144:147], v[96:99], a[16:19]
    buffer_load_dwordx4 v240, s[8:11], s20 offen offset:0 nt lds
    v_mfma_f32_16x16x32_bf16 a[20:23], v[148:151], v[96:99], a[20:23]
    v_add_u32 v254, s25, v252
    ds_read_b64_tr_b16 v[66:67], v244 offset:34816
    v_mfma_f32_16x16x32_bf16 a[24:27], v[152:155], v[96:99], a[24:27]
    v_add_u32 v255, s25, v253
    v_mfma_f32_16x16x32_bf16 a[28:31], v[156:159], v[96:99], a[28:31]
    ds_read_b128 v[32:35], v254 offset:0
    v_mfma_f32_16x16x32_bf16 a[60:63], v[156:159], v[100:103], a[60:63]
    s_cmp_ge_u32 s75, 784
    s_cselect_b32 s90, 1605632, s90
    s_cselect_b32 s99, 896, s99
    v_mfma_f32_16x16x32_bf16 a[56:59], v[152:155], v[100:103], a[56:59]
    ds_read_b64_tr_b16 v[68:69], v245 offset:32768
    v_mfma_f32_16x16x32_bf16 a[52:55], v[148:151], v[100:103], a[52:55]
    buffer_load_dwordx4 v241, s[8:11], s20 offen offset:1024 nt lds
    v_mfma_f32_16x16x32_bf16 a[48:51], v[144:147], v[100:103], a[48:51]
    ds_read_b64_tr_b16 v[70:71], v245 offset:34816
    v_mfma_f32_16x16x32_bf16 a[44:47], v[140:143], v[100:103], a[44:47]
    s_cmp_ge_u32 s75, 784
    s_cselect_b32 s94, s73, s94
    s_cselect_b32 s97, s74, s97
    s_cselect_b64 vcc, -1, 0
    v_mfma_f32_16x16x32_bf16 a[40:43], v[136:139], v[100:103], a[40:43]
    ds_read_b128 v[36:39], v254 offset:2048
    s_mov_b32 s91, 0x00020000
    v_mfma_f32_16x16x32_bf16 a[36:39], v[132:135], v[100:103], a[36:39]
    v_mul_lo_u32 v27, v28, s99
    v_cndmask_b32 v24, v30, v29, vcc
    v_mfma_f32_16x16x32_bf16 a[32:35], v[128:131], v[100:103], a[32:35]
    ds_read_b64_tr_b16 v[72:73], v246 offset:32768
    v_add_u32 v27, v27, v24
    v_mfma_f32_16x16x32_bf16 a[64:67], v[128:131], v[104:107], a[64:67]
    buffer_load_dwordx4 v242, s[8:11], s20 offen offset:2048 nt lds
    v_mfma_f32_16x16x32_bf16 a[68:71], v[132:135], v[104:107], a[68:71]
    ds_read_b64_tr_b16 v[74:75], v246 offset:34816
    s_mul_i32 s70, s69, 13
    v_mfma_f32_16x16x32_bf16 a[72:75], v[136:139], v[104:107], a[72:75]
    buffer_load_dwordx2 v[208:209], v25, s[80:83], s92 offen nt
    v_mfma_f32_16x16x32_bf16 a[76:79], v[140:143], v[104:107], a[76:79]
    ds_read_b128 v[40:43], v254 offset:4096
    v_mfma_f32_16x16x32_bf16 a[80:83], v[144:147], v[104:107], a[80:83]
    v_mfma_f32_16x16x32_bf16 a[84:87], v[148:151], v[104:107], a[84:87]
    ds_read_b64_tr_b16 v[76:77], v247 offset:32768
    s_add_u32 s92, s92, s69
    v_mfma_f32_16x16x32_bf16 a[88:91], v[152:155], v[104:107], a[88:91]
    buffer_load_dwordx4 v243, s[8:11], s20 offen offset:3072 nt lds
    v_mfma_f32_16x16x32_bf16 a[92:95], v[156:159], v[104:107], a[92:95]
    ds_read_b64_tr_b16 v[78:79], v247 offset:34816
    s_add_u32 s20, s20, 262144
    v_mfma_f32_16x16x32_bf16 a[124:127], v[156:159], v[108:111], a[124:127]
    buffer_load_dwordx2 v[210:211], v25, s[80:83], s92 offen nt
    v_mfma_f32_16x16x32_bf16 a[120:123], v[152:155], v[108:111], a[120:123]
    ds_read_b128 v[44:47], v254 offset:6144
    v_mfma_f32_16x16x32_bf16 a[116:119], v[148:151], v[108:111], a[116:119]
    s_add_u32 s92, s92, s69
    v_mfma_f32_16x16x32_bf16 a[112:115], v[144:147], v[108:111], a[112:115]
    ds_read_b64_tr_b16 v[80:81], v248 offset:32768
    v_mfma_f32_16x16x32_bf16 a[108:111], v[140:143], v[108:111], a[108:111]
    buffer_load_dwordx2 v[212:213], v25, s[80:83], s92 offen nt
    v_mfma_f32_16x16x32_bf16 a[104:107], v[136:139], v[108:111], a[104:107]
    ds_read_b64_tr_b16 v[82:83], v248 offset:34816
    v_mfma_f32_16x16x32_bf16 a[100:103], v[132:135], v[108:111], a[100:103]
    v_mfma_f32_16x16x32_bf16 a[96:99], v[128:131], v[108:111], a[96:99]
    ds_read_b128 v[48:51], v254 offset:8192
    s_add_u32 m0, s22, s37
    v_mfma_f32_16x16x32_bf16 a[128:131], v[128:131], v[112:115], a[128:131]
    buffer_load_dwordx4 v232, s[4:7], s21 offen offset:0 lds
    v_mfma_f32_16x16x32_bf16 a[132:135], v[132:135], v[112:115], a[132:135]
    ds_read_b64_tr_b16 v[84:85], v249 offset:32768
    s_add_u32 s92, s92, s69
    v_mfma_f32_16x16x32_bf16 a[136:139], v[136:139], v[112:115], a[136:139]
    buffer_load_dwordx2 v[214:215], v25, s[80:83], s92 offen nt
    v_mfma_f32_16x16x32_bf16 a[140:143], v[140:143], v[112:115], a[140:143]
    ds_read_b64_tr_b16 v[86:87], v249 offset:34816
    v_mfma_f32_16x16x32_bf16 a[144:147], v[144:147], v[112:115], a[144:147]
    v_mfma_f32_16x16x32_bf16 a[148:151], v[148:151], v[112:115], a[148:151]
    ds_read_b128 v[52:55], v254 offset:10240
    s_add_u32 s92, s92, s70
    v_mfma_f32_16x16x32_bf16 a[152:155], v[152:155], v[112:115], a[152:155]
    buffer_load_dwordx4 v233, s[4:7], s21 offen offset:1024 lds
    v_mfma_f32_16x16x32_bf16 a[156:159], v[156:159], v[112:115], a[156:159]
    ds_read_b64_tr_b16 v[88:89], v250 offset:32768
    v_mfma_f32_16x16x32_bf16 a[188:191], v[156:159], v[116:119], a[188:191]
    buffer_load_dwordx2 v[216:217], v25, s[80:83], s92 offen nt
    v_mfma_f32_16x16x32_bf16 a[184:187], v[152:155], v[116:119], a[184:187]
    ds_read_b64_tr_b16 v[90:91], v250 offset:34816
    v_mfma_f32_16x16x32_bf16 a[180:183], v[148:151], v[116:119], a[180:183]
    v_mfma_f32_16x16x32_bf16 a[176:179], v[144:147], v[116:119], a[176:179]
    ds_read_b128 v[56:59], v254 offset:12288
    s_add_u32 s92, s92, s69
    v_mfma_f32_16x16x32_bf16 a[172:175], v[140:143], v[116:119], a[172:175]
    buffer_load_dwordx4 v234, s[4:7], s21 offen offset:2048 lds
    v_mfma_f32_16x16x32_bf16 a[168:171], v[136:139], v[116:119], a[168:171]
    ds_read_b64_tr_b16 v[92:93], v251 offset:32768
    v_mfma_f32_16x16x32_bf16 a[164:167], v[132:135], v[116:119], a[164:167]
    buffer_load_dwordx2 v[218:219], v25, s[80:83], s92 offen nt
    v_mfma_f32_16x16x32_bf16 a[160:163], v[128:131], v[116:119], a[160:163]
    ds_read_b64_tr_b16 v[94:95], v251 offset:34816
    v_mfma_f32_16x16x32_bf16 a[192:195], v[128:131], v[120:123], a[192:195]
    v_mfma_f32_16x16x32_bf16 a[196:199], v[132:135], v[120:123], a[196:199]
    ds_read_b128 v[60:63], v254 offset:14336
    s_add_u32 s92, s92, s69
    v_mfma_f32_16x16x32_bf16 a[200:203], v[136:139], v[120:123], a[200:203]
    buffer_load_dwordx4 v235, s[4:7], s21 offen offset:3072 lds
    v_mfma_f32_16x16x32_bf16 a[204:207], v[140:143], v[120:123], a[204:207]
    v_mfma_f32_16x16x32_bf16 a[208:211], v[144:147], v[120:123], a[208:211]
    buffer_load_dwordx2 v[220:221], v25, s[80:83], s92 offen nt
    v_mfma_f32_16x16x32_bf16 a[212:215], v[148:151], v[120:123], a[212:215]
    v_mfma_f32_16x16x32_bf16 a[216:219], v[152:155], v[120:123], a[216:219]
    s_add_u32 s92, s92, s69
    v_mfma_f32_16x16x32_bf16 a[220:223], v[156:159], v[120:123], a[220:223]
    v_mfma_f32_16x16x32_bf16 a[252:255], v[156:159], v[124:127], a[252:255]
    buffer_load_dwordx2 v[222:223], v25, s[80:83], s92 offen nt
    v_mfma_f32_16x16x32_bf16 a[248:251], v[152:155], v[124:127], a[248:251]
    v_mfma_f32_16x16x32_bf16 a[244:247], v[148:151], v[124:127], a[244:247]
    v_mfma_f32_16x16x32_bf16 a[240:243], v[144:147], v[124:127], a[240:243]
    v_mfma_f32_16x16x32_bf16 a[236:239], v[140:143], v[124:127], a[236:239]
    v_mfma_f32_16x16x32_bf16 a[232:235], v[136:139], v[124:127], a[232:235]
    v_mfma_f32_16x16x32_bf16 a[228:231], v[132:135], v[124:127], a[228:231]
    v_mfma_f32_16x16x32_bf16 a[224:227], v[128:131], v[124:127], a[224:227]
    s_mov_b32 s35, 5
    s_branch G_K_mid
    .p2align 4
G_K_loop:
    s_waitcnt vmcnt(18) lgkmcnt(0)
    s_barrier
    v_mfma_f32_16x16x32_bf16 a[0:3], v[64:67], v[32:35], a[0:3]
    v_mfma_f32_16x16x32_bf16 a[4:7], v[68:71], v[32:35], a[4:7]
    v_mfma_f32_16x16x32_bf16 a[8:11], v[72:75], v[32:35], a[8:11]
    s_cmp_eq_u32 s20, s79
    s_cbranch_scc1 G_K_sig0
G_K_sigback0:
    v_mfma_f32_16x16x32_bf16 a[12:15], v[76:79], v[32:35], a[12:15]
    ds_read_b64_tr_b16 v[128:129], v244 offset:16384
    s_add_u32 m0, s24, 0
    v_mfma_f32_16x16x32_bf16 a[16:19], v[80:83], v[32:35], a[16:19]
    buffer_load_dwordx4 v240, s[8:11], s20 offen offset:0 nt lds
    v_mfma_f32_16x16x32_bf16 a[20:23], v[84:87], v[32:35], a[20:23]
    ds_read_b64_tr_b16 v[130:131], v244 offset:18432
    v_perm_b32 v8, v210, v208, s76
    v_mfma_f32_16x16x32_bf16 a[24:27], v[88:91], v[32:35], a[24:27]
    v_perm_b32 v12, v210, v208, s77
    v_perm_b32 v16, v211, v209, s76
    v_mfma_f32_16x16x32_bf16 a[28:31], v[92:95], v[32:35], a[28:31]
    ds_read_b128 v[96:99], v255 offset:0
    v_perm_b32 v20, v211, v209, s77
    v_mfma_f32_16x16x32_bf16 a[60:63], v[92:95], v[36:39], a[60:63]
    v_perm_b32 v9, v214, v212, s76
    v_mfma_f32_16x16x32_bf16 a[56:59], v[88:91], v[36:39], a[56:59]
    ds_read_b64_tr_b16 v[132:133], v245 offset:16384
    v_mfma_f32_16x16x32_bf16 a[52:55], v[84:87], v[36:39], a[52:55]
    buffer_load_dwordx4 v241, s[8:11], s20 offen offset:1024 nt lds
    v_mfma_f32_16x16x32_bf16 a[48:51], v[80:83], v[36:39], a[48:51]
    ds_read_b64_tr_b16 v[134:135], v245 offset:18432
    v_perm_b32 v13, v214, v212, s77
    v_mfma_f32_16x16x32_bf16 a[44:47], v[76:79], v[36:39], a[44:47]
    v_perm_b32 v17, v215, v213, s76
    v_mfma_f32_16x16x32_bf16 a[40:43], v[72:75], v[36:39], a[40:43]
    ds_read_b128 v[100:103], v255 offset:2048
    v_perm_b32 v21, v215, v213, s77
    v_mfma_f32_16x16x32_bf16 a[36:39], v[68:71], v[36:39], a[36:39]
    v_mfma_f32_16x16x32_bf16 a[32:35], v[64:67], v[36:39], a[32:35]
    ds_read_b64_tr_b16 v[136:137], v246 offset:16384
    v_mfma_f32_16x16x32_bf16 a[64:67], v[64:67], v[40:43], a[64:67]
    buffer_load_dwordx4 v242, s[8:11], s20 offen offset:2048 nt lds
    v_mfma_f32_16x16x32_bf16 a[68:71], v[68:71], v[40:43], a[68:71]
    ds_read_b64_tr_b16 v[138:139], v246 offset:18432
    v_mfma_f32_16x16x32_bf16 a[72:75], v[72:75], v[40:43], a[72:75]
    buffer_load_dwordx2 v[208:209], v26, s[84:87], s93 offen nt
    v_mfma_f32_16x16x32_bf16 a[76:79], v[76:79], v[40:43], a[76:79]
    ds_read_b128 v[104:107], v255 offset:4096
    s_add_u32 s93, s93, s98
    v_mfma_f32_16x16x32_bf16 a[80:83], v[80:83], v[40:43], a[80:83]
    v_mfma_f32_16x16x32_bf16 a[84:87], v[84:87], v[40:43], a[84:87]
    ds_read_b64_tr_b16 v[140:141], v247 offset:16384
    v_perm_b32 v10, v218, v216, s76
    v_mfma_f32_16x16x32_bf16 a[88:91], v[88:91], v[40:43], a[88:91]
    buffer_load_dwordx4 v243, s[8:11], s20 offen offset:3072 nt lds
    v_mfma_f32_16x16x32_bf16 a[92:95], v[92:95], v[40:43], a[92:95]
    ds_read_b64_tr_b16 v[142:143], v247 offset:18432
    s_add_u32 s20, s20, 262144
    v_mfma_f32_16x16x32_bf16 a[124:127], v[92:95], v[44:47], a[124:127]
    v_perm_b32 v14, v218, v216, s77
    v_perm_b32 v18, v219, v217, s76
    v_mfma_f32_16x16x32_bf16 a[120:123], v[88:91], v[44:47], a[120:123]
    ds_read_b128 v[108:111], v255 offset:6144
    v_mfma_f32_16x16x32_bf16 a[116:119], v[84:87], v[44:47], a[116:119]
    v_perm_b32 v22, v219, v217, s77
    v_mfma_f32_16x16x32_bf16 a[112:115], v[80:83], v[44:47], a[112:115]
    ds_read_b64_tr_b16 v[144:145], v248 offset:16384
    v_mfma_f32_16x16x32_bf16 a[108:111], v[76:79], v[44:47], a[108:111]
    buffer_load_dwordx2 v[210:211], v26, s[84:87], s93 offen nt
    v_mfma_f32_16x16x32_bf16 a[104:107], v[72:75], v[44:47], a[104:107]
    ds_read_b64_tr_b16 v[146:147], v248 offset:18432
    v_mfma_f32_16x16x32_bf16 a[100:103], v[68:71], v[44:47], a[100:103]
    v_mfma_f32_16x16x32_bf16 a[96:99], v[64:67], v[44:47], a[96:99]
    ds_read_b128 v[112:115], v255 offset:8192
    s_add_u32 m0, s22, s29
    v_mfma_f32_16x16x32_bf16 a[128:131], v[64:67], v[48:51], a[128:131]
    buffer_load_dwordx4 v236, s[4:7], s21 offen offset:0 lds
    v_mfma_f32_16x16x32_bf16 a[132:135], v[68:71], v[48:51], a[132:135]
    ds_read_b64_tr_b16 v[148:149], v249 offset:16384
    s_add_u32 s93, s93, s98
    v_mfma_f32_16x16x32_bf16 a[136:139], v[72:75], v[48:51], a[136:139]
    v_perm_b32 v11, v222, v220, s76
    v_mfma_f32_16x16x32_bf16 a[140:143], v[76:79], v[48:51], a[140:143]
    ds_read_b64_tr_b16 v[150:151], v249 offset:18432
    v_mfma_f32_16x16x32_bf16 a[144:147], v[80:83], v[48:51], a[144:147]
    v_perm_b32 v15, v222, v220, s77
    v_mfma_f32_16x16x32_bf16 a[148:151], v[84:87], v[48:51], a[148:151]
    ds_read_b128 v[116:119], v255 offset:10240
    v_mfma_f32_16x16x32_bf16 a[152:155], v[88:91], v[48:51], a[152:155]
    buffer_load_dwordx4 v237, s[4:7], s21 offen offset:1024 lds
    v_mfma_f32_16x16x32_bf16 a[156:159], v[92:95], v[48:51], a[156:159]
    ds_read_b64_tr_b16 v[152:153], v250 offset:16384
    v_perm_b32 v19, v223, v221, s76
    v_mfma_f32_16x16x32_bf16 a[188:191], v[92:95], v[52:55], a[188:191]
    v_perm_b32 v23, v223, v221, s77
    v_mfma_f32_16x16x32_bf16 a[184:187], v[88:91], v[52:55], a[184:187]
    ds_read_b64_tr_b16 v[154:155], v250 offset:18432
    v_mfma_f32_16x16x32_bf16 a[180:183], v[84:87], v[52:55], a[180:183]
    buffer_load_dwordx2 v[212:213], v26, s[84:87], s93 offen nt
    v_mfma_f32_16x16x32_bf16 a[176:179], v[80:83], v[52:55], a[176:179]
    ds_read_b128 v[120:123], v255 offset:12288
    v_mfma_f32_16x16x32_bf16 a[172:175], v[76:79], v[52:55], a[172:175]
    buffer_load_dwordx4 v238, s[4:7], s21 offen offset:2048 lds
    v_mfma_f32_16x16x32_bf16 a[168:171], v[72:75], v[52:55], a[168:171]
    ds_read_b64_tr_b16 v[156:157], v251 offset:16384
    s_add_u32 s93, s93, s98
    v_mfma_f32_16x16x32_bf16 a[164:167], v[68:71], v[52:55], a[164:167]
    v_mfma_f32_16x16x32_bf16 a[160:163], v[64:67], v[52:55], a[160:163]
    ds_read_b64_tr_b16 v[158:159], v251 offset:18432
    v_mfma_f32_16x16x32_bf16 a[192:195], v[64:67], v[56:59], a[192:195]
    buffer_load_dwordx2 v[214:215], v26, s[84:87], s93 offen nt
    v_mfma_f32_16x16x32_bf16 a[196:199], v[68:71], v[56:59], a[196:199]
    ds_read_b128 v[124:127], v255 offset:14336
    v_mfma_f32_16x16x32_bf16 a[200:203], v[72:75], v[56:59], a[200:203]
    buffer_load_dwordx4 v239, s[4:7], s21 offen offset:3072 lds
    v_mfma_f32_16x16x32_bf16 a[204:207], v[76:79], v[56:59], a[204:207]
    s_add_u32 s21, s21, 128
    s_add_u32 s22, s22, 32768
    v_mfma_f32_16x16x32_bf16 a[208:211], v[80:83], v[56:59], a[208:211]
    s_cmp_eq_u32 s22, 163840
    s_cselect_b32 s22, 65536, s22
    v_mfma_f32_16x16x32_bf16 a[212:215], v[84:87], v[56:59], a[212:215]
    s_mul_i32 s70, s98, 13
    s_add_u32 s93, s93, s70
    v_mfma_f32_16x16x32_bf16 a[216:219], v[88:91], v[56:59], a[216:219]
    v_mfma_f32_16x16x32_bf16 a[220:223], v[92:95], v[56:59], a[220:223]
    v_mfma_f32_16x16x32_bf16 a[252:255], v[92:95], v[60:63], a[252:255]
    v_mfma_f32_16x16x32_bf16 a[248:251], v[88:91], v[60:63], a[248:251]
    v_mfma_f32_16x16x32_bf16 a[244:247], v[84:87], v[60:63], a[244:247]
    v_mfma_f32_16x16x32_bf16 a[240:243], v[80:83], v[60:63], a[240:243]
    v_mfma_f32_16x16x32_bf16 a[236:239], v[76:79], v[60:63], a[236:239]
    buffer_store_dwordx4 v[8:11], v1, s[12:15], s78 offen offset:0 sc1
    v_mfma_f32_16x16x32_bf16 a[232:235], v[72:75], v[60:63], a[232:235]
    v_mfma_f32_16x16x32_bf16 a[228:231], v[68:71], v[60:63], a[228:231]
    v_mfma_f32_16x16x32_bf16 a[224:227], v[64:67], v[60:63], a[224:227]
    s_waitcnt vmcnt(22) lgkmcnt(0)
    s_barrier
    v_mfma_f32_16x16x32_bf16 a[0:3], v[128:131], v[96:99], a[0:3]
    s_add_u32 s25, s25, 32768
    v_mfma_f32_16x16x32_bf16 a[4:7], v[132:135], v[96:99], a[4:7]
    s_cmp_eq_u32 s25, 163840
    s_cselect_b32 s25, 65536, s25
    v_mfma_f32_16x16x32_bf16 a[8:11], v[136:139], v[96:99], a[8:11]
    s_cmp_eq_u32 s20, s79
    s_cbranch_scc1 G_K_sig1
G_K_sigback1:
    v_mfma_f32_16x16x32_bf16 a[12:15], v[140:143], v[96:99], a[12:15]
    ds_read_b64_tr_b16 v[64:65], v244 offset:32768
    s_add_u32 m0, s24, 16384
    v_mfma_f32_16x16x32_bf16 a[16:19], v[144:147], v[96:99], a[16:19]
    buffer_load_dwordx4 v240, s[8:11], s20 offen offset:0 nt lds
    v_mfma_f32_16x16x32_bf16 a[20:23], v[148:151], v[96:99], a[20:23]
    v_add_u32 v254, s25, v252
    ds_read_b64_tr_b16 v[66:67], v244 offset:34816
    v_mfma_f32_16x16x32_bf16 a[24:27], v[152:155], v[96:99], a[24:27]
    v_add_u32 v255, s25, v253
    v_mfma_f32_16x16x32_bf16 a[28:31], v[156:159], v[96:99], a[28:31]
    ds_read_b128 v[32:35], v254 offset:0
    v_mfma_f32_16x16x32_bf16 a[60:63], v[156:159], v[100:103], a[60:63]
    buffer_load_dwordx2 v[216:217], v26, s[84:87], s93 offen nt
    v_mfma_f32_16x16x32_bf16 a[56:59], v[152:155], v[100:103], a[56:59]
    ds_read_b64_tr_b16 v[68:69], v245 offset:32768
    s_add_u32 s93, s93, s98
    v_mfma_f32_16x16x32_bf16 a[52:55], v[148:151], v[100:103], a[52:55]
    buffer_load_dwordx4 v241, s[8:11], s20 offen offset:1024 nt lds
    v_mfma_f32_16x16x32_bf16 a[48:51], v[144:147], v[100:103], a[48:51]
    ds_read_b64_tr_b16 v[70:71], v245 offset:34816
    v_mfma_f32_16x16x32_bf16 a[44:47], v[140:143], v[100:103], a[44:47]
    buffer_load_dwordx2 v[218:219], v26, s[84:87], s93 offen nt
    v_mfma_f32_16x16x32_bf16 a[40:43], v[136:139], v[100:103], a[40:43]
    ds_read_b128 v[36:39], v254 offset:2048
    v_mfma_f32_16x16x32_bf16 a[36:39], v[132:135], v[100:103], a[36:39]
    s_add_u32 s93, s93, s98
    v_mfma_f32_16x16x32_bf16 a[32:35], v[128:131], v[100:103], a[32:35]
    ds_read_b64_tr_b16 v[72:73], v246 offset:32768
    v_mfma_f32_16x16x32_bf16 a[64:67], v[128:131], v[104:107], a[64:67]
    buffer_load_dwordx4 v242, s[8:11], s20 offen offset:2048 nt lds
    v_mfma_f32_16x16x32_bf16 a[68:71], v[132:135], v[104:107], a[68:71]
    ds_read_b64_tr_b16 v[74:75], v246 offset:34816
    v_mfma_f32_16x16x32_bf16 a[72:75], v[136:139], v[104:107], a[72:75]
    buffer_load_dwordx2 v[220:221], v26, s[84:87], s93 offen nt
    v_mfma_f32_16x16x32_bf16 a[76:79], v[140:143], v[104:107], a[76:79]
    ds_read_b128 v[40:43], v254 offset:4096
    v_mfma_f32_16x16x32_bf16 a[80:83], v[144:147], v[104:107], a[80:83]
    v_mfma_f32_16x16x32_bf16 a[84:87], v[148:151], v[104:107], a[84:87]
    ds_read_b64_tr_b16 v[76:77], v247 offset:32768
    v_mfma_f32_16x16x32_bf16 a[88:91], v[152:155], v[104:107], a[88:91]
    buffer_load_dwordx4 v243, s[8:11], s20 offen offset:3072 nt lds
    v_mfma_f32_16x16x32_bf16 a[92:95], v[156:159], v[104:107], a[92:95]
    ds_read_b64_tr_b16 v[78:79], v247 offset:34816
    s_add_u32 s20, s20, 262144
    v_mfma_f32_16x16x32_bf16 a[124:127], v[156:159], v[108:111], a[124:127]
    s_add_u32 s93, s93, s98
    v_mfma_f32_16x16x32_bf16 a[120:123], v[152:155], v[108:111], a[120:123]
    ds_read_b128 v[44:47], v254 offset:6144
    v_mfma_f32_16x16x32_bf16 a[116:119], v[148:151], v[108:111], a[116:119]
    buffer_load_dwordx2 v[222:223], v26, s[84:87], s93 offen nt
    v_mfma_f32_16x16x32_bf16 a[112:115], v[144:147], v[108:111], a[112:115]
    ds_read_b64_tr_b16 v[80:81], v248 offset:32768
    v_mfma_f32_16x16x32_bf16 a[108:111], v[140:143], v[108:111], a[108:111]
    v_mfma_f32_16x16x32_bf16 a[104:107], v[136:139], v[108:111], a[104:107]
    ds_read_b64_tr_b16 v[82:83], v248 offset:34816
    v_mfma_f32_16x16x32_bf16 a[100:103], v[132:135], v[108:111], a[100:103]
    s_mov_b32 s84, s88
    v_mfma_f32_16x16x32_bf16 a[96:99], v[128:131], v[108:111], a[96:99]
    ds_read_b128 v[48:51], v254 offset:8192
    s_add_u32 m0, s22, s37
    v_mfma_f32_16x16x32_bf16 a[128:131], v[128:131], v[112:115], a[128:131]
    buffer_load_dwordx4 v232, s[4:7], s21 offen offset:0 lds
    v_mfma_f32_16x16x32_bf16 a[132:135], v[132:135], v[112:115], a[132:135]
    ds_read_b64_tr_b16 v[84:85], v249 offset:32768
    s_mov_b32 s85, s89
    v_mfma_f32_16x16x32_bf16 a[136:139], v[136:139], v[112:115], a[136:139]
    v_mfma_f32_16x16x32_bf16 a[140:143], v[140:143], v[112:115], a[140:143]
    ds_read_b64_tr_b16 v[86:87], v249 offset:34816
    s_mov_b32 s86, s90
    v_mfma_f32_16x16x32_bf16 a[144:147], v[144:147], v[112:115], a[144:147]
    v_mfma_f32_16x16x32_bf16 a[148:151], v[148:151], v[112:115], a[148:151]
    ds_read_b128 v[52:55], v254 offset:10240
    v_mfma_f32_16x16x32_bf16 a[152:155], v[152:155], v[112:115], a[152:155]
    buffer_load_dwordx4 v233, s[4:7], s21 offen offset:1024 lds
    v_mfma_f32_16x16x32_bf16 a[156:159], v[156:159], v[112:115], a[156:159]
    ds_read_b64_tr_b16 v[88:89], v250 offset:32768
    s_mov_b32 s93, s94
    v_mfma_f32_16x16x32_bf16 a[188:191], v[156:159], v[116:119], a[188:191]
    v_mfma_f32_16x16x32_bf16 a[184:187], v[152:155], v[116:119], a[184:187]
    ds_read_b64_tr_b16 v[90:91], v250 offset:34816
    s_mov_b32 s98, s99
    v_mfma_f32_16x16x32_bf16 a[180:183], v[148:151], v[116:119], a[180:183]
    v_mfma_f32_16x16x32_bf16 a[176:179], v[144:147], v[116:119], a[176:179]
    ds_read_b128 v[56:59], v254 offset:12288
    v_mov_b32 v26, v27
    v_mfma_f32_16x16x32_bf16 a[172:175], v[140:143], v[116:119], a[172:175]
    buffer_load_dwordx4 v234, s[4:7], s21 offen offset:2048 lds
    v_mfma_f32_16x16x32_bf16 a[168:171], v[136:139], v[116:119], a[168:171]
    ds_read_b64_tr_b16 v[92:93], v251 offset:32768
    v_mfma_f32_16x16x32_bf16 a[164:167], v[132:135], v[116:119], a[164:167]
    s_mov_b32 s90, 0
    v_mfma_f32_16x16x32_bf16 a[160:163], v[128:131], v[116:119], a[160:163]
    ds_read_b64_tr_b16 v[94:95], v251 offset:34816
    v_mfma_f32_16x16x32_bf16 a[192:195], v[128:131], v[120:123], a[192:195]
    v_mfma_f32_16x16x32_bf16 a[196:199], v[132:135], v[120:123], a[196:199]
    ds_read_b128 v[60:63], v254 offset:14336
    s_mov_b32 s94, 0
    v_mfma_f32_16x16x32_bf16 a[200:203], v[136:139], v[120:123], a[200:203]
    buffer_load_dwordx4 v235, s[4:7], s21 offen offset:3072 lds
    v_mfma_f32_16x16x32_bf16 a[204:207], v[140:143], v[120:123], a[204:207]
    v_mfma_f32_16x16x32_bf16 a[208:211], v[144:147], v[120:123], a[208:211]
    s_mov_b32 s99, 0
    v_mfma_f32_16x16x32_bf16 a[212:215], v[148:151], v[120:123], a[212:215]
    v_mfma_f32_16x16x32_bf16 a[216:219], v[152:155], v[120:123], a[216:219]
    v_mfma_f32_16x16x32_bf16 a[220:223], v[156:159], v[120:123], a[220:223]
    v_mfma_f32_16x16x32_bf16 a[252:255], v[156:159], v[124:127], a[252:255]
    v_mfma_f32_16x16x32_bf16 a[248:251], v[152:155], v[124:127], a[248:251]
    v_mfma_f32_16x16x32_bf16 a[244:247], v[148:151], v[124:127], a[244:247]
    v_mfma_f32_16x16x32_bf16 a[240:243], v[144:147], v[124:127], a[240:243]
    v_mfma_f32_16x16x32_bf16 a[236:239], v[140:143], v[124:127], a[236:239]
    buffer_store_dwordx4 v[12:15], v1, s[12:15], s78 offen offset:1024 sc1
    v_mfma_f32_16x16x32_bf16 a[232:235], v[136:139], v[124:127], a[232:235]
    v_mfma_f32_16x16x32_bf16 a[228:231], v[132:135], v[124:127], a[228:231]
    v_mfma_f32_16x16x32_bf16 a[224:227], v[128:131], v[124:127], a[224:227]
G_K_mid:
    s_waitcnt vmcnt(26) lgkmcnt(0)
    s_barrier
    v_mfma_f32_16x16x32_bf16 a[0:3], v[64:67], v[32:35], a[0:3]
    v_mfma_f32_16x16x32_bf16 a[4:7], v[68:71], v[32:35], a[4:7]
    v_mfma_f32_16x16x32_bf16 a[8:11], v[72:75], v[32:35], a[8:11]
    s_cmp_eq_u32 s20, s79
    s_cbranch_scc1 G_K_sig2
G_K_sigback2:
    v_mfma_f32_16x16x32_bf16 a[12:15], v[76:79], v[32:35], a[12:15]
    ds_read_b64_tr_b16 v[128:129], v244 offset:49152
    s_add_u32 m0, s24, 32768
    v_mfma_f32_16x16x32_bf16 a[16:19], v[80:83], v[32:35], a[16:19]
    buffer_load_dwordx4 v240, s[8:11], s20 offen offset:0 nt lds
    v_mfma_f32_16x16x32_bf16 a[20:23], v[84:87], v[32:35], a[20:23]
    ds_read_b64_tr_b16 v[130:131], v244 offset:51200
    v_mfma_f32_16x16x32_bf16 a[24:27], v[88:91], v[32:35], a[24:27]
    v_mfma_f32_16x16x32_bf16 a[28:31], v[92:95], v[32:35], a[28:31]
    ds_read_b128 v[96:99], v255 offset:0
    v_mfma_f32_16x16x32_bf16 a[60:63], v[92:95], v[36:39], a[60:63]
    v_mfma_f32_16x16x32_bf16 a[56:59], v[88:91], v[36:39], a[56:59]
    ds_read_b64_tr_b16 v[132:133], v245 offset:49152
    v_mfma_f32_16x16x32_bf16 a[52:55], v[84:87], v[36:39], a[52:55]
    buffer_load_dwordx4 v241, s[8:11], s20 offen offset:1024 nt lds
    v_mfma_f32_16x16x32_bf16 a[48:51], v[80:83], v[36:39], a[48:51]
    ds_read_b64_tr_b16 v[134:135], v245 offset:51200
    v_mfma_f32_16x16x32_bf16 a[44:47], v[76:79], v[36:39], a[44:47]
    v_mfma_f32_16x16x32_bf16 a[40:43], v[72:75], v[36:39], a[40:43]
    ds_read_b128 v[100:103], v255 offset:2048
    v_mfma_f32_16x16x32_bf16 a[36:39], v[68:71], v[36:39], a[36:39]
    v_mfma_f32_16x16x32_bf16 a[32:35], v[64:67], v[36:39], a[32:35]
    ds_read_b64_tr_b16 v[136:137], v246 offset:49152
    v_mfma_f32_16x16x32_bf16 a[64:67], v[64:67], v[40:43], a[64:67]
    buffer_load_dwordx4 v242, s[8:11], s20 offen offset:2048 nt lds
    v_mfma_f32_16x16x32_bf16 a[68:71], v[68:71], v[40:43], a[68:71]
    ds_read_b64_tr_b16 v[138:139], v246 offset:51200
    v_mfma_f32_16x16x32_bf16 a[72:75], v[72:75], v[40:43], a[72:75]
    v_mfma_f32_16x16x32_bf16 a[76:79], v[76:79], v[40:43], a[76:79]
    ds_read_b128 v[104:107], v255 offset:4096
    v_mfma_f32_16x16x32_bf16 a[80:83], v[80:83], v[40:43], a[80:83]
    v_mfma_f32_16x16x32_bf16 a[84:87], v[84:87], v[40:43], a[84:87]
    ds_read_b64_tr_b16 v[140:141], v247 offset:49152
    v_mfma_f32_16x16x32_bf16 a[88:91], v[88:91], v[40:43], a[88:91]
    buffer_load_dwordx4 v243, s[8:11], s20 offen offset:3072 nt lds
    v_mfma_f32_16x16x32_bf16 a[92:95], v[92:95], v[40:43], a[92:95]
    ds_read_b64_tr_b16 v[142:143], v247 offset:51200
    s_add_u32 s20, s20, 262144
    v_mfma_f32_16x16x32_bf16 a[124:127], v[92:95], v[44:47], a[124:127]
    v_mfma_f32_16x16x32_bf16 a[120:123], v[88:91], v[44:47], a[120:123]
    ds_read_b128 v[108:111], v255 offset:6144
    v_mfma_f32_16x16x32_bf16 a[116:119], v[84:87], v[44:47], a[116:119]
    v_mfma_f32_16x16x32_bf16 a[112:115], v[80:83], v[44:47], a[112:115]
    ds_read_b64_tr_b16 v[144:145], v248 offset:49152
    v_mfma_f32_16x16x32_bf16 a[108:111], v[76:79], v[44:47], a[108:111]
    v_mfma_f32_16x16x32_bf16 a[104:107], v[72:75], v[44:47], a[104:107]
    ds_read_b64_tr_b16 v[146:147], v248 offset:51200
    v_mfma_f32_16x16x32_bf16 a[100:103], v[68:71], v[44:47], a[100:103]
    v_mfma_f32_16x16x32_bf16 a[96:99], v[64:67], v[44:47], a[96:99]
    ds_read_b128 v[112:115], v255 offset:8192
    s_add_u32 m0, s22, s29
    v_mfma_f32_16x16x32_bf16 a[128:131], v[64:67], v[48:51], a[128:131]
    buffer_load_dwordx4 v236, s[4:7], s21 offen offset:0 lds
    v_mfma_f32_16x16x32_bf16 a[132:135], v[68:71], v[48:51], a[132:135]
    ds_read_b64_tr_b16 v[148:149], v249 offset:49152
    v_mfma_f32_16x16x32_bf16 a[136:139], v[72:75], v[48:51], a[136:139]
    v_mfma_f32_16x16x32_bf16 a[140:143], v[76:79], v[48:51], a[140:143]
    ds_read_b64_tr_b16 v[150:151], v249 offset:51200
    v_mfma_f32_16x16x32_bf16 a[144:147], v[80:83], v[48:51], a[144:147]
    v_mfma_f32_16x16x32_bf16 a[148:151], v[84:87], v[48:51], a[148:151]
    ds_read_b128 v[116:119], v255 offset:10240
    v_mfma_f32_16x16x32_bf16 a[152:155], v[88:91], v[48:51], a[152:155]
    buffer_load_dwordx4 v237, s[4:7], s21 offen offset:1024 lds
    v_mfma_f32_16x16x32_bf16 a[156:159], v[92:95], v[48:51], a[156:159]
    ds_read_b64_tr_b16 v[152:153], v250 offset:49152
    v_mfma_f32_16x16x32_bf16 a[188:191], v[92:95], v[52:55], a[188:191]
    v_mfma_f32_16x16x32_bf16 a[184:187], v[88:91], v[52:55], a[184:187]
    ds_read_b64_tr_b16 v[154:155], v250 offset:51200
    v_mfma_f32_16x16x32_bf16 a[180:183], v[84:87], v[52:55], a[180:183]
    v_mfma_f32_16x16x32_bf16 a[176:179], v[80:83], v[52:55], a[176:179]
    ds_read_b128 v[120:123], v255 offset:12288
    v_mfma_f32_16x16x32_bf16 a[172:175], v[76:79], v[52:55], a[172:175]
    buffer_load_dwordx4 v238, s[4:7], s21 offen offset:2048 lds
    v_mfma_f32_16x16x32_bf16 a[168:171], v[72:75], v[52:55], a[168:171]
    ds_read_b64_tr_b16 v[156:157], v251 offset:49152
    v_mfma_f32_16x16x32_bf16 a[164:167], v[68:71], v[52:55], a[164:167]
    v_mfma_f32_16x16x32_bf16 a[160:163], v[64:67], v[52:55], a[160:163]
    ds_read_b64_tr_b16 v[158:159], v251 offset:51200
    v_mfma_f32_16x16x32_bf16 a[192:195], v[64:67], v[56:59], a[192:195]
    v_mfma_f32_16x16x32_bf16 a[196:199], v[68:71], v[56:59], a[196:199]
    ds_read_b128 v[124:127], v255 offset:14336
    v_mfma_f32_16x16x32_bf16 a[200:203], v[72:75], v[56:59], a[200:203]
    buffer_load_dwordx4 v239, s[4:7], s21 offen offset:3072 lds
    v_mfma_f32_16x16x32_bf16 a[204:207], v[76:79], v[56:59], a[204:207]
    s_add_u32 s21, s21, 128
    s_add_u32 s22, s22, 32768
    v_mfma_f32_16x16x32_bf16 a[208:211], v[80:83], v[56:59], a[208:211]
    s_cmp_eq_u32 s22, 163840
    s_cselect_b32 s22, 65536, s22
    v_mfma_f32_16x16x32_bf16 a[212:215], v[84:87], v[56:59], a[212:215]
    v_mfma_f32_16x16x32_bf16 a[216:219], v[88:91], v[56:59], a[216:219]
    v_mfma_f32_16x16x32_bf16 a[220:223], v[92:95], v[56:59], a[220:223]
    v_mfma_f32_16x16x32_bf16 a[252:255], v[92:95], v[60:63], a[252:255]
    v_mfma_f32_16x16x32_bf16 a[248:251], v[88:91], v[60:63], a[248:251]
    v_mfma_f32_16x16x32_bf16 a[244:247], v[84:87], v[60:63], a[244:247]
    v_mfma_f32_16x16x32_bf16 a[240:243], v[80:83], v[60:63], a[240:243]
    v_mfma_f32_16x16x32_bf16 a[236:239], v[76:79], v[60:63], a[236:239]
    buffer_store_dwordx4 v[16:19], v1, s[12:15], s78 offen offset:2048 sc1
    v_mfma_f32_16x16x32_bf16 a[232:235], v[72:75], v[60:63], a[232:235]
    v_mfma_f32_16x16x32_bf16 a[228:231], v[68:71], v[60:63], a[228:231]
    v_mfma_f32_16x16x32_bf16 a[224:227], v[64:67], v[60:63], a[224:227]
    s_waitcnt vmcnt(22) lgkmcnt(0)
    s_barrier
    v_mfma_f32_16x16x32_bf16 a[0:3], v[128:131], v[96:99], a[0:3]
    s_add_u32 s25, s25, 32768
    v_mfma_f32_16x16x32_bf16 a[4:7], v[132:135], v[96:99], a[4:7]
    s_cmp_eq_u32 s25, 163840
    s_cselect_b32 s25, 65536, s25
    v_mfma_f32_16x16x32_bf16 a[8:11], v[136:139], v[96:99], a[8:11]
    s_cmp_eq_u32 s20, s79
    s_cbranch_scc1 G_K_sig3
G_K_sigback3:
    v_mfma_f32_16x16x32_bf16 a[12:15], v[140:143], v[96:99], a[12:15]
    ds_read_b64_tr_b16 v[64:65], v244 offset:0
    s_add_u32 m0, s24, 49152
    v_mfma_f32_16x16x32_bf16 a[16:19], v[144:147], v[96:99], a[16:19]
    buffer_load_dwordx4 v240, s[8:11], s20 offen offset:0 nt lds
    v_mfma_f32_16x16x32_bf16 a[20:23], v[148:151], v[96:99], a[20:23]
    v_add_u32 v254, s25, v252
    ds_read_b64_tr_b16 v[66:67], v244 offset:2048
    v_mfma_f32_16x16x32_bf16 a[24:27], v[152:155], v[96:99], a[24:27]
    v_add_u32 v255, s25, v253
    v_mfma_f32_16x16x32_bf16 a[28:31], v[156:159], v[96:99], a[28:31]
    ds_read_b128 v[32:35], v254 offset:0
    v_mfma_f32_16x16x32_bf16 a[60:63], v[156:159], v[100:103], a[60:63]
    v_mfma_f32_16x16x32_bf16 a[56:59], v[152:155], v[100:103], a[56:59]
    ds_read_b64_tr_b16 v[68:69], v245 offset:0
    v_mfma_f32_16x16x32_bf16 a[52:55], v[148:151], v[100:103], a[52:55]
    buffer_load_dwordx4 v241, s[8:11], s20 offen offset:1024 nt lds
    v_mfma_f32_16x16x32_bf16 a[48:51], v[144:147], v[100:103], a[48:51]
    ds_read_b64_tr_b16 v[70:71], v245 offset:2048
    v_mfma_f32_16x16x32_bf16 a[44:47], v[140:143], v[100:103], a[44:47]
    v_mfma_f32_16x16x32_bf16 a[40:43], v[136:139], v[100:103], a[40:43]
    ds_read_b128 v[36:39], v254 offset:2048
    v_mfma_f32_16x16x32_bf16 a[36:39], v[132:135], v[100:103], a[36:39]
    v_mfma_f32_16x16x32_bf16 a[32:35], v[128:131], v[100:103], a[32:35]
    ds_read_b64_tr_b16 v[72:73], v246 offset:0
    v_mfma_f32_16x16x32_bf16 a[64:67], v[128:131], v[104:107], a[64:67]
    buffer_load_dwordx4 v242, s[8:11], s20 offen offset:2048 nt lds
    v_mfma_f32_16x16x32_bf16 a[68:71], v[132:135], v[104:107], a[68:71]
    ds_read_b64_tr_b16 v[74:75], v246 offset:2048
    v_mfma_f32_16x16x32_bf16 a[72:75], v[136:139], v[104:107], a[72:75]
    v_mfma_f32_16x16x32_bf16 a[76:79], v[140:143], v[104:107], a[76:79]
    ds_read_b128 v[40:43], v254 offset:4096
    v_mfma_f32_16x16x32_bf16 a[80:83], v[144:147], v[104:107], a[80:83]
    v_mfma_f32_16x16x32_bf16 a[84:87], v[148:151], v[104:107], a[84:87]
    ds_read_b64_tr_b16 v[76:77], v247 offset:0
    v_mfma_f32_16x16x32_bf16 a[88:91], v[152:155], v[104:107], a[88:91]
    buffer_load_dwordx4 v243, s[8:11], s20 offen offset:3072 nt lds
    v_mfma_f32_16x16x32_bf16 a[92:95], v[156:159], v[104:107], a[92:95]
    ds_read_b64_tr_b16 v[78:79], v247 offset:2048
    s_add_u32 s20, s20, 262144
    v_mfma_f32_16x16x32_bf16 a[124:127], v[156:159], v[108:111], a[124:127]
    v_mfma_f32_16x16x32_bf16 a[120:123], v[152:155], v[108:111], a[120:123]
    ds_read_b128 v[44:47], v254 offset:6144
    v_mfma_f32_16x16x32_bf16 a[116:119], v[148:151], v[108:111], a[116:119]
    v_mfma_f32_16x16x32_bf16 a[112:115], v[144:147], v[108:111], a[112:115]
    ds_read_b64_tr_b16 v[80:81], v248 offset:0
    v_mfma_f32_16x16x32_bf16 a[108:111], v[140:143], v[108:111], a[108:111]
    v_mfma_f32_16x16x32_bf16 a[104:107], v[136:139], v[108:111], a[104:107]
    ds_read_b64_tr_b16 v[82:83], v248 offset:2048
    v_mfma_f32_16x16x32_bf16 a[100:103], v[132:135], v[108:111], a[100:103]
    v_mfma_f32_16x16x32_bf16 a[96:99], v[128:131], v[108:111], a[96:99]
    ds_read_b128 v[48:51], v254 offset:8192
    s_add_u32 m0, s22, s37
    v_mfma_f32_16x16x32_bf16 a[128:131], v[128:131], v[112:115], a[128:131]
    buffer_load_dwordx4 v232, s[4:7], s21 offen offset:0 lds
    v_mfma_f32_16x16x32_bf16 a[132:135], v[132:135], v[112:115], a[132:135]
    ds_read_b64_tr_b16 v[84:85], v249 offset:0
    v_mfma_f32_16x16x32_bf16 a[136:139], v[136:139], v[112:115], a[136:139]
    v_mfma_f32_16x16x32_bf16 a[140:143], v[140:143], v[112:115], a[140:143]
    ds_read_b64_tr_b16 v[86:87], v249 offset:2048
    v_mfma_f32_16x16x32_bf16 a[144:147], v[144:147], v[112:115], a[144:147]
    v_mfma_f32_16x16x32_bf16 a[148:151], v[148:151], v[112:115], a[148:151]
    ds_read_b128 v[52:55], v254 offset:10240
    v_mfma_f32_16x16x32_bf16 a[152:155], v[152:155], v[112:115], a[152:155]
    buffer_load_dwordx4 v233, s[4:7], s21 offen offset:1024 lds
    v_mfma_f32_16x16x32_bf16 a[156:159], v[156:159], v[112:115], a[156:159]
    ds_read_b64_tr_b16 v[88:89], v250 offset:0
    v_mfma_f32_16x16x32_bf16 a[188:191], v[156:159], v[116:119], a[188:191]
    v_mfma_f32_16x16x32_bf16 a[184:187], v[152:155], v[116:119], a[184:187]
    ds_read_b64_tr_b16 v[90:91], v250 offset:2048
    v_mfma_f32_16x16x32_bf16 a[180:183], v[148:151], v[116:119], a[180:183]
    v_mfma_f32_16x16x32_bf16 a[176:179], v[144:147], v[116:119], a[176:179]
    ds_read_b128 v[56:59], v254 offset:12288
    v_mfma_f32_16x16x32_bf16 a[172:175], v[140:143], v[116:119], a[172:175]
    buffer_load_dwordx4 v234, s[4:7], s21 offen offset:2048 lds
    v_mfma_f32_16x16x32_bf16 a[168:171], v[136:139], v[116:119], a[168:171]
    ds_read_b64_tr_b16 v[92:93], v251 offset:0
    v_mfma_f32_16x16x32_bf16 a[164:167], v[132:135], v[116:119], a[164:167]
    v_mfma_f32_16x16x32_bf16 a[160:163], v[128:131], v[116:119], a[160:163]
    ds_read_b64_tr_b16 v[94:95], v251 offset:2048
    v_mfma_f32_16x16x32_bf16 a[192:195], v[128:131], v[120:123], a[192:195]
    v_mfma_f32_16x16x32_bf16 a[196:199], v[132:135], v[120:123], a[196:199]
    ds_read_b128 v[60:63], v254 offset:14336
    v_mfma_f32_16x16x32_bf16 a[200:203], v[136:139], v[120:123], a[200:203]
    buffer_load_dwordx4 v235, s[4:7], s21 offen offset:3072 lds
    v_mfma_f32_16x16x32_bf16 a[204:207], v[140:143], v[120:123], a[204:207]
    v_mfma_f32_16x16x32_bf16 a[208:211], v[144:147], v[120:123], a[208:211]
    v_mfma_f32_16x16x32_bf16 a[212:215], v[148:151], v[120:123], a[212:215]
    v_mfma_f32_16x16x32_bf16 a[216:219], v[152:155], v[120:123], a[216:219]
    v_mfma_f32_16x16x32_bf16 a[220:223], v[156:159], v[120:123], a[220:223]
    v_mfma_f32_16x16x32_bf16 a[252:255], v[156:159], v[124:127], a[252:255]
    v_mfma_f32_16x16x32_bf16 a[248:251], v[152:155], v[124:127], a[248:251]
    v_mfma_f32_16x16x32_bf16 a[244:247], v[148:151], v[124:127], a[244:247]
    v_mfma_f32_16x16x32_bf16 a[240:243], v[144:147], v[124:127], a[240:243]
    v_mfma_f32_16x16x32_bf16 a[236:239], v[140:143], v[124:127], a[236:239]
    buffer_store_dwordx4 v[20:23], v1, s[12:15], s78 offen offset:3072 sc1
    v_mfma_f32_16x16x32_bf16 a[232:235], v[136:139], v[124:127], a[232:235]
    s_mov_b32 s78, s95
    s_mov_b32 s95, s96
    v_mfma_f32_16x16x32_bf16 a[228:231], v[132:135], v[124:127], a[228:231]
    s_mov_b32 s96, s97
    s_mov_b32 s97, 268435456
    v_mfma_f32_16x16x32_bf16 a[224:227], v[128:131], v[124:127], a[224:227]
    s_sub_u32 s35, s35, 1
    s_cmp_lg_u32 s35, 0
    s_cbranch_scc1 G_K_loop
    s_waitcnt vmcnt(24) lgkmcnt(0)
    s_barrier
    v_mfma_f32_16x16x32_bf16 a[0:3], v[64:67], v[32:35], a[0:3]
    v_mfma_f32_16x16x32_bf16 a[4:7], v[68:71], v[32:35], a[4:7]
    v_mfma_f32_16x16x32_bf16 a[8:11], v[72:75], v[32:35], a[8:11]
    v_mfma_f32_16x16x32_bf16 a[12:15], v[76:79], v[32:35], a[12:15]
    ds_read_b64_tr_b16 v[128:129], v244 offset:16384
    s_add_u32 m0, s24, 0
    v_mfma_f32_16x16x32_bf16 a[16:19], v[80:83], v[32:35], a[16:19]
    buffer_load_dwordx4 v240, s[8:11], s20 offen offset:0 nt lds
    v_mfma_f32_16x16x32_bf16 a[20:23], v[84:87], v[32:35], a[20:23]
    ds_read_b64_tr_b16 v[130:131], v244 offset:18432
    v_mfma_f32_16x16x32_bf16 a[24:27], v[88:91], v[32:35], a[24:27]
    buffer_load_dword v24, v1, s[44:47], s48 offen
    v_mfma_f32_16x16x32_bf16 a[28:31], v[92:95], v[32:35], a[28:31]
    ds_read_b128 v[96:99], v255 offset:0
    s_mul_i32 s38, s30, 229376
    v_mfma_f32_16x16x32_bf16 a[60:63], v[92:95], v[36:39], a[60:63]
    v_mfma_f32_16x16x32_bf16 a[56:59], v[88:91], v[36:39], a[56:59]
    ds_read_b64_tr_b16 v[132:133], v245 offset:16384
    s_add_u32 s38, s38, 35651584
    v_mfma_f32_16x16x32_bf16 a[52:55], v[84:87], v[36:39], a[52:55]
    buffer_load_dwordx4 v241, s[8:11], s20 offen offset:1024 nt lds
    v_mfma_f32_16x16x32_bf16 a[48:51], v[80:83], v[36:39], a[48:51]
    ds_read_b64_tr_b16 v[134:135], v245 offset:18432
    v_mfma_f32_16x16x32_bf16 a[44:47], v[76:79], v[36:39], a[44:47]
    s_sub_u32 s36, 3, s66
    v_mfma_f32_16x16x32_bf16 a[40:43], v[72:75], v[36:39], a[40:43]
    ds_read_b128 v[100:103], v255 offset:2048
    v_mfma_f32_16x16x32_bf16 a[36:39], v[68:71], v[36:39], a[36:39]
    v_mfma_f32_16x16x32_bf16 a[32:35], v[64:67], v[36:39], a[32:35]
    ds_read_b64_tr_b16 v[136:137], v246 offset:16384
    v_mfma_f32_16x16x32_bf16 a[64:67], v[64:67], v[40:43], a[64:67]
    buffer_load_dwordx4 v242, s[8:11], s20 offen offset:2048 nt lds
    v_mfma_f32_16x16x32_bf16 a[68:71], v[68:71], v[40:43], a[68:71]
    ds_read_b64_tr_b16 v[138:139], v246 offset:18432
    v_mfma_f32_16x16x32_bf16 a[72:75], v[72:75], v[40:43], a[72:75]
    s_cmp_lt_u32 s68, 14
    s_cselect_b32 s26, s36, s66
    v_mfma_f32_16x16x32_bf16 a[76:79], v[76:79], v[40:43], a[76:79]
    ds_read_b128 v[104:107], v255 offset:4096
    v_mfma_f32_16x16x32_bf16 a[80:83], v[80:83], v[40:43], a[80:83]
    v_mfma_f32_16x16x32_bf16 a[84:87], v[84:87], v[40:43], a[84:87]
    ds_read_b64_tr_b16 v[140:141], v247 offset:16384
    s_lshl_b32 s36, s33, 2
    v_mfma_f32_16x16x32_bf16 a[88:91], v[88:91], v[40:43], a[88:91]
    buffer_load_dwordx4 v243, s[8:11], s20 offen offset:3072 nt lds
    v_mfma_f32_16x16x32_bf16 a[92:95], v[92:95], v[40:43], a[92:95]
    ds_read_b64_tr_b16 v[142:143], v247 offset:18432
    s_add_u32 s20, s20, 262144
    v_mfma_f32_16x16x32_bf16 a[124:127], v[92:95], v[44:47], a[124:127]
    s_add_u32 s26, s26, s36
    v_mfma_f32_16x16x32_bf16 a[120:123], v[88:91], v[44:47], a[120:123]
    ds_read_b128 v[108:111], v255 offset:6144
    v_mfma_f32_16x16x32_bf16 a[116:119], v[84:87], v[44:47], a[116:119]
    v_mfma_f32_16x16x32_bf16 a[112:115], v[80:83], v[44:47], a[112:115]
    ds_read_b64_tr_b16 v[144:145], v248 offset:16384
    s_mul_i32 s36, s26, 28672
    v_mfma_f32_16x16x32_bf16 a[108:111], v[76:79], v[44:47], a[108:111]
    v_mfma_f32_16x16x32_bf16 a[104:107], v[72:75], v[44:47], a[104:107]
    ds_read_b64_tr_b16 v[146:147], v248 offset:18432
    v_mfma_f32_16x16x32_bf16 a[100:103], v[68:71], v[44:47], a[100:103]
    s_add_u32 s36, s36, 33554432
    v_mfma_f32_16x16x32_bf16 a[96:99], v[64:67], v[44:47], a[96:99]
    ds_read_b128 v[112:115], v255 offset:8192
    s_add_u32 m0, s22, s29
    v_mfma_f32_16x16x32_bf16 a[128:131], v[64:67], v[48:51], a[128:131]
    buffer_load_dwordx4 v236, s[4:7], s21 offen offset:0 lds
    v_mfma_f32_16x16x32_bf16 a[132:135], v[68:71], v[48:51], a[132:135]
    ds_read_b64_tr_b16 v[148:149], v249 offset:16384
    s_add_u32 s35, s36, 4096
    v_mfma_f32_16x16x32_bf16 a[136:139], v[72:75], v[48:51], a[136:139]
    v_mfma_f32_16x16x32_bf16 a[140:143], v[76:79], v[48:51], a[140:143]
    ds_read_b64_tr_b16 v[150:151], v249 offset:18432
    v_mfma_f32_16x16x32_bf16 a[144:147], v[80:83], v[48:51], a[144:147]
    s_add_u32 s72, s36, 8192
    v_mfma_f32_16x16x32_bf16 a[148:151], v[84:87], v[48:51], a[148:151]
    ds_read_b128 v[116:119], v255 offset:10240
    v_mfma_f32_16x16x32_bf16 a[152:155], v[88:91], v[48:51], a[152:155]
    buffer_load_dwordx4 v237, s[4:7], s21 offen offset:1024 lds
    v_mfma_f32_16x16x32_bf16 a[156:159], v[92:95], v[48:51], a[156:159]
    ds_read_b64_tr_b16 v[152:153], v250 offset:16384
    s_add_u32 s73, s36, 12288
    v_mfma_f32_16x16x32_bf16 a[188:191], v[92:95], v[52:55], a[188:191]
    v_mfma_f32_16x16x32_bf16 a[184:187], v[88:91], v[52:55], a[184:187]
    ds_read_b64_tr_b16 v[154:155], v250 offset:18432
    v_mfma_f32_16x16x32_bf16 a[180:183], v[84:87], v[52:55], a[180:183]
    v_add_u32 v5, 14336, v1
    v_mfma_f32_16x16x32_bf16 a[176:179], v[80:83], v[52:55], a[176:179]
    ds_read_b128 v[120:123], v255 offset:12288
    v_mfma_f32_16x16x32_bf16 a[172:175], v[76:79], v[52:55], a[172:175]
    buffer_load_dwordx4 v238, s[4:7], s21 offen offset:2048 lds
    v_mfma_f32_16x16x32_bf16 a[168:171], v[72:75], v[52:55], a[168:171]
    ds_read_b64_tr_b16 v[156:157], v251 offset:16384
    s_and_b32 s3, s66, 1
    v_mfma_f32_16x16x32_bf16 a[164:167], v[68:71], v[52:55], a[164:167]
    v_mfma_f32_16x16x32_bf16 a[160:163], v[64:67], v[52:55], a[160:163]
    ds_read_b64_tr_b16 v[158:159], v251 offset:18432
    v_mfma_f32_16x16x32_bf16 a[192:195], v[64:67], v[56:59], a[192:195]
    s_lshl_b32 s3, s3, 12
    v_mfma_f32_16x16x32_bf16 a[196:199], v[68:71], v[56:59], a[196:199]
    ds_read_b128 v[124:127], v255 offset:14336
    v_mfma_f32_16x16x32_bf16 a[200:203], v[72:75], v[56:59], a[200:203]
    buffer_load_dwordx4 v239, s[4:7], s21 offen offset:3072 lds
    v_mfma_f32_16x16x32_bf16 a[204:207], v[76:79], v[56:59], a[204:207]
    s_add_u32 s21, s21, 128
    s_add_u32 s22, s22, 32768
    v_mfma_f32_16x16x32_bf16 a[208:211], v[80:83], v[56:59], a[208:211]
    s_cmp_eq_u32 s22, 163840
    s_cselect_b32 s22, 65536, s22
    v_mfma_f32_16x16x32_bf16 a[212:215], v[84:87], v[56:59], a[212:215]
    s_add_u32 s91, s34, s3
    v_mfma_f32_16x16x32_bf16 a[216:219], v[88:91], v[56:59], a[216:219]
    buffer_load_dword v9, off, s[16:19], 0 sc1
    v_mfma_f32_16x16x32_bf16 a[220:223], v[92:95], v[56:59], a[220:223]
    v_mfma_f32_16x16x32_bf16 a[252:255], v[92:95], v[60:63], a[252:255]
    v_mfma_f32_16x16x32_bf16 a[248:251], v[88:91], v[60:63], a[248:251]
    v_mfma_f32_16x16x32_bf16 a[244:247], v[84:87], v[60:63], a[244:247]
    v_mfma_f32_16x16x32_bf16 a[240:243], v[80:83], v[60:63], a[240:243]
    v_mfma_f32_16x16x32_bf16 a[236:239], v[76:79], v[60:63], a[236:239]
    v_mfma_f32_16x16x32_bf16 a[232:235], v[72:75], v[60:63], a[232:235]
    v_mfma_f32_16x16x32_bf16 a[228:231], v[68:71], v[60:63], a[228:231]
    v_mfma_f32_16x16x32_bf16 a[224:227], v[64:67], v[60:63], a[224:227]
    s_waitcnt vmcnt(20) lgkmcnt(0)
    s_barrier
    v_mfma_f32_16x16x32_bf16 a[0:3], v[128:131], v[96:99], a[0:3]
    s_add_u32 s25, s25, 32768
    v_mfma_f32_16x16x32_bf16 a[4:7], v[132:135], v[96:99], a[4:7]
    s_cmp_eq_u32 s25, 163840
    s_cselect_b32 s25, 65536, s25
    v_mfma_f32_16x16x32_bf16 a[8:11], v[136:139], v[96:99], a[8:11]
    v_mfma_f32_16x16x32_bf16 a[12:15], v[140:143], v[96:99], a[12:15]
    ds_read_b64_tr_b16 v[64:65], v244 offset:32768
    s_add_u32 m0, s24, 16384
    v_mfma_f32_16x16x32_bf16 a[16:19], v[144:147], v[96:99], a[16:19]
    buffer_load_dwordx4 v240, s[8:11], s20 offen offset:0 nt lds
    v_mfma_f32_16x16x32_bf16 a[20:23], v[148:151], v[96:99], a[20:23]
    v_add_u32 v254, s25, v252
    ds_read_b64_tr_b16 v[66:67], v244 offset:34816
    v_mfma_f32_16x16x32_bf16 a[24:27], v[152:155], v[96:99], a[24:27]
    v_add_u32 v255, s25, v253
    v_mfma_f32_16x16x32_bf16 a[28:31], v[156:159], v[96:99], a[28:31]
    ds_read_b128 v[32:35], v254 offset:0
    v_mfma_f32_16x16x32_bf16 a[60:63], v[156:159], v[100:103], a[60:63]
    v_mfma_f32_16x16x32_bf16 a[56:59], v[152:155], v[100:103], a[56:59]
    ds_read_b64_tr_b16 v[68:69], v245 offset:32768
    v_mfma_f32_16x16x32_bf16 a[52:55], v[148:151], v[100:103], a[52:55]
    buffer_load_dwordx4 v241, s[8:11], s20 offen offset:1024 nt lds
    v_mfma_f32_16x16x32_bf16 a[48:51], v[144:147], v[100:103], a[48:51]
    ds_read_b64_tr_b16 v[70:71], v245 offset:34816
    v_mfma_f32_16x16x32_bf16 a[44:47], v[140:143], v[100:103], a[44:47]
    v_mfma_f32_16x16x32_bf16 a[40:43], v[136:139], v[100:103], a[40:43]
    ds_read_b128 v[36:39], v254 offset:2048
    v_mfma_f32_16x16x32_bf16 a[36:39], v[132:135], v[100:103], a[36:39]
    v_mfma_f32_16x16x32_bf16 a[32:35], v[128:131], v[100:103], a[32:35]
    ds_read_b64_tr_b16 v[72:73], v246 offset:32768
    v_mfma_f32_16x16x32_bf16 a[64:67], v[128:131], v[104:107], a[64:67]
    buffer_load_dwordx4 v242, s[8:11], s20 offen offset:2048 nt lds
    v_mfma_f32_16x16x32_bf16 a[68:71], v[132:135], v[104:107], a[68:71]
    ds_read_b64_tr_b16 v[74:75], v246 offset:34816
    v_mfma_f32_16x16x32_bf16 a[72:75], v[136:139], v[104:107], a[72:75]
    v_mfma_f32_16x16x32_bf16 a[76:79], v[140:143], v[104:107], a[76:79]
    ds_read_b128 v[40:43], v254 offset:4096
    v_mfma_f32_16x16x32_bf16 a[80:83], v[144:147], v[104:107], a[80:83]
    v_mfma_f32_16x16x32_bf16 a[84:87], v[148:151], v[104:107], a[84:87]
    ds_read_b64_tr_b16 v[76:77], v247 offset:32768
    v_mfma_f32_16x16x32_bf16 a[88:91], v[152:155], v[104:107], a[88:91]
    buffer_load_dwordx4 v243, s[8:11], s20 offen offset:3072 nt lds
    v_mfma_f32_16x16x32_bf16 a[92:95], v[156:159], v[104:107], a[92:95]
    ds_read_b64_tr_b16 v[78:79], v247 offset:34816
    s_add_u32 s20, s20, 262144
    v_mfma_f32_16x16x32_bf16 a[124:127], v[156:159], v[108:111], a[124:127]
    v_mfma_f32_16x16x32_bf16 a[120:123], v[152:155], v[108:111], a[120:123]
    ds_read_b128 v[44:47], v254 offset:6144
    v_mfma_f32_16x16x32_bf16 a[116:119], v[148:151], v[108:111], a[116:119]
    v_mfma_f32_16x16x32_bf16 a[112:115], v[144:147], v[108:111], a[112:115]
    ds_read_b64_tr_b16 v[80:81], v248 offset:32768
    v_mfma_f32_16x16x32_bf16 a[108:111], v[140:143], v[108:111], a[108:111]
    v_mfma_f32_16x16x32_bf16 a[104:107], v[136:139], v[108:111], a[104:107]
    ds_read_b64_tr_b16 v[82:83], v248 offset:34816
    v_mfma_f32_16x16x32_bf16 a[100:103], v[132:135], v[108:111], a[100:103]
    v_mfma_f32_16x16x32_bf16 a[96:99], v[128:131], v[108:111], a[96:99]
    ds_read_b128 v[48:51], v254 offset:8192
    s_add_u32 m0, s22, s37
    v_mfma_f32_16x16x32_bf16 a[128:131], v[128:131], v[112:115], a[128:131]
    buffer_load_dwordx4 v232, s[4:7], s21 offen offset:0 lds
    v_mfma_f32_16x16x32_bf16 a[132:135], v[132:135], v[112:115], a[132:135]
    ds_read_b64_tr_b16 v[84:85], v249 offset:32768
    v_mfma_f32_16x16x32_bf16 a[136:139], v[136:139], v[112:115], a[136:139]
    v_mfma_f32_16x16x32_bf16 a[140:143], v[140:143], v[112:115], a[140:143]
    ds_read_b64_tr_b16 v[86:87], v249 offset:34816
    v_mfma_f32_16x16x32_bf16 a[144:147], v[144:147], v[112:115], a[144:147]
    v_mfma_f32_16x16x32_bf16 a[148:151], v[148:151], v[112:115], a[148:151]
    ds_read_b128 v[52:55], v254 offset:10240
    v_mfma_f32_16x16x32_bf16 a[152:155], v[152:155], v[112:115], a[152:155]
    buffer_load_dwordx4 v233, s[4:7], s21 offen offset:1024 lds
    v_mfma_f32_16x16x32_bf16 a[156:159], v[156:159], v[112:115], a[156:159]
    ds_read_b64_tr_b16 v[88:89], v250 offset:32768
    v_mfma_f32_16x16x32_bf16 a[188:191], v[156:159], v[116:119], a[188:191]
    v_mfma_f32_16x16x32_bf16 a[184:187], v[152:155], v[116:119], a[184:187]
    ds_read_b64_tr_b16 v[90:91], v250 offset:34816
    v_mfma_f32_16x16x32_bf16 a[180:183], v[148:151], v[116:119], a[180:183]
    v_mfma_f32_16x16x32_bf16 a[176:179], v[144:147], v[116:119], a[176:179]
    ds_read_b128 v[56:59], v254 offset:12288
    v_mfma_f32_16x16x32_bf16 a[172:175], v[140:143], v[116:119], a[172:175]
    buffer_load_dwordx4 v234, s[4:7], s21 offen offset:2048 lds
    v_mfma_f32_16x16x32_bf16 a[168:171], v[136:139], v[116:119], a[168:171]
    ds_read_b64_tr_b16 v[92:93], v251 offset:32768
    v_mfma_f32_16x16x32_bf16 a[164:167], v[132:135], v[116:119], a[164:167]
    v_mfma_f32_16x16x32_bf16 a[160:163], v[128:131], v[116:119], a[160:163]
    ds_read_b64_tr_b16 v[94:95], v251 offset:34816
    v_mfma_f32_16x16x32_bf16 a[192:195], v[128:131], v[120:123], a[192:195]
    v_mfma_f32_16x16x32_bf16 a[196:199], v[132:135], v[120:123], a[196:199]
    ds_read_b128 v[60:63], v254 offset:14336
    v_mfma_f32_16x16x32_bf16 a[200:203], v[136:139], v[120:123], a[200:203]
    buffer_load_dwordx4 v235, s[4:7], s21 offen offset:3072 lds
    v_mfma_f32_16x16x32_bf16 a[204:207], v[140:143], v[120:123], a[204:207]
    v_mfma_f32_16x16x32_bf16 a[208:211], v[144:147], v[120:123], a[208:211]
    v_mfma_f32_16x16x32_bf16 a[212:215], v[148:151], v[120:123], a[212:215]
    v_mfma_f32_16x16x32_bf16 a[216:219], v[152:155], v[120:123], a[216:219]
    v_mfma_f32_16x16x32_bf16 a[220:223], v[156:159], v[120:123], a[220:223]
    v_mfma_f32_16x16x32_bf16 a[252:255], v[156:159], v[124:127], a[252:255]
    v_mfma_f32_16x16x32_bf16 a[248:251], v[152:155], v[124:127], a[248:251]
    v_mfma_f32_16x16x32_bf16 a[244:247], v[148:151], v[124:127], a[244:247]
    v_mfma_f32_16x16x32_bf16 a[240:243], v[144:147], v[124:127], a[240:243]
    v_mfma_f32_16x16x32_bf16 a[236:239], v[140:143], v[124:127], a[236:239]
    v_mfma_f32_16x16x32_bf16 a[232:235], v[136:139], v[124:127], a[232:235]
    v_mfma_f32_16x16x32_bf16 a[228:231], v[132:135], v[124:127], a[228:231]
    v_mfma_f32_16x16x32_bf16 a[224:227], v[128:131], v[124:127], a[224:227]
    s_waitcnt vmcnt(23) lgkmcnt(0)
    s_barrier
    v_mfma_f32_16x16x32_bf16 a[0:3], v[64:67], v[32:35], a[0:3]
    v_mfma_f32_16x16x32_bf16 a[4:7], v[68:71], v[32:35], a[4:7]
    v_mfma_f32_16x16x32_bf16 a[8:11], v[72:75], v[32:35], a[8:11]
    v_mfma_f32_16x16x32_bf16 a[12:15], v[76:79], v[32:35], a[12:15]
    ds_read_b64_tr_b16 v[128:129], v244 offset:49152
    s_add_u32 m0, s24, 32768
    v_mfma_f32_16x16x32_bf16 a[16:19], v[80:83], v[32:35], a[16:19]
    buffer_load_dwordx4 v240, s[8:11], s20 offen offset:0 nt lds
    v_mfma_f32_16x16x32_bf16 a[20:23], v[84:87], v[32:35], a[20:23]
    ds_read_b64_tr_b16 v[130:131], v244 offset:51200
    v_mfma_f32_16x16x32_bf16 a[24:27], v[88:91], v[32:35], a[24:27]
    v_mfma_f32_16x16x32_bf16 a[28:31], v[92:95], v[32:35], a[28:31]
    ds_read_b128 v[96:99], v255 offset:0
    v_mfma_f32_16x16x32_bf16 a[60:63], v[92:95], v[36:39], a[60:63]
    v_mfma_f32_16x16x32_bf16 a[56:59], v[88:91], v[36:39], a[56:59]
    ds_read_b64_tr_b16 v[132:133], v245 offset:49152
    v_mfma_f32_16x16x32_bf16 a[52:55], v[84:87], v[36:39], a[52:55]
    buffer_load_dwordx4 v241, s[8:11], s20 offen offset:1024 nt lds
    v_mfma_f32_16x16x32_bf16 a[48:51], v[80:83], v[36:39], a[48:51]
    ds_read_b64_tr_b16 v[134:135], v245 offset:51200
    v_mfma_f32_16x16x32_bf16 a[44:47], v[76:79], v[36:39], a[44:47]
    v_mfma_f32_16x16x32_bf16 a[40:43], v[72:75], v[36:39], a[40:43]
    ds_read_b128 v[100:103], v255 offset:2048
    v_mfma_f32_16x16x32_bf16 a[36:39], v[68:71], v[36:39], a[36:39]
    v_mfma_f32_16x16x32_bf16 a[32:35], v[64:67], v[36:39], a[32:35]
    ds_read_b64_tr_b16 v[136:137], v246 offset:49152
    v_mfma_f32_16x16x32_bf16 a[64:67], v[64:67], v[40:43], a[64:67]
    buffer_load_dwordx4 v242, s[8:11], s20 offen offset:2048 nt lds
    v_mfma_f32_16x16x32_bf16 a[68:71], v[68:71], v[40:43], a[68:71]
    ds_read_b64_tr_b16 v[138:139], v246 offset:51200
    v_mfma_f32_16x16x32_bf16 a[72:75], v[72:75], v[40:43], a[72:75]
    v_mfma_f32_16x16x32_bf16 a[76:79], v[76:79], v[40:43], a[76:79]
    ds_read_b128 v[104:107], v255 offset:4096
    v_mfma_f32_16x16x32_bf16 a[80:83], v[80:83], v[40:43], a[80:83]
    v_mfma_f32_16x16x32_bf16 a[84:87], v[84:87], v[40:43], a[84:87]
    ds_read_b64_tr_b16 v[140:141], v247 offset:49152
    v_mfma_f32_16x16x32_bf16 a[88:91], v[88:91], v[40:43], a[88:91]
    buffer_load_dwordx4 v243, s[8:11], s20 offen offset:3072 nt lds
    v_mfma_f32_16x16x32_bf16 a[92:95], v[92:95], v[40:43], a[92:95]
    ds_read_b64_tr_b16 v[142:143], v247 offset:51200
    s_add_u32 s20, s20, 262144
    v_mfma_f32_16x16x32_bf16 a[124:127], v[92:95], v[44:47], a[124:127]
    v_mfma_f32_16x16x32_bf16 a[120:123], v[88:91], v[44:47], a[120:123]
    ds_read_b128 v[108:111], v255 offset:6144
    v_mfma_f32_16x16x32_bf16 a[116:119], v[84:87], v[44:47], a[116:119]
    v_mfma_f32_16x16x32_bf16 a[112:115], v[80:83], v[44:47], a[112:115]
    ds_read_b64_tr_b16 v[144:145], v248 offset:49152
    v_mfma_f32_16x16x32_bf16 a[108:111], v[76:79], v[44:47], a[108:111]
    v_mfma_f32_16x16x32_bf16 a[104:107], v[72:75], v[44:47], a[104:107]
    ds_read_b64_tr_b16 v[146:147], v248 offset:51200
    v_mfma_f32_16x16x32_bf16 a[100:103], v[68:71], v[44:47], a[100:103]
    v_mfma_f32_16x16x32_bf16 a[96:99], v[64:67], v[44:47], a[96:99]
    ds_read_b128 v[112:115], v255 offset:8192
    s_add_u32 m0, s22, s29
    v_mfma_f32_16x16x32_bf16 a[128:131], v[64:67], v[48:51], a[128:131]
    buffer_load_dwordx4 v236, s[4:7], s21 offen offset:0 lds
    v_mfma_f32_16x16x32_bf16 a[132:135], v[68:71], v[48:51], a[132:135]
    ds_read_b64_tr_b16 v[148:149], v249 offset:49152
    v_mfma_f32_16x16x32_bf16 a[136:139], v[72:75], v[48:51], a[136:139]
    v_mfma_f32_16x16x32_bf16 a[140:143], v[76:79], v[48:51], a[140:143]
    ds_read_b64_tr_b16 v[150:151], v249 offset:51200
    s_waitcnt vmcnt(13)
    v_mfma_f32_16x16x32_bf16 a[144:147], v[80:83], v[48:51], a[144:147]
    v_cmp_gt_u32 vcc, 0x100, v9
    v_mfma_f32_16x16x32_bf16 a[148:151], v[84:87], v[48:51], a[148:151]
    ds_read_b128 v[116:119], v255 offset:10240
    v_mfma_f32_16x16x32_bf16 a[152:155], v[88:91], v[48:51], a[152:155]
    buffer_load_dwordx4 v237, s[4:7], s21 offen offset:1024 lds
    v_mfma_f32_16x16x32_bf16 a[156:159], v[92:95], v[48:51], a[156:159]
    ds_read_b64_tr_b16 v[152:153], v250 offset:49152
    s_nop 0
    v_mfma_f32_16x16x32_bf16 a[188:191], v[92:95], v[52:55], a[188:191]
    s_nop 0
    v_mfma_f32_16x16x32_bf16 a[184:187], v[88:91], v[52:55], a[184:187]
    ds_read_b64_tr_b16 v[154:155], v250 offset:51200
    s_cbranch_vccnz G_K_spin
G_K_spinback:
    v_mfma_f32_16x16x32_bf16 a[180:183], v[84:87], v[52:55], a[180:183]
    v_mfma_f32_16x16x32_bf16 a[176:179], v[80:83], v[52:55], a[176:179]
    ds_read_b128 v[120:123], v255 offset:12288
    s_mul_i32 s93, s2, 384
    v_mfma_f32_16x16x32_bf16 a[172:175], v[76:79], v[52:55], a[172:175]
    buffer_load_dwordx4 v238, s[4:7], s21 offen offset:2048 lds
    v_mfma_f32_16x16x32_bf16 a[168:171], v[72:75], v[52:55], a[168:171]
    ds_read_b64_tr_b16 v[156:157], v251 offset:49152
    s_add_u32 s93, s93, 111149056
    v_mfma_f32_16x16x32_bf16 a[164:167], v[68:71], v[52:55], a[164:167]
    s_mul_i32 s3, s67, 384
    v_mfma_f32_16x16x32_bf16 a[160:163], v[64:67], v[52:55], a[160:163]
    ds_read_b64_tr_b16 v[158:159], v251 offset:51200
    v_mfma_f32_16x16x32_bf16 a[192:195], v[64:67], v[56:59], a[192:195]
    s_add_u32 s3, s3, 111149056
    v_mfma_f32_16x16x32_bf16 a[196:199], v[68:71], v[56:59], a[196:199]
    ds_read_b128 v[124:127], v255 offset:14336
    v_mfma_f32_16x16x32_bf16 a[200:203], v[72:75], v[56:59], a[200:203]
    buffer_load_dwordx4 v239, s[4:7], s21 offen offset:3072 lds
    v_mfma_f32_16x16x32_bf16 a[204:207], v[76:79], v[56:59], a[204:207]
    s_add_u32 s21, s21, 128
    s_add_u32 s22, s22, 32768
    v_mfma_f32_16x16x32_bf16 a[208:211], v[80:83], v[56:59], a[208:211]
    s_cmp_eq_u32 s22, 163840
    s_cselect_b32 s22, 65536, s22
    v_mfma_f32_16x16x32_bf16 a[212:215], v[84:87], v[56:59], a[212:215]
    v_and_b32 v9, 31, v2
    v_mul_u32_u24 v9, 3072, v9
    v_mfma_f32_16x16x32_bf16 a[216:219], v[88:91], v[56:59], a[216:219]
    buffer_load_dword v28, v9, s[12:15], s3 offen sc1
    v_mfma_f32_16x16x32_bf16 a[220:223], v[92:95], v[56:59], a[220:223]
    s_and_b32 s94, s2, 15
    v_mfma_f32_16x16x32_bf16 a[252:255], v[92:95], v[60:63], a[252:255]
    s_mul_i32 s94, s94, 384
    v_mfma_f32_16x16x32_bf16 a[248:251], v[88:91], v[60:63], a[248:251]
    v_mfma_f32_16x16x32_bf16 a[244:247], v[84:87], v[60:63], a[244:247]
    s_add_u32 s94, s94, 111149056
    v_mfma_f32_16x16x32_bf16 a[240:243], v[80:83], v[60:63], a[240:243]
    v_mfma_f32_16x16x32_bf16 a[236:239], v[76:79], v[60:63], a[236:239]
    v_mfma_f32_16x16x32_bf16 a[232:235], v[72:75], v[60:63], a[232:235]
    v_mfma_f32_16x16x32_bf16 a[228:231], v[68:71], v[60:63], a[228:231]
    v_mfma_f32_16x16x32_bf16 a[224:227], v[64:67], v[60:63], a[224:227]
    s_waitcnt vmcnt(18) lgkmcnt(0)
    s_barrier
    v_mfma_f32_16x16x32_bf16 a[0:3], v[128:131], v[96:99], a[0:3]
    s_add_u32 s25, s25, 32768
    v_mfma_f32_16x16x32_bf16 a[4:7], v[132:135], v[96:99], a[4:7]
    s_cmp_eq_u32 s25, 163840
    s_cselect_b32 s25, 65536, s25
    v_mfma_f32_16x16x32_bf16 a[8:11], v[136:139], v[96:99], a[8:11]
    v_mfma_f32_16x16x32_bf16 a[12:15], v[140:143], v[96:99], a[12:15]
    ds_read_b64_tr_b16 v[64:65], v244 offset:0
    s_add_u32 m0, s24, 49152
    v_mfma_f32_16x16x32_bf16 a[16:19], v[144:147], v[96:99], a[16:19]
    buffer_load_dwordx4 v240, s[8:11], s20 offen offset:0 nt lds
    v_mfma_f32_16x16x32_bf16 a[20:23], v[148:151], v[96:99], a[20:23]
    v_add_u32 v254, s25, v252
    ds_read_b64_tr_b16 v[66:67], v244 offset:2048
    v_mfma_f32_16x16x32_bf16 a[24:27], v[152:155], v[96:99], a[24:27]
    v_add_u32 v255, s25, v253
    v_mfma_f32_16x16x32_bf16 a[28:31], v[156:159], v[96:99], a[28:31]
    ds_read_b128 v[32:35], v254 offset:0
    v_mfma_f32_16x16x32_bf16 a[60:63], v[156:159], v[100:103], a[60:63]
    buffer_load_dwordx4 v241, s[8:11], s20 offen offset:1024 nt lds
    v_mfma_f32_16x16x32_bf16 a[56:59], v[152:155], v[100:103], a[56:59]
    ds_read_b64_tr_b16 v[68:69], v245 offset:0
    v_mfma_f32_16x16x32_bf16 a[52:55], v[148:151], v[100:103], a[52:55]
    v_mfma_f32_16x16x32_bf16 a[48:51], v[144:147], v[100:103], a[48:51]
    ds_read_b64_tr_b16 v[70:71], v245 offset:2048
    v_mfma_f32_16x16x32_bf16 a[44:47], v[140:143], v[100:103], a[44:47]
    buffer_load_dwordx4 v242, s[8:11], s20 offen offset:2048 nt lds
    v_mfma_f32_16x16x32_bf16 a[40:43], v[136:139], v[100:103], a[40:43]
    ds_read_b128 v[36:39], v254 offset:2048
    v_mfma_f32_16x16x32_bf16 a[36:39], v[132:135], v[100:103], a[36:39]
    v_mfma_f32_16x16x32_bf16 a[32:35], v[128:131], v[100:103], a[32:35]
    ds_read_b64_tr_b16 v[72:73], v246 offset:0
    v_mfma_f32_16x16x32_bf16 a[64:67], v[128:131], v[104:107], a[64:67]
    buffer_load_dwordx4 v243, s[8:11], s20 offen offset:3072 nt lds
    v_mfma_f32_16x16x32_bf16 a[68:71], v[132:135], v[104:107], a[68:71]
    ds_read_b64_tr_b16 v[74:75], v246 offset:2048
    s_add_u32 s20, s20, 262144
    v_mfma_f32_16x16x32_bf16 a[72:75], v[136:139], v[104:107], a[72:75]
    v_mfma_f32_16x16x32_bf16 a[76:79], v[140:143], v[104:107], a[76:79]
    ds_read_b128 v[40:43], v254 offset:4096
    v_mfma_f32_16x16x32_bf16 a[80:83], v[144:147], v[104:107], a[80:83]
    v_mfma_f32_16x16x32_bf16 a[84:87], v[148:151], v[104:107], a[84:87]
    ds_read_b64_tr_b16 v[76:77], v247 offset:0
    s_add_u32 s39, s38, 0
    s_add_u32 m0, s24, 98304
    v_mfma_f32_16x16x32_bf16 a[88:91], v[152:155], v[104:107], a[88:91]
    buffer_load_dwordx4 v4, s[12:15], s39 offen offset:0 lds
    v_mfma_f32_16x16x32_bf16 a[92:95], v[156:159], v[104:107], a[92:95]
    ds_read_b64_tr_b16 v[78:79], v247 offset:2048
    v_mfma_f32_16x16x32_bf16 a[124:127], v[156:159], v[108:111], a[124:127]
    v_mfma_f32_16x16x32_bf16 a[120:123], v[152:155], v[108:111], a[120:123]
    ds_read_b128 v[44:47], v254 offset:6144
    v_mfma_f32_16x16x32_bf16 a[116:119], v[148:151], v[108:111], a[116:119]
    buffer_load_dwordx4 v4, s[12:15], s39 offen offset:1024 lds
    v_mfma_f32_16x16x32_bf16 a[112:115], v[144:147], v[108:111], a[112:115]
    ds_read_b64_tr_b16 v[80:81], v248 offset:0
    v_mfma_f32_16x16x32_bf16 a[108:111], v[140:143], v[108:111], a[108:111]
    v_mfma_f32_16x16x32_bf16 a[104:107], v[136:139], v[108:111], a[104:107]
    ds_read_b64_tr_b16 v[82:83], v248 offset:2048
    v_mfma_f32_16x16x32_bf16 a[100:103], v[132:135], v[108:111], a[100:103]
    buffer_load_dwordx4 v4, s[12:15], s39 offen offset:2048 lds
    v_mfma_f32_16x16x32_bf16 a[96:99], v[128:131], v[108:111], a[96:99]
    ds_read_b128 v[48:51], v254 offset:8192
    v_mfma_f32_16x16x32_bf16 a[128:131], v[128:131], v[112:115], a[128:131]
    v_mfma_f32_16x16x32_bf16 a[132:135], v[132:135], v[112:115], a[132:135]
    ds_read_b64_tr_b16 v[84:85], v249 offset:0
    v_mfma_f32_16x16x32_bf16 a[136:139], v[136:139], v[112:115], a[136:139]
    buffer_load_dwordx4 v4, s[12:15], s39 offen offset:3072 lds
    v_mfma_f32_16x16x32_bf16 a[140:143], v[140:143], v[112:115], a[140:143]
    ds_read_b64_tr_b16 v[86:87], v249 offset:2048
    v_mfma_f32_16x16x32_bf16 a[144:147], v[144:147], v[112:115], a[144:147]
    v_mfma_f32_16x16x32_bf16 a[148:151], v[148:151], v[112:115], a[148:151]
    ds_read_b128 v[52:55], v254 offset:10240
    v_mfma_f32_16x16x32_bf16 a[152:155], v[152:155], v[112:115], a[152:155]
    v_mfma_f32_16x16x32_bf16 a[156:159], v[156:159], v[112:115], a[156:159]
    ds_read_b64_tr_b16 v[88:89], v250 offset:0
    s_add_u32 s39, s38, 16384
    s_add_u32 m0, s24, 114688
    v_mfma_f32_16x16x32_bf16 a[188:191], v[156:159], v[116:119], a[188:191]
    buffer_load_dwordx4 v4, s[12:15], s39 offen offset:0 lds
    v_mfma_f32_16x16x32_bf16 a[184:187], v[152:155], v[116:119], a[184:187]
    ds_read_b64_tr_b16 v[90:91], v250 offset:2048
    v_mfma_f32_16x16x32_bf16 a[180:183], v[148:151], v[116:119], a[180:183]
    v_mfma_f32_16x16x32_bf16 a[176:179], v[144:147], v[116:119], a[176:179]
    ds_read_b128 v[56:59], v254 offset:12288
    v_mfma_f32_16x16x32_bf16 a[172:175], v[140:143], v[116:119], a[172:175]
    buffer_load_dwordx4 v4, s[12:15], s39 offen offset:1024 lds
    v_mfma_f32_16x16x32_bf16 a[168:171], v[136:139], v[116:119], a[168:171]
    ds_read_b64_tr_b16 v[92:93], v251 offset:0
    v_mfma_f32_16x16x32_bf16 a[164:167], v[132:135], v[116:119], a[164:167]
    v_mfma_f32_16x16x32_bf16 a[160:163], v[128:131], v[116:119], a[160:163]
    ds_read_b64_tr_b16 v[94:95], v251 offset:2048
    v_mfma_f32_16x16x32_bf16 a[192:195], v[128:131], v[120:123], a[192:195]
    buffer_load_dwordx4 v4, s[12:15], s39 offen offset:2048 lds
    v_mfma_f32_16x16x32_bf16 a[196:199], v[132:135], v[120:123], a[196:199]
    ds_read_b128 v[60:63], v254 offset:14336
    v_mfma_f32_16x16x32_bf16 a[200:203], v[136:139], v[120:123], a[200:203]
    v_mfma_f32_16x16x32_bf16 a[204:207], v[140:143], v[120:123], a[204:207]
    v_mfma_f32_16x16x32_bf16 a[208:211], v[144:147], v[120:123], a[208:211]
    buffer_load_dwordx4 v4, s[12:15], s39 offen offset:3072 lds
    v_mfma_f32_16x16x32_bf16 a[212:215], v[148:151], v[120:123], a[212:215]
    v_mfma_f32_16x16x32_bf16 a[216:219], v[152:155], v[120:123], a[216:219]
    v_mfma_f32_16x16x32_bf16 a[220:223], v[156:159], v[120:123], a[220:223]
    v_mfma_f32_16x16x32_bf16 a[252:255], v[156:159], v[124:127], a[252:255]
    v_mfma_f32_16x16x32_bf16 a[248:251], v[152:155], v[124:127], a[248:251]
    v_mfma_f32_16x16x32_bf16 a[244:247], v[148:151], v[124:127], a[244:247]
    v_mfma_f32_16x16x32_bf16 a[240:243], v[144:147], v[124:127], a[240:243]
    v_mfma_f32_16x16x32_bf16 a[236:239], v[140:143], v[124:127], a[236:239]
    v_mfma_f32_16x16x32_bf16 a[232:235], v[136:139], v[124:127], a[232:235]
    v_mfma_f32_16x16x32_bf16 a[228:231], v[132:135], v[124:127], a[228:231]
    v_mfma_f32_16x16x32_bf16 a[224:227], v[128:131], v[124:127], a[224:227]
    s_waitcnt vmcnt(25) lgkmcnt(0)
    s_barrier
    v_mfma_f32_16x16x32_bf16 a[0:3], v[64:67], v[32:35], a[0:3]
    v_mfma_f32_16x16x32_bf16 a[4:7], v[68:71], v[32:35], a[4:7]
    v_mfma_f32_16x16x32_bf16 a[8:11], v[72:75], v[32:35], a[8:11]
    v_mfma_f32_16x16x32_bf16 a[12:15], v[76:79], v[32:35], a[12:15]
    ds_read_b64_tr_b16 v[128:129], v244 offset:16384
    s_add_u32 s39, s38, 32768
    s_add_u32 m0, s24, 0
    v_mfma_f32_16x16x32_bf16 a[16:19], v[80:83], v[32:35], a[16:19]
    buffer_load_dwordx4 v4, s[12:15], s39 offen offset:0 lds
    v_mfma_f32_16x16x32_bf16 a[20:23], v[84:87], v[32:35], a[20:23]
    ds_read_b64_tr_b16 v[130:131], v244 offset:18432
    v_mfma_f32_16x16x32_bf16 a[24:27], v[88:91], v[32:35], a[24:27]
    buffer_load_dwordx4 v[160:163], v1, s[12:15], s36 offen offset:0 sc1
    v_mfma_f32_16x16x32_bf16 a[28:31], v[92:95], v[32:35], a[28:31]
    ds_read_b128 v[96:99], v255 offset:0
    v_mfma_f32_16x16x32_bf16 a[60:63], v[92:95], v[36:39], a[60:63]
    buffer_load_dwordx4 v[164:167], v5, s[12:15], s36 offen offset:0 sc1
    v_mfma_f32_16x16x32_bf16 a[56:59], v[88:91], v[36:39], a[56:59]
    ds_read_b64_tr_b16 v[132:133], v245 offset:16384
    v_mfma_f32_16x16x32_bf16 a[52:55], v[84:87], v[36:39], a[52:55]
    v_mfma_f32_16x16x32_bf16 a[48:51], v[80:83], v[36:39], a[48:51]
    ds_read_b64_tr_b16 v[134:135], v245 offset:18432
    v_mfma_f32_16x16x32_bf16 a[44:47], v[76:79], v[36:39], a[44:47]
    buffer_load_dwordx4 v[168:171], v1, s[12:15], s36 offen offset:1024 sc1
    v_mfma_f32_16x16x32_bf16 a[40:43], v[72:75], v[36:39], a[40:43]
    ds_read_b128 v[100:103], v255 offset:2048
    v_mfma_f32_16x16x32_bf16 a[36:39], v[68:71], v[36:39], a[36:39]
    v_mfma_f32_16x16x32_bf16 a[32:35], v[64:67], v[36:39], a[32:35]
    ds_read_b64_tr_b16 v[136:137], v246 offset:16384
    v_mfma_f32_16x16x32_bf16 a[64:67], v[64:67], v[40:43], a[64:67]
    v_mfma_f32_16x16x32_bf16 a[68:71], v[68:71], v[40:43], a[68:71]
    ds_read_b64_tr_b16 v[138:139], v246 offset:18432
    v_mfma_f32_16x16x32_bf16 a[72:75], v[72:75], v[40:43], a[72:75]
    buffer_load_dwordx4 v4, s[12:15], s39 offen offset:1024 lds
    v_mfma_f32_16x16x32_bf16 a[76:79], v[76:79], v[40:43], a[76:79]
    ds_read_b128 v[104:107], v255 offset:4096
    v_mfma_f32_16x16x32_bf16 a[80:83], v[80:83], v[40:43], a[80:83]
    buffer_load_dwordx4 v[172:175], v5, s[12:15], s36 offen offset:1024 sc1
    v_mfma_f32_16x16x32_bf16 a[84:87], v[84:87], v[40:43], a[84:87]
    ds_read_b64_tr_b16 v[140:141], v247 offset:16384
    v_mfma_f32_16x16x32_bf16 a[88:91], v[88:91], v[40:43], a[88:91]
    v_mfma_f32_16x16x32_bf16 a[92:95], v[92:95], v[40:43], a[92:95]
    ds_read_b64_tr_b16 v[142:143], v247 offset:18432
    v_mfma_f32_16x16x32_bf16 a[124:127], v[92:95], v[44:47], a[124:127]
    buffer_load_dwordx4 v[176:179], v1, s[12:15], s36 offen offset:2048 sc1
    v_mfma_f32_16x16x32_bf16 a[120:123], v[88:91], v[44:47], a[120:123]
    ds_read_b128 v[108:111], v255 offset:6144
    v_mfma_f32_16x16x32_bf16 a[116:119], v[84:87], v[44:47], a[116:119]
    v_mfma_f32_16x16x32_bf16 a[112:115], v[80:83], v[44:47], a[112:115]
    ds_read_b64_tr_b16 v[144:145], v248 offset:16384
    v_mfma_f32_16x16x32_bf16 a[108:111], v[76:79], v[44:47], a[108:111]
    v_mfma_f32_16x16x32_bf16 a[104:107], v[72:75], v[44:47], a[104:107]
    ds_read_b64_tr_b16 v[146:147], v248 offset:18432
    v_mfma_f32_16x16x32_bf16 a[100:103], v[68:71], v[44:47], a[100:103]
    buffer_load_dwordx4 v[180:183], v5, s[12:15], s36 offen offset:2048 sc1
    v_mfma_f32_16x16x32_bf16 a[96:99], v[64:67], v[44:47], a[96:99]
    ds_read_b128 v[112:115], v255 offset:8192
    v_mfma_f32_16x16x32_bf16 a[128:131], v[64:67], v[48:51], a[128:131]
    buffer_load_dwordx4 v4, s[12:15], s39 offen offset:2048 lds
    v_mfma_f32_16x16x32_bf16 a[132:135], v[68:71], v[48:51], a[132:135]
    ds_read_b64_tr_b16 v[148:149], v249 offset:16384
    v_mfma_f32_16x16x32_bf16 a[136:139], v[72:75], v[48:51], a[136:139]
    v_mfma_f32_16x16x32_bf16 a[140:143], v[76:79], v[48:51], a[140:143]
    ds_read_b64_tr_b16 v[150:151], v249 offset:18432
    v_mfma_f32_16x16x32_bf16 a[144:147], v[80:83], v[48:51], a[144:147]
    buffer_load_dwordx4 v[184:187], v1, s[12:15], s36 offen offset:3072 sc1
    v_mfma_f32_16x16x32_bf16 a[148:151], v[84:87], v[48:51], a[148:151]
    ds_read_b128 v[116:119], v255 offset:10240
    v_mfma_f32_16x16x32_bf16 a[152:155], v[88:91], v[48:51], a[152:155]
    v_mfma_f32_16x16x32_bf16 a[156:159], v[92:95], v[48:51], a[156:159]
    ds_read_b64_tr_b16 v[152:153], v250 offset:16384
    v_mfma_f32_16x16x32_bf16 a[188:191], v[92:95], v[52:55], a[188:191]
    v_mfma_f32_16x16x32_bf16 a[184:187], v[88:91], v[52:55], a[184:187]
    ds_read_b64_tr_b16 v[154:155], v250 offset:18432
    v_mfma_f32_16x16x32_bf16 a[180:183], v[84:87], v[52:55], a[180:183]
    buffer_load_dwordx4 v[188:191], v5, s[12:15], s36 offen offset:3072 sc1
    v_mfma_f32_16x16x32_bf16 a[176:179], v[80:83], v[52:55], a[176:179]
    ds_read_b128 v[120:123], v255 offset:12288
    v_mfma_f32_16x16x32_bf16 a[172:175], v[76:79], v[52:55], a[172:175]
    v_mfma_f32_16x16x32_bf16 a[168:171], v[72:75], v[52:55], a[168:171]
    ds_read_b64_tr_b16 v[156:157], v251 offset:16384
    v_mfma_f32_16x16x32_bf16 a[164:167], v[68:71], v[52:55], a[164:167]
    buffer_load_dwordx4 v4, s[12:15], s39 offen offset:3072 lds
    v_mfma_f32_16x16x32_bf16 a[160:163], v[64:67], v[52:55], a[160:163]
    ds_read_b64_tr_b16 v[158:159], v251 offset:18432
    v_mfma_f32_16x16x32_bf16 a[192:195], v[64:67], v[56:59], a[192:195]
    buffer_load_dwordx4 v[192:195], v1, s[12:15], s35 offen offset:0 sc1
    v_mfma_f32_16x16x32_bf16 a[196:199], v[68:71], v[56:59], a[196:199]
    ds_read_b128 v[124:127], v255 offset:14336
    v_mfma_f32_16x16x32_bf16 a[200:203], v[72:75], v[56:59], a[200:203]
    v_mfma_f32_16x16x32_bf16 a[204:207], v[76:79], v[56:59], a[204:207]
    v_mfma_f32_16x16x32_bf16 a[208:211], v[80:83], v[56:59], a[208:211]
    v_mfma_f32_16x16x32_bf16 a[212:215], v[84:87], v[56:59], a[212:215]
    v_mfma_f32_16x16x32_bf16 a[216:219], v[88:91], v[56:59], a[216:219]
    buffer_load_dwordx4 v[196:199], v5, s[12:15], s35 offen offset:0 sc1
    v_mfma_f32_16x16x32_bf16 a[220:223], v[92:95], v[56:59], a[220:223]
    v_mfma_f32_16x16x32_bf16 a[252:255], v[92:95], v[60:63], a[252:255]
    v_mfma_f32_16x16x32_bf16 a[248:251], v[88:91], v[60:63], a[248:251]
    v_mfma_f32_16x16x32_bf16 a[244:247], v[84:87], v[60:63], a[244:247]
    v_mfma_f32_16x16x32_bf16 a[240:243], v[80:83], v[60:63], a[240:243]
    v_mfma_f32_16x16x32_bf16 a[236:239], v[76:79], v[60:63], a[236:239]
    v_mfma_f32_16x16x32_bf16 a[232:235], v[72:75], v[60:63], a[232:235]
    v_mfma_f32_16x16x32_bf16 a[228:231], v[68:71], v[60:63], a[228:231]
    v_mfma_f32_16x16x32_bf16 a[224:227], v[64:67], v[60:63], a[224:227]
    s_waitcnt vmcnt(27) lgkmcnt(0)
    s_barrier
    v_mfma_f32_16x16x32_bf16 a[0:3], v[128:131], v[96:99], a[0:3]
    s_add_u32 s25, s25, 32768
    v_mfma_f32_16x16x32_bf16 a[4:7], v[132:135], v[96:99], a[4:7]
    s_cmp_eq_u32 s25, 163840
    s_cselect_b32 s25, 65536, s25
    v_mfma_f32_16x16x32_bf16 a[8:11], v[136:139], v[96:99], a[8:11]
    v_mfma_f32_16x16x32_bf16 a[12:15], v[140:143], v[96:99], a[12:15]
    ds_read_b64_tr_b16 v[64:65], v244 offset:32768
    s_add_u32 s39, s38, 49152
    s_add_u32 m0, s24, 16384
    v_mfma_f32_16x16x32_bf16 a[16:19], v[144:147], v[96:99], a[16:19]
    buffer_load_dwordx4 v4, s[12:15], s39 offen offset:0 lds
    v_mfma_f32_16x16x32_bf16 a[20:23], v[148:151], v[96:99], a[20:23]
    v_add_u32 v254, s25, v252
    ds_read_b64_tr_b16 v[66:67], v244 offset:34816
    v_mfma_f32_16x16x32_bf16 a[24:27], v[152:155], v[96:99], a[24:27]
    v_add_u32 v255, s25, v253
    v_mfma_f32_16x16x32_bf16 a[28:31], v[156:159], v[96:99], a[28:31]
    ds_read_b128 v[32:35], v254 offset:0
    v_mfma_f32_16x16x32_bf16 a[60:63], v[156:159], v[100:103], a[60:63]
    buffer_load_dwordx4 v[200:203], v1, s[12:15], s35 offen offset:1024 sc1
    v_mfma_f32_16x16x32_bf16 a[56:59], v[152:155], v[100:103], a[56:59]
    ds_read_b64_tr_b16 v[68:69], v245 offset:32768
    v_mfma_f32_16x16x32_bf16 a[52:55], v[148:151], v[100:103], a[52:55]
    buffer_load_dwordx4 v4, s[12:15], s39 offen offset:1024 lds
    v_mfma_f32_16x16x32_bf16 a[48:51], v[144:147], v[100:103], a[48:51]
    ds_read_b64_tr_b16 v[70:71], v245 offset:34816
    v_mfma_f32_16x16x32_bf16 a[44:47], v[140:143], v[100:103], a[44:47]
    buffer_load_dwordx4 v[204:207], v5, s[12:15], s35 offen offset:1024 sc1
    v_mfma_f32_16x16x32_bf16 a[40:43], v[136:139], v[100:103], a[40:43]
    ds_read_b128 v[36:39], v254 offset:2048
    s_getreg_b32 s3, hwreg(HW_REG_XCC_ID, 0, 4)
    v_mfma_f32_16x16x32_bf16 a[36:39], v[132:135], v[100:103], a[36:39]
    s_waitcnt vmcnt(30)
    v_mfma_f32_16x16x32_bf16 a[32:35], v[128:131], v[100:103], a[32:35]
    ds_read_b64_tr_b16 v[72:73], v246 offset:32768
    v_mfma_f32_16x16x32_bf16 a[64:67], v[128:131], v[104:107], a[64:67]
    buffer_load_dwordx4 v4, s[12:15], s39 offen offset:2048 lds
    v_mfma_f32_16x16x32_bf16 a[68:71], v[132:135], v[104:107], a[68:71]
    ds_read_b64_tr_b16 v[74:75], v246 offset:34816
    s_add_u32 s3, s3, 1
    v_mfma_f32_16x16x32_bf16 a[72:75], v[136:139], v[104:107], a[72:75]
    v_mfma_f32_16x16x32_bf16 a[76:79], v[140:143], v[104:107], a[76:79]
    ds_read_b128 v[40:43], v254 offset:4096
    v_mfma_f32_16x16x32_bf16 a[80:83], v[144:147], v[104:107], a[80:83]
    v_cmp_ne_u32 vcc, s3, v28
    v_mfma_f32_16x16x32_bf16 a[84:87], v[148:151], v[104:107], a[84:87]
    ds_read_b64_tr_b16 v[76:77], v247 offset:32768
    v_mfma_f32_16x16x32_bf16 a[88:91], v[152:155], v[104:107], a[88:91]
    buffer_load_dwordx4 v4, s[12:15], s39 offen offset:3072 lds
    v_mfma_f32_16x16x32_bf16 a[92:95], v[156:159], v[104:107], a[92:95]
    ds_read_b64_tr_b16 v[78:79], v247 offset:34816
    v_mov_b32 v28, 268435456
    v_mfma_f32_16x16x32_bf16 a[124:127], v[156:159], v[108:111], a[124:127]
    v_mfma_f32_16x16x32_bf16 a[120:123], v[152:155], v[108:111], a[120:123]
    ds_read_b128 v[44:47], v254 offset:6144
    v_mfma_f32_16x16x32_bf16 a[116:119], v[148:151], v[108:111], a[116:119]
    s_nop 0
    v_mfma_f32_16x16x32_bf16 a[112:115], v[144:147], v[108:111], a[112:115]
    ds_read_b64_tr_b16 v[80:81], v248 offset:32768
    v_mfma_f32_16x16x32_bf16 a[108:111], v[140:143], v[108:111], a[108:111]
    s_cmp_eq_u64 vcc, 0
    s_cselect_b32 s92, 1, 0
    s_cselect_b64 vcc, -1, 0
    v_mfma_f32_16x16x32_bf16 a[104:107], v[136:139], v[108:111], a[104:107]
    ds_read_b64_tr_b16 v[82:83], v248 offset:34816
    v_mfma_f32_16x16x32_bf16 a[100:103], v[132:135], v[108:111], a[100:103]
    v_mfma_f32_16x16x32_bf16 a[96:99], v[128:131], v[108:111], a[96:99]
    ds_read_b128 v[48:51], v254 offset:8192
    s_add_u32 s39, s38, 65536
    s_add_u32 m0, s24, 131072
    v_mfma_f32_16x16x32_bf16 a[128:131], v[128:131], v[112:115], a[128:131]
    buffer_load_dwordx4 v4, s[12:15], s39 offen offset:0 lds
    v_mfma_f32_16x16x32_bf16 a[132:135], v[132:135], v[112:115], a[132:135]
    ds_read_b64_tr_b16 v[84:85], v249 offset:32768
    v_mfma_f32_16x16x32_bf16 a[136:139], v[136:139], v[112:115], a[136:139]
    v_cndmask_b32 v30, v28, v31, vcc
    v_mfma_f32_16x16x32_bf16 a[140:143], v[140:143], v[112:115], a[140:143]
    ds_read_b64_tr_b16 v[86:87], v249 offset:34816
    v_mfma_f32_16x16x32_bf16 a[144:147], v[144:147], v[112:115], a[144:147]
    v_mfma_f32_16x16x32_bf16 a[148:151], v[148:151], v[112:115], a[148:151]
    ds_read_b128 v[52:55], v254 offset:10240
    v_cndmask_b32 v29, v31, v28, vcc
    v_mfma_f32_16x16x32_bf16 a[152:155], v[152:155], v[112:115], a[152:155]
    buffer_load_dwordx4 v4, s[12:15], s39 offen offset:1024 lds
    v_mfma_f32_16x16x32_bf16 a[156:159], v[156:159], v[112:115], a[156:159]
    ds_read_b64_tr_b16 v[88:89], v250 offset:32768
    v_mfma_f32_16x16x32_bf16 a[188:191], v[156:159], v[116:119], a[188:191]
    s_and_b32 s3, s49, 7
    v_mfma_f32_16x16x32_bf16 a[184:187], v[152:155], v[116:119], a[184:187]
    ds_read_b64_tr_b16 v[90:91], v250 offset:34816
    v_mfma_f32_16x16x32_bf16 a[180:183], v[148:151], v[116:119], a[180:183]
    v_mfma_f32_16x16x32_bf16 a[176:179], v[144:147], v[116:119], a[176:179]
    ds_read_b128 v[56:59], v254 offset:12288
    s_lshl_b32 s3, s3, 13
    v_mfma_f32_16x16x32_bf16 a[172:175], v[140:143], v[116:119], a[172:175]
    buffer_load_dwordx4 v4, s[12:15], s39 offen offset:2048 lds
    v_mfma_f32_16x16x32_bf16 a[168:171], v[136:139], v[116:119], a[168:171]
    ds_read_b64_tr_b16 v[92:93], v251 offset:32768
    v_mfma_f32_16x16x32_bf16 a[164:167], v[132:135], v[116:119], a[164:167]
    s_add_u32 s3, s3, s38
    v_mfma_f32_16x16x32_bf16 a[160:163], v[128:131], v[116:119], a[160:163]
    ds_read_b64_tr_b16 v[94:95], v251 offset:34816
    v_mfma_f32_16x16x32_bf16 a[192:195], v[128:131], v[120:123], a[192:195]
    s_add_u32 s3, s3, 163840
    v_mfma_f32_16x16x32_bf16 a[196:199], v[132:135], v[120:123], a[196:199]
    ds_read_b128 v[60:63], v254 offset:14336
    v_mfma_f32_16x16x32_bf16 a[200:203], v[136:139], v[120:123], a[200:203]
    buffer_load_dwordx4 v4, s[12:15], s39 offen offset:3072 lds
    v_mfma_f32_16x16x32_bf16 a[204:207], v[140:143], v[120:123], a[204:207]
    v_lshlrev_b32 v24, 3, v1
    v_mfma_f32_16x16x32_bf16 a[208:211], v[144:147], v[120:123], a[208:211]
    v_mfma_f32_16x16x32_bf16 a[212:215], v[148:151], v[120:123], a[212:215]
    v_mfma_f32_16x16x32_bf16 a[216:219], v[152:155], v[120:123], a[216:219]
    buffer_load_dword v24, v24, s[12:15], s3 offen
    v_mfma_f32_16x16x32_bf16 a[220:223], v[156:159], v[120:123], a[220:223]
    v_mfma_f32_16x16x32_bf16 a[252:255], v[156:159], v[124:127], a[252:255]
    v_mfma_f32_16x16x32_bf16 a[248:251], v[152:155], v[124:127], a[248:251]
    v_mfma_f32_16x16x32_bf16 a[244:247], v[148:151], v[124:127], a[244:247]
    v_mfma_f32_16x16x32_bf16 a[240:243], v[144:147], v[124:127], a[240:243]
    v_mfma_f32_16x16x32_bf16 a[236:239], v[140:143], v[124:127], a[236:239]
    v_mfma_f32_16x16x32_bf16 a[232:235], v[136:139], v[124:127], a[232:235]
    v_mfma_f32_16x16x32_bf16 a[228:231], v[132:135], v[124:127], a[228:231]
    v_mfma_f32_16x16x32_bf16 a[224:227], v[128:131], v[124:127], a[224:227]
    s_waitcnt vmcnt(33) lgkmcnt(0)
    s_barrier
    v_mfma_f32_16x16x32_bf16 a[0:3], v[64:67], v[32:35], a[0:3]
    v_mfma_f32_16x16x32_bf16 a[4:7], v[68:71], v[32:35], a[4:7]
    v_mfma_f32_16x16x32_bf16 a[8:11], v[72:75], v[32:35], a[8:11]
    v_mfma_f32_16x16x32_bf16 a[12:15], v[76:79], v[32:35], a[12:15]
    ds_read_b64_tr_b16 v[128:129], v244 offset:49152
    s_add_u32 s39, s38, 81920
    s_add_u32 m0, s24, 147456
    v_mfma_f32_16x16x32_bf16 a[16:19], v[80:83], v[32:35], a[16:19]
    buffer_load_dwordx4 v4, s[12:15], s39 offen offset:0 lds
    v_mfma_f32_16x16x32_bf16 a[20:23], v[84:87], v[32:35], a[20:23]
    ds_read_b64_tr_b16 v[130:131], v244 offset:51200
    v_mfma_f32_16x16x32_bf16 a[24:27], v[88:91], v[32:35], a[24:27]
    v_mfma_f32_16x16x32_bf16 a[28:31], v[92:95], v[32:35], a[28:31]
    ds_read_b128 v[96:99], v255 offset:0
    v_mfma_f32_16x16x32_bf16 a[60:63], v[92:95], v[36:39], a[60:63]
    v_mfma_f32_16x16x32_bf16 a[56:59], v[88:91], v[36:39], a[56:59]
    ds_read_b64_tr_b16 v[132:133], v245 offset:49152
    v_mfma_f32_16x16x32_bf16 a[52:55], v[84:87], v[36:39], a[52:55]
    buffer_load_dwordx4 v4, s[12:15], s39 offen offset:1024 lds
    v_mfma_f32_16x16x32_bf16 a[48:51], v[80:83], v[36:39], a[48:51]
    ds_read_b64_tr_b16 v[134:135], v245 offset:51200
    v_mfma_f32_16x16x32_bf16 a[44:47], v[76:79], v[36:39], a[44:47]
    v_mfma_f32_16x16x32_bf16 a[40:43], v[72:75], v[36:39], a[40:43]
    ds_read_b128 v[100:103], v255 offset:2048
    v_mfma_f32_16x16x32_bf16 a[36:39], v[68:71], v[36:39], a[36:39]
    buffer_load_dwordx4 v[32:35], v1, s[12:15], s35 offen offset:2048 sc1
    v_mfma_f32_16x16x32_bf16 a[32:35], v[64:67], v[36:39], a[32:35]
    ds_read_b64_tr_b16 v[136:137], v246 offset:49152
    v_mfma_f32_16x16x32_bf16 a[64:67], v[64:67], v[40:43], a[64:67]
    buffer_load_dwordx4 v4, s[12:15], s39 offen offset:2048 lds
    v_mfma_f32_16x16x32_bf16 a[68:71], v[68:71], v[40:43], a[68:71]
    ds_read_b64_tr_b16 v[138:139], v246 offset:51200
    v_mfma_f32_16x16x32_bf16 a[72:75], v[72:75], v[40:43], a[72:75]
    v_mfma_f32_16x16x32_bf16 a[76:79], v[76:79], v[40:43], a[76:79]
    ds_read_b128 v[104:107], v255 offset:4096
    v_mfma_f32_16x16x32_bf16 a[80:83], v[80:83], v[40:43], a[80:83]
    v_mfma_f32_16x16x32_bf16 a[84:87], v[84:87], v[40:43], a[84:87]
    ds_read_b64_tr_b16 v[140:141], v247 offset:49152
    v_mfma_f32_16x16x32_bf16 a[88:91], v[88:91], v[40:43], a[88:91]
    buffer_load_dwordx4 v4, s[12:15], s39 offen offset:3072 lds
    buffer_load_dwordx4 v[36:39], v5, s[12:15], s35 offen offset:2048 sc1
    v_mfma_f32_16x16x32_bf16 a[92:95], v[92:95], v[40:43], a[92:95]
    ds_read_b64_tr_b16 v[142:143], v247 offset:51200
    v_mfma_f32_16x16x32_bf16 a[124:127], v[92:95], v[44:47], a[124:127]
    v_mfma_f32_16x16x32_bf16 a[120:123], v[88:91], v[44:47], a[120:123]
    ds_read_b128 v[108:111], v255 offset:6144
    v_mfma_f32_16x16x32_bf16 a[116:119], v[84:87], v[44:47], a[116:119]
    v_mfma_f32_16x16x32_bf16 a[112:115], v[80:83], v[44:47], a[112:115]
    ds_read_b64_tr_b16 v[144:145], v248 offset:49152
    v_mfma_f32_16x16x32_bf16 a[108:111], v[76:79], v[44:47], a[108:111]
    v_mfma_f32_16x16x32_bf16 a[104:107], v[72:75], v[44:47], a[104:107]
    ds_read_b64_tr_b16 v[146:147], v248 offset:51200
    v_mfma_f32_16x16x32_bf16 a[100:103], v[68:71], v[44:47], a[100:103]
    buffer_load_dwordx4 v[40:43], v1, s[12:15], s35 offen offset:3072 sc1
    v_mfma_f32_16x16x32_bf16 a[96:99], v[64:67], v[44:47], a[96:99]
    ds_read_b128 v[112:115], v255 offset:8192
    s_add_u32 s39, s38, 98304
    s_add_u32 m0, s24, 32768
    v_mfma_f32_16x16x32_bf16 a[128:131], v[64:67], v[48:51], a[128:131]
    buffer_load_dwordx4 v4, s[12:15], s39 offen offset:0 lds
    v_mfma_f32_16x16x32_bf16 a[132:135], v[68:71], v[48:51], a[132:135]
    ds_read_b64_tr_b16 v[148:149], v249 offset:49152
    v_mfma_f32_16x16x32_bf16 a[136:139], v[72:75], v[48:51], a[136:139]
    v_mfma_f32_16x16x32_bf16 a[140:143], v[76:79], v[48:51], a[140:143]
    ds_read_b64_tr_b16 v[150:151], v249 offset:51200
    v_mfma_f32_16x16x32_bf16 a[144:147], v[80:83], v[48:51], a[144:147]
    v_mfma_f32_16x16x32_bf16 a[148:151], v[84:87], v[48:51], a[148:151]
    ds_read_b128 v[116:119], v255 offset:10240
    v_mfma_f32_16x16x32_bf16 a[152:155], v[88:91], v[48:51], a[152:155]
    buffer_load_dwordx4 v4, s[12:15], s39 offen offset:1024 lds
    buffer_load_dwordx4 v[44:47], v5, s[12:15], s35 offen offset:3072 sc1
    v_mfma_f32_16x16x32_bf16 a[156:159], v[92:95], v[48:51], a[156:159]
    ds_read_b64_tr_b16 v[152:153], v250 offset:49152
    v_mfma_f32_16x16x32_bf16 a[188:191], v[92:95], v[52:55], a[188:191]
    v_mfma_f32_16x16x32_bf16 a[184:187], v[88:91], v[52:55], a[184:187]
    ds_read_b64_tr_b16 v[154:155], v250 offset:51200
    v_mfma_f32_16x16x32_bf16 a[180:183], v[84:87], v[52:55], a[180:183]
    v_mfma_f32_16x16x32_bf16 a[176:179], v[80:83], v[52:55], a[176:179]
    ds_read_b128 v[120:123], v255 offset:12288
    v_mfma_f32_16x16x32_bf16 a[172:175], v[76:79], v[52:55], a[172:175]
    buffer_load_dwordx4 v4, s[12:15], s39 offen offset:2048 lds
    v_mfma_f32_16x16x32_bf16 a[168:171], v[72:75], v[52:55], a[168:171]
    ds_read_b64_tr_b16 v[156:157], v251 offset:49152
    v_mfma_f32_16x16x32_bf16 a[164:167], v[68:71], v[52:55], a[164:167]
    buffer_load_dwordx4 v[48:51], v1, s[12:15], s72 offen offset:0 sc1
    v_mfma_f32_16x16x32_bf16 a[160:163], v[64:67], v[52:55], a[160:163]
    ds_read_b64_tr_b16 v[158:159], v251 offset:51200
    v_mfma_f32_16x16x32_bf16 a[192:195], v[64:67], v[56:59], a[192:195]
    v_mfma_f32_16x16x32_bf16 a[196:199], v[68:71], v[56:59], a[196:199]
    ds_read_b128 v[124:127], v255 offset:14336
    v_mfma_f32_16x16x32_bf16 a[200:203], v[72:75], v[56:59], a[200:203]
    buffer_load_dwordx4 v4, s[12:15], s39 offen offset:3072 lds
    v_mfma_f32_16x16x32_bf16 a[204:207], v[76:79], v[56:59], a[204:207]
    v_mfma_f32_16x16x32_bf16 a[208:211], v[80:83], v[56:59], a[208:211]
    v_mfma_f32_16x16x32_bf16 a[212:215], v[84:87], v[56:59], a[212:215]
    v_mfma_f32_16x16x32_bf16 a[216:219], v[88:91], v[56:59], a[216:219]
    buffer_load_dwordx4 v[52:55], v5, s[12:15], s72 offen offset:0 sc1
    v_mfma_f32_16x16x32_bf16 a[220:223], v[92:95], v[56:59], a[220:223]
    v_mfma_f32_16x16x32_bf16 a[252:255], v[92:95], v[60:63], a[252:255]
    v_mfma_f32_16x16x32_bf16 a[248:251], v[88:91], v[60:63], a[248:251]
    v_mfma_f32_16x16x32_bf16 a[244:247], v[84:87], v[60:63], a[244:247]
    v_mfma_f32_16x16x32_bf16 a[240:243], v[80:83], v[60:63], a[240:243]
    v_mfma_f32_16x16x32_bf16 a[236:239], v[76:79], v[60:63], a[236:239]
    buffer_load_dwordx4 v[56:59], v1, s[12:15], s72 offen offset:1024 sc1
    v_mfma_f32_16x16x32_bf16 a[232:235], v[72:75], v[60:63], a[232:235]
    v_mfma_f32_16x16x32_bf16 a[228:231], v[68:71], v[60:63], a[228:231]
    v_mfma_f32_16x16x32_bf16 a[224:227], v[64:67], v[60:63], a[224:227]
    s_waitcnt lgkmcnt(0)
    s_barrier
    v_mfma_f32_16x16x32_bf16 a[0:3], v[128:131], v[96:99], a[0:3]
    v_mfma_f32_16x16x32_bf16 a[4:7], v[132:135], v[96:99], a[4:7]
    v_mfma_f32_16x16x32_bf16 a[8:11], v[136:139], v[96:99], a[8:11]
    v_mfma_f32_16x16x32_bf16 a[12:15], v[140:143], v[96:99], a[12:15]
    s_add_u32 s39, s38, 114688
    s_add_u32 m0, s24, 49152
    v_mfma_f32_16x16x32_bf16 a[16:19], v[144:147], v[96:99], a[16:19]
    buffer_load_dwordx4 v4, s[12:15], s39 offen offset:0 lds
    v_mfma_f32_16x16x32_bf16 a[20:23], v[148:151], v[96:99], a[20:23]
    v_mfma_f32_16x16x32_bf16 a[24:27], v[152:155], v[96:99], a[24:27]
    v_mfma_f32_16x16x32_bf16 a[28:31], v[156:159], v[96:99], a[28:31]
    v_mfma_f32_16x16x32_bf16 a[60:63], v[156:159], v[100:103], a[60:63]
    v_mfma_f32_16x16x32_bf16 a[56:59], v[152:155], v[100:103], a[56:59]
    v_mfma_f32_16x16x32_bf16 a[52:55], v[148:151], v[100:103], a[52:55]
    buffer_load_dwordx4 v4, s[12:15], s39 offen offset:1024 lds
    v_mfma_f32_16x16x32_bf16 a[48:51], v[144:147], v[100:103], a[48:51]
    v_mfma_f32_16x16x32_bf16 a[44:47], v[140:143], v[100:103], a[44:47]
    v_mfma_f32_16x16x32_bf16 a[40:43], v[136:139], v[100:103], a[40:43]
    v_mfma_f32_16x16x32_bf16 a[36:39], v[132:135], v[100:103], a[36:39]
    v_mfma_f32_16x16x32_bf16 a[32:35], v[128:131], v[100:103], a[32:35]
    v_mfma_f32_16x16x32_bf16 a[64:67], v[128:131], v[104:107], a[64:67]
    buffer_load_dwordx4 v4, s[12:15], s39 offen offset:2048 lds
    v_mfma_f32_16x16x32_bf16 a[68:71], v[132:135], v[104:107], a[68:71]
    v_mfma_f32_16x16x32_bf16 a[72:75], v[136:139], v[104:107], a[72:75]
    v_mfma_f32_16x16x32_bf16 a[76:79], v[140:143], v[104:107], a[76:79]
    buffer_load_dwordx4 v[60:63], v5, s[12:15], s72 offen offset:1024 sc1
    v_mfma_f32_16x16x32_bf16 a[80:83], v[144:147], v[104:107], a[80:83]
    v_accvgpr_read_b32 v8, a0
    v_accvgpr_read_b32 v9, a1
    v_mfma_f32_16x16x32_bf16 a[84:87], v[148:151], v[104:107], a[84:87]
    v_accvgpr_read_b32 v10, a2
    v_accvgpr_read_b32 v11, a3
    v_mfma_f32_16x16x32_bf16 a[88:91], v[152:155], v[104:107], a[88:91]
    buffer_load_dwordx4 v4, s[12:15], s39 offen offset:3072 lds
    v_mfma_f32_16x16x32_bf16 a[92:95], v[156:159], v[104:107], a[92:95]
    v_accvgpr_read_b32 v12, a4
    v_accvgpr_read_b32 v13, a5
    v_mfma_f32_16x16x32_bf16 a[124:127], v[156:159], v[108:111], a[124:127]
    v_accvgpr_read_b32 v14, a6
    v_accvgpr_read_b32 v15, a7
    v_mfma_f32_16x16x32_bf16 a[120:123], v[152:155], v[108:111], a[120:123]
    v_cvt_pk_bf16_f32 v208, v8, v9
    v_cvt_pk_bf16_f32 v209, v10, v11
    v_mfma_f32_16x16x32_bf16 a[116:119], v[148:151], v[108:111], a[116:119]
    v_cvt_pk_bf16_f32 v210, v12, v13
    v_cvt_pk_bf16_f32 v211, v14, v15
    v_mfma_f32_16x16x32_bf16 a[112:115], v[144:147], v[108:111], a[112:115]
    v_accvgpr_read_b32 v8, a8
    v_accvgpr_read_b32 v9, a9
    v_mfma_f32_16x16x32_bf16 a[108:111], v[140:143], v[108:111], a[108:111]
    v_accvgpr_read_b32 v10, a10
    v_accvgpr_read_b32 v11, a11
    v_mfma_f32_16x16x32_bf16 a[104:107], v[136:139], v[108:111], a[104:107]
    v_accvgpr_read_b32 v12, a12
    v_accvgpr_read_b32 v13, a13
    v_mfma_f32_16x16x32_bf16 a[100:103], v[132:135], v[108:111], a[100:103]
    v_accvgpr_read_b32 v14, a14
    v_accvgpr_read_b32 v15, a15
    v_mfma_f32_16x16x32_bf16 a[96:99], v[128:131], v[108:111], a[96:99]
    s_add_u32 s39, s38, 131072
    s_add_u32 m0, s24, 65536
    v_mfma_f32_16x16x32_bf16 a[128:131], v[128:131], v[112:115], a[128:131]
    buffer_load_dwordx4 v4, s[12:15], s39 offen offset:0 lds
    v_mfma_f32_16x16x32_bf16 a[132:135], v[132:135], v[112:115], a[132:135]
    v_cvt_pk_bf16_f32 v212, v8, v9
    v_cvt_pk_bf16_f32 v213, v10, v11
    v_mfma_f32_16x16x32_bf16 a[136:139], v[136:139], v[112:115], a[136:139]
    v_cvt_pk_bf16_f32 v214, v12, v13
    v_cvt_pk_bf16_f32 v215, v14, v15
    v_mfma_f32_16x16x32_bf16 a[140:143], v[140:143], v[112:115], a[140:143]
    s_add_u32 s90, s91, 0
    v_mfma_f32_16x16x32_bf16 a[144:147], v[144:147], v[112:115], a[144:147]
    buffer_store_dwordx4 v[208:211], v1, s[12:15], s90 offen offset:0 sc1
    v_mfma_f32_16x16x32_bf16 a[148:151], v[148:151], v[112:115], a[148:151]
    v_accvgpr_read_b32 v8, a16
    v_accvgpr_read_b32 v9, a17
    v_mfma_f32_16x16x32_bf16 a[152:155], v[152:155], v[112:115], a[152:155]
    buffer_load_dwordx4 v4, s[12:15], s39 offen offset:1024 lds
    v_mfma_f32_16x16x32_bf16 a[156:159], v[156:159], v[112:115], a[156:159]
    v_accvgpr_read_b32 v10, a18
    v_accvgpr_read_b32 v11, a19
    v_mfma_f32_16x16x32_bf16 a[188:191], v[156:159], v[116:119], a[188:191]
    v_accvgpr_read_b32 v12, a20
    v_accvgpr_read_b32 v13, a21
    v_mfma_f32_16x16x32_bf16 a[184:187], v[152:155], v[116:119], a[184:187]
    v_accvgpr_read_b32 v14, a22
    v_accvgpr_read_b32 v15, a23
    v_mfma_f32_16x16x32_bf16 a[180:183], v[148:151], v[116:119], a[180:183]
    v_cvt_pk_bf16_f32 v216, v8, v9
    v_cvt_pk_bf16_f32 v217, v10, v11
    v_mfma_f32_16x16x32_bf16 a[176:179], v[144:147], v[116:119], a[176:179]
    v_cvt_pk_bf16_f32 v218, v12, v13
    v_cvt_pk_bf16_f32 v219, v14, v15
    v_mfma_f32_16x16x32_bf16 a[172:175], v[140:143], v[116:119], a[172:175]
    buffer_load_dwordx4 v4, s[12:15], s39 offen offset:2048 lds
    v_mfma_f32_16x16x32_bf16 a[168:171], v[136:139], v[116:119], a[168:171]
    v_accvgpr_read_b32 v8, a24
    v_accvgpr_read_b32 v9, a25
    v_mfma_f32_16x16x32_bf16 a[164:167], v[132:135], v[116:119], a[164:167]
    v_accvgpr_read_b32 v10, a26
    v_accvgpr_read_b32 v11, a27
    v_mfma_f32_16x16x32_bf16 a[160:163], v[128:131], v[116:119], a[160:163]
    v_accvgpr_read_b32 v12, a28
    v_accvgpr_read_b32 v13, a29
    v_mfma_f32_16x16x32_bf16 a[192:195], v[128:131], v[120:123], a[192:195]
    v_accvgpr_read_b32 v14, a30
    v_accvgpr_read_b32 v15, a31
    v_mfma_f32_16x16x32_bf16 a[196:199], v[132:135], v[120:123], a[196:199]
    v_cvt_pk_bf16_f32 v220, v8, v9
    v_cvt_pk_bf16_f32 v221, v10, v11
    v_mfma_f32_16x16x32_bf16 a[200:203], v[136:139], v[120:123], a[200:203]
    buffer_load_dwordx4 v4, s[12:15], s39 offen offset:3072 lds
    v_mfma_f32_16x16x32_bf16 a[204:207], v[140:143], v[120:123], a[204:207]
    v_cvt_pk_bf16_f32 v222, v12, v13
    v_cvt_pk_bf16_f32 v223, v14, v15
    v_mfma_f32_16x16x32_bf16 a[208:211], v[144:147], v[120:123], a[208:211]
    buffer_store_dwordx4 v[212:215], v1, s[12:15], s90 offen offset:1024 sc1
    v_mfma_f32_16x16x32_bf16 a[212:215], v[148:151], v[120:123], a[212:215]
    v_accvgpr_read_b32 v8, a32
    v_accvgpr_read_b32 v9, a33
    v_mfma_f32_16x16x32_bf16 a[216:219], v[152:155], v[120:123], a[216:219]
    v_accvgpr_read_b32 v10, a34
    v_accvgpr_read_b32 v11, a35
    v_mfma_f32_16x16x32_bf16 a[220:223], v[156:159], v[120:123], a[220:223]
    v_accvgpr_read_b32 v12, a36
    v_accvgpr_read_b32 v13, a37
    v_mfma_f32_16x16x32_bf16 a[252:255], v[156:159], v[124:127], a[252:255]
    v_accvgpr_read_b32 v14, a38
    v_accvgpr_read_b32 v15, a39
    v_mfma_f32_16x16x32_bf16 a[248:251], v[152:155], v[124:127], a[248:251]
    v_cvt_pk_bf16_f32 v224, v8, v9
    v_cvt_pk_bf16_f32 v225, v10, v11
    v_mfma_f32_16x16x32_bf16 a[244:247], v[148:151], v[124:127], a[244:247]
    v_cvt_pk_bf16_f32 v226, v12, v13
    v_cvt_pk_bf16_f32 v227, v14, v15
    v_mfma_f32_16x16x32_bf16 a[240:243], v[144:147], v[124:127], a[240:243]
    v_accvgpr_read_b32 v8, a40
    v_accvgpr_read_b32 v9, a41
    v_mfma_f32_16x16x32_bf16 a[236:239], v[140:143], v[124:127], a[236:239]
    v_accvgpr_read_b32 v10, a42
    v_accvgpr_read_b32 v11, a43
    v_mfma_f32_16x16x32_bf16 a[232:235], v[136:139], v[124:127], a[232:235]
    v_accvgpr_read_b32 v12, a44
    v_accvgpr_read_b32 v13, a45
    v_mfma_f32_16x16x32_bf16 a[228:231], v[132:135], v[124:127], a[228:231]
    v_accvgpr_read_b32 v14, a46
    v_accvgpr_read_b32 v15, a47
    v_cvt_pk_bf16_f32 v228, v8, v9
    v_cvt_pk_bf16_f32 v229, v10, v11
    v_cvt_pk_bf16_f32 v230, v12, v13
    v_cvt_pk_bf16_f32 v231, v14, v15
    buffer_store_dwordx4 v[216:219], v1, s[12:15], s90 offen offset:2048 sc1
    v_mfma_f32_16x16x32_bf16 a[224:227], v[128:131], v[124:127], a[224:227]
    v_accvgpr_read_b32 v112, a48
    v_accvgpr_read_b32 v113, a49
    v_accvgpr_read_b32 v114, a50
    v_accvgpr_read_b32 v115, a51
    v_accvgpr_read_b32 v116, a52
    v_accvgpr_read_b32 v117, a53
    v_accvgpr_read_b32 v118, a54
    v_accvgpr_read_b32 v119, a55
    v_cvt_pk_bf16_f32 v232, v112, v113
    v_cvt_pk_bf16_f32 v233, v114, v115
    v_cvt_pk_bf16_f32 v234, v116, v117
    v_cvt_pk_bf16_f32 v235, v118, v119
    v_accvgpr_read_b32 v120, a56
    v_accvgpr_read_b32 v121, a57
    v_accvgpr_read_b32 v122, a58
    v_accvgpr_read_b32 v123, a59
    v_accvgpr_read_b32 v124, a60
    v_accvgpr_read_b32 v125, a61
    v_accvgpr_read_b32 v126, a62
    v_accvgpr_read_b32 v127, a63
    v_cvt_pk_bf16_f32 v236, v120, v121
    v_cvt_pk_bf16_f32 v237, v122, v123
    v_cvt_pk_bf16_f32 v238, v124, v125
    v_cvt_pk_bf16_f32 v239, v126, v127
    v_accvgpr_read_b32 v96, a64
    v_accvgpr_read_b32 v97, a65
    v_accvgpr_read_b32 v98, a66
    v_accvgpr_read_b32 v99, a67
    v_accvgpr_read_b32 v100, a68
    v_accvgpr_read_b32 v101, a69
    v_accvgpr_read_b32 v102, a70
    v_accvgpr_read_b32 v103, a71
    v_cvt_pk_bf16_f32 v240, v96, v97
    v_cvt_pk_bf16_f32 v241, v98, v99
    v_cvt_pk_bf16_f32 v242, v100, v101
    v_cvt_pk_bf16_f32 v243, v102, v103
    buffer_store_dwordx4 v[220:223], v1, s[12:15], s90 offen offset:3072 sc1
    v_accvgpr_read_b32 v104, a72
    v_accvgpr_read_b32 v105, a73
    v_accvgpr_read_b32 v106, a74
    v_accvgpr_read_b32 v107, a75
    v_accvgpr_read_b32 v108, a76
    v_accvgpr_read_b32 v109, a77
    v_accvgpr_read_b32 v110, a78
    v_accvgpr_read_b32 v111, a79
    v_cvt_pk_bf16_f32 v244, v104, v105
    v_cvt_pk_bf16_f32 v245, v106, v107
    v_cvt_pk_bf16_f32 v246, v108, v109
    v_cvt_pk_bf16_f32 v247, v110, v111
    v_accvgpr_read_b32 v112, a80
    v_accvgpr_read_b32 v113, a81
    v_accvgpr_read_b32 v114, a82
    v_accvgpr_read_b32 v115, a83
    v_accvgpr_read_b32 v116, a84
    v_accvgpr_read_b32 v117, a85
    v_accvgpr_read_b32 v118, a86
    v_accvgpr_read_b32 v119, a87
    v_cvt_pk_bf16_f32 v248, v112, v113
    v_cvt_pk_bf16_f32 v249, v114, v115
    v_cvt_pk_bf16_f32 v250, v116, v117
    v_cvt_pk_bf16_f32 v251, v118, v119
    v_accvgpr_read_b32 v120, a88
    v_accvgpr_read_b32 v121, a89
    v_accvgpr_read_b32 v122, a90
    v_accvgpr_read_b32 v123, a91
    v_accvgpr_read_b32 v124, a92
    v_accvgpr_read_b32 v125, a93
    v_accvgpr_read_b32 v126, a94
    v_accvgpr_read_b32 v127, a95
    v_cvt_pk_bf16_f32 v252, v120, v121
    v_cvt_pk_bf16_f32 v253, v122, v123
    v_cvt_pk_bf16_f32 v254, v124, v125
    v_cvt_pk_bf16_f32 v255, v126, v127
    v_accvgpr_read_b32 v96, a96
    v_accvgpr_read_b32 v97, a97
    v_accvgpr_read_b32 v98, a98
    v_accvgpr_read_b32 v99, a99
    v_accvgpr_read_b32 v100, a100
    v_accvgpr_read_b32 v101, a101
    v_accvgpr_read_b32 v102, a102
    v_accvgpr_read_b32 v103, a103
    v_cvt_pk_bf16_f32 v208, v96, v97
    v_cvt_pk_bf16_f32 v209, v98, v99
    v_cvt_pk_bf16_f32 v210, v100, v101
    v_cvt_pk_bf16_f32 v211, v102, v103
    v_accvgpr_read_b32 v104, a104
    v_accvgpr_read_b32 v105, a105
    v_accvgpr_read_b32 v106, a106
    v_accvgpr_read_b32 v107, a107
    v_accvgpr_read_b32 v108, a108
    v_accvgpr_read_b32 v109, a109
    v_accvgpr_read_b32 v110, a110
    v_accvgpr_read_b32 v111, a111
    v_cvt_pk_bf16_f32 v212, v104, v105
    v_cvt_pk_bf16_f32 v213, v106, v107
    v_cvt_pk_bf16_f32 v214, v108, v109
    v_cvt_pk_bf16_f32 v215, v110, v111
    s_add_u32 s90, s91, 8192
    buffer_store_dwordx4 v[224:227], v1, s[12:15], s90 offen offset:0 sc1
    v_accvgpr_read_b32 v112, a112
    v_accvgpr_read_b32 v113, a113
    v_accvgpr_read_b32 v114, a114
    v_accvgpr_read_b32 v115, a115
    v_accvgpr_read_b32 v116, a116
    v_accvgpr_read_b32 v117, a117
    v_accvgpr_read_b32 v118, a118
    v_accvgpr_read_b32 v119, a119
    v_cvt_pk_bf16_f32 v216, v112, v113
    v_cvt_pk_bf16_f32 v217, v114, v115
    v_cvt_pk_bf16_f32 v218, v116, v117
    v_cvt_pk_bf16_f32 v219, v118, v119
    v_accvgpr_read_b32 v120, a120
    v_accvgpr_read_b32 v121, a121
    v_accvgpr_read_b32 v122, a122
    v_accvgpr_read_b32 v123, a123
    v_accvgpr_read_b32 v124, a124
    v_accvgpr_read_b32 v125, a125
    v_accvgpr_read_b32 v126, a126
    v_accvgpr_read_b32 v127, a127
    v_cvt_pk_bf16_f32 v220, v120, v121
    v_cvt_pk_bf16_f32 v221, v122, v123
    v_cvt_pk_bf16_f32 v222, v124, v125
    v_cvt_pk_bf16_f32 v223, v126, v127
    v_add_u32 v6, 0x10000, v1
    v_add_u32 v13, 0x20000, v1
    v_mov_b32 v14, 1
    s_cmp_lt_u32 s68, 14
    s_cselect_b32 s3, 8, 0
    v_min_u32 v15, 1, v2
    v_add_u32 v15, s3, v15
    v_mul_u32_u24 v15, 6144, v15
    s_waitcnt vmcnt(14)
    s_barrier
    ds_read_b128 v[96:99], v6 offset:32768
    ds_read_b128 v[100:103], v6 offset:33792
    ds_read_b128 v[104:107], v6 offset:34816
    ds_read_b128 v[108:111], v6 offset:35840
    ds_read_b128 v[112:115], v6 offset:36864
    ds_read_b128 v[116:119], v6 offset:37888
    ds_read_b128 v[120:123], v6 offset:38912
    ds_read_b128 v[124:127], v6 offset:39936
    s_waitcnt lgkmcnt(4)
    v_mfma_f32_16x16x32_bf16 a[0:3], v[96:99], v[160:163], 0
    ds_read_b128 v[128:131], v6 offset:40960
    v_mfma_f32_16x16x32_bf16 a[4:7], v[96:99], v[164:167], 0
    s_add_u32 s39, s38, 147456
    s_add_u32 m0, s24, 81920
    v_mfma_f32_16x16x32_bf16 a[8:11], v[100:103], v[160:163], 0
    ds_read_b128 v[132:135], v6 offset:41984
    v_mfma_f32_16x16x32_bf16 a[12:15], v[100:103], v[164:167], 0
    buffer_load_dwordx4 v4, s[12:15], s39 offen offset:0 lds
    v_mfma_f32_16x16x32_bf16 a[16:19], v[104:107], v[160:163], 0
    ds_read_b128 v[136:139], v6 offset:43008
    v_mfma_f32_16x16x32_bf16 a[20:23], v[104:107], v[164:167], 0
    buffer_load_dwordx4 v[64:67], v1, s[12:15], s72 offen offset:2048 sc1
    v_mfma_f32_16x16x32_bf16 a[24:27], v[108:111], v[160:163], 0
    ds_read_b128 v[140:143], v6 offset:44032
    v_mfma_f32_16x16x32_bf16 a[28:31], v[108:111], v[164:167], 0
    s_waitcnt lgkmcnt(4)
    v_mfma_f32_16x16x32_bf16 a[32:35], v[112:115], v[160:163], 0
    ds_read_b128 v[144:147], v6 offset:45056
    v_mfma_f32_16x16x32_bf16 a[36:39], v[112:115], v[164:167], 0
    buffer_store_dwordx4 v[228:231], v1, s[12:15], s90 offen offset:1024 sc1
    v_mfma_f32_16x16x32_bf16 a[40:43], v[116:119], v[160:163], 0
    ds_read_b128 v[148:151], v6 offset:46080
    s_lshl_b32 s86, s31, 2
    v_mfma_f32_16x16x32_bf16 a[44:47], v[116:119], v[164:167], 0
    buffer_load_dwordx4 v4, s[12:15], s39 offen offset:1024 lds
    v_mfma_f32_16x16x32_bf16 a[48:51], v[120:123], v[160:163], 0
    ds_read_b128 v[152:155], v6 offset:47104
    s_sub_u32 s34, 28, s86
    v_mfma_f32_16x16x32_bf16 a[52:55], v[120:123], v[164:167], 0
    buffer_load_dwordx4 v[68:71], v5, s[12:15], s72 offen offset:2048 sc1
    v_mfma_f32_16x16x32_bf16 a[56:59], v[124:127], v[160:163], 0
    ds_read_b128 v[156:159], v6 offset:48128
    s_add_u32 s35, s86, 4
    v_mfma_f32_16x16x32_bf16 a[60:63], v[124:127], v[164:167], 0
    s_waitcnt lgkmcnt(4)
    v_mfma_f32_16x16x32_bf16 a[64:67], v[128:131], v[160:163], 0
    ds_read_b128 v[96:99], v6 offset:49152
    v_mfma_f32_16x16x32_bf16 a[68:71], v[128:131], v[164:167], 0
    s_cmp_eq_u32 s32, 1
    s_cselect_b32 s87, 36, 32
    v_mfma_f32_16x16x32_bf16 a[72:75], v[132:135], v[160:163], 0
    ds_read_b128 v[100:103], v6 offset:50176
    v_mfma_f32_16x16x32_bf16 a[76:79], v[132:135], v[164:167], 0
    buffer_load_dwordx4 v4, s[12:15], s39 offen offset:2048 lds
    v_mfma_f32_16x16x32_bf16 a[80:83], v[136:139], v[160:163], 0
    ds_read_b128 v[104:107], v6 offset:51200
    v_mfma_f32_16x16x32_bf16 a[84:87], v[136:139], v[164:167], 0
    buffer_load_dwordx4 v[72:75], v1, s[12:15], s72 offen offset:3072 sc1
    v_mfma_f32_16x16x32_bf16 a[88:91], v[140:143], v[160:163], 0
    ds_read_b128 v[108:111], v6 offset:52224
    v_mfma_f32_16x16x32_bf16 a[92:95], v[140:143], v[164:167], 0
    s_waitcnt lgkmcnt(4)
    v_mfma_f32_16x16x32_bf16 a[96:99], v[144:147], v[160:163], 0
    ds_read_b128 v[112:115], v6 offset:53248
    v_mfma_f32_16x16x32_bf16 a[100:103], v[144:147], v[164:167], 0
    s_cmp_lt_u32 s68, 14
    s_cselect_b32 s34, s34, s87
    s_cselect_b32 s35, s35, 0
    s_cselect_b32 s87, 1225728, 0
    v_mfma_f32_16x16x32_bf16 a[104:107], v[148:151], v[160:163], 0
    ds_read_b128 v[116:119], v6 offset:54272
    s_mov_b32 s37, 0x47800000
    v_mfma_f32_16x16x32_bf16 a[108:111], v[148:151], v[164:167], 0
    buffer_load_dwordx4 v4, s[12:15], s39 offen offset:3072 lds
    v_mfma_f32_16x16x32_bf16 a[112:115], v[152:155], v[160:163], 0
    ds_read_b128 v[120:123], v6 offset:55296
    v_mfma_f32_16x16x32_bf16 a[116:119], v[152:155], v[164:167], 0
    buffer_load_dwordx4 v[76:79], v5, s[12:15], s72 offen offset:3072 sc1
    v_mfma_f32_16x16x32_bf16 a[120:123], v[156:159], v[160:163], 0
    ds_read_b128 v[124:127], v6 offset:56320
    v_mfma_f32_16x16x32_bf16 a[124:127], v[156:159], v[164:167], 0
    s_waitcnt lgkmcnt(4)
    v_mfma_f32_16x16x32_bf16 a[0:3], v[96:99], v[168:171], a[0:3]
    ds_read_b128 v[128:131], v6 offset:57344
    v_mfma_f32_16x16x32_bf16 a[4:7], v[96:99], v[172:175], a[4:7]
    buffer_store_dwordx4 v[232:235], v1, s[12:15], s90 offen offset:2048 sc1
    v_mfma_f32_16x16x32_bf16 a[8:11], v[100:103], v[168:171], a[8:11]
    ds_read_b128 v[132:135], v6 offset:58368
    s_mul_i32 s88, s30, 2181376
    v_mfma_f32_16x16x32_bf16 a[12:15], v[100:103], v[172:175], a[12:15]
    s_add_u32 s88, s88, 117440512
    s_add_u32 s25, s88, s87
    v_mfma_f32_16x16x32_bf16 a[16:19], v[104:107], v[168:171], a[16:19]
    ds_read_b128 v[136:139], v6 offset:59392
    s_sub_u32 s89, s34, 1
    v_mfma_f32_16x16x32_bf16 a[20:23], v[104:107], v[172:175], a[20:23]
    buffer_load_dwordx4 v[80:83], v1, s[12:15], s73 offen offset:0 sc1
    v_mfma_f32_16x16x32_bf16 a[24:27], v[108:111], v[168:171], a[24:27]
    ds_read_b128 v[140:143], v6 offset:60416
    v_subrev_u32 v9, 0, v2
    v_mfma_f32_16x16x32_bf16 a[28:31], v[108:111], v[172:175], a[28:31]
    v_min_i32 v10, s89, v9
    s_waitcnt lgkmcnt(4)
    v_mfma_f32_16x16x32_bf16 a[32:35], v[112:115], v[168:171], a[32:35]
    ds_read_b128 v[144:147], v6 offset:61440
    v_mfma_f32_16x16x32_bf16 a[36:39], v[112:115], v[172:175], a[36:39]
    buffer_store_dwordx4 v[236:239], v1, s[12:15], s90 offen offset:3072 sc1
    v_mfma_f32_16x16x32_bf16 a[40:43], v[116:119], v[168:171], a[40:43]
    ds_read_b128 v[148:151], v6 offset:62464
    v_subrev_u32 v11, 1, v9
    v_mfma_f32_16x16x32_bf16 a[44:47], v[116:119], v[172:175], a[44:47]
    v_max_i32 v11, 0, v11
    v_min_i32 v11, s89, v11
    v_mfma_f32_16x16x32_bf16 a[48:51], v[120:123], v[168:171], a[48:51]
    ds_read_b128 v[152:155], v6 offset:63488
    v_mul_i32_i24 v10, 34048, v10
    v_mfma_f32_16x16x32_bf16 a[52:55], v[120:123], v[172:175], a[52:55]
    buffer_load_dwordx4 v[84:87], v5, s[12:15], s73 offen offset:0 sc1
    v_mfma_f32_16x16x32_bf16 a[56:59], v[124:127], v[168:171], a[56:59]
    ds_read_b128 v[156:159], v6 offset:64512
    v_mul_i32_i24 v11, 34048, v11
    v_mfma_f32_16x16x32_bf16 a[60:63], v[124:127], v[172:175], a[60:63]
    v_add_u32 v10, s25, v10
    s_waitcnt lgkmcnt(4)
    v_mfma_f32_16x16x32_bf16 a[64:67], v[128:131], v[168:171], a[64:67]
    ds_read_b128 v[96:99], v1 offset:0
    s_add_u32 s90, s91, 34048
    v_mfma_f32_16x16x32_bf16 a[68:71], v[128:131], v[172:175], a[68:71]
    buffer_store_dwordx4 v[240:243], v1, s[12:15], s90 offen offset:0 sc1
    v_mfma_f32_16x16x32_bf16 a[72:75], v[132:135], v[168:171], a[72:75]
    ds_read_b128 v[100:103], v1 offset:1024
    v_add_u32 v11, s25, v11
    v_mfma_f32_16x16x32_bf16 a[76:79], v[132:135], v[172:175], a[76:79]
    v_add_u32 v11, 0x4000, v11
    v_mfma_f32_16x16x32_bf16 a[80:83], v[136:139], v[168:171], a[80:83]
    ds_read_b128 v[104:107], v1 offset:2048
    v_mfma_f32_16x16x32_bf16 a[84:87], v[136:139], v[172:175], a[84:87]
    buffer_load_dwordx4 v[88:91], v1, s[12:15], s73 offen offset:1024 sc1
    v_mfma_f32_16x16x32_bf16 a[88:91], v[140:143], v[168:171], a[88:91]
    ds_read_b128 v[108:111], v1 offset:3072
    v_mov_b32 v7, v10
    v_mfma_f32_16x16x32_bf16 a[92:95], v[140:143], v[172:175], a[92:95]
    v_mov_b32 v8, v11
    s_waitcnt lgkmcnt(4)
    v_mfma_f32_16x16x32_bf16 a[96:99], v[144:147], v[168:171], a[96:99]
    ds_read_b128 v[112:115], v1 offset:4096
    s_add_u32 s86, s86, 3
    v_mfma_f32_16x16x32_bf16 a[100:103], v[144:147], v[172:175], a[100:103]
    v_mfma_f32_16x16x32_bf16 a[104:107], v[148:151], v[168:171], a[104:107]
    ds_read_b128 v[116:119], v1 offset:5120
    s_mul_i32 s86, s86, 34048
    v_mfma_f32_16x16x32_bf16 a[108:111], v[148:151], v[172:175], a[108:111]
    buffer_load_dwordx4 v[92:95], v5, s[12:15], s73 offen offset:1024 sc1
    v_mfma_f32_16x16x32_bf16 a[112:115], v[152:155], v[168:171], a[112:115]
    ds_read_b128 v[120:123], v1 offset:6144
    v_mfma_f32_16x16x32_bf16 a[116:119], v[152:155], v[172:175], a[116:119]
    v_mfma_f32_16x16x32_bf16 a[120:123], v[156:159], v[168:171], a[120:123]
    ds_read_b128 v[124:127], v1 offset:7168
    v_mfma_f32_16x16x32_bf16 a[124:127], v[156:159], v[172:175], a[124:127]
    s_waitcnt lgkmcnt(4)
    v_mfma_f32_16x16x32_bf16 a[0:3], v[96:99], v[176:179], a[0:3]
    ds_read_b128 v[128:131], v1 offset:8192
    v_mfma_f32_16x16x32_bf16 a[4:7], v[96:99], v[180:183], a[4:7]
    buffer_store_dwordx4 v[244:247], v1, s[12:15], s90 offen offset:1024 sc1
    v_mfma_f32_16x16x32_bf16 a[8:11], v[100:103], v[176:179], a[8:11]
    ds_read_b128 v[132:135], v1 offset:9216
    s_add_u32 s25, s88, s86
    v_mfma_f32_16x16x32_bf16 a[12:15], v[100:103], v[180:183], a[12:15]
    s_sub_u32 s89, s35, 1
    v_subrev_u32 v9, s34, v2
    v_mfma_f32_16x16x32_bf16 a[16:19], v[104:107], v[176:179], a[16:19]
    ds_read_b128 v[136:139], v1 offset:10240
    v_min_i32 v10, s89, v9
    v_mfma_f32_16x16x32_bf16 a[20:23], v[104:107], v[180:183], a[20:23]
    v_subrev_u32 v11, 1, v9
    v_max_i32 v11, 0, v11
    v_mfma_f32_16x16x32_bf16 a[24:27], v[108:111], v[176:179], a[24:27]
    ds_read_b128 v[140:143], v1 offset:11264
    v_min_i32 v11, s89, v11
    v_mfma_f32_16x16x32_bf16 a[28:31], v[108:111], v[180:183], a[28:31]
    v_mul_i32_i24 v10, -34048, v10
    s_waitcnt lgkmcnt(4)
    v_mfma_f32_16x16x32_bf16 a[32:35], v[112:115], v[176:179], a[32:35]
    ds_read_b128 v[144:147], v1 offset:12288
    v_mul_i32_i24 v11, -34048, v11
    v_mfma_f32_16x16x32_bf16 a[36:39], v[112:115], v[180:183], a[36:39]
    v_add_u32 v10, s25, v10
    v_add_u32 v11, s25, v11
    v_mfma_f32_16x16x32_bf16 a[40:43], v[116:119], v[176:179], a[40:43]
    ds_read_b128 v[148:151], v1 offset:13312
    v_add_u32 v11, 0x4000, v11
    v_mfma_f32_16x16x32_bf16 a[44:47], v[116:119], v[180:183], a[44:47]
    buffer_store_dwordx4 v[248:251], v1, s[12:15], s90 offen offset:2048 sc1
    v_mfma_f32_16x16x32_bf16 a[48:51], v[120:123], v[176:179], a[48:51]
    ds_read_b128 v[152:155], v1 offset:14336
    v_cmp_le_i32 vcc, 0, v9
    v_mfma_f32_16x16x32_bf16 a[52:55], v[120:123], v[180:183], a[52:55]
    s_nop 1
    v_cndmask_b32 v7, v7, v10, vcc
    v_mfma_f32_16x16x32_bf16 a[56:59], v[124:127], v[176:179], a[56:59]
    ds_read_b128 v[156:159], v1 offset:15360
    v_cmp_le_i32 vcc, 1, v9
    v_mfma_f32_16x16x32_bf16 a[60:63], v[124:127], v[180:183], a[60:63]
    s_nop 1
    s_waitcnt lgkmcnt(4)
    v_mfma_f32_16x16x32_bf16 a[64:67], v[128:131], v[176:179], a[64:67]
    ds_read_b128 v[96:99], v1 offset:16384
    v_cndmask_b32 v8, v8, v11, vcc
    v_mfma_f32_16x16x32_bf16 a[68:71], v[128:131], v[180:183], a[68:71]
    s_add_u32 s69, s34, s35
    s_add_u32 s69, s69, 1
    v_mfma_f32_16x16x32_bf16 a[72:75], v[132:135], v[176:179], a[72:75]
    ds_read_b128 v[100:103], v1 offset:17408
    s_mul_i32 s25, s30, 229376
    v_mfma_f32_16x16x32_bf16 a[76:79], v[132:135], v[180:183], a[76:79]
    s_add_u32 s25, s25, 39845888
    v_mfma_f32_16x16x32_bf16 a[80:83], v[136:139], v[176:179], a[80:83]
    ds_read_b128 v[104:107], v1 offset:18432
    v_subrev_u32 v9, s69, v2
    v_mfma_f32_16x16x32_bf16 a[84:87], v[136:139], v[180:183], a[84:87]
    v_min_i32 v10, 6, v9
    v_mfma_f32_16x16x32_bf16 a[88:91], v[140:143], v[176:179], a[88:91]
    ds_read_b128 v[108:111], v1 offset:19456
    v_mfma_f32_16x16x32_bf16 a[92:95], v[140:143], v[180:183], a[92:95]
    s_waitcnt lgkmcnt(4)
    v_mfma_f32_16x16x32_bf16 a[96:99], v[144:147], v[176:179], a[96:99]
    ds_read_b128 v[112:115], v1 offset:20480
    v_mfma_f32_16x16x32_bf16 a[100:103], v[144:147], v[180:183], a[100:103]
    buffer_store_dwordx4 v[252:255], v1, s[12:15], s90 offen offset:3072 sc1
    v_mfma_f32_16x16x32_bf16 a[104:107], v[148:151], v[176:179], a[104:107]
    ds_read_b128 v[116:119], v1 offset:21504
    v_subrev_u32 v11, 0, v9
    v_mfma_f32_16x16x32_bf16 a[108:111], v[148:151], v[180:183], a[108:111]
    v_max_i32 v11, 0, v11
    v_min_i32 v11, 6, v11
    v_mfma_f32_16x16x32_bf16 a[112:115], v[152:155], v[176:179], a[112:115]
    ds_read_b128 v[120:123], v1 offset:22528
    v_mul_i32_i24 v10, 32768, v10
    v_mfma_f32_16x16x32_bf16 a[116:119], v[152:155], v[180:183], a[116:119]
    v_mul_i32_i24 v11, 32768, v11
    v_add_u32 v10, s25, v10
    v_mfma_f32_16x16x32_bf16 a[120:123], v[156:159], v[176:179], a[120:123]
    ds_read_b128 v[124:127], v1 offset:23552
    v_add_u32 v11, s25, v11
    v_mfma_f32_16x16x32_bf16 a[124:127], v[156:159], v[180:183], a[124:127]
    v_add_u32 v11, 0x4000, v11
    s_waitcnt lgkmcnt(4)
    v_mfma_f32_16x16x32_bf16 a[0:3], v[96:99], v[184:187], a[0:3]
    ds_read_b128 v[128:131], v1 offset:24576
    v_cmp_le_i32 vcc, 0, v9
    v_mfma_f32_16x16x32_bf16 a[4:7], v[96:99], v[188:191], a[4:7]
    s_nop 1
    v_cndmask_b32 v7, v7, v10, vcc
    v_mfma_f32_16x16x32_bf16 a[8:11], v[100:103], v[184:187], a[8:11]
    ds_read_b128 v[132:135], v1 offset:25600
    v_cmp_le_i32 vcc, 0, v9
    v_mfma_f32_16x16x32_bf16 a[12:15], v[100:103], v[188:191], a[12:15]
    s_add_u32 s90, s91, 42240
    v_mfma_f32_16x16x32_bf16 a[16:19], v[104:107], v[184:187], a[16:19]
    ds_read_b128 v[136:139], v1 offset:26624
    v_mfma_f32_16x16x32_bf16 a[20:23], v[104:107], v[188:191], a[20:23]
    buffer_store_dwordx4 v[208:211], v1, s[12:15], s90 offen offset:0 sc1
    v_mfma_f32_16x16x32_bf16 a[24:27], v[108:111], v[184:187], a[24:27]
    ds_read_b128 v[140:143], v1 offset:27648
    s_nop 1
    v_mfma_f32_16x16x32_bf16 a[28:31], v[108:111], v[188:191], a[28:31]
    v_cndmask_b32 v8, v8, v11, vcc
    s_waitcnt lgkmcnt(4)
    v_mfma_f32_16x16x32_bf16 a[32:35], v[112:115], v[184:187], a[32:35]
    ds_read_b128 v[144:147], v1 offset:28672
    s_and_b32 s86, s68, 1
    v_mfma_f32_16x16x32_bf16 a[36:39], v[112:115], v[188:191], a[36:39]
    s_lshl_b32 s78, s67, 1
    s_add_u32 s78, s78, s86
    v_mfma_f32_16x16x32_bf16 a[40:43], v[116:119], v[184:187], a[40:43]
    ds_read_b128 v[148:151], v1 offset:29696
    s_lshr_b32 s79, s68, 1
    v_mfma_f32_16x16x32_bf16 a[44:47], v[116:119], v[188:191], a[44:47]
    s_add_u32 s69, s69, 7
    s_min_u32 s25, s79, 13
    v_mfma_f32_16x16x32_bf16 a[48:51], v[120:123], v[184:187], a[48:51]
    ds_read_b128 v[152:155], v1 offset:30720
    s_mul_i32 s25, s25, 229376
    v_mfma_f32_16x16x32_bf16 a[52:55], v[120:123], v[188:191], a[52:55]
    s_add_u32 s25, s25, 44040192
    v_mfma_f32_16x16x32_bf16 a[56:59], v[124:127], v[184:187], a[56:59]
    ds_read_b128 v[156:159], v1 offset:31744
    v_subrev_u32 v9, s69, v2
    v_mfma_f32_16x16x32_bf16 a[60:63], v[124:127], v[188:191], a[60:63]
    v_min_i32 v10, 6, v9
    s_waitcnt lgkmcnt(4)
    v_mfma_f32_16x16x32_bf16 a[64:67], v[128:131], v[184:187], a[64:67]
    ds_read_b128 v[96:99], v13 offset:0
    v_mfma_f32_16x16x32_bf16 a[68:71], v[128:131], v[188:191], a[68:71]
    buffer_store_dwordx4 v[212:215], v1, s[12:15], s90 offen offset:1024 sc1
    v_mfma_f32_16x16x32_bf16 a[72:75], v[132:135], v[184:187], a[72:75]
    ds_read_b128 v[100:103], v13 offset:1024
    v_subrev_u32 v11, 0, v9
    v_mfma_f32_16x16x32_bf16 a[76:79], v[132:135], v[188:191], a[76:79]
    v_max_i32 v11, 0, v11
    v_min_i32 v11, 6, v11
    v_mfma_f32_16x16x32_bf16 a[80:83], v[136:139], v[184:187], a[80:83]
    ds_read_b128 v[104:107], v13 offset:2048
    v_mul_i32_i24 v10, 32768, v10
    v_mfma_f32_16x16x32_bf16 a[84:87], v[136:139], v[188:191], a[84:87]
    v_mul_i32_i24 v11, 32768, v11
    v_mfma_f32_16x16x32_bf16 a[88:91], v[140:143], v[184:187], a[88:91]
    ds_read_b128 v[108:111], v13 offset:3072
    v_add_u32 v10, s25, v10
    v_mfma_f32_16x16x32_bf16 a[92:95], v[140:143], v[188:191], a[92:95]
    v_add_u32 v11, s25, v11
    s_waitcnt lgkmcnt(4)
    v_mfma_f32_16x16x32_bf16 a[96:99], v[144:147], v[184:187], a[96:99]
    ds_read_b128 v[112:115], v13 offset:4096
    v_add_u32 v11, 0x4000, v11
    v_mfma_f32_16x16x32_bf16 a[100:103], v[144:147], v[188:191], a[100:103]
    v_cmp_le_i32 vcc, 0, v9
    s_nop 1
    v_mfma_f32_16x16x32_bf16 a[104:107], v[148:151], v[184:187], a[104:107]
    ds_read_b128 v[116:119], v13 offset:5120
    v_cndmask_b32 v7, v7, v10, vcc
    v_mfma_f32_16x16x32_bf16 a[108:111], v[148:151], v[188:191], a[108:111]
    v_cmp_le_i32 vcc, 0, v9
    v_mfma_f32_16x16x32_bf16 a[112:115], v[152:155], v[184:187], a[112:115]
    ds_read_b128 v[120:123], v13 offset:6144
    v_mfma_f32_16x16x32_bf16 a[116:119], v[152:155], v[188:191], a[116:119]
    v_mfma_f32_16x16x32_bf16 a[120:123], v[156:159], v[184:187], a[120:123]
    ds_read_b128 v[124:127], v13 offset:7168
    v_mfma_f32_16x16x32_bf16 a[124:127], v[156:159], v[188:191], a[124:127]
    s_waitcnt lgkmcnt(4)
    s_waitcnt vmcnt(25)
    s_barrier
    v_mfma_f32_16x16x32_bf16 a[0:3], v[96:99], v[192:195], a[0:3]
    ds_read_b128 v[128:131], v13 offset:8192
    v_mfma_f32_16x16x32_bf16 a[4:7], v[96:99], v[196:199], a[4:7]
    s_add_u32 s39, s38, 163840
    s_add_u32 m0, s24, 0
    v_mfma_f32_16x16x32_bf16 a[8:11], v[100:103], v[192:195], a[8:11]
    ds_read_b128 v[132:135], v13 offset:9216
    v_mfma_f32_16x16x32_bf16 a[12:15], v[100:103], v[196:199], a[12:15]
    buffer_load_dwordx4 v4, s[12:15], s39 offen offset:0 lds
    v_mfma_f32_16x16x32_bf16 a[16:19], v[104:107], v[192:195], a[16:19]
    ds_read_b128 v[136:139], v13 offset:10240
    v_mfma_f32_16x16x32_bf16 a[20:23], v[104:107], v[196:199], a[20:23]
    v_mfma_f32_16x16x32_bf16 a[24:27], v[108:111], v[192:195], a[24:27]
    ds_read_b128 v[140:143], v13 offset:11264
    v_mfma_f32_16x16x32_bf16 a[28:31], v[108:111], v[196:199], a[28:31]
    s_waitcnt lgkmcnt(4)
    v_mfma_f32_16x16x32_bf16 a[32:35], v[112:115], v[192:195], a[32:35]
    ds_read_b128 v[144:147], v13 offset:12288
    v_mfma_f32_16x16x32_bf16 a[36:39], v[112:115], v[196:199], a[36:39]
    v_mfma_f32_16x16x32_bf16 a[40:43], v[116:119], v[192:195], a[40:43]
    ds_read_b128 v[148:151], v13 offset:13312
    v_mfma_f32_16x16x32_bf16 a[44:47], v[116:119], v[196:199], a[44:47]
    buffer_load_dwordx4 v4, s[12:15], s39 offen offset:1024 lds
    v_mfma_f32_16x16x32_bf16 a[48:51], v[120:123], v[192:195], a[48:51]
    ds_read_b128 v[152:155], v13 offset:14336
    v_mfma_f32_16x16x32_bf16 a[52:55], v[120:123], v[196:199], a[52:55]
    buffer_store_dwordx4 v[216:219], v1, s[12:15], s90 offen offset:2048 sc1
    v_mfma_f32_16x16x32_bf16 a[56:59], v[124:127], v[192:195], a[56:59]
    ds_read_b128 v[156:159], v13 offset:15360
    v_mfma_f32_16x16x32_bf16 a[60:63], v[124:127], v[196:199], a[60:63]
    s_waitcnt lgkmcnt(4)
    v_mfma_f32_16x16x32_bf16 a[64:67], v[128:131], v[192:195], a[64:67]
    ds_read_b128 v[96:99], v13 offset:16384
    v_mfma_f32_16x16x32_bf16 a[68:71], v[128:131], v[196:199], a[68:71]
    v_mfma_f32_16x16x32_bf16 a[72:75], v[132:135], v[192:195], a[72:75]
    ds_read_b128 v[100:103], v13 offset:17408
    v_mfma_f32_16x16x32_bf16 a[76:79], v[132:135], v[196:199], a[76:79]
    buffer_load_dwordx4 v4, s[12:15], s39 offen offset:2048 lds
    v_mfma_f32_16x16x32_bf16 a[80:83], v[136:139], v[192:195], a[80:83]
    ds_read_b128 v[104:107], v13 offset:18432
    v_mfma_f32_16x16x32_bf16 a[84:87], v[136:139], v[196:199], a[84:87]
    v_mfma_f32_16x16x32_bf16 a[88:91], v[140:143], v[192:195], a[88:91]
    ds_read_b128 v[108:111], v13 offset:19456
    v_mfma_f32_16x16x32_bf16 a[92:95], v[140:143], v[196:199], a[92:95]
    s_waitcnt lgkmcnt(4)
    v_mfma_f32_16x16x32_bf16 a[96:99], v[144:147], v[192:195], a[96:99]
    ds_read_b128 v[112:115], v13 offset:20480
    v_mfma_f32_16x16x32_bf16 a[100:103], v[144:147], v[196:199], a[100:103]
    buffer_store_dwordx4 v[220:223], v1, s[12:15], s90 offen offset:3072 sc1
    v_mfma_f32_16x16x32_bf16 a[104:107], v[148:151], v[192:195], a[104:107]
    ds_read_b128 v[116:119], v13 offset:21504
    v_mfma_f32_16x16x32_bf16 a[108:111], v[148:151], v[196:199], a[108:111]
    buffer_load_dwordx4 v4, s[12:15], s39 offen offset:3072 lds
    v_mfma_f32_16x16x32_bf16 a[112:115], v[152:155], v[192:195], a[112:115]
    ds_read_b128 v[120:123], v13 offset:22528
    v_accvgpr_read_b32 v16, a128
    v_mfma_f32_16x16x32_bf16 a[116:119], v[152:155], v[196:199], a[116:119]
    v_accvgpr_read_b32 v17, a129
    v_mfma_f32_16x16x32_bf16 a[120:123], v[156:159], v[192:195], a[120:123]
    ds_read_b128 v[124:127], v13 offset:23552
    v_accvgpr_read_b32 v18, a130
    v_mfma_f32_16x16x32_bf16 a[124:127], v[156:159], v[196:199], a[124:127]
    v_accvgpr_read_b32 v19, a131
    s_waitcnt lgkmcnt(4)
    v_mfma_f32_16x16x32_bf16 a[0:3], v[96:99], v[200:203], a[0:3]
    ds_read_b128 v[128:131], v13 offset:24576
    v_accvgpr_read_b32 v20, a132
    v_mfma_f32_16x16x32_bf16 a[4:7], v[96:99], v[204:207], a[4:7]
    s_add_u32 s39, s38, 180224
    s_add_u32 m0, s24, 16384
    v_mfma_f32_16x16x32_bf16 a[8:11], v[100:103], v[200:203], a[8:11]
    ds_read_b128 v[132:135], v13 offset:25600
    v_accvgpr_read_b32 v21, a133
    v_mfma_f32_16x16x32_bf16 a[12:15], v[100:103], v[204:207], a[12:15]
    buffer_load_dwordx4 v4, s[12:15], s39 offen offset:0 lds
    v_mfma_f32_16x16x32_bf16 a[16:19], v[104:107], v[200:203], a[16:19]
    ds_read_b128 v[136:139], v13 offset:26624
    v_accvgpr_read_b32 v22, a134
    v_mfma_f32_16x16x32_bf16 a[20:23], v[104:107], v[204:207], a[20:23]
    v_accvgpr_read_b32 v23, a135
    v_cvt_pk_bf16_f32 v224, v16, v17
    v_mfma_f32_16x16x32_bf16 a[24:27], v[108:111], v[200:203], a[24:27]
    ds_read_b128 v[140:143], v13 offset:27648
    v_cvt_pk_bf16_f32 v225, v18, v19
    v_mfma_f32_16x16x32_bf16 a[28:31], v[108:111], v[204:207], a[28:31]
    v_cvt_pk_bf16_f32 v226, v20, v21
    s_waitcnt lgkmcnt(4)
    v_mfma_f32_16x16x32_bf16 a[32:35], v[112:115], v[200:203], a[32:35]
    ds_read_b128 v[144:147], v13 offset:28672
    v_cvt_pk_bf16_f32 v227, v22, v23
    v_mfma_f32_16x16x32_bf16 a[36:39], v[112:115], v[204:207], a[36:39]
    s_add_u32 s90, s91, 68096
    v_mfma_f32_16x16x32_bf16 a[40:43], v[116:119], v[200:203], a[40:43]
    ds_read_b128 v[148:151], v13 offset:29696
    v_mfma_f32_16x16x32_bf16 a[44:47], v[116:119], v[204:207], a[44:47]
    buffer_load_dwordx4 v4, s[12:15], s39 offen offset:1024 lds
    v_mfma_f32_16x16x32_bf16 a[48:51], v[120:123], v[200:203], a[48:51]
    ds_read_b128 v[152:155], v13 offset:30720
    v_mfma_f32_16x16x32_bf16 a[52:55], v[120:123], v[204:207], a[52:55]
    buffer_store_dwordx4 v[224:227], v1, s[12:15], s90 offen offset:0 sc1
    v_mfma_f32_16x16x32_bf16 a[56:59], v[124:127], v[200:203], a[56:59]
    ds_read_b128 v[156:159], v13 offset:31744
    v_accvgpr_read_b32 v16, a136
    v_mfma_f32_16x16x32_bf16 a[60:63], v[124:127], v[204:207], a[60:63]
    v_accvgpr_read_b32 v17, a137
    s_waitcnt lgkmcnt(4)
    v_mfma_f32_16x16x32_bf16 a[64:67], v[128:131], v[200:203], a[64:67]
    ds_read_b128 v[96:99], v1 offset:32768
    v_accvgpr_read_b32 v18, a138
    v_mfma_f32_16x16x32_bf16 a[68:71], v[128:131], v[204:207], a[68:71]
    v_accvgpr_read_b32 v19, a139
    v_accvgpr_read_b32 v20, a140
    v_mfma_f32_16x16x32_bf16 a[72:75], v[132:135], v[200:203], a[72:75]
    ds_read_b128 v[100:103], v1 offset:33792
    v_accvgpr_read_b32 v21, a141
    v_mfma_f32_16x16x32_bf16 a[76:79], v[132:135], v[204:207], a[76:79]
    buffer_load_dwordx4 v4, s[12:15], s39 offen offset:2048 lds
    v_mfma_f32_16x16x32_bf16 a[80:83], v[136:139], v[200:203], a[80:83]
    ds_read_b128 v[104:107], v1 offset:34816
    v_accvgpr_read_b32 v22, a142
    v_mfma_f32_16x16x32_bf16 a[84:87], v[136:139], v[204:207], a[84:87]
    v_accvgpr_read_b32 v23, a143
    v_cvt_pk_bf16_f32 v228, v16, v17
    v_mfma_f32_16x16x32_bf16 a[88:91], v[140:143], v[200:203], a[88:91]
    ds_read_b128 v[108:111], v1 offset:35840
    v_cvt_pk_bf16_f32 v229, v18, v19
    v_mfma_f32_16x16x32_bf16 a[92:95], v[140:143], v[204:207], a[92:95]
    v_cvt_pk_bf16_f32 v230, v20, v21
    s_waitcnt lgkmcnt(4)
    v_mfma_f32_16x16x32_bf16 a[96:99], v[144:147], v[200:203], a[96:99]
    ds_read_b128 v[112:115], v1 offset:36864
    v_cvt_pk_bf16_f32 v231, v22, v23
    v_mfma_f32_16x16x32_bf16 a[100:103], v[144:147], v[204:207], a[100:103]
    v_mfma_f32_16x16x32_bf16 a[104:107], v[148:151], v[200:203], a[104:107]
    ds_read_b128 v[116:119], v1 offset:37888
    v_mfma_f32_16x16x32_bf16 a[108:111], v[148:151], v[204:207], a[108:111]
    buffer_load_dwordx4 v4, s[12:15], s39 offen offset:3072 lds
    v_mfma_f32_16x16x32_bf16 a[112:115], v[152:155], v[200:203], a[112:115]
    ds_read_b128 v[120:123], v1 offset:38912
    v_mfma_f32_16x16x32_bf16 a[116:119], v[152:155], v[204:207], a[116:119]
    buffer_store_dwordx4 v[228:231], v1, s[12:15], s90 offen offset:1024 sc1
    v_mfma_f32_16x16x32_bf16 a[120:123], v[156:159], v[200:203], a[120:123]
    ds_read_b128 v[124:127], v1 offset:39936
    v_mfma_f32_16x16x32_bf16 a[124:127], v[156:159], v[204:207], a[124:127]
    s_waitcnt lgkmcnt(4)
    s_waitcnt vmcnt(17)
    s_barrier
    v_mfma_f32_16x16x32_bf16 a[0:3], v[96:99], v[32:35], a[0:3]
    ds_read_b128 v[128:131], v1 offset:40960
    v_accvgpr_read_b32 v16, a144
    v_mfma_f32_16x16x32_bf16 a[4:7], v[96:99], v[36:39], a[4:7]
    s_add_u32 s39, s38, 196608
    s_add_u32 m0, s24, 131072
    v_mfma_f32_16x16x32_bf16 a[8:11], v[100:103], v[32:35], a[8:11]
    ds_read_b128 v[132:135], v1 offset:41984
    v_accvgpr_read_b32 v17, a145
    v_mfma_f32_16x16x32_bf16 a[12:15], v[100:103], v[36:39], a[12:15]
    buffer_load_dwordx4 v4, s[12:15], s39 offen offset:0 lds
    v_mfma_f32_16x16x32_bf16 a[16:19], v[104:107], v[32:35], a[16:19]
    ds_read_b128 v[136:139], v1 offset:43008
    v_accvgpr_read_b32 v18, a146
    v_mfma_f32_16x16x32_bf16 a[20:23], v[104:107], v[36:39], a[20:23]
    v_accvgpr_read_b32 v19, a147
    v_accvgpr_read_b32 v20, a148
    v_mfma_f32_16x16x32_bf16 a[24:27], v[108:111], v[32:35], a[24:27]
    ds_read_b128 v[140:143], v1 offset:44032
    v_accvgpr_read_b32 v21, a149
    v_mfma_f32_16x16x32_bf16 a[28:31], v[108:111], v[36:39], a[28:31]
    v_accvgpr_read_b32 v22, a150
    s_waitcnt lgkmcnt(4)
    v_mfma_f32_16x16x32_bf16 a[32:35], v[112:115], v[32:35], a[32:35]
    ds_read_b128 v[144:147], v1 offset:45056
    v_accvgpr_read_b32 v23, a151
    v_mfma_f32_16x16x32_bf16 a[36:39], v[112:115], v[36:39], a[36:39]
    v_cvt_pk_bf16_f32 v232, v16, v17
    v_cvt_pk_bf16_f32 v233, v18, v19
    v_mfma_f32_16x16x32_bf16 a[40:43], v[116:119], v[32:35], a[40:43]
    ds_read_b128 v[148:151], v1 offset:46080
    v_cvt_pk_bf16_f32 v234, v20, v21
    v_mfma_f32_16x16x32_bf16 a[44:47], v[116:119], v[36:39], a[44:47]
    buffer_load_dwordx4 v4, s[12:15], s39 offen offset:1024 lds
    v_mfma_f32_16x16x32_bf16 a[48:51], v[120:123], v[32:35], a[48:51]
    ds_read_b128 v[152:155], v1 offset:47104
    v_cvt_pk_bf16_f32 v235, v22, v23
    v_mfma_f32_16x16x32_bf16 a[52:55], v[120:123], v[36:39], a[52:55]
    buffer_store_dwordx4 v[232:235], v1, s[12:15], s90 offen offset:2048 sc1
    v_mfma_f32_16x16x32_bf16 a[56:59], v[124:127], v[32:35], a[56:59]
    ds_read_b128 v[156:159], v1 offset:48128
    v_accvgpr_read_b32 v16, a152
    v_mfma_f32_16x16x32_bf16 a[60:63], v[124:127], v[36:39], a[60:63]
    v_accvgpr_read_b32 v17, a153
    s_waitcnt lgkmcnt(4)
    v_mfma_f32_16x16x32_bf16 a[64:67], v[128:131], v[32:35], a[64:67]
    ds_read_b128 v[96:99], v1 offset:49152
    v_accvgpr_read_b32 v18, a154
    v_mfma_f32_16x16x32_bf16 a[68:71], v[128:131], v[36:39], a[68:71]
    v_accvgpr_read_b32 v19, a155
    v_accvgpr_read_b32 v20, a156
    v_mfma_f32_16x16x32_bf16 a[72:75], v[132:135], v[32:35], a[72:75]
    ds_read_b128 v[100:103], v1 offset:50176
    v_accvgpr_read_b32 v21, a157
    v_mfma_f32_16x16x32_bf16 a[76:79], v[132:135], v[36:39], a[76:79]
    buffer_load_dwordx4 v4, s[12:15], s39 offen offset:2048 lds
    v_mfma_f32_16x16x32_bf16 a[80:83], v[136:139], v[32:35], a[80:83]
    ds_read_b128 v[104:107], v1 offset:51200
    v_accvgpr_read_b32 v22, a158
    v_mfma_f32_16x16x32_bf16 a[84:87], v[136:139], v[36:39], a[84:87]
    v_accvgpr_read_b32 v23, a159
    v_cvt_pk_bf16_f32 v236, v16, v17
    v_mfma_f32_16x16x32_bf16 a[88:91], v[140:143], v[32:35], a[88:91]
    ds_read_b128 v[108:111], v1 offset:52224
    v_cvt_pk_bf16_f32 v237, v18, v19
    v_mfma_f32_16x16x32_bf16 a[92:95], v[140:143], v[36:39], a[92:95]
    v_cvt_pk_bf16_f32 v238, v20, v21
    s_waitcnt lgkmcnt(4)
    v_mfma_f32_16x16x32_bf16 a[96:99], v[144:147], v[32:35], a[96:99]
    ds_read_b128 v[112:115], v1 offset:53248
    v_cvt_pk_bf16_f32 v239, v22, v23
    v_mfma_f32_16x16x32_bf16 a[100:103], v[144:147], v[36:39], a[100:103]
    buffer_store_dwordx4 v[236:239], v1, s[12:15], s90 offen offset:3072 sc1
    v_mfma_f32_16x16x32_bf16 a[104:107], v[148:151], v[32:35], a[104:107]
    ds_read_b128 v[116:119], v1 offset:54272
    v_accvgpr_read_b32 v16, a160
    v_mfma_f32_16x16x32_bf16 a[108:111], v[148:151], v[36:39], a[108:111]
    buffer_load_dwordx4 v4, s[12:15], s39 offen offset:3072 lds
    v_mfma_f32_16x16x32_bf16 a[112:115], v[152:155], v[32:35], a[112:115]
    ds_read_b128 v[120:123], v1 offset:55296
    v_accvgpr_read_b32 v17, a161
    v_mfma_f32_16x16x32_bf16 a[116:119], v[152:155], v[36:39], a[116:119]
    v_accvgpr_read_b32 v18, a162
    v_accvgpr_read_b32 v19, a163
    v_mfma_f32_16x16x32_bf16 a[120:123], v[156:159], v[32:35], a[120:123]
    ds_read_b128 v[124:127], v1 offset:56320
    v_accvgpr_read_b32 v20, a164
    v_mfma_f32_16x16x32_bf16 a[124:127], v[156:159], v[36:39], a[124:127]
    v_accvgpr_read_b32 v21, a165
    s_waitcnt lgkmcnt(4)
    v_mfma_f32_16x16x32_bf16 a[0:3], v[96:99], v[40:43], a[0:3]
    ds_read_b128 v[128:131], v1 offset:57344
    v_accvgpr_read_b32 v22, a166
    v_mfma_f32_16x16x32_bf16 a[4:7], v[96:99], v[44:47], a[4:7]
    s_add_u32 s39, s38, 212992
    s_add_u32 m0, s24, 147456
    v_mfma_f32_16x16x32_bf16 a[8:11], v[100:103], v[40:43], a[8:11]
    ds_read_b128 v[132:135], v1 offset:58368
    v_accvgpr_read_b32 v23, a167
    v_mfma_f32_16x16x32_bf16 a[12:15], v[100:103], v[44:47], a[12:15]
    buffer_load_dwordx4 v4, s[12:15], s39 offen offset:0 lds
    v_mfma_f32_16x16x32_bf16 a[16:19], v[104:107], v[40:43], a[16:19]
    ds_read_b128 v[136:139], v1 offset:59392
    v_cvt_pk_bf16_f32 v240, v16, v17
    v_mfma_f32_16x16x32_bf16 a[20:23], v[104:107], v[44:47], a[20:23]
    v_cvt_pk_bf16_f32 v241, v18, v19
    v_cvt_pk_bf16_f32 v242, v20, v21
    v_mfma_f32_16x16x32_bf16 a[24:27], v[108:111], v[40:43], a[24:27]
    ds_read_b128 v[140:143], v1 offset:60416
    v_cvt_pk_bf16_f32 v243, v22, v23
    v_mfma_f32_16x16x32_bf16 a[28:31], v[108:111], v[44:47], a[28:31]
    s_add_u32 s90, s91, 76288
    s_waitcnt lgkmcnt(4)
    v_mfma_f32_16x16x32_bf16 a[32:35], v[112:115], v[40:43], a[32:35]
    ds_read_b128 v[144:147], v1 offset:61440
    v_mfma_f32_16x16x32_bf16 a[36:39], v[112:115], v[44:47], a[36:39]
    buffer_store_dwordx4 v[240:243], v1, s[12:15], s90 offen offset:0 sc1
    v_mfma_f32_16x16x32_bf16 a[40:43], v[116:119], v[40:43], a[40:43]
    ds_read_b128 v[148:151], v1 offset:62464
    v_accvgpr_read_b32 v16, a168
    v_mfma_f32_16x16x32_bf16 a[44:47], v[116:119], v[44:47], a[44:47]
    buffer_load_dwordx4 v4, s[12:15], s39 offen offset:1024 lds
    v_mfma_f32_16x16x32_bf16 a[48:51], v[120:123], v[40:43], a[48:51]
    ds_read_b128 v[152:155], v1 offset:63488
    v_accvgpr_read_b32 v17, a169
    v_mfma_f32_16x16x32_bf16 a[52:55], v[120:123], v[44:47], a[52:55]
    v_accvgpr_read_b32 v18, a170
    v_accvgpr_read_b32 v19, a171
    v_mfma_f32_16x16x32_bf16 a[56:59], v[124:127], v[40:43], a[56:59]
    ds_read_b128 v[156:159], v1 offset:64512
    v_accvgpr_read_b32 v20, a172
    v_mfma_f32_16x16x32_bf16 a[60:63], v[124:127], v[44:47], a[60:63]
    v_accvgpr_read_b32 v21, a173
    s_waitcnt lgkmcnt(4)
    v_mfma_f32_16x16x32_bf16 a[64:67], v[128:131], v[40:43], a[64:67]
    ds_read_b128 v[96:99], v6 offset:0
    v_accvgpr_read_b32 v22, a174
    v_mfma_f32_16x16x32_bf16 a[68:71], v[128:131], v[44:47], a[68:71]
    v_accvgpr_read_b32 v23, a175
    v_cvt_pk_bf16_f32 v244, v16, v17
    v_mfma_f32_16x16x32_bf16 a[72:75], v[132:135], v[40:43], a[72:75]
    ds_read_b128 v[100:103], v6 offset:1024
    v_cvt_pk_bf16_f32 v245, v18, v19
    v_mfma_f32_16x16x32_bf16 a[76:79], v[132:135], v[44:47], a[76:79]
    buffer_load_dwordx4 v4, s[12:15], s39 offen offset:2048 lds
    v_mfma_f32_16x16x32_bf16 a[80:83], v[136:139], v[40:43], a[80:83]
    ds_read_b128 v[104:107], v6 offset:2048
    v_cvt_pk_bf16_f32 v246, v20, v21
    v_mfma_f32_16x16x32_bf16 a[84:87], v[136:139], v[44:47], a[84:87]
    v_cvt_pk_bf16_f32 v247, v22, v23
    v_mfma_f32_16x16x32_bf16 a[88:91], v[140:143], v[40:43], a[88:91]
    ds_read_b128 v[108:111], v6 offset:3072
    v_mfma_f32_16x16x32_bf16 a[92:95], v[140:143], v[44:47], a[92:95]
    s_waitcnt lgkmcnt(4)
    v_mfma_f32_16x16x32_bf16 a[96:99], v[144:147], v[40:43], a[96:99]
    ds_read_b128 v[112:115], v6 offset:4096
    v_mfma_f32_16x16x32_bf16 a[100:103], v[144:147], v[44:47], a[100:103]
    buffer_store_dwordx4 v[244:247], v1, s[12:15], s90 offen offset:1024 sc1
    v_mfma_f32_16x16x32_bf16 a[104:107], v[148:151], v[40:43], a[104:107]
    ds_read_b128 v[116:119], v6 offset:5120
    v_accvgpr_read_b32 v16, a176
    v_mfma_f32_16x16x32_bf16 a[108:111], v[148:151], v[44:47], a[108:111]
    buffer_load_dwordx4 v4, s[12:15], s39 offen offset:3072 lds
    v_mfma_f32_16x16x32_bf16 a[112:115], v[152:155], v[40:43], a[112:115]
    ds_read_b128 v[120:123], v6 offset:6144
    v_accvgpr_read_b32 v17, a177
    v_mfma_f32_16x16x32_bf16 a[116:119], v[152:155], v[44:47], a[116:119]
    v_accvgpr_read_b32 v18, a178
    v_accvgpr_read_b32 v19, a179
    v_mfma_f32_16x16x32_bf16 a[120:123], v[156:159], v[40:43], a[120:123]
    ds_read_b128 v[124:127], v6 offset:7168
    v_accvgpr_read_b32 v20, a180
    v_accvgpr_read_b32 v21, a181
    v_accvgpr_read_b32 v22, a182
    v_accvgpr_read_b32 v23, a183
    v_cvt_pk_bf16_f32 v248, v16, v17
    v_cvt_pk_bf16_f32 v249, v18, v19
    v_cvt_pk_bf16_f32 v250, v20, v21
    v_cvt_pk_bf16_f32 v251, v22, v23
    buffer_store_dwordx4 v[248:251], v1, s[12:15], s90 offen offset:2048 sc1
    v_mfma_f32_16x16x32_bf16 a[124:127], v[156:159], v[44:47], a[124:127]
    s_waitcnt lgkmcnt(4)
    v_mfma_f32_16x16x32_bf16 a[0:3], v[96:99], v[48:51], a[0:3]
    ds_read_b128 v[128:131], v6 offset:8192
    v_accvgpr_read_b32 v16, a184
    v_mfma_f32_16x16x32_bf16 a[4:7], v[96:99], v[52:55], a[4:7]
    v_accvgpr_read_b32 v17, a185
    v_accvgpr_read_b32 v18, a186
    v_mfma_f32_16x16x32_bf16 a[8:11], v[100:103], v[48:51], a[8:11]
    ds_read_b128 v[132:135], v6 offset:9216
    v_accvgpr_read_b32 v19, a187
    v_mfma_f32_16x16x32_bf16 a[12:15], v[100:103], v[52:55], a[12:15]
    v_accvgpr_read_b32 v20, a188
    v_accvgpr_read_b32 v21, a189
    v_mfma_f32_16x16x32_bf16 a[16:19], v[104:107], v[48:51], a[16:19]
    ds_read_b128 v[136:139], v6 offset:10240
    v_accvgpr_read_b32 v22, a190
    v_mfma_f32_16x16x32_bf16 a[20:23], v[104:107], v[52:55], a[20:23]
    v_accvgpr_read_b32 v23, a191
    v_mfma_f32_16x16x32_bf16 a[24:27], v[108:111], v[48:51], a[24:27]
    ds_read_b128 v[140:143], v6 offset:11264
    v_cvt_pk_bf16_f32 v252, v16, v17
    v_mfma_f32_16x16x32_bf16 a[28:31], v[108:111], v[52:55], a[28:31]
    v_cvt_pk_bf16_f32 v253, v18, v19
    s_waitcnt lgkmcnt(4)
    v_mfma_f32_16x16x32_bf16 a[32:35], v[112:115], v[48:51], a[32:35]
    ds_read_b128 v[144:147], v6 offset:12288
    v_cvt_pk_bf16_f32 v254, v20, v21
    v_mfma_f32_16x16x32_bf16 a[36:39], v[112:115], v[52:55], a[36:39]
    v_cvt_pk_bf16_f32 v255, v22, v23
    v_mfma_f32_16x16x32_bf16 a[40:43], v[116:119], v[48:51], a[40:43]
    ds_read_b128 v[148:151], v6 offset:13312
    v_mfma_f32_16x16x32_bf16 a[44:47], v[116:119], v[52:55], a[44:47]
    buffer_store_dwordx4 v[252:255], v1, s[12:15], s90 offen offset:3072 sc1
    v_mfma_f32_16x16x32_bf16 a[48:51], v[120:123], v[48:51], a[48:51]
    ds_read_b128 v[152:155], v6 offset:14336
    v_accvgpr_read_b32 v16, a192
    v_mfma_f32_16x16x32_bf16 a[52:55], v[120:123], v[52:55], a[52:55]
    v_accvgpr_read_b32 v17, a193
    v_mfma_f32_16x16x32_bf16 a[56:59], v[124:127], v[48:51], a[56:59]
    ds_read_b128 v[156:159], v6 offset:15360
    v_accvgpr_read_b32 v18, a194
    v_mfma_f32_16x16x32_bf16 a[60:63], v[124:127], v[52:55], a[60:63]
    s_waitcnt lgkmcnt(4)
    v_mfma_f32_16x16x32_bf16 a[64:67], v[128:131], v[48:51], a[64:67]
    ds_read_b128 v[96:99], v6 offset:16384
    v_accvgpr_read_b32 v19, a195
    v_mfma_f32_16x16x32_bf16 a[68:71], v[128:131], v[52:55], a[68:71]
    v_accvgpr_read_b32 v20, a196
    v_mfma_f32_16x16x32_bf16 a[72:75], v[132:135], v[48:51], a[72:75]
    ds_read_b128 v[100:103], v6 offset:17408
    v_accvgpr_read_b32 v21, a197
    v_mfma_f32_16x16x32_bf16 a[76:79], v[132:135], v[52:55], a[76:79]
    v_accvgpr_read_b32 v22, a198
    v_mfma_f32_16x16x32_bf16 a[80:83], v[136:139], v[48:51], a[80:83]
    ds_read_b128 v[104:107], v6 offset:18432
    v_accvgpr_read_b32 v23, a199
    v_mfma_f32_16x16x32_bf16 a[84:87], v[136:139], v[52:55], a[84:87]
    v_cvt_pk_bf16_f32 v208, v16, v17
    v_mfma_f32_16x16x32_bf16 a[88:91], v[140:143], v[48:51], a[88:91]
    ds_read_b128 v[108:111], v6 offset:19456
    v_cvt_pk_bf16_f32 v209, v18, v19
    v_mfma_f32_16x16x32_bf16 a[92:95], v[140:143], v[52:55], a[92:95]
    v_cvt_pk_bf16_f32 v210, v20, v21
    s_waitcnt lgkmcnt(4)
    v_mfma_f32_16x16x32_bf16 a[96:99], v[144:147], v[48:51], a[96:99]
    ds_read_b128 v[112:115], v6 offset:20480
    v_cvt_pk_bf16_f32 v211, v22, v23
    v_mfma_f32_16x16x32_bf16 a[100:103], v[144:147], v[52:55], a[100:103]
    s_add_u32 s90, s91, 102144
    v_mfma_f32_16x16x32_bf16 a[104:107], v[148:151], v[48:51], a[104:107]
    ds_read_b128 v[116:119], v6 offset:21504
    v_mfma_f32_16x16x32_bf16 a[108:111], v[148:151], v[52:55], a[108:111]
    buffer_store_dwordx4 v[208:211], v1, s[12:15], s90 offen offset:0 sc1
    v_mfma_f32_16x16x32_bf16 a[112:115], v[152:155], v[48:51], a[112:115]
    ds_read_b128 v[120:123], v6 offset:22528
    v_mfma_f32_16x16x32_bf16 a[116:119], v[152:155], v[52:55], a[116:119]
    v_accvgpr_read_b32 v16, a200
    v_mfma_f32_16x16x32_bf16 a[120:123], v[156:159], v[48:51], a[120:123]
    ds_read_b128 v[124:127], v6 offset:23552
    v_accvgpr_read_b32 v17, a201
    v_mfma_f32_16x16x32_bf16 a[124:127], v[156:159], v[52:55], a[124:127]
    v_accvgpr_read_b32 v18, a202
    s_waitcnt lgkmcnt(4)
    v_mfma_f32_16x16x32_bf16 a[0:3], v[96:99], v[56:59], a[0:3]
    ds_read_b128 v[128:131], v6 offset:24576
    v_accvgpr_read_b32 v19, a203
    v_mfma_f32_16x16x32_bf16 a[4:7], v[96:99], v[60:63], a[4:7]
    v_accvgpr_read_b32 v20, a204
    v_mfma_f32_16x16x32_bf16 a[8:11], v[100:103], v[56:59], a[8:11]
    ds_read_b128 v[132:135], v6 offset:25600
    v_accvgpr_read_b32 v21, a205
    v_mfma_f32_16x16x32_bf16 a[12:15], v[100:103], v[60:63], a[12:15]
    v_accvgpr_read_b32 v22, a206
    v_mfma_f32_16x16x32_bf16 a[16:19], v[104:107], v[56:59], a[16:19]
    ds_read_b128 v[136:139], v6 offset:26624
    v_mfma_f32_16x16x32_bf16 a[20:23], v[104:107], v[60:63], a[20:23]
    v_accvgpr_read_b32 v23, a207
    v_mfma_f32_16x16x32_bf16 a[24:27], v[108:111], v[56:59], a[24:27]
    ds_read_b128 v[140:143], v6 offset:27648
    v_cvt_pk_bf16_f32 v212, v16, v17
    v_mfma_f32_16x16x32_bf16 a[28:31], v[108:111], v[60:63], a[28:31]
    v_cvt_pk_bf16_f32 v213, v18, v19
    s_waitcnt lgkmcnt(4)
    v_mfma_f32_16x16x32_bf16 a[32:35], v[112:115], v[56:59], a[32:35]
    ds_read_b128 v[144:147], v6 offset:28672
    v_cvt_pk_bf16_f32 v214, v20, v21
    v_mfma_f32_16x16x32_bf16 a[36:39], v[112:115], v[60:63], a[36:39]
    v_cvt_pk_bf16_f32 v215, v22, v23
    v_mfma_f32_16x16x32_bf16 a[40:43], v[116:119], v[56:59], a[40:43]
    ds_read_b128 v[148:151], v6 offset:29696
    v_mfma_f32_16x16x32_bf16 a[44:47], v[116:119], v[60:63], a[44:47]
    buffer_store_dwordx4 v[212:215], v1, s[12:15], s90 offen offset:1024 sc1
    v_mfma_f32_16x16x32_bf16 a[48:51], v[120:123], v[56:59], a[48:51]
    ds_read_b128 v[152:155], v6 offset:30720
    v_accvgpr_read_b32 v16, a208
    v_mfma_f32_16x16x32_bf16 a[52:55], v[120:123], v[60:63], a[52:55]
    v_accvgpr_read_b32 v17, a209
    v_mfma_f32_16x16x32_bf16 a[56:59], v[124:127], v[56:59], a[56:59]
    ds_read_b128 v[156:159], v6 offset:31744
    v_accvgpr_read_b32 v18, a210
    v_mfma_f32_16x16x32_bf16 a[60:63], v[124:127], v[60:63], a[60:63]
    s_waitcnt vmcnt(17) lgkmcnt(4)
    s_barrier
    v_mfma_f32_16x16x32_bf16 a[64:67], v[128:131], v[56:59], a[64:67]
    ds_read_b128 v[96:99], v1 offset:0
    v_accvgpr_read_b32 v19, a211
    v_mfma_f32_16x16x32_bf16 a[68:71], v[128:131], v[60:63], a[68:71]
    buffer_store_dword v14, v30, s[12:15], s93 offen offset:4
    v_mfma_f32_16x16x32_bf16 a[72:75], v[132:135], v[56:59], a[72:75]
    ds_read_b128 v[100:103], v1 offset:1024
    v_accvgpr_read_b32 v20, a212
    v_mfma_f32_16x16x32_bf16 a[76:79], v[132:135], v[60:63], a[76:79]
    buffer_store_dword v14, v29, s[12:15], s93 offen offset:4 sc1
    v_mfma_f32_16x16x32_bf16 a[80:83], v[136:139], v[56:59], a[80:83]
    ds_read_b128 v[104:107], v1 offset:2048
    v_accvgpr_read_b32 v21, a213
    v_mfma_f32_16x16x32_bf16 a[84:87], v[136:139], v[60:63], a[84:87]
    v_accvgpr_read_b32 v22, a214
    v_accvgpr_read_b32 v23, a215
    v_mfma_f32_16x16x32_bf16 a[88:91], v[140:143], v[56:59], a[88:91]
    ds_read_b128 v[108:111], v1 offset:3072
    v_cvt_pk_bf16_f32 v216, v16, v17
    v_mfma_f32_16x16x32_bf16 a[92:95], v[140:143], v[60:63], a[92:95]
    v_cvt_pk_bf16_f32 v217, v18, v19
    s_waitcnt lgkmcnt(4)
    v_mfma_f32_16x16x32_bf16 a[96:99], v[144:147], v[56:59], a[96:99]
    ds_read_b128 v[112:115], v1 offset:4096
    v_cvt_pk_bf16_f32 v218, v20, v21
    v_mfma_f32_16x16x32_bf16 a[100:103], v[144:147], v[60:63], a[100:103]
    v_cvt_pk_bf16_f32 v219, v22, v23
    v_mfma_f32_16x16x32_bf16 a[104:107], v[148:151], v[56:59], a[104:107]
    ds_read_b128 v[116:119], v1 offset:5120
    v_mfma_f32_16x16x32_bf16 a[108:111], v[148:151], v[60:63], a[108:111]
    buffer_store_dwordx4 v[216:219], v1, s[12:15], s90 offen offset:2048 sc1
    v_mfma_f32_16x16x32_bf16 a[112:115], v[152:155], v[56:59], a[112:115]
    ds_read_b128 v[120:123], v1 offset:6144
    v_mfma_f32_16x16x32_bf16 a[116:119], v[152:155], v[60:63], a[116:119]
    v_mfma_f32_16x16x32_bf16 a[120:123], v[156:159], v[56:59], a[120:123]
    ds_read_b128 v[124:127], v1 offset:7168
    v_mfma_f32_16x16x32_bf16 a[124:127], v[156:159], v[60:63], a[124:127]
    s_waitcnt lgkmcnt(4)
    v_mfma_f32_16x16x32_bf16 a[0:3], v[96:99], v[64:67], a[0:3]
    ds_read_b128 v[128:131], v1 offset:8192
    v_accvgpr_read_b32 v16, a216
    v_mfma_f32_16x16x32_bf16 a[4:7], v[96:99], v[68:71], a[4:7]
    v_accvgpr_read_b32 v17, a217
    v_accvgpr_read_b32 v18, a218
    v_mfma_f32_16x16x32_bf16 a[8:11], v[100:103], v[64:67], a[8:11]
    ds_read_b128 v[132:135], v1 offset:9216
    v_accvgpr_read_b32 v19, a219
    v_mfma_f32_16x16x32_bf16 a[12:15], v[100:103], v[68:71], a[12:15]
    v_accvgpr_read_b32 v20, a220
    v_accvgpr_read_b32 v21, a221
    v_mfma_f32_16x16x32_bf16 a[16:19], v[104:107], v[64:67], a[16:19]
    ds_read_b128 v[136:139], v1 offset:10240
    v_accvgpr_read_b32 v22, a222
    v_mfma_f32_16x16x32_bf16 a[20:23], v[104:107], v[68:71], a[20:23]
    v_accvgpr_read_b32 v23, a223
    v_cvt_pk_bf16_f32 v220, v16, v17
    v_mfma_f32_16x16x32_bf16 a[24:27], v[108:111], v[64:67], a[24:27]
    ds_read_b128 v[140:143], v1 offset:11264
    v_cvt_pk_bf16_f32 v221, v18, v19
    v_mfma_f32_16x16x32_bf16 a[28:31], v[108:111], v[68:71], a[28:31]
    v_cvt_pk_bf16_f32 v222, v20, v21
    s_waitcnt lgkmcnt(4)
    v_mfma_f32_16x16x32_bf16 a[32:35], v[112:115], v[64:67], a[32:35]
    ds_read_b128 v[144:147], v1 offset:12288
    v_cvt_pk_bf16_f32 v223, v22, v23
    v_mfma_f32_16x16x32_bf16 a[36:39], v[112:115], v[68:71], a[36:39]
    buffer_store_dwordx4 v[220:223], v1, s[12:15], s90 offen offset:3072 sc1
    v_mfma_f32_16x16x32_bf16 a[40:43], v[116:119], v[64:67], a[40:43]
    ds_read_b128 v[148:151], v1 offset:13312
    v_accvgpr_read_b32 v16, a224
    v_mfma_f32_16x16x32_bf16 a[44:47], v[116:119], v[68:71], a[44:47]
    v_accvgpr_read_b32 v17, a225
    v_accvgpr_read_b32 v18, a226
    v_mfma_f32_16x16x32_bf16 a[48:51], v[120:123], v[64:67], a[48:51]
    ds_read_b128 v[152:155], v1 offset:14336
    v_accvgpr_read_b32 v19, a227
    v_mfma_f32_16x16x32_bf16 a[52:55], v[120:123], v[68:71], a[52:55]
    v_accvgpr_read_b32 v20, a228
    v_mfma_f32_16x16x32_bf16 a[56:59], v[124:127], v[64:67], a[56:59]
    ds_read_b128 v[156:159], v1 offset:15360
    v_accvgpr_read_b32 v21, a229
    v_mfma_f32_16x16x32_bf16 a[60:63], v[124:127], v[68:71], a[60:63]
    v_accvgpr_read_b32 v22, a230
    s_waitcnt lgkmcnt(4)
    v_mfma_f32_16x16x32_bf16 a[64:67], v[128:131], v[64:67], a[64:67]
    ds_read_b128 v[96:99], v1 offset:16384
    v_accvgpr_read_b32 v23, a231
    v_mfma_f32_16x16x32_bf16 a[68:71], v[128:131], v[68:71], a[68:71]
    v_cvt_pk_bf16_f32 v224, v16, v17
    v_cvt_pk_bf16_f32 v225, v18, v19
    v_mfma_f32_16x16x32_bf16 a[72:75], v[132:135], v[64:67], a[72:75]
    ds_read_b128 v[100:103], v1 offset:17408
    v_cvt_pk_bf16_f32 v226, v20, v21
    v_mfma_f32_16x16x32_bf16 a[76:79], v[132:135], v[68:71], a[76:79]
    v_cvt_pk_bf16_f32 v227, v22, v23
    v_mfma_f32_16x16x32_bf16 a[80:83], v[136:139], v[64:67], a[80:83]
    ds_read_b128 v[104:107], v1 offset:18432
    s_add_u32 s90, s91, 110336
    v_mfma_f32_16x16x32_bf16 a[84:87], v[136:139], v[68:71], a[84:87]
    buffer_store_dwordx4 v[224:227], v1, s[12:15], s90 offen offset:0 sc1
    v_mfma_f32_16x16x32_bf16 a[88:91], v[140:143], v[64:67], a[88:91]
    ds_read_b128 v[108:111], v1 offset:19456
    v_accvgpr_read_b32 v16, a232
    v_mfma_f32_16x16x32_bf16 a[92:95], v[140:143], v[68:71], a[92:95]
    v_accvgpr_read_b32 v17, a233
    s_waitcnt lgkmcnt(4)
    v_mfma_f32_16x16x32_bf16 a[96:99], v[144:147], v[64:67], a[96:99]
    ds_read_b128 v[112:115], v1 offset:20480
    v_accvgpr_read_b32 v18, a234
    v_mfma_f32_16x16x32_bf16 a[100:103], v[144:147], v[68:71], a[100:103]
    v_accvgpr_read_b32 v19, a235
    v_mfma_f32_16x16x32_bf16 a[104:107], v[148:151], v[64:67], a[104:107]
    ds_read_b128 v[116:119], v1 offset:21504
    v_accvgpr_read_b32 v20, a236
    v_mfma_f32_16x16x32_bf16 a[108:111], v[148:151], v[68:71], a[108:111]
    v_accvgpr_read_b32 v21, a237
    v_mfma_f32_16x16x32_bf16 a[112:115], v[152:155], v[64:67], a[112:115]
    ds_read_b128 v[120:123], v1 offset:22528
    v_accvgpr_read_b32 v22, a238
    v_mfma_f32_16x16x32_bf16 a[116:119], v[152:155], v[68:71], a[116:119]
    v_accvgpr_read_b32 v23, a239
    v_mfma_f32_16x16x32_bf16 a[120:123], v[156:159], v[64:67], a[120:123]
    ds_read_b128 v[124:127], v1 offset:23552
    v_cvt_pk_bf16_f32 v228, v16, v17
    v_mfma_f32_16x16x32_bf16 a[124:127], v[156:159], v[68:71], a[124:127]
    v_cvt_pk_bf16_f32 v229, v18, v19
    s_waitcnt lgkmcnt(4)
    v_mfma_f32_16x16x32_bf16 a[0:3], v[96:99], v[72:75], a[0:3]
    ds_read_b128 v[128:131], v1 offset:24576
    v_cvt_pk_bf16_f32 v230, v20, v21
    v_mfma_f32_16x16x32_bf16 a[4:7], v[96:99], v[76:79], a[4:7]
    v_cvt_pk_bf16_f32 v231, v22, v23
    v_mfma_f32_16x16x32_bf16 a[8:11], v[100:103], v[72:75], a[8:11]
    ds_read_b128 v[132:135], v1 offset:25600
    v_mfma_f32_16x16x32_bf16 a[12:15], v[100:103], v[76:79], a[12:15]
    buffer_store_dwordx4 v[228:231], v1, s[12:15], s90 offen offset:1024 sc1
    v_mfma_f32_16x16x32_bf16 a[16:19], v[104:107], v[72:75], a[16:19]
    ds_read_b128 v[136:139], v1 offset:26624
    v_accvgpr_read_b32 v16, a240
    v_mfma_f32_16x16x32_bf16 a[20:23], v[104:107], v[76:79], a[20:23]
    v_accvgpr_read_b32 v17, a241
    v_accvgpr_read_b32 v18, a242
    v_mfma_f32_16x16x32_bf16 a[24:27], v[108:111], v[72:75], a[24:27]
    ds_read_b128 v[140:143], v1 offset:27648
    v_accvgpr_read_b32 v19, a243
    v_mfma_f32_16x16x32_bf16 a[28:31], v[108:111], v[76:79], a[28:31]
    v_accvgpr_read_b32 v20, a244
    s_waitcnt lgkmcnt(4)
    v_mfma_f32_16x16x32_bf16 a[32:35], v[112:115], v[72:75], a[32:35]
    ds_read_b128 v[144:147], v1 offset:28672
    v_accvgpr_read_b32 v21, a245
    v_mfma_f32_16x16x32_bf16 a[36:39], v[112:115], v[76:79], a[36:39]
    v_accvgpr_read_b32 v22, a246
    v_accvgpr_read_b32 v23, a247
    v_mfma_f32_16x16x32_bf16 a[40:43], v[116:119], v[72:75], a[40:43]
    ds_read_b128 v[148:151], v1 offset:29696
    v_cvt_pk_bf16_f32 v232, v16, v17
    v_mfma_f32_16x16x32_bf16 a[44:47], v[116:119], v[76:79], a[44:47]
    v_cvt_pk_bf16_f32 v233, v18, v19
    v_mfma_f32_16x16x32_bf16 a[48:51], v[120:123], v[72:75], a[48:51]
    ds_read_b128 v[152:155], v1 offset:30720
    v_cvt_pk_bf16_f32 v234, v20, v21
    v_mfma_f32_16x16x32_bf16 a[52:55], v[120:123], v[76:79], a[52:55]
    v_cvt_pk_bf16_f32 v235, v22, v23
    v_mfma_f32_16x16x32_bf16 a[56:59], v[124:127], v[72:75], a[56:59]
    ds_read_b128 v[156:159], v1 offset:31744
    v_mfma_f32_16x16x32_bf16 a[60:63], v[124:127], v[76:79], a[60:63]
    s_waitcnt vmcnt(10) lgkmcnt(4)
    s_barrier
    v_mfma_f32_16x16x32_bf16 a[64:67], v[128:131], v[72:75], a[64:67]
    ds_read_b128 v[96:99], v13 offset:0
    v_mfma_f32_16x16x32_bf16 a[68:71], v[128:131], v[76:79], a[68:71]
    buffer_store_dwordx4 v[232:235], v1, s[12:15], s90 offen offset:2048 sc1
    v_mfma_f32_16x16x32_bf16 a[72:75], v[132:135], v[72:75], a[72:75]
    ds_read_b128 v[100:103], v13 offset:1024
    v_accvgpr_read_b32 v16, a248
    v_mfma_f32_16x16x32_bf16 a[76:79], v[132:135], v[76:79], a[76:79]
    v_accvgpr_read_b32 v17, a249
    v_accvgpr_read_b32 v18, a250
    v_mfma_f32_16x16x32_bf16 a[80:83], v[136:139], v[72:75], a[80:83]
    ds_read_b128 v[104:107], v13 offset:2048
    v_accvgpr_read_b32 v19, a251
    v_mfma_f32_16x16x32_bf16 a[84:87], v[136:139], v[76:79], a[84:87]
    v_accvgpr_read_b32 v20, a252
    v_accvgpr_read_b32 v21, a253
    v_mfma_f32_16x16x32_bf16 a[88:91], v[140:143], v[72:75], a[88:91]
    ds_read_b128 v[108:111], v13 offset:3072
    v_accvgpr_read_b32 v22, a254
    v_mfma_f32_16x16x32_bf16 a[92:95], v[140:143], v[76:79], a[92:95]
    v_accvgpr_read_b32 v23, a255
    s_waitcnt lgkmcnt(4)
    v_mfma_f32_16x16x32_bf16 a[96:99], v[144:147], v[72:75], a[96:99]
    ds_read_b128 v[112:115], v13 offset:4096
    v_cvt_pk_bf16_f32 v236, v16, v17
    v_mfma_f32_16x16x32_bf16 a[100:103], v[144:147], v[76:79], a[100:103]
    v_cvt_pk_bf16_f32 v237, v18, v19
    v_cvt_pk_bf16_f32 v238, v20, v21
    v_mfma_f32_16x16x32_bf16 a[104:107], v[148:151], v[72:75], a[104:107]
    ds_read_b128 v[116:119], v13 offset:5120
    v_cvt_pk_bf16_f32 v239, v22, v23
    v_mfma_f32_16x16x32_bf16 a[108:111], v[148:151], v[76:79], a[108:111]
    buffer_store_dwordx4 v[236:239], v1, s[12:15], s90 offen offset:3072 sc1
    v_mfma_f32_16x16x32_bf16 a[112:115], v[152:155], v[72:75], a[112:115]
    ds_read_b128 v[120:123], v13 offset:6144
    v_mfma_f32_16x16x32_bf16 a[116:119], v[152:155], v[76:79], a[116:119]
    v_mfma_f32_16x16x32_bf16 a[120:123], v[156:159], v[72:75], a[120:123]
    ds_read_b128 v[124:127], v13 offset:7168
    v_mfma_f32_16x16x32_bf16 a[124:127], v[156:159], v[76:79], a[124:127]
    s_waitcnt lgkmcnt(4)
    v_mfma_f32_16x16x32_bf16 a[0:3], v[96:99], v[80:83], a[0:3]
    ds_read_b128 v[128:131], v13 offset:8192
    s_nop 1
    v_mfma_f32_16x16x32_bf16 a[4:7], v[96:99], v[84:87], a[4:7]
    v_cndmask_b32 v8, v8, v11, vcc
    v_mfma_f32_16x16x32_bf16 a[8:11], v[100:103], v[80:83], a[8:11]
    ds_read_b128 v[132:135], v13 offset:9216
    v_mfma_f32_16x16x32_bf16 a[12:15], v[100:103], v[84:87], a[12:15]
    v_mfma_f32_16x16x32_bf16 a[16:19], v[104:107], v[80:83], a[16:19]
    ds_read_b128 v[136:139], v13 offset:10240
    v_lshrrev_b32 v9, 4, v2
    v_mfma_f32_16x16x32_bf16 a[20:23], v[104:107], v[84:87], a[20:23]
    v_mfma_f32_16x16x32_bf16 a[24:27], v[108:111], v[80:83], a[24:27]
    ds_read_b128 v[140:143], v13 offset:11264
    v_mfma_f32_16x16x32_bf16 a[28:31], v[108:111], v[84:87], a[28:31]
    s_waitcnt lgkmcnt(4)
    v_mfma_f32_16x16x32_bf16 a[32:35], v[112:115], v[80:83], a[32:35]
    ds_read_b128 v[144:147], v13 offset:12288
    v_lshlrev_b32 v9, 2, v9
    v_mfma_f32_16x16x32_bf16 a[36:39], v[112:115], v[84:87], a[36:39]
    v_mfma_f32_16x16x32_bf16 a[40:43], v[116:119], v[80:83], a[40:43]
    ds_read_b128 v[148:151], v13 offset:13312
    v_mfma_f32_16x16x32_bf16 a[44:47], v[116:119], v[84:87], a[44:47]
    v_and_b32 v10, 15, v2
    v_mfma_f32_16x16x32_bf16 a[48:51], v[120:123], v[80:83], a[48:51]
    ds_read_b128 v[152:155], v13 offset:14336
    v_mfma_f32_16x16x32_bf16 a[52:55], v[120:123], v[84:87], a[52:55]
    v_mfma_f32_16x16x32_bf16 a[56:59], v[124:127], v[80:83], a[56:59]
    ds_read_b128 v[156:159], v13 offset:15360
    v_add_u32 v11, 0, v9
    v_mfma_f32_16x16x32_bf16 a[60:63], v[124:127], v[84:87], a[60:63]
    s_waitcnt lgkmcnt(4)
    v_mfma_f32_16x16x32_bf16 a[64:67], v[128:131], v[80:83], a[64:67]
    ds_read_b128 v[96:99], v13 offset:16384
    v_mfma_f32_16x16x32_bf16 a[68:71], v[128:131], v[84:87], a[68:71]
    v_cmp_gt_u32 s[70:71], v11, v10
    v_mfma_f32_16x16x32_bf16 a[72:75], v[132:135], v[80:83], a[72:75]
    ds_read_b128 v[100:103], v13 offset:17408
    v_mfma_f32_16x16x32_bf16 a[76:79], v[132:135], v[84:87], a[76:79]
    v_mfma_f32_16x16x32_bf16 a[80:83], v[136:139], v[80:83], a[80:83]
    ds_read_b128 v[104:107], v13 offset:18432
    v_add_u32 v11, 1, v9
    v_mfma_f32_16x16x32_bf16 a[84:87], v[136:139], v[84:87], a[84:87]
    v_mfma_f32_16x16x32_bf16 a[88:91], v[140:143], v[80:83], a[88:91]
    ds_read_b128 v[108:111], v13 offset:19456
    v_mfma_f32_16x16x32_bf16 a[92:95], v[140:143], v[84:87], a[92:95]
    v_cmp_gt_u32 s[72:73], v11, v10
    s_waitcnt lgkmcnt(4)
    v_mfma_f32_16x16x32_bf16 a[96:99], v[144:147], v[80:83], a[96:99]
    ds_read_b128 v[112:115], v13 offset:20480
    v_mfma_f32_16x16x32_bf16 a[100:103], v[144:147], v[84:87], a[100:103]
    v_mfma_f32_16x16x32_bf16 a[104:107], v[148:151], v[80:83], a[104:107]
    ds_read_b128 v[116:119], v13 offset:21504
    v_add_u32 v11, 2, v9
    v_mfma_f32_16x16x32_bf16 a[108:111], v[148:151], v[84:87], a[108:111]
    v_mfma_f32_16x16x32_bf16 a[112:115], v[152:155], v[80:83], a[112:115]
    ds_read_b128 v[120:123], v13 offset:22528
    v_mfma_f32_16x16x32_bf16 a[116:119], v[152:155], v[84:87], a[116:119]
    buffer_load_dword v12, v15, s[12:15], s94 offen offset:4 sc1
    v_mfma_f32_16x16x32_bf16 a[120:123], v[156:159], v[80:83], a[120:123]
    ds_read_b128 v[124:127], v13 offset:23552
    v_cmp_gt_u32 s[74:75], v11, v10
    v_mfma_f32_16x16x32_bf16 a[124:127], v[156:159], v[84:87], a[124:127]
    s_waitcnt lgkmcnt(4)
    v_mfma_f32_16x16x32_bf16 a[0:3], v[96:99], v[88:91], a[0:3]
    ds_read_b128 v[128:131], v13 offset:24576
    v_mfma_f32_16x16x32_bf16 a[4:7], v[96:99], v[92:95], a[4:7]
    v_add_u32 v11, 3, v9
    v_mfma_f32_16x16x32_bf16 a[8:11], v[100:103], v[88:91], a[8:11]
    ds_read_b128 v[132:135], v13 offset:25600
    v_mfma_f32_16x16x32_bf16 a[12:15], v[100:103], v[92:95], a[12:15]
    v_mfma_f32_16x16x32_bf16 a[16:19], v[104:107], v[88:91], a[16:19]
    ds_read_b128 v[136:139], v13 offset:26624
    v_cmp_gt_u32 s[76:77], v11, v10
    v_mfma_f32_16x16x32_bf16 a[20:23], v[104:107], v[92:95], a[20:23]
    v_mfma_f32_16x16x32_bf16 a[24:27], v[108:111], v[88:91], a[24:27]
    ds_read_b128 v[140:143], v13 offset:27648
    v_mfma_f32_16x16x32_bf16 a[28:31], v[108:111], v[92:95], a[28:31]
    s_waitcnt lgkmcnt(4)
    v_mfma_f32_16x16x32_bf16 a[32:35], v[112:115], v[88:91], a[32:35]
    ds_read_b128 v[144:147], v13 offset:28672
    v_mfma_f32_16x16x32_bf16 a[36:39], v[112:115], v[92:95], a[36:39]
    v_mfma_f32_16x16x32_bf16 a[40:43], v[116:119], v[88:91], a[40:43]
    ds_read_b128 v[148:151], v13 offset:29696
    v_mfma_f32_16x16x32_bf16 a[44:47], v[116:119], v[92:95], a[44:47]
    v_readlane_b32 s27, v8, 1
    v_mfma_f32_16x16x32_bf16 a[48:51], v[120:123], v[88:91], a[48:51]
    ds_read_b128 v[152:155], v13 offset:30720
    v_mfma_f32_16x16x32_bf16 a[52:55], v[120:123], v[92:95], a[52:55]
    v_readlane_b32 s23, v7, 0
    s_add_u32 m0, s24, 32768
    v_mfma_f32_16x16x32_bf16 a[56:59], v[124:127], v[88:91], a[56:59]
    ds_read_b128 v[156:159], v13 offset:31744
    v_mfma_f32_16x16x32_bf16 a[60:63], v[124:127], v[92:95], a[60:63]
    s_waitcnt vmcnt(0) lgkmcnt(4)
    s_barrier
    v_mfma_f32_16x16x32_bf16 a[64:67], v[128:131], v[88:91], a[64:67]
    buffer_store_dword v14, v30, s[12:15], s93 offen offset:8
    v_mfma_f32_16x16x32_bf16 a[68:71], v[128:131], v[92:95], a[68:71]
    v_cmp_ne_u32 vcc, 1, v12
    v_mfma_f32_16x16x32_bf16 a[72:75], v[132:135], v[88:91], a[72:75]
    buffer_store_dword v14, v29, s[12:15], s93 offen offset:8 sc1
    v_mfma_f32_16x16x32_bf16 a[76:79], v[132:135], v[92:95], a[76:79]
    s_cbranch_vccnz QK_spin
QK_spinback:
    v_mfma_f32_16x16x32_bf16 a[80:83], v[136:139], v[88:91], a[80:83]
    buffer_load_dwordx4 v4, s[12:15], s23 offen offset:0 lds
    v_mfma_f32_16x16x32_bf16 a[84:87], v[136:139], v[92:95], a[84:87]
    buffer_load_dwordx4 v4, s[12:15], s23 offen offset:1024 lds
    v_mfma_f32_16x16x32_bf16 a[88:91], v[140:143], v[88:91], a[88:91]
    buffer_load_dwordx4 v4, s[12:15], s23 offen offset:2048 lds
    v_mfma_f32_16x16x32_bf16 a[92:95], v[140:143], v[92:95], a[92:95]
    buffer_load_dwordx4 v4, s[12:15], s23 offen offset:3072 lds
    s_waitcnt lgkmcnt(0)
    v_mfma_f32_16x16x32_bf16 a[96:99], v[144:147], v[88:91], a[96:99]
    s_add_u32 m0, s24, 114688
    v_readlane_b32 s23, v7, 1
    v_mfma_f32_16x16x32_bf16 a[100:103], v[144:147], v[92:95], a[100:103]
    buffer_load_dwordx4 v4, s[12:15], s27 offen offset:0 lds
    v_mfma_f32_16x16x32_bf16 a[104:107], v[148:151], v[88:91], a[104:107]
    buffer_load_dwordx4 v4, s[12:15], s27 offen offset:1024 lds
    v_mfma_f32_16x16x32_bf16 a[108:111], v[148:151], v[92:95], a[108:111]
    buffer_load_dwordx4 v4, s[12:15], s27 offen offset:2048 lds
    v_mfma_f32_16x16x32_bf16 a[112:115], v[152:155], v[88:91], a[112:115]
    buffer_load_dwordx4 v4, s[12:15], s27 offen offset:3072 lds
    v_mfma_f32_16x16x32_bf16 a[116:119], v[152:155], v[92:95], a[116:119]
    s_add_u32 m0, s24, 49152
    v_mfma_f32_16x16x32_bf16 a[120:123], v[156:159], v[88:91], a[120:123]
    buffer_load_dwordx4 v4, s[12:15], s23 offen offset:0 lds
    v_mfma_f32_16x16x32_bf16 a[124:127], v[156:159], v[92:95], a[124:127]
    buffer_load_dwordx4 v4, s[12:15], s23 offen offset:1024 lds
    buffer_load_dwordx4 v4, s[12:15], s23 offen offset:2048 lds
    buffer_load_dwordx4 v4, s[12:15], s23 offen offset:3072 lds
    s_branch G_done
G_V:
    s_waitcnt vmcnt(12) lgkmcnt(0)
    s_barrier
    v_mfma_f32_16x16x32_bf16 a[0:3], v[32:35], v[64:67], 0
    v_mfma_f32_16x16x32_bf16 a[4:7], v[32:35], v[68:71], 0
    v_mfma_f32_16x16x32_bf16 a[8:11], v[32:35], v[72:75], 0
    v_mfma_f32_16x16x32_bf16 a[12:15], v[32:35], v[76:79], 0
    ds_read_b64_tr_b16 v[128:129], v244 offset:16384
    s_add_u32 m0, s24, 49152
    v_mfma_f32_16x16x32_bf16 a[16:19], v[32:35], v[80:83], 0
    buffer_load_dwordx4 v240, s[8:11], s20 offen offset:0 nt lds
    v_mfma_f32_16x16x32_bf16 a[20:23], v[32:35], v[84:87], 0
    ds_read_b64_tr_b16 v[130:131], v244 offset:18432
    v_mov_b32 v12, 0x3f803f80
    v_mfma_f32_16x16x32_bf16 a[24:27], v[32:35], v[88:91], 0
    v_dot2_f32_bf16 v14, v160, v12, 0
    v_dot2_f32_bf16 v16, v160, v160, 0
    v_mfma_f32_16x16x32_bf16 a[28:31], v[32:35], v[92:95], 0
    ds_read_b128 v[96:99], v255 offset:0
    v_dot2_f32_bf16 v15, v164, v12, 0
    v_mfma_f32_16x16x32_bf16 a[60:63], v[36:39], v[92:95], 0
    buffer_load_dwordx4 v241, s[8:11], s20 offen offset:1024 nt lds
    v_mfma_f32_16x16x32_bf16 a[56:59], v[36:39], v[88:91], 0
    ds_read_b64_tr_b16 v[132:133], v245 offset:16384
    v_dot2_f32_bf16 v17, v164, v164, 0
    v_mfma_f32_16x16x32_bf16 a[52:55], v[36:39], v[84:87], 0
    v_dot2_f32_bf16 v14, v161, v12, v14
    v_dot2_f32_bf16 v16, v161, v161, v16
    v_mfma_f32_16x16x32_bf16 a[48:51], v[36:39], v[80:83], 0
    ds_read_b64_tr_b16 v[134:135], v245 offset:18432
    v_dot2_f32_bf16 v15, v165, v12, v15
    v_mfma_f32_16x16x32_bf16 a[44:47], v[36:39], v[76:79], 0
    buffer_load_dwordx4 v242, s[8:11], s20 offen offset:2048 nt lds
    v_mfma_f32_16x16x32_bf16 a[40:43], v[36:39], v[72:75], 0
    ds_read_b128 v[100:103], v255 offset:2048
    v_dot2_f32_bf16 v17, v165, v165, v17
    v_mfma_f32_16x16x32_bf16 a[36:39], v[36:39], v[68:71], 0
    v_dot2_f32_bf16 v14, v162, v12, v14
    v_dot2_f32_bf16 v16, v162, v162, v16
    v_mfma_f32_16x16x32_bf16 a[32:35], v[36:39], v[64:67], 0
    ds_read_b64_tr_b16 v[136:137], v246 offset:16384
    v_dot2_f32_bf16 v15, v166, v12, v15
    v_mfma_f32_16x16x32_bf16 a[64:67], v[40:43], v[64:67], 0
    buffer_load_dwordx4 v243, s[8:11], s20 offen offset:3072 nt lds
    v_mfma_f32_16x16x32_bf16 a[68:71], v[40:43], v[68:71], 0
    ds_read_b64_tr_b16 v[138:139], v246 offset:18432
    s_add_u32 s20, s20, 262144
    v_mfma_f32_16x16x32_bf16 a[72:75], v[40:43], v[72:75], 0
    v_dot2_f32_bf16 v17, v166, v166, v17
    v_dot2_f32_bf16 v14, v163, v12, v14
    v_mfma_f32_16x16x32_bf16 a[76:79], v[40:43], v[76:79], 0
    ds_read_b128 v[104:107], v255 offset:4096
    v_dot2_f32_bf16 v16, v163, v163, v16
    v_mfma_f32_16x16x32_bf16 a[80:83], v[40:43], v[80:83], 0
    v_dot2_f32_bf16 v15, v167, v12, v15
    v_dot2_f32_bf16 v17, v167, v167, v17
    v_mfma_f32_16x16x32_bf16 a[84:87], v[40:43], v[84:87], 0
    ds_read_b64_tr_b16 v[140:141], v247 offset:16384
    s_add_u32 m0, s22, s37
    v_mfma_f32_16x16x32_bf16 a[88:91], v[40:43], v[88:91], 0
    buffer_load_dwordx4 v232, s[4:7], s21 offen offset:0 lds
    v_mfma_f32_16x16x32_bf16 a[92:95], v[40:43], v[92:95], 0
    ds_read_b64_tr_b16 v[142:143], v247 offset:18432
    v_and_b32 v9, 3, v2
    v_mfma_f32_16x16x32_bf16 a[124:127], v[44:47], v[92:95], 0
    v_and_b32 v10, 60, v2
    v_and_b32 v11, 1, v9
    v_mfma_f32_16x16x32_bf16 a[120:123], v[44:47], v[88:91], 0
    ds_read_b128 v[108:111], v255 offset:6144
    v_add_f32_dpp v14, v14, v14 row_ror:1 row_mask:0xf bank_mask:0xf
    v_mfma_f32_16x16x32_bf16 a[116:119], v[44:47], v[84:87], 0
    buffer_load_dwordx4 v233, s[4:7], s21 offen offset:1024 lds
    v_mfma_f32_16x16x32_bf16 a[112:115], v[44:47], v[80:83], 0
    ds_read_b64_tr_b16 v[144:145], v248 offset:16384
    v_add_f32_dpp v15, v15, v15 row_ror:1 row_mask:0xf bank_mask:0xf
    v_mfma_f32_16x16x32_bf16 a[108:111], v[44:47], v[76:79], 0
    v_add_f32_dpp v16, v16, v16 row_ror:1 row_mask:0xf bank_mask:0xf
    v_add_f32_dpp v17, v17, v17 row_ror:1 row_mask:0xf bank_mask:0xf
    v_mfma_f32_16x16x32_bf16 a[104:107], v[44:47], v[72:75], 0
    ds_read_b64_tr_b16 v[146:147], v248 offset:18432
    v_add_f32_dpp v14, v14, v14 row_ror:2 row_mask:0xf bank_mask:0xf
    v_mfma_f32_16x16x32_bf16 a[100:103], v[44:47], v[68:71], 0
    buffer_load_dwordx4 v234, s[4:7], s21 offen offset:2048 lds
    v_mfma_f32_16x16x32_bf16 a[96:99], v[44:47], v[64:67], 0
    ds_read_b128 v[112:115], v255 offset:8192
    v_add_f32_dpp v15, v15, v15 row_ror:2 row_mask:0xf bank_mask:0xf
    v_mfma_f32_16x16x32_bf16 a[128:131], v[48:51], v[64:67], 0
    v_add_f32_dpp v16, v16, v16 row_ror:2 row_mask:0xf bank_mask:0xf
    v_add_f32_dpp v17, v17, v17 row_ror:2 row_mask:0xf bank_mask:0xf
    v_mfma_f32_16x16x32_bf16 a[132:135], v[48:51], v[68:71], 0
    ds_read_b64_tr_b16 v[148:149], v249 offset:16384
    v_add_f32_dpp v14, v14, v14 row_ror:4 row_mask:0xf bank_mask:0xf
    v_mfma_f32_16x16x32_bf16 a[136:139], v[48:51], v[72:75], 0
    buffer_load_dwordx4 v235, s[4:7], s21 offen offset:3072 lds
    v_mfma_f32_16x16x32_bf16 a[140:143], v[48:51], v[76:79], 0
    ds_read_b64_tr_b16 v[150:151], v249 offset:18432
    v_add_f32_dpp v15, v15, v15 row_ror:4 row_mask:0xf bank_mask:0xf
    v_mfma_f32_16x16x32_bf16 a[144:147], v[48:51], v[80:83], 0
    v_add_f32_dpp v16, v16, v16 row_ror:4 row_mask:0xf bank_mask:0xf
    v_add_f32_dpp v17, v17, v17 row_ror:4 row_mask:0xf bank_mask:0xf
    v_mfma_f32_16x16x32_bf16 a[148:151], v[48:51], v[84:87], 0
    ds_read_b128 v[116:119], v255 offset:10240
    v_add_f32_dpp v14, v14, v14 row_ror:8 row_mask:0xf bank_mask:0xf
    v_mfma_f32_16x16x32_bf16 a[152:155], v[48:51], v[88:91], 0
    v_add_f32_dpp v15, v15, v15 row_ror:8 row_mask:0xf bank_mask:0xf
    v_add_f32_dpp v16, v16, v16 row_ror:8 row_mask:0xf bank_mask:0xf
    v_mfma_f32_16x16x32_bf16 a[156:159], v[48:51], v[92:95], 0
    ds_read_b64_tr_b16 v[152:153], v250 offset:16384
    s_add_u32 m0, s22, s29
    v_mfma_f32_16x16x32_bf16 a[188:191], v[52:55], v[92:95], 0
    buffer_load_dwordx4 v236, s[4:7], s21 offen offset:0 lds
    v_mfma_f32_16x16x32_bf16 a[184:187], v[52:55], v[88:91], 0
    ds_read_b64_tr_b16 v[154:155], v250 offset:18432
    v_add_f32_dpp v17, v17, v17 row_ror:8 row_mask:0xf bank_mask:0xf
    v_mfma_f32_16x16x32_bf16 a[180:183], v[52:55], v[84:87], 0
    s_bfe_u32 s31, s68, 0x30001
    s_lshr_b32 s32, s68, 4
    v_mfma_f32_16x16x32_bf16 a[176:179], v[52:55], v[80:83], 0
    ds_read_b128 v[120:123], v255 offset:12288
    s_sub_u32 s3, 15, s31
    v_mfma_f32_16x16x32_bf16 a[172:175], v[52:55], v[76:79], 0
    buffer_load_dwordx4 v237, s[4:7], s21 offen offset:1024 lds
    v_mfma_f32_16x16x32_bf16 a[168:171], v[52:55], v[72:75], 0
    ds_read_b64_tr_b16 v[156:157], v251 offset:16384
    v_mfma_f32_16x16x32_bf16 a[164:167], v[52:55], v[68:71], 0
    s_cmp_eq_u32 s32, 1
    s_cselect_b32 s33, s3, s31
    v_mfma_f32_16x16x32_bf16 a[160:163], v[52:55], v[64:67], 0
    ds_read_b64_tr_b16 v[158:159], v251 offset:18432
    s_mul_i32 s34, s30, 2181376
    v_mfma_f32_16x16x32_bf16 a[192:195], v[56:59], v[64:67], 0
    buffer_load_dwordx4 v238, s[4:7], s21 offen offset:2048 lds
    v_mfma_f32_16x16x32_bf16 a[196:199], v[56:59], v[68:71], 0
    ds_read_b128 v[124:127], v255 offset:14336
    s_add_u32 s34, s34, 117440512
    v_mfma_f32_16x16x32_bf16 a[200:203], v[56:59], v[72:75], 0
    s_mul_i32 s3, s27, 272384
    s_add_u32 s34, s34, s3
    v_mfma_f32_16x16x32_bf16 a[204:207], v[56:59], v[76:79], 0
    s_lshr_b32 s3, s66, 1
    s_mul_i32 s3, s3, 136192
    v_mfma_f32_16x16x32_bf16 a[208:211], v[56:59], v[80:83], 0
    buffer_load_dwordx4 v239, s[4:7], s21 offen offset:3072 lds
    v_mfma_f32_16x16x32_bf16 a[212:215], v[56:59], v[84:87], 0
    s_add_u32 s21, s21, 128
    s_add_u32 s22, s22, 32768
    v_mfma_f32_16x16x32_bf16 a[216:219], v[56:59], v[88:91], 0
    s_cmp_eq_u32 s22, 163840
    s_cselect_b32 s22, 65536, s22
    v_mfma_f32_16x16x32_bf16 a[220:223], v[56:59], v[92:95], 0
    s_add_u32 s34, s34, s3
    s_lshl_b32 s3, s28, 14
    v_mfma_f32_16x16x32_bf16 a[252:255], v[60:63], v[92:95], 0
    s_add_u32 s34, s34, s3
    v_cmp_eq_u32 vcc, 0, v0
    v_mfma_f32_16x16x32_bf16 a[248:251], v[60:63], v[88:91], 0
    v_mov_b32 v31, 268435456
    s_and_b32 s79, s68, 7
    v_mfma_f32_16x16x32_bf16 a[244:247], v[60:63], v[84:87], 0
    v_cndmask_b32 v31, v31, 0, vcc
    s_add_u32 s79, s79, 18
    v_mfma_f32_16x16x32_bf16 a[240:243], v[60:63], v[80:83], 0
    s_mov_b32 s78, 268435456
    s_lshl_b32 s79, s79, 18
    v_mfma_f32_16x16x32_bf16 a[236:239], v[60:63], v[76:79], 0
    s_mov_b32 s76, 0x05040100
    s_mov_b32 s77, 0x07060302
    v_mfma_f32_16x16x32_bf16 a[232:235], v[60:63], v[72:75], 0
    v_add_u32 v4, s24, v1
    v_mfma_f32_16x16x32_bf16 a[228:231], v[60:63], v[68:71], 0
    v_mfma_f32_16x16x32_bf16 a[224:227], v[60:63], v[64:67], 0
    s_waitcnt vmcnt(12) lgkmcnt(0)
    s_barrier
    v_mfma_f32_16x16x32_bf16 a[0:3], v[96:99], v[128:131], a[0:3]
    s_add_u32 s25, s25, 32768
    v_mfma_f32_16x16x32_bf16 a[4:7], v[96:99], v[132:135], a[4:7]
    s_cmp_eq_u32 s25, 163840
    s_cselect_b32 s25, 65536, s25
    v_mfma_f32_16x16x32_bf16 a[8:11], v[96:99], v[136:139], a[8:11]
    v_mfma_f32_16x16x32_bf16 a[12:15], v[96:99], v[140:143], a[12:15]
    ds_read_b64_tr_b16 v[64:65], v244 offset:32768
    s_add_u32 m0, s24, 0
    v_mfma_f32_16x16x32_bf16 a[16:19], v[96:99], v[144:147], a[16:19]
    buffer_load_dwordx4 v240, s[8:11], s20 offen offset:0 nt lds
    v_mfma_f32_16x16x32_bf16 a[20:23], v[96:99], v[148:151], a[20:23]
    v_add_u32 v254, s25, v252
    ds_read_b64_tr_b16 v[66:67], v244 offset:34816
    v_mfma_f32_16x16x32_bf16 a[24:27], v[96:99], v[152:155], a[24:27]
    v_add_u32 v255, s25, v253
    s_and_b32 s71, s49, 7
    v_mfma_f32_16x16x32_bf16 a[28:31], v[96:99], v[156:159], a[28:31]
    ds_read_b128 v[32:35], v254 offset:0
    s_lshr_b32 s72, s49, 3
    v_mfma_f32_16x16x32_bf16 a[60:63], v[100:103], v[156:159], a[60:63]
    buffer_load_dwordx4 v241, s[8:11], s20 offen offset:1024 nt lds
    v_mfma_f32_16x16x32_bf16 a[56:59], v[100:103], v[152:155], a[56:59]
    ds_read_b64_tr_b16 v[68:69], v245 offset:32768
    s_mul_i32 s96, s30, 229376
    v_mfma_f32_16x16x32_bf16 a[52:55], v[100:103], v[148:151], a[52:55]
    s_mul_i32 s73, s71, 28672
    s_add_u32 s93, s96, s73
    v_mfma_f32_16x16x32_bf16 a[48:51], v[100:103], v[144:147], a[48:51]
    ds_read_b64_tr_b16 v[70:71], v245 offset:34816
    s_lshl_b32 s73, s72, 7
    v_mfma_f32_16x16x32_bf16 a[44:47], v[100:103], v[140:143], a[44:47]
    buffer_load_dwordx4 v242, s[8:11], s20 offen offset:2048 nt lds
    v_mfma_f32_16x16x32_bf16 a[40:43], v[100:103], v[136:139], a[40:43]
    ds_read_b128 v[36:39], v254 offset:2048
    s_add_u32 s93, s93, s73
    v_mfma_f32_16x16x32_bf16 a[36:39], v[100:103], v[132:135], a[36:39]
    s_xor_b32 s73, s72, s30
    v_mfma_f32_16x16x32_bf16 a[32:35], v[100:103], v[128:131], a[32:35]
    ds_read_b64_tr_b16 v[72:73], v246 offset:32768
    v_mfma_f32_16x16x32_bf16 a[64:67], v[104:107], v[128:131], a[64:67]
    buffer_load_dwordx4 v243, s[8:11], s20 offen offset:3072 nt lds
    v_mfma_f32_16x16x32_bf16 a[68:71], v[104:107], v[132:135], a[68:71]
    ds_read_b64_tr_b16 v[74:75], v246 offset:34816
    s_add_u32 s20, s20, 262144
    v_mfma_f32_16x16x32_bf16 a[72:75], v[104:107], v[136:139], a[72:75]
    s_bitcmp1_b32 s73, 0
    s_cselect_b32 s73, 0, 4
    v_mfma_f32_16x16x32_bf16 a[76:79], v[104:107], v[140:143], a[76:79]
    ds_read_b128 v[40:43], v254 offset:4096
    v_mfma_f32_16x16x32_bf16 a[80:83], v[104:107], v[144:147], a[80:83]
    s_cmp_eq_u32 s72, 6
    s_cselect_b32 s73, 0, s73
    v_mfma_f32_16x16x32_bf16 a[84:87], v[104:107], v[148:151], a[84:87]
    ds_read_b64_tr_b16 v[76:77], v247 offset:32768
    s_add_u32 m0, s24, 16384
    v_mfma_f32_16x16x32_bf16 a[88:91], v[104:107], v[152:155], a[88:91]
    buffer_load_dwordx4 v240, s[8:11], s20 offen offset:0 nt lds
    v_mfma_f32_16x16x32_bf16 a[92:95], v[104:107], v[156:159], a[92:95]
    ds_read_b64_tr_b16 v[78:79], v247 offset:34816
    s_lshr_b32 s74, s72, 1
    v_mfma_f32_16x16x32_bf16 a[124:127], v[108:111], v[156:159], a[124:127]
    s_add_u32 s73, s73, s74
    s_lshl_b32 s73, s73, 3
    v_mfma_f32_16x16x32_bf16 a[120:123], v[108:111], v[152:155], a[120:123]
    ds_read_b128 v[44:47], v254 offset:6144
    s_add_u32 s73, s73, s71
    v_mfma_f32_16x16x32_bf16 a[116:119], v[108:111], v[148:151], a[116:119]
    buffer_load_dwordx4 v241, s[8:11], s20 offen offset:1024 nt lds
    v_mfma_f32_16x16x32_bf16 a[112:115], v[108:111], v[144:147], a[112:115]
    ds_read_b64_tr_b16 v[80:81], v248 offset:32768
    s_lshl_b32 s73, s73, 12
    v_mfma_f32_16x16x32_bf16 a[108:111], v[108:111], v[140:143], a[108:111]
    s_add_u32 s96, s96, s73
    s_add_u32 s96, s96, 39845888
    v_mfma_f32_16x16x32_bf16 a[104:107], v[108:111], v[136:139], a[104:107]
    ds_read_b64_tr_b16 v[82:83], v248 offset:34816
    s_lshl_b32 s70, s30, 3
    v_mfma_f32_16x16x32_bf16 a[100:103], v[108:111], v[132:135], a[100:103]
    buffer_load_dwordx4 v242, s[8:11], s20 offen offset:2048 nt lds
    v_mfma_f32_16x16x32_bf16 a[96:99], v[108:111], v[128:131], a[96:99]
    ds_read_b128 v[48:51], v254 offset:8192
    s_add_u32 s70, s70, s49
    v_mfma_f32_16x16x32_bf16 a[128:131], v[112:115], v[128:131], a[128:131]
    s_add_u32 s70, s70, 312
    s_mul_i32 s71, s70, 9363
    v_mfma_f32_16x16x32_bf16 a[132:135], v[112:115], v[132:135], a[132:135]
    ds_read_b64_tr_b16 v[84:85], v249 offset:32768
    s_lshr_b32 s71, s71, 16
    v_mfma_f32_16x16x32_bf16 a[136:139], v[112:115], v[136:139], a[136:139]
    buffer_load_dwordx4 v243, s[8:11], s20 offen offset:3072 nt lds
    v_mfma_f32_16x16x32_bf16 a[140:143], v[112:115], v[140:143], a[140:143]
    ds_read_b64_tr_b16 v[86:87], v249 offset:34816
    s_add_u32 s20, s20, 262144
    v_mfma_f32_16x16x32_bf16 a[144:147], v[112:115], v[144:147], a[144:147]
    s_mul_i32 s72, s71, 7
    s_sub_u32 s72, s70, s72
    v_mfma_f32_16x16x32_bf16 a[148:151], v[112:115], v[148:151], a[148:151]
    ds_read_b128 v[52:55], v254 offset:10240
    s_mul_i32 s73, s71, 28672
    v_mfma_f32_16x16x32_bf16 a[152:155], v[112:115], v[152:155], a[152:155]
    s_lshl_b32 s74, s72, 7
    s_add_u32 s73, s73, s74
    v_mfma_f32_16x16x32_bf16 a[156:159], v[112:115], v[156:159], a[156:159]
    ds_read_b64_tr_b16 v[88:89], v250 offset:32768
    s_add_u32 m0, s22, s37
    v_mfma_f32_16x16x32_bf16 a[188:191], v[116:119], v[156:159], a[188:191]
    buffer_load_dwordx4 v232, s[4:7], s21 offen offset:0 lds
    v_mfma_f32_16x16x32_bf16 a[184:187], v[116:119], v[152:155], a[184:187]
    ds_read_b64_tr_b16 v[90:91], v250 offset:34816
    s_mul_i32 s74, s72, 229376
    v_mfma_f32_16x16x32_bf16 a[180:183], v[116:119], v[148:151], a[180:183]
    s_bfe_u32 s72, s71, 0x10001
    s_mul_i32 s72, s72, 114688
    v_mfma_f32_16x16x32_bf16 a[176:179], v[116:119], v[144:147], a[176:179]
    ds_read_b128 v[56:59], v254 offset:12288
    s_add_u32 s74, s74, s72
    v_mfma_f32_16x16x32_bf16 a[172:175], v[116:119], v[140:143], a[172:175]
    buffer_load_dwordx4 v233, s[4:7], s21 offen offset:1024 lds
    v_mfma_f32_16x16x32_bf16 a[168:171], v[116:119], v[136:139], a[168:171]
    ds_read_b64_tr_b16 v[92:93], v251 offset:32768
    s_and_b32 s72, s71, 1
    v_mfma_f32_16x16x32_bf16 a[164:167], v[116:119], v[132:135], a[164:167]
    s_lshr_b32 s71, s71, 2
    s_lshl_b32 s71, s71, 1
    v_mfma_f32_16x16x32_bf16 a[160:163], v[116:119], v[128:131], a[160:163]
    ds_read_b64_tr_b16 v[94:95], v251 offset:34816
    s_add_u32 s71, s71, s72
    v_mfma_f32_16x16x32_bf16 a[192:195], v[120:123], v[128:131], a[192:195]
    buffer_load_dwordx4 v234, s[4:7], s21 offen offset:2048 lds
    v_mfma_f32_16x16x32_bf16 a[196:199], v[120:123], v[132:135], a[196:199]
    ds_read_b128 v[60:63], v254 offset:14336
    s_lshl_b32 s71, s71, 12
    v_mfma_f32_16x16x32_bf16 a[200:203], v[120:123], v[136:139], a[200:203]
    s_add_u32 s74, s74, s71
    s_add_u32 s74, s74, 48234496
    v_mfma_f32_16x16x32_bf16 a[204:207], v[120:123], v[140:143], a[204:207]
    s_cmp_ge_u32 s70, 392
    s_cselect_b32 s73, 0, s73
    s_cselect_b32 s74, 268435456, s74
    v_mfma_f32_16x16x32_bf16 a[208:211], v[120:123], v[144:147], a[208:211]
    buffer_load_dwordx4 v235, s[4:7], s21 offen offset:3072 lds
    v_mfma_f32_16x16x32_bf16 a[212:215], v[120:123], v[148:151], a[212:215]
    s_mov_b32 s86, 3670016
    s_mov_b32 s98, 896
    v_mfma_f32_16x16x32_bf16 a[216:219], v[120:123], v[152:155], a[216:219]
    s_cmp_ge_u32 s49, 56
    s_cselect_b32 s84, s58, s50
    s_cselect_b32 s85, s59, s51
    v_mfma_f32_16x16x32_bf16 a[220:223], v[120:123], v[156:159], a[220:223]
    s_cmp_ge_u32 s49, 56
    s_cselect_b32 s86, 1605632, s86
    s_cselect_b32 s98, 896, s98
    v_mfma_f32_16x16x32_bf16 a[252:255], v[124:127], v[156:159], a[252:255]
    s_cmp_ge_u32 s49, 56
    s_cselect_b32 s93, s73, s93
    s_cselect_b32 s96, s74, s96
    s_cselect_b64 vcc, -1, 0
    v_mfma_f32_16x16x32_bf16 a[248:251], v[124:127], v[152:155], a[248:251]
    s_mov_b32 s87, 0x00020000
    v_mul_lo_u32 v26, v28, s98
    v_mfma_f32_16x16x32_bf16 a[244:247], v[124:127], v[148:151], a[244:247]
    v_cndmask_b32 v24, v30, v29, vcc
    v_add_u32 v26, v26, v24
    v_mfma_f32_16x16x32_bf16 a[240:243], v[124:127], v[144:147], a[240:243]
    v_mov_b32 v12, v14
    v_mov_b32 v13, v15
    v_mfma_f32_16x16x32_bf16 a[236:239], v[124:127], v[140:143], a[236:239]
    s_nop 0
    v_permlane16_swap_b32 v14, v12
    v_mfma_f32_16x16x32_bf16 a[232:235], v[124:127], v[136:139], a[232:235]
    v_permlane16_swap_b32 v15, v13
    s_nop 0
    v_mfma_f32_16x16x32_bf16 a[228:231], v[124:127], v[132:135], a[228:231]
    v_add_f32 v14, v14, v12
    v_add_f32 v15, v15, v13
    v_mfma_f32_16x16x32_bf16 a[224:227], v[124:127], v[128:131], a[224:227]
    s_waitcnt vmcnt(20) lgkmcnt(0)
    s_barrier
    v_mfma_f32_16x16x32_bf16 a[0:3], v[32:35], v[64:67], a[0:3]
    v_mfma_f32_16x16x32_bf16 a[4:7], v[32:35], v[68:71], a[4:7]
    v_mfma_f32_16x16x32_bf16 a[8:11], v[32:35], v[72:75], a[8:11]
    v_mfma_f32_16x16x32_bf16 a[12:15], v[32:35], v[76:79], a[12:15]
    ds_read_b64_tr_b16 v[128:129], v244 offset:49152
    s_add_u32 m0, s24, 32768
    v_mfma_f32_16x16x32_bf16 a[16:19], v[32:35], v[80:83], a[16:19]
    buffer_load_dwordx4 v240, s[8:11], s20 offen offset:0 nt lds
    v_mfma_f32_16x16x32_bf16 a[20:23], v[32:35], v[84:87], a[20:23]
    ds_read_b64_tr_b16 v[130:131], v244 offset:51200
    v_mov_b32 v12, v14
    v_mfma_f32_16x16x32_bf16 a[24:27], v[32:35], v[88:91], a[24:27]
    v_mov_b32 v13, v15
    s_nop 0
    v_mfma_f32_16x16x32_bf16 a[28:31], v[32:35], v[92:95], a[28:31]
    ds_read_b128 v[96:99], v255 offset:0
    v_permlane32_swap_b32 v14, v12
    v_mfma_f32_16x16x32_bf16 a[60:63], v[36:39], v[92:95], a[60:63]
    v_permlane32_swap_b32 v15, v13
    s_nop 0
    v_mfma_f32_16x16x32_bf16 a[56:59], v[36:39], v[88:91], a[56:59]
    ds_read_b64_tr_b16 v[132:133], v245 offset:49152
    v_add_f32 v14, v14, v12
    v_mfma_f32_16x16x32_bf16 a[52:55], v[36:39], v[84:87], a[52:55]
    buffer_load_dwordx4 v241, s[8:11], s20 offen offset:1024 nt lds
    v_mfma_f32_16x16x32_bf16 a[48:51], v[36:39], v[80:83], a[48:51]
    ds_read_b64_tr_b16 v[134:135], v245 offset:51200
    v_add_f32 v15, v15, v13
    v_mfma_f32_16x16x32_bf16 a[44:47], v[36:39], v[76:79], a[44:47]
    v_mov_b32 v12, v16
    v_mov_b32 v13, v17
    v_mfma_f32_16x16x32_bf16 a[40:43], v[36:39], v[72:75], a[40:43]
    ds_read_b128 v[100:103], v255 offset:2048
    s_nop 0
    v_mfma_f32_16x16x32_bf16 a[36:39], v[36:39], v[68:71], a[36:39]
    v_permlane16_swap_b32 v16, v12
    v_permlane16_swap_b32 v17, v13
    v_mfma_f32_16x16x32_bf16 a[32:35], v[36:39], v[64:67], a[32:35]
    ds_read_b64_tr_b16 v[136:137], v246 offset:49152
    s_nop 0
    v_mfma_f32_16x16x32_bf16 a[64:67], v[40:43], v[64:67], a[64:67]
    buffer_load_dwordx4 v242, s[8:11], s20 offen offset:2048 nt lds
    v_mfma_f32_16x16x32_bf16 a[68:71], v[40:43], v[68:71], a[68:71]
    ds_read_b64_tr_b16 v[138:139], v246 offset:51200
    v_add_f32 v16, v16, v12
    v_mfma_f32_16x16x32_bf16 a[72:75], v[40:43], v[72:75], a[72:75]
    v_add_f32 v17, v17, v13
    v_mov_b32 v12, v16
    v_mfma_f32_16x16x32_bf16 a[76:79], v[40:43], v[76:79], a[76:79]
    ds_read_b128 v[104:107], v255 offset:4096
    v_mov_b32 v13, v17
    v_mfma_f32_16x16x32_bf16 a[80:83], v[40:43], v[80:83], a[80:83]
    s_nop 0
    v_permlane32_swap_b32 v16, v12
    v_mfma_f32_16x16x32_bf16 a[84:87], v[40:43], v[84:87], a[84:87]
    ds_read_b64_tr_b16 v[140:141], v247 offset:49152
    v_permlane32_swap_b32 v17, v13
    v_mfma_f32_16x16x32_bf16 a[88:91], v[40:43], v[88:91], a[88:91]
    buffer_load_dwordx4 v243, s[8:11], s20 offen offset:3072 nt lds
    v_mfma_f32_16x16x32_bf16 a[92:95], v[40:43], v[92:95], a[92:95]
    ds_read_b64_tr_b16 v[142:143], v247 offset:51200
    s_add_u32 s20, s20, 262144
    v_mfma_f32_16x16x32_bf16 a[124:127], v[44:47], v[92:95], a[124:127]
    s_nop 0
    v_add_f32 v16, v16, v12
    v_mfma_f32_16x16x32_bf16 a[120:123], v[44:47], v[88:91], a[120:123]
    ds_read_b128 v[108:111], v255 offset:6144
    v_add_f32 v17, v17, v13
    v_mfma_f32_16x16x32_bf16 a[116:119], v[44:47], v[84:87], a[116:119]
    v_mul_f32 v14, 0x3b124925, v14
    v_mul_f32 v16, 0x3b124925, v16
    v_mfma_f32_16x16x32_bf16 a[112:115], v[44:47], v[80:83], a[112:115]
    ds_read_b64_tr_b16 v[144:145], v248 offset:49152
    v_fma_f32 v16, -v14, v14, v16
    v_mfma_f32_16x16x32_bf16 a[108:111], v[44:47], v[76:79], a[108:111]
    v_max_f32 v16, 0, v16
    v_add_f32 v16, 0x3727c5ac, v16
    v_mfma_f32_16x16x32_bf16 a[104:107], v[44:47], v[72:75], a[104:107]
    ds_read_b64_tr_b16 v[146:147], v248 offset:51200
    v_rsq_f32 v16, v16
    v_mfma_f32_16x16x32_bf16 a[100:103], v[44:47], v[68:71], a[100:103]
    v_mul_f32 v15, 0x3b124925, v15
    v_mul_f32 v17, 0x3b124925, v17
    v_mfma_f32_16x16x32_bf16 a[96:99], v[44:47], v[64:67], a[96:99]
    ds_read_b128 v[112:115], v255 offset:8192
    s_add_u32 m0, s22, s29
    v_mfma_f32_16x16x32_bf16 a[128:131], v[48:51], v[64:67], a[128:131]
    buffer_load_dwordx4 v236, s[4:7], s21 offen offset:0 lds
    v_mfma_f32_16x16x32_bf16 a[132:135], v[48:51], v[68:71], a[132:135]
    ds_read_b64_tr_b16 v[148:149], v249 offset:49152
    v_fma_f32 v17, -v15, v15, v17
    v_mfma_f32_16x16x32_bf16 a[136:139], v[48:51], v[72:75], a[136:139]
    v_max_f32 v17, 0, v17
    v_add_f32 v17, 0x3727c5ac, v17
    v_mfma_f32_16x16x32_bf16 a[140:143], v[48:51], v[76:79], a[140:143]
    ds_read_b64_tr_b16 v[150:151], v249 offset:51200
    v_rsq_f32 v17, v17
    v_mfma_f32_16x16x32_bf16 a[144:147], v[48:51], v[80:83], a[144:147]
    v_lshl_add_u32 v10, v11, 1, v10
    v_mul_f32 v16, 0x3db8aa3b, v16
    v_mfma_f32_16x16x32_bf16 a[148:151], v[48:51], v[84:87], a[148:151]
    ds_read_b128 v[116:119], v255 offset:10240
    v_mul_f32 v14, v14, v16
    v_mfma_f32_16x16x32_bf16 a[152:155], v[48:51], v[88:91], a[152:155]
    buffer_load_dwordx4 v237, s[4:7], s21 offen offset:1024 lds
    v_mfma_f32_16x16x32_bf16 a[156:159], v[48:51], v[92:95], a[156:159]
    ds_read_b64_tr_b16 v[152:153], v250 offset:49152
    v_mul_f32 v17, 0x3db8aa3b, v17
    v_mfma_f32_16x16x32_bf16 a[188:191], v[52:55], v[92:95], a[188:191]
    v_mul_f32 v15, v15, v17
    s_lshl_b32 s75, s30, 6
    v_mfma_f32_16x16x32_bf16 a[184:187], v[52:55], v[88:91], a[184:187]
    ds_read_b64_tr_b16 v[154:155], v250 offset:51200
    s_add_u32 s75, s75, s49
    v_mfma_f32_16x16x32_bf16 a[180:183], v[52:55], v[84:87], a[180:183]
    s_cmp_ge_u32 s75, 392
    s_cselect_b32 s54, s56, s54
    s_cselect_b32 s55, s57, s55
    s_cselect_b32 s73, 392, 0
    s_cselect_b32 s97, 4096, 0
    v_mfma_f32_16x16x32_bf16 a[176:179], v[52:55], v[80:83], a[176:179]
    ds_read_b128 v[120:123], v255 offset:12288
    s_sub_u32 s70, s75, s73
    v_mfma_f32_16x16x32_bf16 a[172:175], v[52:55], v[76:79], a[172:175]
    buffer_load_dwordx4 v238, s[4:7], s21 offen offset:2048 lds
    v_mfma_f32_16x16x32_bf16 a[168:171], v[52:55], v[72:75], a[168:171]
    ds_read_b64_tr_b16 v[156:157], v251 offset:49152
    s_lshr_b32 s71, s70, 2
    v_mfma_f32_16x16x32_bf16 a[164:167], v[52:55], v[68:71], a[164:167]
    s_mul_i32 s71, s71, 9363
    s_lshr_b32 s71, s71, 16
    v_mfma_f32_16x16x32_bf16 a[160:163], v[52:55], v[64:67], a[160:163]
    ds_read_b64_tr_b16 v[158:159], v251 offset:51200
    s_mul_i32 s72, s71, 28
    v_mfma_f32_16x16x32_bf16 a[192:195], v[56:59], v[64:67], a[192:195]
    s_sub_u32 s72, s70, s72
    s_mul_i32 s94, s71, 114688
    v_mfma_f32_16x16x32_bf16 a[196:199], v[56:59], v[68:71], a[196:199]
    ds_read_b128 v[124:127], v255 offset:14336
    s_lshl_b32 s73, s72, 7
    v_mfma_f32_16x16x32_bf16 a[200:203], v[56:59], v[72:75], a[200:203]
    buffer_load_dwordx4 v239, s[4:7], s21 offen offset:3072 lds
    v_mfma_f32_16x16x32_bf16 a[204:207], v[56:59], v[76:79], a[204:207]
    s_add_u32 s21, s21, 128
    s_add_u32 s22, s22, 32768
    v_mfma_f32_16x16x32_bf16 a[208:211], v[56:59], v[80:83], a[208:211]
    s_cmp_eq_u32 s22, 163840
    s_cselect_b32 s22, 65536, s22
    v_mfma_f32_16x16x32_bf16 a[212:215], v[56:59], v[84:87], a[212:215]
    s_add_u32 s94, s94, s73
    s_mul_i32 s73, s72, 114688
    v_mfma_f32_16x16x32_bf16 a[216:219], v[56:59], v[88:91], a[216:219]
    s_add_u32 s97, s97, s73
    s_lshl_b32 s73, s71, 13
    v_mfma_f32_16x16x32_bf16 a[220:223], v[56:59], v[92:95], a[220:223]
    s_add_u32 s97, s97, s73
    s_add_u32 s97, s97, 44040192
    v_mfma_f32_16x16x32_bf16 a[252:255], v[60:63], v[92:95], a[252:255]
    s_sub_u32 s70, s75, 784
    s_max_i32 s70, s70, 0
    v_mfma_f32_16x16x32_bf16 a[248:251], v[60:63], v[88:91], a[248:251]
    s_mul_i32 s71, s70, 9363
    s_lshr_b32 s71, s71, 16
    v_mfma_f32_16x16x32_bf16 a[244:247], v[60:63], v[84:87], a[244:247]
    s_mul_i32 s72, s71, 7
    s_sub_u32 s72, s70, s72
    v_mfma_f32_16x16x32_bf16 a[240:243], v[60:63], v[80:83], a[240:243]
    s_mul_i32 s73, s71, 28672
    s_lshl_b32 s74, s72, 7
    v_mfma_f32_16x16x32_bf16 a[236:239], v[60:63], v[76:79], a[236:239]
    s_add_u32 s73, s73, s74
    s_mul_i32 s74, s72, 229376
    v_mfma_f32_16x16x32_bf16 a[232:235], v[60:63], v[72:75], a[232:235]
    s_bfe_u32 s72, s71, 0x10001
    v_mfma_f32_16x16x32_bf16 a[228:231], v[60:63], v[68:71], a[228:231]
    v_mfma_f32_16x16x32_bf16 a[224:227], v[60:63], v[64:67], a[224:227]
    s_waitcnt vmcnt(16) lgkmcnt(0)
    s_barrier
    v_mfma_f32_16x16x32_bf16 a[0:3], v[96:99], v[128:131], a[0:3]
    s_add_u32 s25, s25, 32768
    v_mfma_f32_16x16x32_bf16 a[4:7], v[96:99], v[132:135], a[4:7]
    s_cmp_eq_u32 s25, 163840
    s_cselect_b32 s25, 65536, s25
    v_mfma_f32_16x16x32_bf16 a[8:11], v[96:99], v[136:139], a[8:11]
    v_mfma_f32_16x16x32_bf16 a[12:15], v[96:99], v[140:143], a[12:15]
    ds_read_b64_tr_b16 v[64:65], v244 offset:0
    s_add_u32 m0, s24, 49152
    v_mfma_f32_16x16x32_bf16 a[16:19], v[96:99], v[144:147], a[16:19]
    buffer_load_dwordx4 v240, s[8:11], s20 offen offset:0 nt lds
    v_mfma_f32_16x16x32_bf16 a[20:23], v[96:99], v[148:151], a[20:23]
    v_add_u32 v254, s25, v252
    ds_read_b64_tr_b16 v[66:67], v244 offset:2048
    v_mfma_f32_16x16x32_bf16 a[24:27], v[96:99], v[152:155], a[24:27]
    v_add_u32 v255, s25, v253
    v_lshrrev_b32 v9, 1, v9
    v_mfma_f32_16x16x32_bf16 a[28:31], v[96:99], v[156:159], a[28:31]
    ds_read_b128 v[32:35], v254 offset:0
    v_mul_u32_u24 v11, 4682, v10
    v_mfma_f32_16x16x32_bf16 a[60:63], v[100:103], v[156:159], a[60:63]
    v_lshrrev_b32 v11, 16, v11
    v_min_u32 v11, 3, v11
    v_mfma_f32_16x16x32_bf16 a[56:59], v[100:103], v[152:155], a[56:59]
    ds_read_b64_tr_b16 v[68:69], v245 offset:0
    v_mul_u32_u24 v11, 6176, v11
    v_mfma_f32_16x16x32_bf16 a[52:55], v[100:103], v[148:151], a[52:55]
    buffer_load_dwordx4 v241, s[8:11], s20 offen offset:1024 nt lds
    v_mfma_f32_16x16x32_bf16 a[48:51], v[100:103], v[144:147], a[48:51]
    ds_read_b64_tr_b16 v[70:71], v245 offset:2048
    v_mul_u32_u24 v10, 144, v10
    v_mfma_f32_16x16x32_bf16 a[44:47], v[100:103], v[140:143], a[44:47]
    v_add_u32 v18, v10, v11
    v_lshl_add_u32 v18, v9, 3, v18
    v_mfma_f32_16x16x32_bf16 a[40:43], v[100:103], v[136:139], a[40:43]
    ds_read_b128 v[36:39], v254 offset:2048
    s_lshl_b32 s3, s66, 5
    v_mfma_f32_16x16x32_bf16 a[36:39], v[100:103], v[132:135], a[36:39]
    s_add_u32 s3, s3, 102400
    v_add_u32 v18, s3, v18
    v_mfma_f32_16x16x32_bf16 a[32:35], v[100:103], v[128:131], a[32:35]
    ds_read_b64_tr_b16 v[72:73], v246 offset:0
    v_lshlrev_b32 v12, 16, v160
    v_mfma_f32_16x16x32_bf16 a[64:67], v[104:107], v[128:131], a[64:67]
    buffer_load_dwordx4 v242, s[8:11], s20 offen offset:2048 nt lds
    v_mfma_f32_16x16x32_bf16 a[68:71], v[104:107], v[132:135], a[68:71]
    ds_read_b64_tr_b16 v[74:75], v246 offset:2048
    v_and_b32 v13, 0xffff0000, v160
    v_mfma_f32_16x16x32_bf16 a[72:75], v[104:107], v[136:139], a[72:75]
    v_fma_f32 v12, v12, v16, -v14
    v_fma_f32 v13, v13, v16, -v14
    v_mfma_f32_16x16x32_bf16 a[76:79], v[104:107], v[140:143], a[76:79]
    ds_read_b128 v[40:43], v254 offset:4096
    v_cvt_pk_bf16_f32 v160, v12, v13
    v_mfma_f32_16x16x32_bf16 a[80:83], v[104:107], v[144:147], a[80:83]
    v_lshlrev_b32 v12, 16, v161
    v_and_b32 v13, 0xffff0000, v161
    v_mfma_f32_16x16x32_bf16 a[84:87], v[104:107], v[148:151], a[84:87]
    ds_read_b64_tr_b16 v[76:77], v247 offset:0
    v_fma_f32 v12, v12, v16, -v14
    v_mfma_f32_16x16x32_bf16 a[88:91], v[104:107], v[152:155], a[88:91]
    buffer_load_dwordx4 v243, s[8:11], s20 offen offset:3072 nt lds
    v_mfma_f32_16x16x32_bf16 a[92:95], v[104:107], v[156:159], a[92:95]
    ds_read_b64_tr_b16 v[78:79], v247 offset:2048
    s_add_u32 s20, s20, 262144
    v_mfma_f32_16x16x32_bf16 a[124:127], v[108:111], v[156:159], a[124:127]
    v_fma_f32 v13, v13, v16, -v14
    v_cvt_pk_bf16_f32 v161, v12, v13
    v_mfma_f32_16x16x32_bf16 a[120:123], v[108:111], v[152:155], a[120:123]
    ds_read_b128 v[44:47], v254 offset:6144
    v_lshlrev_b32 v12, 16, v162
    v_mfma_f32_16x16x32_bf16 a[116:119], v[108:111], v[148:151], a[116:119]
    v_and_b32 v13, 0xffff0000, v162
    v_fma_f32 v12, v12, v16, -v14
    v_mfma_f32_16x16x32_bf16 a[112:115], v[108:111], v[144:147], a[112:115]
    ds_read_b64_tr_b16 v[80:81], v248 offset:0
    v_fma_f32 v13, v13, v16, -v14
    v_mfma_f32_16x16x32_bf16 a[108:111], v[108:111], v[140:143], a[108:111]
    v_cvt_pk_bf16_f32 v162, v12, v13
    v_lshlrev_b32 v12, 16, v163
    v_mfma_f32_16x16x32_bf16 a[104:107], v[108:111], v[136:139], a[104:107]
    ds_read_b64_tr_b16 v[82:83], v248 offset:2048
    v_and_b32 v13, 0xffff0000, v163
    v_mfma_f32_16x16x32_bf16 a[100:103], v[108:111], v[132:135], a[100:103]
    v_fma_f32 v12, v12, v16, -v14
    v_fma_f32 v13, v13, v16, -v14
    v_mfma_f32_16x16x32_bf16 a[96:99], v[108:111], v[128:131], a[96:99]
    ds_read_b128 v[48:51], v254 offset:8192
    s_add_u32 m0, s22, s37
    v_mfma_f32_16x16x32_bf16 a[128:131], v[112:115], v[128:131], a[128:131]
    buffer_load_dwordx4 v232, s[4:7], s21 offen offset:0 lds
    v_mfma_f32_16x16x32_bf16 a[132:135], v[112:115], v[132:135], a[132:135]
    ds_read_b64_tr_b16 v[84:85], v249 offset:0
    v_cvt_pk_bf16_f32 v163, v12, v13
    v_mfma_f32_16x16x32_bf16 a[136:139], v[112:115], v[136:139], a[136:139]
    ds_write_b64 v18, v[160:161] offset:0
    ds_write_b64 v18, v[162:163] offset:144
    v_mfma_f32_16x16x32_bf16 a[140:143], v[112:115], v[140:143], a[140:143]
    ds_read_b64_tr_b16 v[86:87], v249 offset:2048
    v_lshlrev_b32 v12, 16, v164
    v_mfma_f32_16x16x32_bf16 a[144:147], v[112:115], v[144:147], a[144:147]
    v_and_b32 v13, 0xffff0000, v164
    v_fma_f32 v12, v12, v17, -v15
    v_mfma_f32_16x16x32_bf16 a[148:151], v[112:115], v[148:151], a[148:151]
    ds_read_b128 v[52:55], v254 offset:10240
    v_fma_f32 v13, v13, v17, -v15
    v_mfma_f32_16x16x32_bf16 a[152:155], v[112:115], v[152:155], a[152:155]
    buffer_load_dwordx4 v233, s[4:7], s21 offen offset:1024 lds
    v_mfma_f32_16x16x32_bf16 a[156:159], v[112:115], v[156:159], a[156:159]
    ds_read_b64_tr_b16 v[88:89], v250 offset:0
    v_cvt_pk_bf16_f32 v164, v12, v13
    v_mfma_f32_16x16x32_bf16 a[188:191], v[116:119], v[156:159], a[188:191]
    v_lshlrev_b32 v12, 16, v165
    v_and_b32 v13, 0xffff0000, v165
    v_mfma_f32_16x16x32_bf16 a[184:187], v[116:119], v[152:155], a[184:187]
    ds_read_b64_tr_b16 v[90:91], v250 offset:2048
    v_fma_f32 v12, v12, v17, -v15
    v_mfma_f32_16x16x32_bf16 a[180:183], v[116:119], v[148:151], a[180:183]
    v_fma_f32 v13, v13, v17, -v15
    v_mfma_f32_16x16x32_bf16 a[176:179], v[116:119], v[144:147], a[176:179]
    ds_read_b128 v[56:59], v254 offset:12288
    v_cvt_pk_bf16_f32 v165, v12, v13
    v_mfma_f32_16x16x32_bf16 a[172:175], v[116:119], v[140:143], a[172:175]
    buffer_load_dwordx4 v234, s[4:7], s21 offen offset:2048 lds
    v_mfma_f32_16x16x32_bf16 a[168:171], v[116:119], v[136:139], a[168:171]
    ds_read_b64_tr_b16 v[92:93], v251 offset:0
    v_lshlrev_b32 v12, 16, v166
    v_mfma_f32_16x16x32_bf16 a[164:167], v[116:119], v[132:135], a[164:167]
    v_and_b32 v13, 0xffff0000, v166
    v_fma_f32 v12, v12, v17, -v15
    v_mfma_f32_16x16x32_bf16 a[160:163], v[116:119], v[128:131], a[160:163]
    ds_read_b64_tr_b16 v[94:95], v251 offset:2048
    v_fma_f32 v13, v13, v17, -v15
    v_mfma_f32_16x16x32_bf16 a[192:195], v[120:123], v[128:131], a[192:195]
    v_cvt_pk_bf16_f32 v166, v12, v13
    v_mfma_f32_16x16x32_bf16 a[196:199], v[120:123], v[132:135], a[196:199]
    ds_read_b128 v[60:63], v254 offset:14336
    v_lshlrev_b32 v12, 16, v167
    v_mfma_f32_16x16x32_bf16 a[200:203], v[120:123], v[136:139], a[200:203]
    buffer_load_dwordx4 v235, s[4:7], s21 offen offset:3072 lds
    v_mfma_f32_16x16x32_bf16 a[204:207], v[120:123], v[140:143], a[204:207]
    v_and_b32 v13, 0xffff0000, v167
    v_fma_f32 v12, v12, v17, -v15
    v_mfma_f32_16x16x32_bf16 a[208:211], v[120:123], v[144:147], a[208:211]
    v_fma_f32 v13, v13, v17, -v15
    v_mfma_f32_16x16x32_bf16 a[212:215], v[120:123], v[148:151], a[212:215]
    v_cvt_pk_bf16_f32 v167, v12, v13
    v_mfma_f32_16x16x32_bf16 a[216:219], v[120:123], v[152:155], a[216:219]
    ds_write_b64 v18, v[164:165] offset:16
    v_mfma_f32_16x16x32_bf16 a[220:223], v[120:123], v[156:159], a[220:223]
    ds_write_b64 v18, v[166:167] offset:160
    v_mfma_f32_16x16x32_bf16 a[252:255], v[124:127], v[156:159], a[252:255]
    v_lshrrev_b32 v11, 3, v2
    v_mfma_f32_16x16x32_bf16 a[248:251], v[124:127], v[152:155], a[248:251]
    v_add_lshl_u32 v11, v11, v2, 4
    v_mfma_f32_16x16x32_bf16 a[244:247], v[124:127], v[148:151], a[244:247]
    v_add_u32 v11, s29, v11
    v_mfma_f32_16x16x32_bf16 a[240:243], v[124:127], v[144:147], a[240:243]
    v_add_u32 v11, 98304, v11
    v_mfma_f32_16x16x32_bf16 a[236:239], v[124:127], v[140:143], a[236:239]
    v_mfma_f32_16x16x32_bf16 a[232:235], v[124:127], v[136:139], a[232:235]
    v_mfma_f32_16x16x32_bf16 a[228:231], v[124:127], v[132:135], a[228:231]
    v_mfma_f32_16x16x32_bf16 a[224:227], v[124:127], v[128:131], a[224:227]
    s_waitcnt vmcnt(20) lgkmcnt(0)
    s_barrier
    v_mfma_f32_16x16x32_bf16 a[0:3], v[32:35], v[64:67], a[0:3]
    ds_read_b128 v[160:163], v11
    ds_read_b128 v[164:167], v11 offset:1152
    v_mfma_f32_16x16x32_bf16 a[4:7], v[32:35], v[68:71], a[4:7]
    v_mfma_f32_16x16x32_bf16 a[8:11], v[32:35], v[72:75], a[8:11]
    v_mfma_f32_16x16x32_bf16 a[12:15], v[32:35], v[76:79], a[12:15]
    ds_read_b64_tr_b16 v[128:129], v244 offset:16384
    s_add_u32 m0, s24, 0
    v_mfma_f32_16x16x32_bf16 a[16:19], v[32:35], v[80:83], a[16:19]
    buffer_load_dwordx4 v240, s[8:11], s20 offen offset:0 nt lds
    v_mfma_f32_16x16x32_bf16 a[20:23], v[32:35], v[84:87], a[20:23]
    ds_read_b64_tr_b16 v[130:131], v244 offset:18432
    v_mfma_f32_16x16x32_bf16 a[24:27], v[32:35], v[88:91], a[24:27]
    v_mfma_f32_16x16x32_bf16 a[28:31], v[32:35], v[92:95], a[28:31]
    ds_read_b128 v[96:99], v255 offset:0
    v_mfma_f32_16x16x32_bf16 a[60:63], v[36:39], v[92:95], a[60:63]
    v_mfma_f32_16x16x32_bf16 a[56:59], v[36:39], v[88:91], a[56:59]
    ds_read_b64_tr_b16 v[132:133], v245 offset:16384
    v_mfma_f32_16x16x32_bf16 a[52:55], v[36:39], v[84:87], a[52:55]
    buffer_load_dwordx4 v241, s[8:11], s20 offen offset:1024 nt lds
    v_mfma_f32_16x16x32_bf16 a[48:51], v[36:39], v[80:83], a[48:51]
    ds_read_b64_tr_b16 v[134:135], v245 offset:18432
    v_mfma_f32_16x16x32_bf16 a[44:47], v[36:39], v[76:79], a[44:47]
    s_waitcnt lgkmcnt(5)
    v_mfma_f32_16x16x32_bf16 a[40:43], v[36:39], v[72:75], a[40:43]
    ds_read_b128 v[100:103], v255 offset:2048
    v_lshrrev_b32 v9, 3, v2
    v_mfma_f32_16x16x32_bf16 a[36:39], v[36:39], v[68:71], a[36:39]
    v_lshlrev_b32 v9, 8, v9
    v_and_b32 v10, 7, v2
    v_mfma_f32_16x16x32_bf16 a[32:35], v[36:39], v[64:67], a[32:35]
    ds_read_b64_tr_b16 v[136:137], v246 offset:16384
    v_lshl_add_u32 v9, v10, 4, v9
    v_mfma_f32_16x16x32_bf16 a[64:67], v[40:43], v[64:67], a[64:67]
    buffer_load_dwordx4 v242, s[8:11], s20 offen offset:2048 nt lds
    v_mfma_f32_16x16x32_bf16 a[68:71], v[40:43], v[68:71], a[68:71]
    ds_read_b64_tr_b16 v[138:139], v246 offset:18432
    v_cmp_gt_u32 vcc, 48, v2
    v_mfma_f32_16x16x32_bf16 a[72:75], v[40:43], v[72:75], a[72:75]
    v_mov_b32 v10, 268435456
    s_lshr_b32 s36, s2, 1
    v_mfma_f32_16x16x32_bf16 a[76:79], v[40:43], v[76:79], a[76:79]
    ds_read_b128 v[104:107], v255 offset:4096
    s_mul_i32 s36, s36, 14336
    v_mfma_f32_16x16x32_bf16 a[80:83], v[40:43], v[80:83], a[80:83]
    v_cndmask_b32 v10, v10, v9, vcc
    s_and_b32 s3, s2, 1
    v_mfma_f32_16x16x32_bf16 a[84:87], v[40:43], v[84:87], a[84:87]
    ds_read_b64_tr_b16 v[140:141], v247 offset:16384
    s_lshl_b32 s3, s3, 7
    v_mfma_f32_16x16x32_bf16 a[88:91], v[40:43], v[88:91], a[88:91]
    buffer_load_dwordx4 v243, s[8:11], s20 offen offset:3072 nt lds
    v_mfma_f32_16x16x32_bf16 a[92:95], v[40:43], v[92:95], a[92:95]
    ds_read_b64_tr_b16 v[142:143], v247 offset:18432
    s_add_u32 s20, s20, 262144
    v_mfma_f32_16x16x32_bf16 a[124:127], v[44:47], v[92:95], a[124:127]
    s_add_u32 s36, s36, s3
    s_mul_i32 s3, s66, 3584
    v_mfma_f32_16x16x32_bf16 a[120:123], v[44:47], v[88:91], a[120:123]
    ds_read_b128 v[108:111], v255 offset:6144
    s_add_u32 s36, s36, s3
    v_mfma_f32_16x16x32_bf16 a[116:119], v[44:47], v[84:87], a[116:119]
    s_add_u32 s36, s36, 33554432
    v_mfma_f32_16x16x32_bf16 a[112:115], v[44:47], v[80:83], a[112:115]
    ds_read_b64_tr_b16 v[144:145], v248 offset:16384
    buffer_store_dwordx4 v[160:163], v9, s[12:15], s36 offen sc1
    v_mfma_f32_16x16x32_bf16 a[108:111], v[44:47], v[76:79], a[108:111]
    v_mfma_f32_16x16x32_bf16 a[104:107], v[44:47], v[72:75], a[104:107]
    ds_read_b64_tr_b16 v[146:147], v248 offset:18432
    buffer_store_dwordx4 v[164:167], v10, s[12:15], s36 offen offset:2048 sc1
    v_mfma_f32_16x16x32_bf16 a[100:103], v[44:47], v[68:71], a[100:103]
    s_getreg_b32 s39, hwreg(HW_REG_XCC_ID, 0, 4)
    s_mul_i32 s3, s2, 384
    v_mfma_f32_16x16x32_bf16 a[96:99], v[44:47], v[64:67], a[96:99]
    ds_read_b128 v[112:115], v255 offset:8192
    s_add_u32 m0, s22, s29
    v_mfma_f32_16x16x32_bf16 a[128:131], v[48:51], v[64:67], a[128:131]
    buffer_load_dwordx4 v236, s[4:7], s21 offen offset:0 lds
    v_mfma_f32_16x16x32_bf16 a[132:135], v[48:51], v[68:71], a[132:135]
    ds_read_b64_tr_b16 v[148:149], v249 offset:16384
    s_add_u32 s39, s39, 1
    v_mfma_f32_16x16x32_bf16 a[136:139], v[48:51], v[72:75], a[136:139]
    s_add_u32 s3, s3, 111149056
    v_cmp_gt_u32 vcc, 16, v0
    v_mfma_f32_16x16x32_bf16 a[140:143], v[48:51], v[76:79], a[140:143]
    ds_read_b64_tr_b16 v[150:151], v249 offset:18432
    v_mov_b32 v9, 268435456
    v_mfma_f32_16x16x32_bf16 a[144:147], v[48:51], v[80:83], a[144:147]
    v_mov_b32 v12, 0
    v_mfma_f32_16x16x32_bf16 a[148:151], v[48:51], v[84:87], a[148:151]
    ds_read_b128 v[116:119], v255 offset:10240
    v_cndmask_b32 v9, v9, v1, vcc
    v_mfma_f32_16x16x32_bf16 a[152:155], v[48:51], v[88:91], a[152:155]
    buffer_load_dwordx4 v237, s[4:7], s21 offen offset:1024 lds
    v_mfma_f32_16x16x32_bf16 a[156:159], v[48:51], v[92:95], a[156:159]
    ds_read_b64_tr_b16 v[152:153], v250 offset:16384
    v_mov_b32 v13, 0
    v_mfma_f32_16x16x32_bf16 a[188:191], v[52:55], v[92:95], a[188:191]
    v_mov_b32 v14, 0
    v_mov_b32 v15, 0
    v_mfma_f32_16x16x32_bf16 a[184:187], v[52:55], v[88:91], a[184:187]
    ds_read_b64_tr_b16 v[154:155], v250 offset:18432
    v_writelane_b32 v12, s39, 0
    v_mfma_f32_16x16x32_bf16 a[180:183], v[52:55], v[84:87], a[180:183]
    buffer_store_dwordx4 v[12:15], v9, s[12:15], s3 offen sc1
    v_mfma_f32_16x16x32_bf16 a[176:179], v[52:55], v[80:83], a[176:179]
    ds_read_b128 v[120:123], v255 offset:12288
    s_lshl_b32 s3, s2, 2
    v_mfma_f32_16x16x32_bf16 a[172:175], v[52:55], v[76:79], a[172:175]
    buffer_load_dwordx4 v238, s[4:7], s21 offen offset:2048 lds
    v_mfma_f32_16x16x32_bf16 a[168:171], v[52:55], v[72:75], a[168:171]
    ds_read_b64_tr_b16 v[156:157], v251 offset:16384
    s_add_u32 s3, s3, 111280128
    v_mfma_f32_16x16x32_bf16 a[164:167], v[52:55], v[68:71], a[164:167]
    buffer_store_dword v13, v31, s[12:15], s3 offen sc1
    s_mul_i32 s72, s72, 114688
    v_mfma_f32_16x16x32_bf16 a[160:163], v[52:55], v[64:67], a[160:163]
    ds_read_b64_tr_b16 v[158:159], v251 offset:18432
    s_add_u32 s74, s74, s72
    v_mfma_f32_16x16x32_bf16 a[192:195], v[56:59], v[64:67], a[192:195]
    v_mfma_f32_16x16x32_bf16 a[196:199], v[56:59], v[68:71], a[196:199]
    ds_read_b128 v[124:127], v255 offset:14336
    s_and_b32 s72, s71, 1
    v_mfma_f32_16x16x32_bf16 a[200:203], v[56:59], v[72:75], a[200:203]
    buffer_load_dwordx4 v239, s[4:7], s21 offen offset:3072 lds
    v_mfma_f32_16x16x32_bf16 a[204:207], v[56:59], v[76:79], a[204:207]
    s_add_u32 s21, s21, 128
    s_add_u32 s22, s22, 32768
    v_mfma_f32_16x16x32_bf16 a[208:211], v[56:59], v[80:83], a[208:211]
    s_cmp_eq_u32 s22, 163840
    s_cselect_b32 s22, 65536, s22
    v_mfma_f32_16x16x32_bf16 a[212:215], v[56:59], v[84:87], a[212:215]
    s_lshr_b32 s71, s71, 2
    s_lshl_b32 s71, s71, 1
    v_mfma_f32_16x16x32_bf16 a[216:219], v[56:59], v[88:91], a[216:219]
    s_add_u32 s71, s71, s72
    s_lshl_b32 s71, s71, 12
    v_mfma_f32_16x16x32_bf16 a[220:223], v[56:59], v[92:95], a[220:223]
    s_add_u32 s74, s74, s71
    s_add_u32 s74, s74, 48234496
    v_mfma_f32_16x16x32_bf16 a[252:255], v[60:63], v[92:95], a[252:255]
    s_mov_b32 s90, 1605632
    v_mfma_f32_16x16x32_bf16 a[248:251], v[60:63], v[88:91], a[248:251]
    s_mov_b32 s99, 3584
    v_mfma_f32_16x16x32_bf16 a[244:247], v[60:63], v[84:87], a[244:247]
    s_cmp_ge_u32 s75, 784
    s_cselect_b32 s88, s58, s54
    s_cselect_b32 s89, s59, s55
    v_mfma_f32_16x16x32_bf16 a[240:243], v[60:63], v[80:83], a[240:243]
    v_mfma_f32_16x16x32_bf16 a[236:239], v[60:63], v[76:79], a[236:239]
    v_mfma_f32_16x16x32_bf16 a[232:235], v[60:63], v[72:75], a[232:235]
    v_mfma_f32_16x16x32_bf16 a[228:231], v[60:63], v[68:71], a[228:231]
    v_mfma_f32_16x16x32_bf16 a[224:227], v[60:63], v[64:67], a[224:227]
    s_waitcnt vmcnt(20) lgkmcnt(0)
    s_barrier
    v_mfma_f32_16x16x32_bf16 a[0:3], v[96:99], v[128:131], a[0:3]
    s_add_u32 s25, s25, 32768
    v_mfma_f32_16x16x32_bf16 a[4:7], v[96:99], v[132:135], a[4:7]
    s_cmp_eq_u32 s25, 163840
    s_cselect_b32 s25, 65536, s25
    v_mfma_f32_16x16x32_bf16 a[8:11], v[96:99], v[136:139], a[8:11]
    v_mfma_f32_16x16x32_bf16 a[12:15], v[96:99], v[140:143], a[12:15]
    ds_read_b64_tr_b16 v[64:65], v244 offset:32768
    s_add_u32 m0, s24, 16384
    v_mfma_f32_16x16x32_bf16 a[16:19], v[96:99], v[144:147], a[16:19]
    buffer_load_dwordx4 v240, s[8:11], s20 offen offset:0 nt lds
    v_mfma_f32_16x16x32_bf16 a[20:23], v[96:99], v[148:151], a[20:23]
    v_add_u32 v254, s25, v252
    ds_read_b64_tr_b16 v[66:67], v244 offset:34816
    v_mfma_f32_16x16x32_bf16 a[24:27], v[96:99], v[152:155], a[24:27]
    v_add_u32 v255, s25, v253
    v_mfma_f32_16x16x32_bf16 a[28:31], v[96:99], v[156:159], a[28:31]
    ds_read_b128 v[32:35], v254 offset:0
    v_mfma_f32_16x16x32_bf16 a[60:63], v[100:103], v[156:159], a[60:63]
    s_cmp_ge_u32 s75, 784
    s_cselect_b32 s90, 1605632, s90
    s_cselect_b32 s99, 896, s99
    v_mfma_f32_16x16x32_bf16 a[56:59], v[100:103], v[152:155], a[56:59]
    ds_read_b64_tr_b16 v[68:69], v245 offset:32768
    v_mfma_f32_16x16x32_bf16 a[52:55], v[100:103], v[148:151], a[52:55]
    buffer_load_dwordx4 v241, s[8:11], s20 offen offset:1024 nt lds
    v_mfma_f32_16x16x32_bf16 a[48:51], v[100:103], v[144:147], a[48:51]
    ds_read_b64_tr_b16 v[70:71], v245 offset:34816
    v_mfma_f32_16x16x32_bf16 a[44:47], v[100:103], v[140:143], a[44:47]
    s_cmp_ge_u32 s75, 784
    s_cselect_b32 s94, s73, s94
    s_cselect_b32 s97, s74, s97
    s_cselect_b64 vcc, -1, 0
    v_mfma_f32_16x16x32_bf16 a[40:43], v[100:103], v[136:139], a[40:43]
    ds_read_b128 v[36:39], v254 offset:2048
    s_mov_b32 s91, 0x00020000
    v_mfma_f32_16x16x32_bf16 a[36:39], v[100:103], v[132:135], a[36:39]
    v_mul_lo_u32 v27, v28, s99
    v_cndmask_b32 v24, v30, v29, vcc
    v_mfma_f32_16x16x32_bf16 a[32:35], v[100:103], v[128:131], a[32:35]
    ds_read_b64_tr_b16 v[72:73], v246 offset:32768
    v_add_u32 v27, v27, v24
    v_mfma_f32_16x16x32_bf16 a[64:67], v[104:107], v[128:131], a[64:67]
    buffer_load_dwordx4 v242, s[8:11], s20 offen offset:2048 nt lds
    v_mfma_f32_16x16x32_bf16 a[68:71], v[104:107], v[132:135], a[68:71]
    ds_read_b64_tr_b16 v[74:75], v246 offset:34816
    s_mul_i32 s70, s69, 13
    v_mfma_f32_16x16x32_bf16 a[72:75], v[104:107], v[136:139], a[72:75]
    buffer_load_dwordx2 v[208:209], v25, s[80:83], s92 offen nt
    v_mfma_f32_16x16x32_bf16 a[76:79], v[104:107], v[140:143], a[76:79]
    ds_read_b128 v[40:43], v254 offset:4096
    v_mfma_f32_16x16x32_bf16 a[80:83], v[104:107], v[144:147], a[80:83]
    v_mfma_f32_16x16x32_bf16 a[84:87], v[104:107], v[148:151], a[84:87]
    ds_read_b64_tr_b16 v[76:77], v247 offset:32768
    s_add_u32 s92, s92, s69
    v_mfma_f32_16x16x32_bf16 a[88:91], v[104:107], v[152:155], a[88:91]
    buffer_load_dwordx4 v243, s[8:11], s20 offen offset:3072 nt lds
    v_mfma_f32_16x16x32_bf16 a[92:95], v[104:107], v[156:159], a[92:95]
    ds_read_b64_tr_b16 v[78:79], v247 offset:34816
    s_add_u32 s20, s20, 262144
    v_mfma_f32_16x16x32_bf16 a[124:127], v[108:111], v[156:159], a[124:127]
    buffer_load_dwordx2 v[210:211], v25, s[80:83], s92 offen nt
    v_mfma_f32_16x16x32_bf16 a[120:123], v[108:111], v[152:155], a[120:123]
    ds_read_b128 v[44:47], v254 offset:6144
    v_mfma_f32_16x16x32_bf16 a[116:119], v[108:111], v[148:151], a[116:119]
    s_add_u32 s92, s92, s69
    v_mfma_f32_16x16x32_bf16 a[112:115], v[108:111], v[144:147], a[112:115]
    ds_read_b64_tr_b16 v[80:81], v248 offset:32768
    v_mfma_f32_16x16x32_bf16 a[108:111], v[108:111], v[140:143], a[108:111]
    buffer_load_dwordx2 v[212:213], v25, s[80:83], s92 offen nt
    v_mfma_f32_16x16x32_bf16 a[104:107], v[108:111], v[136:139], a[104:107]
    ds_read_b64_tr_b16 v[82:83], v248 offset:34816
    v_mfma_f32_16x16x32_bf16 a[100:103], v[108:111], v[132:135], a[100:103]
    v_mfma_f32_16x16x32_bf16 a[96:99], v[108:111], v[128:131], a[96:99]
    ds_read_b128 v[48:51], v254 offset:8192
    s_add_u32 m0, s22, s37
    v_mfma_f32_16x16x32_bf16 a[128:131], v[112:115], v[128:131], a[128:131]
    buffer_load_dwordx4 v232, s[4:7], s21 offen offset:0 lds
    v_mfma_f32_16x16x32_bf16 a[132:135], v[112:115], v[132:135], a[132:135]
    ds_read_b64_tr_b16 v[84:85], v249 offset:32768
    s_add_u32 s92, s92, s69
    v_mfma_f32_16x16x32_bf16 a[136:139], v[112:115], v[136:139], a[136:139]
    buffer_load_dwordx2 v[214:215], v25, s[80:83], s92 offen nt
    v_mfma_f32_16x16x32_bf16 a[140:143], v[112:115], v[140:143], a[140:143]
    ds_read_b64_tr_b16 v[86:87], v249 offset:34816
    v_mfma_f32_16x16x32_bf16 a[144:147], v[112:115], v[144:147], a[144:147]
    v_mfma_f32_16x16x32_bf16 a[148:151], v[112:115], v[148:151], a[148:151]
    ds_read_b128 v[52:55], v254 offset:10240
    s_add_u32 s92, s92, s70
    v_mfma_f32_16x16x32_bf16 a[152:155], v[112:115], v[152:155], a[152:155]
    buffer_load_dwordx4 v233, s[4:7], s21 offen offset:1024 lds
    v_mfma_f32_16x16x32_bf16 a[156:159], v[112:115], v[156:159], a[156:159]
    ds_read_b64_tr_b16 v[88:89], v250 offset:32768
    v_mfma_f32_16x16x32_bf16 a[188:191], v[116:119], v[156:159], a[188:191]
    buffer_load_dwordx2 v[216:217], v25, s[80:83], s92 offen nt
    v_mfma_f32_16x16x32_bf16 a[184:187], v[116:119], v[152:155], a[184:187]
    ds_read_b64_tr_b16 v[90:91], v250 offset:34816
    v_mfma_f32_16x16x32_bf16 a[180:183], v[116:119], v[148:151], a[180:183]
    v_mfma_f32_16x16x32_bf16 a[176:179], v[116:119], v[144:147], a[176:179]
    ds_read_b128 v[56:59], v254 offset:12288
    s_add_u32 s92, s92, s69
    v_mfma_f32_16x16x32_bf16 a[172:175], v[116:119], v[140:143], a[172:175]
    buffer_load_dwordx4 v234, s[4:7], s21 offen offset:2048 lds
    v_mfma_f32_16x16x32_bf16 a[168:171], v[116:119], v[136:139], a[168:171]
    ds_read_b64_tr_b16 v[92:93], v251 offset:32768
    v_mfma_f32_16x16x32_bf16 a[164:167], v[116:119], v[132:135], a[164:167]
    buffer_load_dwordx2 v[218:219], v25, s[80:83], s92 offen nt
    v_mfma_f32_16x16x32_bf16 a[160:163], v[116:119], v[128:131], a[160:163]
    ds_read_b64_tr_b16 v[94:95], v251 offset:34816
    v_mfma_f32_16x16x32_bf16 a[192:195], v[120:123], v[128:131], a[192:195]
    v_mfma_f32_16x16x32_bf16 a[196:199], v[120:123], v[132:135], a[196:199]
    ds_read_b128 v[60:63], v254 offset:14336
    s_add_u32 s92, s92, s69
    v_mfma_f32_16x16x32_bf16 a[200:203], v[120:123], v[136:139], a[200:203]
    buffer_load_dwordx4 v235, s[4:7], s21 offen offset:3072 lds
    v_mfma_f32_16x16x32_bf16 a[204:207], v[120:123], v[140:143], a[204:207]
    v_mfma_f32_16x16x32_bf16 a[208:211], v[120:123], v[144:147], a[208:211]
    buffer_load_dwordx2 v[220:221], v25, s[80:83], s92 offen nt
    v_mfma_f32_16x16x32_bf16 a[212:215], v[120:123], v[148:151], a[212:215]
    v_mfma_f32_16x16x32_bf16 a[216:219], v[120:123], v[152:155], a[216:219]
    s_add_u32 s92, s92, s69
    v_mfma_f32_16x16x32_bf16 a[220:223], v[120:123], v[156:159], a[220:223]
    v_mfma_f32_16x16x32_bf16 a[252:255], v[124:127], v[156:159], a[252:255]
    buffer_load_dwordx2 v[222:223], v25, s[80:83], s92 offen nt
    v_mfma_f32_16x16x32_bf16 a[248:251], v[124:127], v[152:155], a[248:251]
    v_mfma_f32_16x16x32_bf16 a[244:247], v[124:127], v[148:151], a[244:247]
    v_mfma_f32_16x16x32_bf16 a[240:243], v[124:127], v[144:147], a[240:243]
    v_mfma_f32_16x16x32_bf16 a[236:239], v[124:127], v[140:143], a[236:239]
    v_mfma_f32_16x16x32_bf16 a[232:235], v[124:127], v[136:139], a[232:235]
    v_mfma_f32_16x16x32_bf16 a[228:231], v[124:127], v[132:135], a[228:231]
    v_mfma_f32_16x16x32_bf16 a[224:227], v[124:127], v[128:131], a[224:227]
    s_mov_b32 s35, 5
    s_branch G_V_mid
    .p2align 4
G_V_loop:
    s_waitcnt vmcnt(18) lgkmcnt(0)
    s_barrier
    v_mfma_f32_16x16x32_bf16 a[0:3], v[32:35], v[64:67], a[0:3]
    v_mfma_f32_16x16x32_bf16 a[4:7], v[32:35], v[68:71], a[4:7]
    v_mfma_f32_16x16x32_bf16 a[8:11], v[32:35], v[72:75], a[8:11]
    s_cmp_eq_u32 s20, s79
    s_cbranch_scc1 G_V_sig0
G_V_sigback0:
    v_mfma_f32_16x16x32_bf16 a[12:15], v[32:35], v[76:79], a[12:15]
    ds_read_b64_tr_b16 v[128:129], v244 offset:16384
    s_add_u32 m0, s24, 0
    v_mfma_f32_16x16x32_bf16 a[16:19], v[32:35], v[80:83], a[16:19]
    buffer_load_dwordx4 v240, s[8:11], s20 offen offset:0 nt lds
    v_mfma_f32_16x16x32_bf16 a[20:23], v[32:35], v[84:87], a[20:23]
    ds_read_b64_tr_b16 v[130:131], v244 offset:18432
    v_perm_b32 v8, v210, v208, s76
    v_mfma_f32_16x16x32_bf16 a[24:27], v[32:35], v[88:91], a[24:27]
    v_perm_b32 v12, v210, v208, s77
    v_perm_b32 v16, v211, v209, s76
    v_mfma_f32_16x16x32_bf16 a[28:31], v[32:35], v[92:95], a[28:31]
    ds_read_b128 v[96:99], v255 offset:0
    v_perm_b32 v20, v211, v209, s77
    v_mfma_f32_16x16x32_bf16 a[60:63], v[36:39], v[92:95], a[60:63]
    v_perm_b32 v9, v214, v212, s76
    v_mfma_f32_16x16x32_bf16 a[56:59], v[36:39], v[88:91], a[56:59]
    ds_read_b64_tr_b16 v[132:133], v245 offset:16384
    v_mfma_f32_16x16x32_bf16 a[52:55], v[36:39], v[84:87], a[52:55]
    buffer_load_dwordx4 v241, s[8:11], s20 offen offset:1024 nt lds
    v_mfma_f32_16x16x32_bf16 a[48:51], v[36:39], v[80:83], a[48:51]
    ds_read_b64_tr_b16 v[134:135], v245 offset:18432
    v_perm_b32 v13, v214, v212, s77
    v_mfma_f32_16x16x32_bf16 a[44:47], v[36:39], v[76:79], a[44:47]
    v_perm_b32 v17, v215, v213, s76
    v_mfma_f32_16x16x32_bf16 a[40:43], v[36:39], v[72:75], a[40:43]
    ds_read_b128 v[100:103], v255 offset:2048
    v_perm_b32 v21, v215, v213, s77
    v_mfma_f32_16x16x32_bf16 a[36:39], v[36:39], v[68:71], a[36:39]
    v_mfma_f32_16x16x32_bf16 a[32:35], v[36:39], v[64:67], a[32:35]
    ds_read_b64_tr_b16 v[136:137], v246 offset:16384
    v_mfma_f32_16x16x32_bf16 a[64:67], v[40:43], v[64:67], a[64:67]
    buffer_load_dwordx4 v242, s[8:11], s20 offen offset:2048 nt lds
    v_mfma_f32_16x16x32_bf16 a[68:71], v[40:43], v[68:71], a[68:71]
    ds_read_b64_tr_b16 v[138:139], v246 offset:18432
    v_mfma_f32_16x16x32_bf16 a[72:75], v[40:43], v[72:75], a[72:75]
    buffer_load_dwordx2 v[208:209], v26, s[84:87], s93 offen nt
    v_mfma_f32_16x16x32_bf16 a[76:79], v[40:43], v[76:79], a[76:79]
    ds_read_b128 v[104:107], v255 offset:4096
    s_add_u32 s93, s93, s98
    v_mfma_f32_16x16x32_bf16 a[80:83], v[40:43], v[80:83], a[80:83]
    v_mfma_f32_16x16x32_bf16 a[84:87], v[40:43], v[84:87], a[84:87]
    ds_read_b64_tr_b16 v[140:141], v247 offset:16384
    v_perm_b32 v10, v218, v216, s76
    v_mfma_f32_16x16x32_bf16 a[88:91], v[40:43], v[88:91], a[88:91]
    buffer_load_dwordx4 v243, s[8:11], s20 offen offset:3072 nt lds
    v_mfma_f32_16x16x32_bf16 a[92:95], v[40:43], v[92:95], a[92:95]
    ds_read_b64_tr_b16 v[142:143], v247 offset:18432
    s_add_u32 s20, s20, 262144
    v_mfma_f32_16x16x32_bf16 a[124:127], v[44:47], v[92:95], a[124:127]
    v_perm_b32 v14, v218, v216, s77
    v_perm_b32 v18, v219, v217, s76
    v_mfma_f32_16x16x32_bf16 a[120:123], v[44:47], v[88:91], a[120:123]
    ds_read_b128 v[108:111], v255 offset:6144
    v_mfma_f32_16x16x32_bf16 a[116:119], v[44:47], v[84:87], a[116:119]
    v_perm_b32 v22, v219, v217, s77
    v_mfma_f32_16x16x32_bf16 a[112:115], v[44:47], v[80:83], a[112:115]
    ds_read_b64_tr_b16 v[144:145], v248 offset:16384
    v_mfma_f32_16x16x32_bf16 a[108:111], v[44:47], v[76:79], a[108:111]
    buffer_load_dwordx2 v[210:211], v26, s[84:87], s93 offen nt
    v_mfma_f32_16x16x32_bf16 a[104:107], v[44:47], v[72:75], a[104:107]
    ds_read_b64_tr_b16 v[146:147], v248 offset:18432
    v_mfma_f32_16x16x32_bf16 a[100:103], v[44:47], v[68:71], a[100:103]
    v_mfma_f32_16x16x32_bf16 a[96:99], v[44:47], v[64:67], a[96:99]
    ds_read_b128 v[112:115], v255 offset:8192
    s_add_u32 m0, s22, s29
    v_mfma_f32_16x16x32_bf16 a[128:131], v[48:51], v[64:67], a[128:131]
    buffer_load_dwordx4 v236, s[4:7], s21 offen offset:0 lds
    v_mfma_f32_16x16x32_bf16 a[132:135], v[48:51], v[68:71], a[132:135]
    ds_read_b64_tr_b16 v[148:149], v249 offset:16384
    s_add_u32 s93, s93, s98
    v_mfma_f32_16x16x32_bf16 a[136:139], v[48:51], v[72:75], a[136:139]
    v_perm_b32 v11, v222, v220, s76
    v_mfma_f32_16x16x32_bf16 a[140:143], v[48:51], v[76:79], a[140:143]
    ds_read_b64_tr_b16 v[150:151], v249 offset:18432
    v_mfma_f32_16x16x32_bf16 a[144:147], v[48:51], v[80:83], a[144:147]
    v_perm_b32 v15, v222, v220, s77
    v_mfma_f32_16x16x32_bf16 a[148:151], v[48:51], v[84:87], a[148:151]
    ds_read_b128 v[116:119], v255 offset:10240
    v_mfma_f32_16x16x32_bf16 a[152:155], v[48:51], v[88:91], a[152:155]
    buffer_load_dwordx4 v237, s[4:7], s21 offen offset:1024 lds
    v_mfma_f32_16x16x32_bf16 a[156:159], v[48:51], v[92:95], a[156:159]
    ds_read_b64_tr_b16 v[152:153], v250 offset:16384
    v_perm_b32 v19, v223, v221, s76
    v_mfma_f32_16x16x32_bf16 a[188:191], v[52:55], v[92:95], a[188:191]
    v_perm_b32 v23, v223, v221, s77
    v_mfma_f32_16x16x32_bf16 a[184:187], v[52:55], v[88:91], a[184:187]
    ds_read_b64_tr_b16 v[154:155], v250 offset:18432
    v_mfma_f32_16x16x32_bf16 a[180:183], v[52:55], v[84:87], a[180:183]
    buffer_load_dwordx2 v[212:213], v26, s[84:87], s93 offen nt
    v_mfma_f32_16x16x32_bf16 a[176:179], v[52:55], v[80:83], a[176:179]
    ds_read_b128 v[120:123], v255 offset:12288
    v_mfma_f32_16x16x32_bf16 a[172:175], v[52:55], v[76:79], a[172:175]
    buffer_load_dwordx4 v238, s[4:7], s21 offen offset:2048 lds
    v_mfma_f32_16x16x32_bf16 a[168:171], v[52:55], v[72:75], a[168:171]
    ds_read_b64_tr_b16 v[156:157], v251 offset:16384
    s_add_u32 s93, s93, s98
    v_mfma_f32_16x16x32_bf16 a[164:167], v[52:55], v[68:71], a[164:167]
    v_mfma_f32_16x16x32_bf16 a[160:163], v[52:55], v[64:67], a[160:163]
    ds_read_b64_tr_b16 v[158:159], v251 offset:18432
    v_mfma_f32_16x16x32_bf16 a[192:195], v[56:59], v[64:67], a[192:195]
    buffer_load_dwordx2 v[214:215], v26, s[84:87], s93 offen nt
    v_mfma_f32_16x16x32_bf16 a[196:199], v[56:59], v[68:71], a[196:199]
    ds_read_b128 v[124:127], v255 offset:14336
    v_mfma_f32_16x16x32_bf16 a[200:203], v[56:59], v[72:75], a[200:203]
    buffer_load_dwordx4 v239, s[4:7], s21 offen offset:3072 lds
    v_mfma_f32_16x16x32_bf16 a[204:207], v[56:59], v[76:79], a[204:207]
    s_add_u32 s21, s21, 128
    s_add_u32 s22, s22, 32768
    v_mfma_f32_16x16x32_bf16 a[208:211], v[56:59], v[80:83], a[208:211]
    s_cmp_eq_u32 s22, 163840
    s_cselect_b32 s22, 65536, s22
    v_mfma_f32_16x16x32_bf16 a[212:215], v[56:59], v[84:87], a[212:215]
    s_mul_i32 s70, s98, 13
    s_add_u32 s93, s93, s70
    v_mfma_f32_16x16x32_bf16 a[216:219], v[56:59], v[88:91], a[216:219]
    v_mfma_f32_16x16x32_bf16 a[220:223], v[56:59], v[92:95], a[220:223]
    v_mfma_f32_16x16x32_bf16 a[252:255], v[60:63], v[92:95], a[252:255]
    v_mfma_f32_16x16x32_bf16 a[248:251], v[60:63], v[88:91], a[248:251]
    v_mfma_f32_16x16x32_bf16 a[244:247], v[60:63], v[84:87], a[244:247]
    v_mfma_f32_16x16x32_bf16 a[240:243], v[60:63], v[80:83], a[240:243]
    v_mfma_f32_16x16x32_bf16 a[236:239], v[60:63], v[76:79], a[236:239]
    buffer_store_dwordx4 v[8:11], v1, s[12:15], s78 offen offset:0 sc1
    v_mfma_f32_16x16x32_bf16 a[232:235], v[60:63], v[72:75], a[232:235]
    v_mfma_f32_16x16x32_bf16 a[228:231], v[60:63], v[68:71], a[228:231]
    v_mfma_f32_16x16x32_bf16 a[224:227], v[60:63], v[64:67], a[224:227]
    s_waitcnt vmcnt(22) lgkmcnt(0)
    s_barrier
    v_mfma_f32_16x16x32_bf16 a[0:3], v[96:99], v[128:131], a[0:3]
    s_add_u32 s25, s25, 32768
    v_mfma_f32_16x16x32_bf16 a[4:7], v[96:99], v[132:135], a[4:7]
    s_cmp_eq_u32 s25, 163840
    s_cselect_b32 s25, 65536, s25
    v_mfma_f32_16x16x32_bf16 a[8:11], v[96:99], v[136:139], a[8:11]
    s_cmp_eq_u32 s20, s79
    s_cbranch_scc1 G_V_sig1
G_V_sigback1:
    v_mfma_f32_16x16x32_bf16 a[12:15], v[96:99], v[140:143], a[12:15]
    ds_read_b64_tr_b16 v[64:65], v244 offset:32768
    s_add_u32 m0, s24, 16384
    v_mfma_f32_16x16x32_bf16 a[16:19], v[96:99], v[144:147], a[16:19]
    buffer_load_dwordx4 v240, s[8:11], s20 offen offset:0 nt lds
    v_mfma_f32_16x16x32_bf16 a[20:23], v[96:99], v[148:151], a[20:23]
    v_add_u32 v254, s25, v252
    ds_read_b64_tr_b16 v[66:67], v244 offset:34816
    v_mfma_f32_16x16x32_bf16 a[24:27], v[96:99], v[152:155], a[24:27]
    v_add_u32 v255, s25, v253
    v_mfma_f32_16x16x32_bf16 a[28:31], v[96:99], v[156:159], a[28:31]
    ds_read_b128 v[32:35], v254 offset:0
    v_mfma_f32_16x16x32_bf16 a[60:63], v[100:103], v[156:159], a[60:63]
    buffer_load_dwordx2 v[216:217], v26, s[84:87], s93 offen nt
    v_mfma_f32_16x16x32_bf16 a[56:59], v[100:103], v[152:155], a[56:59]
    ds_read_b64_tr_b16 v[68:69], v245 offset:32768
    s_add_u32 s93, s93, s98
    v_mfma_f32_16x16x32_bf16 a[52:55], v[100:103], v[148:151], a[52:55]
    buffer_load_dwordx4 v241, s[8:11], s20 offen offset:1024 nt lds
    v_mfma_f32_16x16x32_bf16 a[48:51], v[100:103], v[144:147], a[48:51]
    ds_read_b64_tr_b16 v[70:71], v245 offset:34816
    v_mfma_f32_16x16x32_bf16 a[44:47], v[100:103], v[140:143], a[44:47]
    buffer_load_dwordx2 v[218:219], v26, s[84:87], s93 offen nt
    v_mfma_f32_16x16x32_bf16 a[40:43], v[100:103], v[136:139], a[40:43]
    ds_read_b128 v[36:39], v254 offset:2048
    v_mfma_f32_16x16x32_bf16 a[36:39], v[100:103], v[132:135], a[36:39]
    s_add_u32 s93, s93, s98
    v_mfma_f32_16x16x32_bf16 a[32:35], v[100:103], v[128:131], a[32:35]
    ds_read_b64_tr_b16 v[72:73], v246 offset:32768
    v_mfma_f32_16x16x32_bf16 a[64:67], v[104:107], v[128:131], a[64:67]
    buffer_load_dwordx4 v242, s[8:11], s20 offen offset:2048 nt lds
    v_mfma_f32_16x16x32_bf16 a[68:71], v[104:107], v[132:135], a[68:71]
    ds_read_b64_tr_b16 v[74:75], v246 offset:34816
    v_mfma_f32_16x16x32_bf16 a[72:75], v[104:107], v[136:139], a[72:75]
    buffer_load_dwordx2 v[220:221], v26, s[84:87], s93 offen nt
    v_mfma_f32_16x16x32_bf16 a[76:79], v[104:107], v[140:143], a[76:79]
    ds_read_b128 v[40:43], v254 offset:4096
    v_mfma_f32_16x16x32_bf16 a[80:83], v[104:107], v[144:147], a[80:83]
    v_mfma_f32_16x16x32_bf16 a[84:87], v[104:107], v[148:151], a[84:87]
    ds_read_b64_tr_b16 v[76:77], v247 offset:32768
    v_mfma_f32_16x16x32_bf16 a[88:91], v[104:107], v[152:155], a[88:91]
    buffer_load_dwordx4 v243, s[8:11], s20 offen offset:3072 nt lds
    v_mfma_f32_16x16x32_bf16 a[92:95], v[104:107], v[156:159], a[92:95]
    ds_read_b64_tr_b16 v[78:79], v247 offset:34816
    s_add_u32 s20, s20, 262144
    v_mfma_f32_16x16x32_bf16 a[124:127], v[108:111], v[156:159], a[124:127]
    s_add_u32 s93, s93, s98
    v_mfma_f32_16x16x32_bf16 a[120:123], v[108:111], v[152:155], a[120:123]
    ds_read_b128 v[44:47], v254 offset:6144
    v_mfma_f32_16x16x32_bf16 a[116:119], v[108:111], v[148:151], a[116:119]
    buffer_load_dwordx2 v[222:223], v26, s[84:87], s93 offen nt
    v_mfma_f32_16x16x32_bf16 a[112:115], v[108:111], v[144:147], a[112:115]
    ds_read_b64_tr_b16 v[80:81], v248 offset:32768
    v_mfma_f32_16x16x32_bf16 a[108:111], v[108:111], v[140:143], a[108:111]
    v_mfma_f32_16x16x32_bf16 a[104:107], v[108:111], v[136:139], a[104:107]
    ds_read_b64_tr_b16 v[82:83], v248 offset:34816
    v_mfma_f32_16x16x32_bf16 a[100:103], v[108:111], v[132:135], a[100:103]
    s_mov_b32 s84, s88
    v_mfma_f32_16x16x32_bf16 a[96:99], v[108:111], v[128:131], a[96:99]
    ds_read_b128 v[48:51], v254 offset:8192
    s_add_u32 m0, s22, s37
    v_mfma_f32_16x16x32_bf16 a[128:131], v[112:115], v[128:131], a[128:131]
    buffer_load_dwordx4 v232, s[4:7], s21 offen offset:0 lds
    v_mfma_f32_16x16x32_bf16 a[132:135], v[112:115], v[132:135], a[132:135]
    ds_read_b64_tr_b16 v[84:85], v249 offset:32768
    s_mov_b32 s85, s89
    v_mfma_f32_16x16x32_bf16 a[136:139], v[112:115], v[136:139], a[136:139]
    v_mfma_f32_16x16x32_bf16 a[140:143], v[112:115], v[140:143], a[140:143]
    ds_read_b64_tr_b16 v[86:87], v249 offset:34816
    s_mov_b32 s86, s90
    v_mfma_f32_16x16x32_bf16 a[144:147], v[112:115], v[144:147], a[144:147]
    v_mfma_f32_16x16x32_bf16 a[148:151], v[112:115], v[148:151], a[148:151]
    ds_read_b128 v[52:55], v254 offset:10240
    v_mfma_f32_16x16x32_bf16 a[152:155], v[112:115], v[152:155], a[152:155]
    buffer_load_dwordx4 v233, s[4:7], s21 offen offset:1024 lds
    v_mfma_f32_16x16x32_bf16 a[156:159], v[112:115], v[156:159], a[156:159]
    ds_read_b64_tr_b16 v[88:89], v250 offset:32768
    s_mov_b32 s93, s94
    v_mfma_f32_16x16x32_bf16 a[188:191], v[116:119], v[156:159], a[188:191]
    v_mfma_f32_16x16x32_bf16 a[184:187], v[116:119], v[152:155], a[184:187]
    ds_read_b64_tr_b16 v[90:91], v250 offset:34816
    s_mov_b32 s98, s99
    v_mfma_f32_16x16x32_bf16 a[180:183], v[116:119], v[148:151], a[180:183]
    v_mfma_f32_16x16x32_bf16 a[176:179], v[116:119], v[144:147], a[176:179]
    ds_read_b128 v[56:59], v254 offset:12288
    v_mov_b32 v26, v27
    v_mfma_f32_16x16x32_bf16 a[172:175], v[116:119], v[140:143], a[172:175]
    buffer_load_dwordx4 v234, s[4:7], s21 offen offset:2048 lds
    v_mfma_f32_16x16x32_bf16 a[168:171], v[116:119], v[136:139], a[168:171]
    ds_read_b64_tr_b16 v[92:93], v251 offset:32768
    v_mfma_f32_16x16x32_bf16 a[164:167], v[116:119], v[132:135], a[164:167]
    s_mov_b32 s90, 0
    v_mfma_f32_16x16x32_bf16 a[160:163], v[116:119], v[128:131], a[160:163]
    ds_read_b64_tr_b16 v[94:95], v251 offset:34816
    v_mfma_f32_16x16x32_bf16 a[192:195], v[120:123], v[128:131], a[192:195]
    v_mfma_f32_16x16x32_bf16 a[196:199], v[120:123], v[132:135], a[196:199]
    ds_read_b128 v[60:63], v254 offset:14336
    s_mov_b32 s94, 0
    v_mfma_f32_16x16x32_bf16 a[200:203], v[120:123], v[136:139], a[200:203]
    buffer_load_dwordx4 v235, s[4:7], s21 offen offset:3072 lds
    v_mfma_f32_16x16x32_bf16 a[204:207], v[120:123], v[140:143], a[204:207]
    v_mfma_f32_16x16x32_bf16 a[208:211], v[120:123], v[144:147], a[208:211]
    s_mov_b32 s99, 0
    v_mfma_f32_16x16x32_bf16 a[212:215], v[120:123], v[148:151], a[212:215]
    v_mfma_f32_16x16x32_bf16 a[216:219], v[120:123], v[152:155], a[216:219]
    v_mfma_f32_16x16x32_bf16 a[220:223], v[120:123], v[156:159], a[220:223]
    v_mfma_f32_16x16x32_bf16 a[252:255], v[124:127], v[156:159], a[252:255]
    v_mfma_f32_16x16x32_bf16 a[248:251], v[124:127], v[152:155], a[248:251]
    v_mfma_f32_16x16x32_bf16 a[244:247], v[124:127], v[148:151], a[244:247]
    v_mfma_f32_16x16x32_bf16 a[240:243], v[124:127], v[144:147], a[240:243]
    v_mfma_f32_16x16x32_bf16 a[236:239], v[124:127], v[140:143], a[236:239]
    buffer_store_dwordx4 v[12:15], v1, s[12:15], s78 offen offset:1024 sc1
    v_mfma_f32_16x16x32_bf16 a[232:235], v[124:127], v[136:139], a[232:235]
    v_mfma_f32_16x16x32_bf16 a[228:231], v[124:127], v[132:135], a[228:231]
    v_mfma_f32_16x16x32_bf16 a[224:227], v[124:127], v[128:131], a[224:227]
G_V_mid:
    s_waitcnt vmcnt(26) lgkmcnt(0)
    s_barrier
    v_mfma_f32_16x16x32_bf16 a[0:3], v[32:35], v[64:67], a[0:3]
    v_mfma_f32_16x16x32_bf16 a[4:7], v[32:35], v[68:71], a[4:7]
    v_mfma_f32_16x16x32_bf16 a[8:11], v[32:35], v[72:75], a[8:11]
    s_cmp_eq_u32 s20, s79
    s_cbranch_scc1 G_V_sig2
G_V_sigback2:
    v_mfma_f32_16x16x32_bf16 a[12:15], v[32:35], v[76:79], a[12:15]
    ds_read_b64_tr_b16 v[128:129], v244 offset:49152
    s_add_u32 m0, s24, 32768
    v_mfma_f32_16x16x32_bf16 a[16:19], v[32:35], v[80:83], a[16:19]
    buffer_load_dwordx4 v240, s[8:11], s20 offen offset:0 nt lds
    v_mfma_f32_16x16x32_bf16 a[20:23], v[32:35], v[84:87], a[20:23]
    ds_read_b64_tr_b16 v[130:131], v244 offset:51200
    v_mfma_f32_16x16x32_bf16 a[24:27], v[32:35], v[88:91], a[24:27]
    v_mfma_f32_16x16x32_bf16 a[28:31], v[32:35], v[92:95], a[28:31]
    ds_read_b128 v[96:99], v255 offset:0
    v_mfma_f32_16x16x32_bf16 a[60:63], v[36:39], v[92:95], a[60:63]
    v_mfma_f32_16x16x32_bf16 a[56:59], v[36:39], v[88:91], a[56:59]
    ds_read_b64_tr_b16 v[132:133], v245 offset:49152
    v_mfma_f32_16x16x32_bf16 a[52:55], v[36:39], v[84:87], a[52:55]
    buffer_load_dwordx4 v241, s[8:11], s20 offen offset:1024 nt lds
    v_mfma_f32_16x16x32_bf16 a[48:51], v[36:39], v[80:83], a[48:51]
    ds_read_b64_tr_b16 v[134:135], v245 offset:51200
    v_mfma_f32_16x16x32_bf16 a[44:47], v[36:39], v[76:79], a[44:47]
    v_mfma_f32_16x16x32_bf16 a[40:43], v[36:39], v[72:75], a[40:43]
    ds_read_b128 v[100:103], v255 offset:2048
    v_mfma_f32_16x16x32_bf16 a[36:39], v[36:39], v[68:71], a[36:39]
    v_mfma_f32_16x16x32_bf16 a[32:35], v[36:39], v[64:67], a[32:35]
    ds_read_b64_tr_b16 v[136:137], v246 offset:49152
    v_mfma_f32_16x16x32_bf16 a[64:67], v[40:43], v[64:67], a[64:67]
    buffer_load_dwordx4 v242, s[8:11], s20 offen offset:2048 nt lds
    v_mfma_f32_16x16x32_bf16 a[68:71], v[40:43], v[68:71], a[68:71]
    ds_read_b64_tr_b16 v[138:139], v246 offset:51200
    v_mfma_f32_16x16x32_bf16 a[72:75], v[40:43], v[72:75], a[72:75]
    v_mfma_f32_16x16x32_bf16 a[76:79], v[40:43], v[76:79], a[76:79]
    ds_read_b128 v[104:107], v255 offset:4096
    v_mfma_f32_16x16x32_bf16 a[80:83], v[40:43], v[80:83], a[80:83]
    v_mfma_f32_16x16x32_bf16 a[84:87], v[40:43], v[84:87], a[84:87]
    ds_read_b64_tr_b16 v[140:141], v247 offset:49152
    v_mfma_f32_16x16x32_bf16 a[88:91], v[40:43], v[88:91], a[88:91]
    buffer_load_dwordx4 v243, s[8:11], s20 offen offset:3072 nt lds
    v_mfma_f32_16x16x32_bf16 a[92:95], v[40:43], v[92:95], a[92:95]
    ds_read_b64_tr_b16 v[142:143], v247 offset:51200
    s_add_u32 s20, s20, 262144
    v_mfma_f32_16x16x32_bf16 a[124:127], v[44:47], v[92:95], a[124:127]
    v_mfma_f32_16x16x32_bf16 a[120:123], v[44:47], v[88:91], a[120:123]
    ds_read_b128 v[108:111], v255 offset:6144
    v_mfma_f32_16x16x32_bf16 a[116:119], v[44:47], v[84:87], a[116:119]
    v_mfma_f32_16x16x32_bf16 a[112:115], v[44:47], v[80:83], a[112:115]
    ds_read_b64_tr_b16 v[144:145], v248 offset:49152
    v_mfma_f32_16x16x32_bf16 a[108:111], v[44:47], v[76:79], a[108:111]
    v_mfma_f32_16x16x32_bf16 a[104:107], v[44:47], v[72:75], a[104:107]
    ds_read_b64_tr_b16 v[146:147], v248 offset:51200
    v_mfma_f32_16x16x32_bf16 a[100:103], v[44:47], v[68:71], a[100:103]
    v_mfma_f32_16x16x32_bf16 a[96:99], v[44:47], v[64:67], a[96:99]
    ds_read_b128 v[112:115], v255 offset:8192
    s_add_u32 m0, s22, s29
    v_mfma_f32_16x16x32_bf16 a[128:131], v[48:51], v[64:67], a[128:131]
    buffer_load_dwordx4 v236, s[4:7], s21 offen offset:0 lds
    v_mfma_f32_16x16x32_bf16 a[132:135], v[48:51], v[68:71], a[132:135]
    ds_read_b64_tr_b16 v[148:149], v249 offset:49152
    v_mfma_f32_16x16x32_bf16 a[136:139], v[48:51], v[72:75], a[136:139]
    v_mfma_f32_16x16x32_bf16 a[140:143], v[48:51], v[76:79], a[140:143]
    ds_read_b64_tr_b16 v[150:151], v249 offset:51200
    v_mfma_f32_16x16x32_bf16 a[144:147], v[48:51], v[80:83], a[144:147]
    v_mfma_f32_16x16x32_bf16 a[148:151], v[48:51], v[84:87], a[148:151]
    ds_read_b128 v[116:119], v255 offset:10240
    v_mfma_f32_16x16x32_bf16 a[152:155], v[48:51], v[88:91], a[152:155]
    buffer_load_dwordx4 v237, s[4:7], s21 offen offset:1024 lds
    v_mfma_f32_16x16x32_bf16 a[156:159], v[48:51], v[92:95], a[156:159]
    ds_read_b64_tr_b16 v[152:153], v250 offset:49152
    v_mfma_f32_16x16x32_bf16 a[188:191], v[52:55], v[92:95], a[188:191]
    v_mfma_f32_16x16x32_bf16 a[184:187], v[52:55], v[88:91], a[184:187]
    ds_read_b64_tr_b16 v[154:155], v250 offset:51200
    v_mfma_f32_16x16x32_bf16 a[180:183], v[52:55], v[84:87], a[180:183]
    v_mfma_f32_16x16x32_bf16 a[176:179], v[52:55], v[80:83], a[176:179]
    ds_read_b128 v[120:123], v255 offset:12288
    v_mfma_f32_16x16x32_bf16 a[172:175], v[52:55], v[76:79], a[172:175]
    buffer_load_dwordx4 v238, s[4:7], s21 offen offset:2048 lds
    v_mfma_f32_16x16x32_bf16 a[168:171], v[52:55], v[72:75], a[168:171]
    ds_read_b64_tr_b16 v[156:157], v251 offset:49152
    v_mfma_f32_16x16x32_bf16 a[164:167], v[52:55], v[68:71], a[164:167]
    v_mfma_f32_16x16x32_bf16 a[160:163], v[52:55], v[64:67], a[160:163]
    ds_read_b64_tr_b16 v[158:159], v251 offset:51200
    v_mfma_f32_16x16x32_bf16 a[192:195], v[56:59], v[64:67], a[192:195]
    v_mfma_f32_16x16x32_bf16 a[196:199], v[56:59], v[68:71], a[196:199]
    ds_read_b128 v[124:127], v255 offset:14336
    v_mfma_f32_16x16x32_bf16 a[200:203], v[56:59], v[72:75], a[200:203]
    buffer_load_dwordx4 v239, s[4:7], s21 offen offset:3072 lds
    v_mfma_f32_16x16x32_bf16 a[204:207], v[56:59], v[76:79], a[204:207]
    s_add_u32 s21, s21, 128
    s_add_u32 s22, s22, 32768
    v_mfma_f32_16x16x32_bf16 a[208:211], v[56:59], v[80:83], a[208:211]
    s_cmp_eq_u32 s22, 163840
    s_cselect_b32 s22, 65536, s22
    v_mfma_f32_16x16x32_bf16 a[212:215], v[56:59], v[84:87], a[212:215]
    v_mfma_f32_16x16x32_bf16 a[216:219], v[56:59], v[88:91], a[216:219]
    v_mfma_f32_16x16x32_bf16 a[220:223], v[56:59], v[92:95], a[220:223]
    v_mfma_f32_16x16x32_bf16 a[252:255], v[60:63], v[92:95], a[252:255]
    v_mfma_f32_16x16x32_bf16 a[248:251], v[60:63], v[88:91], a[248:251]
    v_mfma_f32_16x16x32_bf16 a[244:247], v[60:63], v[84:87], a[244:247]
    v_mfma_f32_16x16x32_bf16 a[240:243], v[60:63], v[80:83], a[240:243]
    v_mfma_f32_16x16x32_bf16 a[236:239], v[60:63], v[76:79], a[236:239]
    buffer_store_dwordx4 v[16:19], v1, s[12:15], s78 offen offset:2048 sc1
    v_mfma_f32_16x16x32_bf16 a[232:235], v[60:63], v[72:75], a[232:235]
    v_mfma_f32_16x16x32_bf16 a[228:231], v[60:63], v[68:71], a[228:231]
    v_mfma_f32_16x16x32_bf16 a[224:227], v[60:63], v[64:67], a[224:227]
    s_waitcnt vmcnt(22) lgkmcnt(0)
    s_barrier
    v_mfma_f32_16x16x32_bf16 a[0:3], v[96:99], v[128:131], a[0:3]
    s_add_u32 s25, s25, 32768
    v_mfma_f32_16x16x32_bf16 a[4:7], v[96:99], v[132:135], a[4:7]
    s_cmp_eq_u32 s25, 163840
    s_cselect_b32 s25, 65536, s25
    v_mfma_f32_16x16x32_bf16 a[8:11], v[96:99], v[136:139], a[8:11]
    s_cmp_eq_u32 s20, s79
    s_cbranch_scc1 G_V_sig3
G_V_sigback3:
    v_mfma_f32_16x16x32_bf16 a[12:15], v[96:99], v[140:143], a[12:15]
    ds_read_b64_tr_b16 v[64:65], v244 offset:0
    s_add_u32 m0, s24, 49152
    v_mfma_f32_16x16x32_bf16 a[16:19], v[96:99], v[144:147], a[16:19]
    buffer_load_dwordx4 v240, s[8:11], s20 offen offset:0 nt lds
    v_mfma_f32_16x16x32_bf16 a[20:23], v[96:99], v[148:151], a[20:23]
    v_add_u32 v254, s25, v252
    ds_read_b64_tr_b16 v[66:67], v244 offset:2048
    v_mfma_f32_16x16x32_bf16 a[24:27], v[96:99], v[152:155], a[24:27]
    v_add_u32 v255, s25, v253
    v_mfma_f32_16x16x32_bf16 a[28:31], v[96:99], v[156:159], a[28:31]
    ds_read_b128 v[32:35], v254 offset:0
    v_mfma_f32_16x16x32_bf16 a[60:63], v[100:103], v[156:159], a[60:63]
    v_mfma_f32_16x16x32_bf16 a[56:59], v[100:103], v[152:155], a[56:59]
    ds_read_b64_tr_b16 v[68:69], v245 offset:0
    v_mfma_f32_16x16x32_bf16 a[52:55], v[100:103], v[148:151], a[52:55]
    buffer_load_dwordx4 v241, s[8:11], s20 offen offset:1024 nt lds
    v_mfma_f32_16x16x32_bf16 a[48:51], v[100:103], v[144:147], a[48:51]
    ds_read_b64_tr_b16 v[70:71], v245 offset:2048
    v_mfma_f32_16x16x32_bf16 a[44:47], v[100:103], v[140:143], a[44:47]
    v_mfma_f32_16x16x32_bf16 a[40:43], v[100:103], v[136:139], a[40:43]
    ds_read_b128 v[36:39], v254 offset:2048
    v_mfma_f32_16x16x32_bf16 a[36:39], v[100:103], v[132:135], a[36:39]
    v_mfma_f32_16x16x32_bf16 a[32:35], v[100:103], v[128:131], a[32:35]
    ds_read_b64_tr_b16 v[72:73], v246 offset:0
    v_mfma_f32_16x16x32_bf16 a[64:67], v[104:107], v[128:131], a[64:67]
    buffer_load_dwordx4 v242, s[8:11], s20 offen offset:2048 nt lds
    v_mfma_f32_16x16x32_bf16 a[68:71], v[104:107], v[132:135], a[68:71]
    ds_read_b64_tr_b16 v[74:75], v246 offset:2048
    v_mfma_f32_16x16x32_bf16 a[72:75], v[104:107], v[136:139], a[72:75]
    v_mfma_f32_16x16x32_bf16 a[76:79], v[104:107], v[140:143], a[76:79]
    ds_read_b128 v[40:43], v254 offset:4096
    v_mfma_f32_16x16x32_bf16 a[80:83], v[104:107], v[144:147], a[80:83]
    v_mfma_f32_16x16x32_bf16 a[84:87], v[104:107], v[148:151], a[84:87]
    ds_read_b64_tr_b16 v[76:77], v247 offset:0
    v_mfma_f32_16x16x32_bf16 a[88:91], v[104:107], v[152:155], a[88:91]
    buffer_load_dwordx4 v243, s[8:11], s20 offen offset:3072 nt lds
    v_mfma_f32_16x16x32_bf16 a[92:95], v[104:107], v[156:159], a[92:95]
    ds_read_b64_tr_b16 v[78:79], v247 offset:2048
    s_add_u32 s20, s20, 262144
    v_mfma_f32_16x16x32_bf16 a[124:127], v[108:111], v[156:159], a[124:127]
    v_mfma_f32_16x16x32_bf16 a[120:123], v[108:111], v[152:155], a[120:123]
    ds_read_b128 v[44:47], v254 offset:6144
    v_mfma_f32_16x16x32_bf16 a[116:119], v[108:111], v[148:151], a[116:119]
    v_mfma_f32_16x16x32_bf16 a[112:115], v[108:111], v[144:147], a[112:115]
    ds_read_b64_tr_b16 v[80:81], v248 offset:0
    v_mfma_f32_16x16x32_bf16 a[108:111], v[108:111], v[140:143], a[108:111]
    v_mfma_f32_16x16x32_bf16 a[104:107], v[108:111], v[136:139], a[104:107]
    ds_read_b64_tr_b16 v[82:83], v248 offset:2048
    v_mfma_f32_16x16x32_bf16 a[100:103], v[108:111], v[132:135], a[100:103]
    v_mfma_f32_16x16x32_bf16 a[96:99], v[108:111], v[128:131], a[96:99]
    ds_read_b128 v[48:51], v254 offset:8192
    s_add_u32 m0, s22, s37
    v_mfma_f32_16x16x32_bf16 a[128:131], v[112:115], v[128:131], a[128:131]
    buffer_load_dwordx4 v232, s[4:7], s21 offen offset:0 lds
    v_mfma_f32_16x16x32_bf16 a[132:135], v[112:115], v[132:135], a[132:135]
    ds_read_b64_tr_b16 v[84:85], v249 offset:0
    v_mfma_f32_16x16x32_bf16 a[136:139], v[112:115], v[136:139], a[136:139]
    v_mfma_f32_16x16x32_bf16 a[140:143], v[112:115], v[140:143], a[140:143]
    ds_read_b64_tr_b16 v[86:87], v249 offset:2048
    v_mfma_f32_16x16x32_bf16 a[144:147], v[112:115], v[144:147], a[144:147]
    v_mfma_f32_16x16x32_bf16 a[148:151], v[112:115], v[148:151], a[148:151]
    ds_read_b128 v[52:55], v254 offset:10240
    v_mfma_f32_16x16x32_bf16 a[152:155], v[112:115], v[152:155], a[152:155]
    buffer_load_dwordx4 v233, s[4:7], s21 offen offset:1024 lds
    v_mfma_f32_16x16x32_bf16 a[156:159], v[112:115], v[156:159], a[156:159]
    ds_read_b64_tr_b16 v[88:89], v250 offset:0
    v_mfma_f32_16x16x32_bf16 a[188:191], v[116:119], v[156:159], a[188:191]
    v_mfma_f32_16x16x32_bf16 a[184:187], v[116:119], v[152:155], a[184:187]
    ds_read_b64_tr_b16 v[90:91], v250 offset:2048
    v_mfma_f32_16x16x32_bf16 a[180:183], v[116:119], v[148:151], a[180:183]
    v_mfma_f32_16x16x32_bf16 a[176:179], v[116:119], v[144:147], a[176:179]
    ds_read_b128 v[56:59], v254 offset:12288
    v_mfma_f32_16x16x32_bf16 a[172:175], v[116:119], v[140:143], a[172:175]
    buffer_load_dwordx4 v234, s[4:7], s21 offen offset:2048 lds
    v_mfma_f32_16x16x32_bf16 a[168:171], v[116:119], v[136:139], a[168:171]
    ds_read_b64_tr_b16 v[92:93], v251 offset:0
    v_mfma_f32_16x16x32_bf16 a[164:167], v[116:119], v[132:135], a[164:167]
    v_mfma_f32_16x16x32_bf16 a[160:163], v[116:119], v[128:131], a[160:163]
    ds_read_b64_tr_b16 v[94:95], v251 offset:2048
    v_mfma_f32_16x16x32_bf16 a[192:195], v[120:123], v[128:131], a[192:195]
    v_mfma_f32_16x16x32_bf16 a[196:199], v[120:123], v[132:135], a[196:199]
    ds_read_b128 v[60:63], v254 offset:14336
    v_mfma_f32_16x16x32_bf16 a[200:203], v[120:123], v[136:139], a[200:203]
    buffer_load_dwordx4 v235, s[4:7], s21 offen offset:3072 lds
    v_mfma_f32_16x16x32_bf16 a[204:207], v[120:123], v[140:143], a[204:207]
    v_mfma_f32_16x16x32_bf16 a[208:211], v[120:123], v[144:147], a[208:211]
    v_mfma_f32_16x16x32_bf16 a[212:215], v[120:123], v[148:151], a[212:215]
    v_mfma_f32_16x16x32_bf16 a[216:219], v[120:123], v[152:155], a[216:219]
    v_mfma_f32_16x16x32_bf16 a[220:223], v[120:123], v[156:159], a[220:223]
    v_mfma_f32_16x16x32_bf16 a[252:255], v[124:127], v[156:159], a[252:255]
    v_mfma_f32_16x16x32_bf16 a[248:251], v[124:127], v[152:155], a[248:251]
    v_mfma_f32_16x16x32_bf16 a[244:247], v[124:127], v[148:151], a[244:247]
    v_mfma_f32_16x16x32_bf16 a[240:243], v[124:127], v[144:147], a[240:243]
    v_mfma_f32_16x16x32_bf16 a[236:239], v[124:127], v[140:143], a[236:239]
    buffer_store_dwordx4 v[20:23], v1, s[12:15], s78 offen offset:3072 sc1
    v_mfma_f32_16x16x32_bf16 a[232:235], v[124:127], v[136:139], a[232:235]
    s_mov_b32 s78, s95
    s_mov_b32 s95, s96
    v_mfma_f32_16x16x32_bf16 a[228:231], v[124:127], v[132:135], a[228:231]
    s_mov_b32 s96, s97
    s_mov_b32 s97, 268435456
    v_mfma_f32_16x16x32_bf16 a[224:227], v[124:127], v[128:131], a[224:227]
    s_sub_u32 s35, s35, 1
    s_cmp_lg_u32 s35, 0
    s_cbranch_scc1 G_V_loop
    s_waitcnt vmcnt(24) lgkmcnt(0)
    s_barrier
    v_mfma_f32_16x16x32_bf16 a[0:3], v[32:35], v[64:67], a[0:3]
    v_mfma_f32_16x16x32_bf16 a[4:7], v[32:35], v[68:71], a[4:7]
    v_mfma_f32_16x16x32_bf16 a[8:11], v[32:35], v[72:75], a[8:11]
    v_mfma_f32_16x16x32_bf16 a[12:15], v[32:35], v[76:79], a[12:15]
    ds_read_b64_tr_b16 v[128:129], v244 offset:16384
    s_add_u32 m0, s24, 0
    v_mfma_f32_16x16x32_bf16 a[16:19], v[32:35], v[80:83], a[16:19]
    buffer_load_dwordx4 v240, s[8:11], s20 offen offset:0 nt lds
    v_mfma_f32_16x16x32_bf16 a[20:23], v[32:35], v[84:87], a[20:23]
    ds_read_b64_tr_b16 v[130:131], v244 offset:18432
    v_mfma_f32_16x16x32_bf16 a[24:27], v[32:35], v[88:91], a[24:27]
    buffer_load_dword v24, v1, s[44:47], s48 offen
    v_mfma_f32_16x16x32_bf16 a[28:31], v[32:35], v[92:95], a[28:31]
    ds_read_b128 v[96:99], v255 offset:0
    s_mul_i32 s38, s30, 229376
    v_mfma_f32_16x16x32_bf16 a[60:63], v[36:39], v[92:95], a[60:63]
    v_mfma_f32_16x16x32_bf16 a[56:59], v[36:39], v[88:91], a[56:59]
    ds_read_b64_tr_b16 v[132:133], v245 offset:16384
    s_add_u32 s38, s38, 35651584
    v_mfma_f32_16x16x32_bf16 a[52:55], v[36:39], v[84:87], a[52:55]
    buffer_load_dwordx4 v241, s[8:11], s20 offen offset:1024 nt lds
    v_mfma_f32_16x16x32_bf16 a[48:51], v[36:39], v[80:83], a[48:51]
    ds_read_b64_tr_b16 v[134:135], v245 offset:18432
    v_mfma_f32_16x16x32_bf16 a[44:47], v[36:39], v[76:79], a[44:47]
    s_sub_u32 s36, 3, s66
    v_mfma_f32_16x16x32_bf16 a[40:43], v[36:39], v[72:75], a[40:43]
    ds_read_b128 v[100:103], v255 offset:2048
    v_mfma_f32_16x16x32_bf16 a[36:39], v[36:39], v[68:71], a[36:39]
    v_mfma_f32_16x16x32_bf16 a[32:35], v[36:39], v[64:67], a[32:35]
    ds_read_b64_tr_b16 v[136:137], v246 offset:16384
    v_mfma_f32_16x16x32_bf16 a[64:67], v[40:43], v[64:67], a[64:67]
    buffer_load_dwordx4 v242, s[8:11], s20 offen offset:2048 nt lds
    v_mfma_f32_16x16x32_bf16 a[68:71], v[40:43], v[68:71], a[68:71]
    ds_read_b64_tr_b16 v[138:139], v246 offset:18432
    v_mfma_f32_16x16x32_bf16 a[72:75], v[40:43], v[72:75], a[72:75]
    s_cmp_lt_u32 s68, 14
    s_cselect_b32 s26, s36, s66
    v_mfma_f32_16x16x32_bf16 a[76:79], v[40:43], v[76:79], a[76:79]
    ds_read_b128 v[104:107], v255 offset:4096
    v_mfma_f32_16x16x32_bf16 a[80:83], v[40:43], v[80:83], a[80:83]
    v_mfma_f32_16x16x32_bf16 a[84:87], v[40:43], v[84:87], a[84:87]
    ds_read_b64_tr_b16 v[140:141], v247 offset:16384
    s_lshl_b32 s36, s33, 2
    v_mfma_f32_16x16x32_bf16 a[88:91], v[40:43], v[88:91], a[88:91]
    buffer_load_dwordx4 v243, s[8:11], s20 offen offset:3072 nt lds
    v_mfma_f32_16x16x32_bf16 a[92:95], v[40:43], v[92:95], a[92:95]
    ds_read_b64_tr_b16 v[142:143], v247 offset:18432
    s_add_u32 s20, s20, 262144
    v_mfma_f32_16x16x32_bf16 a[124:127], v[44:47], v[92:95], a[124:127]
    s_add_u32 s26, s26, s36
    v_mfma_f32_16x16x32_bf16 a[120:123], v[44:47], v[88:91], a[120:123]
    ds_read_b128 v[108:111], v255 offset:6144
    v_mfma_f32_16x16x32_bf16 a[116:119], v[44:47], v[84:87], a[116:119]
    v_mfma_f32_16x16x32_bf16 a[112:115], v[44:47], v[80:83], a[112:115]
    ds_read_b64_tr_b16 v[144:145], v248 offset:16384
    s_mul_i32 s36, s26, 28672
    v_mfma_f32_16x16x32_bf16 a[108:111], v[44:47], v[76:79], a[108:111]
    v_mfma_f32_16x16x32_bf16 a[104:107], v[44:47], v[72:75], a[104:107]
    ds_read_b64_tr_b16 v[146:147], v248 offset:18432
    v_mfma_f32_16x16x32_bf16 a[100:103], v[44:47], v[68:71], a[100:103]
    s_add_u32 s36, s36, 33554432
    v_mfma_f32_16x16x32_bf16 a[96:99], v[44:47], v[64:67], a[96:99]
    ds_read_b128 v[112:115], v255 offset:8192
    s_add_u32 m0, s22, s29
    v_mfma_f32_16x16x32_bf16 a[128:131], v[48:51], v[64:67], a[128:131]
    buffer_load_dwordx4 v236, s[4:7], s21 offen offset:0 lds
    v_mfma_f32_16x16x32_bf16 a[132:135], v[48:51], v[68:71], a[132:135]
    ds_read_b64_tr_b16 v[148:149], v249 offset:16384
    s_add_u32 s35, s36, 4096
    v_mfma_f32_16x16x32_bf16 a[136:139], v[48:51], v[72:75], a[136:139]
    v_mfma_f32_16x16x32_bf16 a[140:143], v[48:51], v[76:79], a[140:143]
    ds_read_b64_tr_b16 v[150:151], v249 offset:18432
    v_mfma_f32_16x16x32_bf16 a[144:147], v[48:51], v[80:83], a[144:147]
    s_add_u32 s72, s36, 8192
    v_mfma_f32_16x16x32_bf16 a[148:151], v[48:51], v[84:87], a[148:151]
    ds_read_b128 v[116:119], v255 offset:10240
    v_mfma_f32_16x16x32_bf16 a[152:155], v[48:51], v[88:91], a[152:155]
    buffer_load_dwordx4 v237, s[4:7], s21 offen offset:1024 lds
    v_mfma_f32_16x16x32_bf16 a[156:159], v[48:51], v[92:95], a[156:159]
    ds_read_b64_tr_b16 v[152:153], v250 offset:16384
    s_add_u32 s73, s36, 12288
    v_mfma_f32_16x16x32_bf16 a[188:191], v[52:55], v[92:95], a[188:191]
    v_mfma_f32_16x16x32_bf16 a[184:187], v[52:55], v[88:91], a[184:187]
    ds_read_b64_tr_b16 v[154:155], v250 offset:18432
    v_mfma_f32_16x16x32_bf16 a[180:183], v[52:55], v[84:87], a[180:183]
    v_add_u32 v5, 14336, v1
    v_mfma_f32_16x16x32_bf16 a[176:179], v[52:55], v[80:83], a[176:179]
    ds_read_b128 v[120:123], v255 offset:12288
    v_mfma_f32_16x16x32_bf16 a[172:175], v[52:55], v[76:79], a[172:175]
    buffer_load_dwordx4 v238, s[4:7], s21 offen offset:2048 lds
    v_mfma_f32_16x16x32_bf16 a[168:171], v[52:55], v[72:75], a[168:171]
    ds_read_b64_tr_b16 v[156:157], v251 offset:16384
    s_and_b32 s3, s66, 1
    v_mfma_f32_16x16x32_bf16 a[164:167], v[52:55], v[68:71], a[164:167]
    v_mfma_f32_16x16x32_bf16 a[160:163], v[52:55], v[64:67], a[160:163]
    ds_read_b64_tr_b16 v[158:159], v251 offset:18432
    v_mfma_f32_16x16x32_bf16 a[192:195], v[56:59], v[64:67], a[192:195]
    s_lshl_b32 s3, s3, 13
    v_mfma_f32_16x16x32_bf16 a[196:199], v[56:59], v[68:71], a[196:199]
    ds_read_b128 v[124:127], v255 offset:14336
    v_mfma_f32_16x16x32_bf16 a[200:203], v[56:59], v[72:75], a[200:203]
    buffer_load_dwordx4 v239, s[4:7], s21 offen offset:3072 lds
    v_mfma_f32_16x16x32_bf16 a[204:207], v[56:59], v[76:79], a[204:207]
    s_add_u32 s21, s21, 128
    s_add_u32 s22, s22, 32768
    v_mfma_f32_16x16x32_bf16 a[208:211], v[56:59], v[80:83], a[208:211]
    s_cmp_eq_u32 s22, 163840
    s_cselect_b32 s22, 65536, s22
    v_mfma_f32_16x16x32_bf16 a[212:215], v[56:59], v[84:87], a[212:215]
    s_add_u32 s91, s34, s3
    v_mfma_f32_16x16x32_bf16 a[216:219], v[56:59], v[88:91], a[216:219]
    buffer_load_dword v9, off, s[16:19], 0 sc1
    v_mfma_f32_16x16x32_bf16 a[220:223], v[56:59], v[92:95], a[220:223]
    v_mfma_f32_16x16x32_bf16 a[252:255], v[60:63], v[92:95], a[252:255]
    v_mfma_f32_16x16x32_bf16 a[248:251], v[60:63], v[88:91], a[248:251]
    v_mfma_f32_16x16x32_bf16 a[244:247], v[60:63], v[84:87], a[244:247]
    v_mfma_f32_16x16x32_bf16 a[240:243], v[60:63], v[80:83], a[240:243]
    v_mfma_f32_16x16x32_bf16 a[236:239], v[60:63], v[76:79], a[236:239]
    v_mfma_f32_16x16x32_bf16 a[232:235], v[60:63], v[72:75], a[232:235]
    v_mfma_f32_16x16x32_bf16 a[228:231], v[60:63], v[68:71], a[228:231]
    v_mfma_f32_16x16x32_bf16 a[224:227], v[60:63], v[64:67], a[224:227]
    s_waitcnt vmcnt(20) lgkmcnt(0)
    s_barrier
    v_mfma_f32_16x16x32_bf16 a[0:3], v[96:99], v[128:131], a[0:3]
    s_add_u32 s25, s25, 32768
    v_mfma_f32_16x16x32_bf16 a[4:7], v[96:99], v[132:135], a[4:7]
    s_cmp_eq_u32 s25, 163840
    s_cselect_b32 s25, 65536, s25
    v_mfma_f32_16x16x32_bf16 a[8:11], v[96:99], v[136:139], a[8:11]
    v_mfma_f32_16x16x32_bf16 a[12:15], v[96:99], v[140:143], a[12:15]
    ds_read_b64_tr_b16 v[64:65], v244 offset:32768
    s_add_u32 m0, s24, 16384
    v_mfma_f32_16x16x32_bf16 a[16:19], v[96:99], v[144:147], a[16:19]
    buffer_load_dwordx4 v240, s[8:11], s20 offen offset:0 nt lds
    v_mfma_f32_16x16x32_bf16 a[20:23], v[96:99], v[148:151], a[20:23]
    v_add_u32 v254, s25, v252
    ds_read_b64_tr_b16 v[66:67], v244 offset:34816
    v_mfma_f32_16x16x32_bf16 a[24:27], v[96:99], v[152:155], a[24:27]
    v_add_u32 v255, s25, v253
    v_mfma_f32_16x16x32_bf16 a[28:31], v[96:99], v[156:159], a[28:31]
    ds_read_b128 v[32:35], v254 offset:0
    v_mfma_f32_16x16x32_bf16 a[60:63], v[100:103], v[156:159], a[60:63]
    v_mfma_f32_16x16x32_bf16 a[56:59], v[100:103], v[152:155], a[56:59]
    ds_read_b64_tr_b16 v[68:69], v245 offset:32768
    v_mfma_f32_16x16x32_bf16 a[52:55], v[100:103], v[148:151], a[52:55]
    buffer_load_dwordx4 v241, s[8:11], s20 offen offset:1024 nt lds
    v_mfma_f32_16x16x32_bf16 a[48:51], v[100:103], v[144:147], a[48:51]
    ds_read_b64_tr_b16 v[70:71], v245 offset:34816
    v_mfma_f32_16x16x32_bf16 a[44:47], v[100:103], v[140:143], a[44:47]
    v_mfma_f32_16x16x32_bf16 a[40:43], v[100:103], v[136:139], a[40:43]
    ds_read_b128 v[36:39], v254 offset:2048
    v_mfma_f32_16x16x32_bf16 a[36:39], v[100:103], v[132:135], a[36:39]
    v_mfma_f32_16x16x32_bf16 a[32:35], v[100:103], v[128:131], a[32:35]
    ds_read_b64_tr_b16 v[72:73], v246 offset:32768
    v_mfma_f32_16x16x32_bf16 a[64:67], v[104:107], v[128:131], a[64:67]
    buffer_load_dwordx4 v242, s[8:11], s20 offen offset:2048 nt lds
    v_mfma_f32_16x16x32_bf16 a[68:71], v[104:107], v[132:135], a[68:71]
    ds_read_b64_tr_b16 v[74:75], v246 offset:34816
    v_mfma_f32_16x16x32_bf16 a[72:75], v[104:107], v[136:139], a[72:75]
    v_mfma_f32_16x16x32_bf16 a[76:79], v[104:107], v[140:143], a[76:79]
    ds_read_b128 v[40:43], v254 offset:4096
    v_mfma_f32_16x16x32_bf16 a[80:83], v[104:107], v[144:147], a[80:83]
    v_mfma_f32_16x16x32_bf16 a[84:87], v[104:107], v[148:151], a[84:87]
    ds_read_b64_tr_b16 v[76:77], v247 offset:32768
    v_mfma_f32_16x16x32_bf16 a[88:91], v[104:107], v[152:155], a[88:91]
    buffer_load_dwordx4 v243, s[8:11], s20 offen offset:3072 nt lds
    v_mfma_f32_16x16x32_bf16 a[92:95], v[104:107], v[156:159], a[92:95]
    ds_read_b64_tr_b16 v[78:79], v247 offset:34816
    s_add_u32 s20, s20, 262144
    v_mfma_f32_16x16x32_bf16 a[124:127], v[108:111], v[156:159], a[124:127]
    v_mfma_f32_16x16x32_bf16 a[120:123], v[108:111], v[152:155], a[120:123]
    ds_read_b128 v[44:47], v254 offset:6144
    v_mfma_f32_16x16x32_bf16 a[116:119], v[108:111], v[148:151], a[116:119]
    v_mfma_f32_16x16x32_bf16 a[112:115], v[108:111], v[144:147], a[112:115]
    ds_read_b64_tr_b16 v[80:81], v248 offset:32768
    v_mfma_f32_16x16x32_bf16 a[108:111], v[108:111], v[140:143], a[108:111]
    v_mfma_f32_16x16x32_bf16 a[104:107], v[108:111], v[136:139], a[104:107]
    ds_read_b64_tr_b16 v[82:83], v248 offset:34816
    v_mfma_f32_16x16x32_bf16 a[100:103], v[108:111], v[132:135], a[100:103]
    v_mfma_f32_16x16x32_bf16 a[96:99], v[108:111], v[128:131], a[96:99]
    ds_read_b128 v[48:51], v254 offset:8192
    s_add_u32 m0, s22, s37
    v_mfma_f32_16x16x32_bf16 a[128:131], v[112:115], v[128:131], a[128:131]
    buffer_load_dwordx4 v232, s[4:7], s21 offen offset:0 lds
    v_mfma_f32_16x16x32_bf16 a[132:135], v[112:115], v[132:135], a[132:135]
    ds_read_b64_tr_b16 v[84:85], v249 offset:32768
    v_mfma_f32_16x16x32_bf16 a[136:139], v[112:115], v[136:139], a[136:139]
    v_mfma_f32_16x16x32_bf16 a[140:143], v[112:115], v[140:143], a[140:143]
    ds_read_b64_tr_b16 v[86:87], v249 offset:34816
    v_mfma_f32_16x16x32_bf16 a[144:147], v[112:115], v[144:147], a[144:147]
    v_mfma_f32_16x16x32_bf16 a[148:151], v[112:115], v[148:151], a[148:151]
    ds_read_b128 v[52:55], v254 offset:10240
    v_mfma_f32_16x16x32_bf16 a[152:155], v[112:115], v[152:155], a[152:155]
    buffer_load_dwordx4 v233, s[4:7], s21 offen offset:1024 lds
    v_mfma_f32_16x16x32_bf16 a[156:159], v[112:115], v[156:159], a[156:159]
    ds_read_b64_tr_b16 v[88:89], v250 offset:32768
    v_mfma_f32_16x16x32_bf16 a[188:191], v[116:119], v[156:159], a[188:191]
    v_mfma_f32_16x16x32_bf16 a[184:187], v[116:119], v[152:155], a[184:187]
    ds_read_b64_tr_b16 v[90:91], v250 offset:34816
    v_mfma_f32_16x16x32_bf16 a[180:183], v[116:119], v[148:151], a[180:183]
    v_mfma_f32_16x16x32_bf16 a[176:179], v[116:119], v[144:147], a[176:179]
    ds_read_b128 v[56:59], v254 offset:12288
    v_mfma_f32_16x16x32_bf16 a[172:175], v[116:119], v[140:143], a[172:175]
    buffer_load_dwordx4 v234, s[4:7], s21 offen offset:2048 lds
    v_mfma_f32_16x16x32_bf16 a[168:171], v[116:119], v[136:139], a[168:171]
    ds_read_b64_tr_b16 v[92:93], v251 offset:32768
    v_mfma_f32_16x16x32_bf16 a[164:167], v[116:119], v[132:135], a[164:167]
    v_mfma_f32_16x16x32_bf16 a[160:163], v[116:119], v[128:131], a[160:163]
    ds_read_b64_tr_b16 v[94:95], v251 offset:34816
    v_mfma_f32_16x16x32_bf16 a[192:195], v[120:123], v[128:131], a[192:195]
    v_mfma_f32_16x16x32_bf16 a[196:199], v[120:123], v[132:135], a[196:199]
    ds_read_b128 v[60:63], v254 offset:14336
    v_mfma_f32_16x16x32_bf16 a[200:203], v[120:123], v[136:139], a[200:203]
    buffer_load_dwordx4 v235, s[4:7], s21 offen offset:3072 lds
    v_mfma_f32_16x16x32_bf16 a[204:207], v[120:123], v[140:143], a[204:207]
    v_mfma_f32_16x16x32_bf16 a[208:211], v[120:123], v[144:147], a[208:211]
    v_mfma_f32_16x16x32_bf16 a[212:215], v[120:123], v[148:151], a[212:215]
    v_mfma_f32_16x16x32_bf16 a[216:219], v[120:123], v[152:155], a[216:219]
    v_mfma_f32_16x16x32_bf16 a[220:223], v[120:123], v[156:159], a[220:223]
    v_mfma_f32_16x16x32_bf16 a[252:255], v[124:127], v[156:159], a[252:255]
    v_mfma_f32_16x16x32_bf16 a[248:251], v[124:127], v[152:155], a[248:251]
    v_mfma_f32_16x16x32_bf16 a[244:247], v[124:127], v[148:151], a[244:247]
    v_mfma_f32_16x16x32_bf16 a[240:243], v[124:127], v[144:147], a[240:243]
    v_mfma_f32_16x16x32_bf16 a[236:239], v[124:127], v[140:143], a[236:239]
    v_mfma_f32_16x16x32_bf16 a[232:235], v[124:127], v[136:139], a[232:235]
    v_mfma_f32_16x16x32_bf16 a[228:231], v[124:127], v[132:135], a[228:231]
    v_mfma_f32_16x16x32_bf16 a[224:227], v[124:127], v[128:131], a[224:227]
    s_waitcnt vmcnt(23) lgkmcnt(0)
    s_barrier
    v_mfma_f32_16x16x32_bf16 a[0:3], v[32:35], v[64:67], a[0:3]
    v_mfma_f32_16x16x32_bf16 a[4:7], v[32:35], v[68:71], a[4:7]
    v_mfma_f32_16x16x32_bf16 a[8:11], v[32:35], v[72:75], a[8:11]
    v_mfma_f32_16x16x32_bf16 a[12:15], v[32:35], v[76:79], a[12:15]
    ds_read_b64_tr_b16 v[128:129], v244 offset:49152
    s_add_u32 m0, s24, 32768
    v_mfma_f32_16x16x32_bf16 a[16:19], v[32:35], v[80:83], a[16:19]
    buffer_load_dwordx4 v240, s[8:11], s20 offen offset:0 nt lds
    v_mfma_f32_16x16x32_bf16 a[20:23], v[32:35], v[84:87], a[20:23]
    ds_read_b64_tr_b16 v[130:131], v244 offset:51200
    v_mfma_f32_16x16x32_bf16 a[24:27], v[32:35], v[88:91], a[24:27]
    v_mfma_f32_16x16x32_bf16 a[28:31], v[32:35], v[92:95], a[28:31]
    ds_read_b128 v[96:99], v255 offset:0
    v_mfma_f32_16x16x32_bf16 a[60:63], v[36:39], v[92:95], a[60:63]
    v_mfma_f32_16x16x32_bf16 a[56:59], v[36:39], v[88:91], a[56:59]
    ds_read_b64_tr_b16 v[132:133], v245 offset:49152
    v_mfma_f32_16x16x32_bf16 a[52:55], v[36:39], v[84:87], a[52:55]
    buffer_load_dwordx4 v241, s[8:11], s20 offen offset:1024 nt lds
    v_mfma_f32_16x16x32_bf16 a[48:51], v[36:39], v[80:83], a[48:51]
    ds_read_b64_tr_b16 v[134:135], v245 offset:51200
    v_mfma_f32_16x16x32_bf16 a[44:47], v[36:39], v[76:79], a[44:47]
    v_mfma_f32_16x16x32_bf16 a[40:43], v[36:39], v[72:75], a[40:43]
    ds_read_b128 v[100:103], v255 offset:2048
    v_mfma_f32_16x16x32_bf16 a[36:39], v[36:39], v[68:71], a[36:39]
    v_mfma_f32_16x16x32_bf16 a[32:35], v[36:39], v[64:67], a[32:35]
    ds_read_b64_tr_b16 v[136:137], v246 offset:49152
    v_mfma_f32_16x16x32_bf16 a[64:67], v[40:43], v[64:67], a[64:67]
    buffer_load_dwordx4 v242, s[8:11], s20 offen offset:2048 nt lds
    v_mfma_f32_16x16x32_bf16 a[68:71], v[40:43], v[68:71], a[68:71]
    ds_read_b64_tr_b16 v[138:139], v246 offset:51200
    v_mfma_f32_16x16x32_bf16 a[72:75], v[40:43], v[72:75], a[72:75]
    v_mfma_f32_16x16x32_bf16 a[76:79], v[40:43], v[76:79], a[76:79]
    ds_read_b128 v[104:107], v255 offset:4096
    v_mfma_f32_16x16x32_bf16 a[80:83], v[40:43], v[80:83], a[80:83]
    v_mfma_f32_16x16x32_bf16 a[84:87], v[40:43], v[84:87], a[84:87]
    ds_read_b64_tr_b16 v[140:141], v247 offset:49152
    v_mfma_f32_16x16x32_bf16 a[88:91], v[40:43], v[88:91], a[88:91]
    buffer_load_dwordx4 v243, s[8:11], s20 offen offset:3072 nt lds
    v_mfma_f32_16x16x32_bf16 a[92:95], v[40:43], v[92:95], a[92:95]
    ds_read_b64_tr_b16 v[142:143], v247 offset:51200
    s_add_u32 s20, s20, 262144
    v_mfma_f32_16x16x32_bf16 a[124:127], v[44:47], v[92:95], a[124:127]
    v_mfma_f32_16x16x32_bf16 a[120:123], v[44:47], v[88:91], a[120:123]
    ds_read_b128 v[108:111], v255 offset:6144
    v_mfma_f32_16x16x32_bf16 a[116:119], v[44:47], v[84:87], a[116:119]
    v_mfma_f32_16x16x32_bf16 a[112:115], v[44:47], v[80:83], a[112:115]
    ds_read_b64_tr_b16 v[144:145], v248 offset:49152
    v_mfma_f32_16x16x32_bf16 a[108:111], v[44:47], v[76:79], a[108:111]
    v_mfma_f32_16x16x32_bf16 a[104:107], v[44:47], v[72:75], a[104:107]
    ds_read_b64_tr_b16 v[146:147], v248 offset:51200
    v_mfma_f32_16x16x32_bf16 a[100:103], v[44:47], v[68:71], a[100:103]
    v_mfma_f32_16x16x32_bf16 a[96:99], v[44:47], v[64:67], a[96:99]
    ds_read_b128 v[112:115], v255 offset:8192
    s_add_u32 m0, s22, s29
    v_mfma_f32_16x16x32_bf16 a[128:131], v[48:51], v[64:67], a[128:131]
    buffer_load_dwordx4 v236, s[4:7], s21 offen offset:0 lds
    v_mfma_f32_16x16x32_bf16 a[132:135], v[48:51], v[68:71], a[132:135]
    ds_read_b64_tr_b16 v[148:149], v249 offset:49152
    v_mfma_f32_16x16x32_bf16 a[136:139], v[48:51], v[72:75], a[136:139]
    v_mfma_f32_16x16x32_bf16 a[140:143], v[48:51], v[76:79], a[140:143]
    ds_read_b64_tr_b16 v[150:151], v249 offset:51200
    s_waitcnt vmcnt(13)
    v_mfma_f32_16x16x32_bf16 a[144:147], v[48:51], v[80:83], a[144:147]
    v_cmp_gt_u32 vcc, 0x100, v9
    v_mfma_f32_16x16x32_bf16 a[148:151], v[48:51], v[84:87], a[148:151]
    ds_read_b128 v[116:119], v255 offset:10240
    v_mfma_f32_16x16x32_bf16 a[152:155], v[48:51], v[88:91], a[152:155]
    buffer_load_dwordx4 v237, s[4:7], s21 offen offset:1024 lds
    v_mfma_f32_16x16x32_bf16 a[156:159], v[48:51], v[92:95], a[156:159]
    ds_read_b64_tr_b16 v[152:153], v250 offset:49152
    s_nop 0
    v_mfma_f32_16x16x32_bf16 a[188:191], v[52:55], v[92:95], a[188:191]
    s_nop 0
    v_mfma_f32_16x16x32_bf16 a[184:187], v[52:55], v[88:91], a[184:187]
    ds_read_b64_tr_b16 v[154:155], v250 offset:51200
    s_cbranch_vccnz G_V_spin
G_V_spinback:
    v_mfma_f32_16x16x32_bf16 a[180:183], v[52:55], v[84:87], a[180:183]
    v_mfma_f32_16x16x32_bf16 a[176:179], v[52:55], v[80:83], a[176:179]
    ds_read_b128 v[120:123], v255 offset:12288
    s_mul_i32 s93, s2, 384
    v_mfma_f32_16x16x32_bf16 a[172:175], v[52:55], v[76:79], a[172:175]
    buffer_load_dwordx4 v238, s[4:7], s21 offen offset:2048 lds
    v_mfma_f32_16x16x32_bf16 a[168:171], v[52:55], v[72:75], a[168:171]
    ds_read_b64_tr_b16 v[156:157], v251 offset:49152
    s_add_u32 s93, s93, 111149056
    v_mfma_f32_16x16x32_bf16 a[164:167], v[52:55], v[68:71], a[164:167]
    s_mul_i32 s3, s67, 384
    v_mfma_f32_16x16x32_bf16 a[160:163], v[52:55], v[64:67], a[160:163]
    ds_read_b64_tr_b16 v[158:159], v251 offset:51200
    v_mfma_f32_16x16x32_bf16 a[192:195], v[56:59], v[64:67], a[192:195]
    s_add_u32 s3, s3, 111149056
    v_mfma_f32_16x16x32_bf16 a[196:199], v[56:59], v[68:71], a[196:199]
    ds_read_b128 v[124:127], v255 offset:14336
    v_mfma_f32_16x16x32_bf16 a[200:203], v[56:59], v[72:75], a[200:203]
    buffer_load_dwordx4 v239, s[4:7], s21 offen offset:3072 lds
    v_mfma_f32_16x16x32_bf16 a[204:207], v[56:59], v[76:79], a[204:207]
    s_add_u32 s21, s21, 128
    s_add_u32 s22, s22, 32768
    v_mfma_f32_16x16x32_bf16 a[208:211], v[56:59], v[80:83], a[208:211]
    s_cmp_eq_u32 s22, 163840
    s_cselect_b32 s22, 65536, s22
    v_mfma_f32_16x16x32_bf16 a[212:215], v[56:59], v[84:87], a[212:215]
    v_and_b32 v9, 31, v2
    v_mul_u32_u24 v9, 3072, v9
    v_mfma_f32_16x16x32_bf16 a[216:219], v[56:59], v[88:91], a[216:219]
    buffer_load_dword v28, v9, s[12:15], s3 offen sc1
    v_mfma_f32_16x16x32_bf16 a[220:223], v[56:59], v[92:95], a[220:223]
    s_and_b32 s94, s2, 15
    v_mfma_f32_16x16x32_bf16 a[252:255], v[60:63], v[92:95], a[252:255]
    s_mul_i32 s94, s94, 384
    v_mfma_f32_16x16x32_bf16 a[248:251], v[60:63], v[88:91], a[248:251]
    v_mfma_f32_16x16x32_bf16 a[244:247], v[60:63], v[84:87], a[244:247]
    s_add_u32 s94, s94, 111149056
    v_mfma_f32_16x16x32_bf16 a[240:243], v[60:63], v[80:83], a[240:243]
    v_mfma_f32_16x16x32_bf16 a[236:239], v[60:63], v[76:79], a[236:239]
    v_mfma_f32_16x16x32_bf16 a[232:235], v[60:63], v[72:75], a[232:235]
    v_mfma_f32_16x16x32_bf16 a[228:231], v[60:63], v[68:71], a[228:231]
    v_mfma_f32_16x16x32_bf16 a[224:227], v[60:63], v[64:67], a[224:227]
    s_waitcnt vmcnt(18) lgkmcnt(0)
    s_barrier
    v_mfma_f32_16x16x32_bf16 a[0:3], v[96:99], v[128:131], a[0:3]
    s_add_u32 s25, s25, 32768
    v_mfma_f32_16x16x32_bf16 a[4:7], v[96:99], v[132:135], a[4:7]
    s_cmp_eq_u32 s25, 163840
    s_cselect_b32 s25, 65536, s25
    v_mfma_f32_16x16x32_bf16 a[8:11], v[96:99], v[136:139], a[8:11]
    v_mfma_f32_16x16x32_bf16 a[12:15], v[96:99], v[140:143], a[12:15]
    ds_read_b64_tr_b16 v[64:65], v244 offset:0
    s_add_u32 m0, s24, 49152
    v_mfma_f32_16x16x32_bf16 a[16:19], v[96:99], v[144:147], a[16:19]
    buffer_load_dwordx4 v240, s[8:11], s20 offen offset:0 nt lds
    v_mfma_f32_16x16x32_bf16 a[20:23], v[96:99], v[148:151], a[20:23]
    v_add_u32 v254, s25, v252
    ds_read_b64_tr_b16 v[66:67], v244 offset:2048
    v_mfma_f32_16x16x32_bf16 a[24:27], v[96:99], v[152:155], a[24:27]
    v_add_u32 v255, s25, v253
    v_mfma_f32_16x16x32_bf16 a[28:31], v[96:99], v[156:159], a[28:31]
    ds_read_b128 v[32:35], v254 offset:0
    v_mfma_f32_16x16x32_bf16 a[60:63], v[100:103], v[156:159], a[60:63]
    buffer_load_dwordx4 v241, s[8:11], s20 offen offset:1024 nt lds
    v_mfma_f32_16x16x32_bf16 a[56:59], v[100:103], v[152:155], a[56:59]
    ds_read_b64_tr_b16 v[68:69], v245 offset:0
    v_mfma_f32_16x16x32_bf16 a[52:55], v[100:103], v[148:151], a[52:55]
    v_mfma_f32_16x16x32_bf16 a[48:51], v[100:103], v[144:147], a[48:51]
    ds_read_b64_tr_b16 v[70:71], v245 offset:2048
    v_mfma_f32_16x16x32_bf16 a[44:47], v[100:103], v[140:143], a[44:47]
    buffer_load_dwordx4 v242, s[8:11], s20 offen offset:2048 nt lds
    v_mfma_f32_16x16x32_bf16 a[40:43], v[100:103], v[136:139], a[40:43]
    ds_read_b128 v[36:39], v254 offset:2048
    v_mfma_f32_16x16x32_bf16 a[36:39], v[100:103], v[132:135], a[36:39]
    v_mfma_f32_16x16x32_bf16 a[32:35], v[100:103], v[128:131], a[32:35]
    ds_read_b64_tr_b16 v[72:73], v246 offset:0
    v_mfma_f32_16x16x32_bf16 a[64:67], v[104:107], v[128:131], a[64:67]
    buffer_load_dwordx4 v243, s[8:11], s20 offen offset:3072 nt lds
    v_mfma_f32_16x16x32_bf16 a[68:71], v[104:107], v[132:135], a[68:71]
    ds_read_b64_tr_b16 v[74:75], v246 offset:2048
    s_add_u32 s20, s20, 262144
    v_mfma_f32_16x16x32_bf16 a[72:75], v[104:107], v[136:139], a[72:75]
    v_mfma_f32_16x16x32_bf16 a[76:79], v[104:107], v[140:143], a[76:79]
    ds_read_b128 v[40:43], v254 offset:4096
    v_mfma_f32_16x16x32_bf16 a[80:83], v[104:107], v[144:147], a[80:83]
    v_mfma_f32_16x16x32_bf16 a[84:87], v[104:107], v[148:151], a[84:87]
    ds_read_b64_tr_b16 v[76:77], v247 offset:0
    s_add_u32 s39, s38, 0
    s_add_u32 m0, s24, 98304
    v_mfma_f32_16x16x32_bf16 a[88:91], v[104:107], v[152:155], a[88:91]
    buffer_load_dwordx4 v4, s[12:15], s39 offen offset:0 lds
    v_mfma_f32_16x16x32_bf16 a[92:95], v[104:107], v[156:159], a[92:95]
    ds_read_b64_tr_b16 v[78:79], v247 offset:2048
    v_mfma_f32_16x16x32_bf16 a[124:127], v[108:111], v[156:159], a[124:127]
    v_mfma_f32_16x16x32_bf16 a[120:123], v[108:111], v[152:155], a[120:123]
    ds_read_b128 v[44:47], v254 offset:6144
    v_mfma_f32_16x16x32_bf16 a[116:119], v[108:111], v[148:151], a[116:119]
    buffer_load_dwordx4 v4, s[12:15], s39 offen offset:1024 lds
    v_mfma_f32_16x16x32_bf16 a[112:115], v[108:111], v[144:147], a[112:115]
    ds_read_b64_tr_b16 v[80:81], v248 offset:0
    v_mfma_f32_16x16x32_bf16 a[108:111], v[108:111], v[140:143], a[108:111]
    v_mfma_f32_16x16x32_bf16 a[104:107], v[108:111], v[136:139], a[104:107]
    ds_read_b64_tr_b16 v[82:83], v248 offset:2048
    v_mfma_f32_16x16x32_bf16 a[100:103], v[108:111], v[132:135], a[100:103]
    buffer_load_dwordx4 v4, s[12:15], s39 offen offset:2048 lds
    v_mfma_f32_16x16x32_bf16 a[96:99], v[108:111], v[128:131], a[96:99]
    ds_read_b128 v[48:51], v254 offset:8192
    v_mfma_f32_16x16x32_bf16 a[128:131], v[112:115], v[128:131], a[128:131]
    v_mfma_f32_16x16x32_bf16 a[132:135], v[112:115], v[132:135], a[132:135]
    ds_read_b64_tr_b16 v[84:85], v249 offset:0
    v_mfma_f32_16x16x32_bf16 a[136:139], v[112:115], v[136:139], a[136:139]
    buffer_load_dwordx4 v4, s[12:15], s39 offen offset:3072 lds
    v_mfma_f32_16x16x32_bf16 a[140:143], v[112:115], v[140:143], a[140:143]
    ds_read_b64_tr_b16 v[86:87], v249 offset:2048
    v_mfma_f32_16x16x32_bf16 a[144:147], v[112:115], v[144:147], a[144:147]
    v_mfma_f32_16x16x32_bf16 a[148:151], v[112:115], v[148:151], a[148:151]
    ds_read_b128 v[52:55], v254 offset:10240
    v_mfma_f32_16x16x32_bf16 a[152:155], v[112:115], v[152:155], a[152:155]
    v_mfma_f32_16x16x32_bf16 a[156:159], v[112:115], v[156:159], a[156:159]
    ds_read_b64_tr_b16 v[88:89], v250 offset:0
    s_add_u32 s39, s38, 16384
    s_add_u32 m0, s24, 114688
    v_mfma_f32_16x16x32_bf16 a[188:191], v[116:119], v[156:159], a[188:191]
    buffer_load_dwordx4 v4, s[12:15], s39 offen offset:0 lds
    v_mfma_f32_16x16x32_bf16 a[184:187], v[116:119], v[152:155], a[184:187]
    ds_read_b64_tr_b16 v[90:91], v250 offset:2048
    v_mfma_f32_16x16x32_bf16 a[180:183], v[116:119], v[148:151], a[180:183]
    v_mfma_f32_16x16x32_bf16 a[176:179], v[116:119], v[144:147], a[176:179]
    ds_read_b128 v[56:59], v254 offset:12288
    v_mfma_f32_16x16x32_bf16 a[172:175], v[116:119], v[140:143], a[172:175]
    buffer_load_dwordx4 v4, s[12:15], s39 offen offset:1024 lds
    v_mfma_f32_16x16x32_bf16 a[168:171], v[116:119], v[136:139], a[168:171]
    ds_read_b64_tr_b16 v[92:93], v251 offset:0
    v_mfma_f32_16x16x32_bf16 a[164:167], v[116:119], v[132:135], a[164:167]
    v_mfma_f32_16x16x32_bf16 a[160:163], v[116:119], v[128:131], a[160:163]
    ds_read_b64_tr_b16 v[94:95], v251 offset:2048
    v_mfma_f32_16x16x32_bf16 a[192:195], v[120:123], v[128:131], a[192:195]
    buffer_load_dwordx4 v4, s[12:15], s39 offen offset:2048 lds
    v_mfma_f32_16x16x32_bf16 a[196:199], v[120:123], v[132:135], a[196:199]
    ds_read_b128 v[60:63], v254 offset:14336
    v_mfma_f32_16x16x32_bf16 a[200:203], v[120:123], v[136:139], a[200:203]
    v_mfma_f32_16x16x32_bf16 a[204:207], v[120:123], v[140:143], a[204:207]
    v_mfma_f32_16x16x32_bf16 a[208:211], v[120:123], v[144:147], a[208:211]
    buffer_load_dwordx4 v4, s[12:15], s39 offen offset:3072 lds
    v_mfma_f32_16x16x32_bf16 a[212:215], v[120:123], v[148:151], a[212:215]
    v_mfma_f32_16x16x32_bf16 a[216:219], v[120:123], v[152:155], a[216:219]
    v_mfma_f32_16x16x32_bf16 a[220:223], v[120:123], v[156:159], a[220:223]
    v_mfma_f32_16x16x32_bf16 a[252:255], v[124:127], v[156:159], a[252:255]
    v_mfma_f32_16x16x32_bf16 a[248:251], v[124:127], v[152:155], a[248:251]
    v_mfma_f32_16x16x32_bf16 a[244:247], v[124:127], v[148:151], a[244:247]
    v_mfma_f32_16x16x32_bf16 a[240:243], v[124:127], v[144:147], a[240:243]
    v_mfma_f32_16x16x32_bf16 a[236:239], v[124:127], v[140:143], a[236:239]
    v_mfma_f32_16x16x32_bf16 a[232:235], v[124:127], v[136:139], a[232:235]
    v_mfma_f32_16x16x32_bf16 a[228:231], v[124:127], v[132:135], a[228:231]
    v_mfma_f32_16x16x32_bf16 a[224:227], v[124:127], v[128:131], a[224:227]
    s_waitcnt vmcnt(25) lgkmcnt(0)
    s_barrier
    v_mfma_f32_16x16x32_bf16 a[0:3], v[32:35], v[64:67], a[0:3]
    v_mfma_f32_16x16x32_bf16 a[4:7], v[32:35], v[68:71], a[4:7]
    v_mfma_f32_16x16x32_bf16 a[8:11], v[32:35], v[72:75], a[8:11]
    v_mfma_f32_16x16x32_bf16 a[12:15], v[32:35], v[76:79], a[12:15]
    ds_read_b64_tr_b16 v[128:129], v244 offset:16384
    s_add_u32 s39, s38, 32768
    s_add_u32 m0, s24, 0
    v_mfma_f32_16x16x32_bf16 a[16:19], v[32:35], v[80:83], a[16:19]
    buffer_load_dwordx4 v4, s[12:15], s39 offen offset:0 lds
    v_mfma_f32_16x16x32_bf16 a[20:23], v[32:35], v[84:87], a[20:23]
    ds_read_b64_tr_b16 v[130:131], v244 offset:18432
    v_mfma_f32_16x16x32_bf16 a[24:27], v[32:35], v[88:91], a[24:27]
    buffer_load_dwordx4 v[160:163], v1, s[12:15], s36 offen offset:0 sc1
    v_mfma_f32_16x16x32_bf16 a[28:31], v[32:35], v[92:95], a[28:31]
    ds_read_b128 v[96:99], v255 offset:0
    v_mfma_f32_16x16x32_bf16 a[60:63], v[36:39], v[92:95], a[60:63]
    buffer_load_dwordx4 v[164:167], v5, s[12:15], s36 offen offset:0 sc1
    v_mfma_f32_16x16x32_bf16 a[56:59], v[36:39], v[88:91], a[56:59]
    ds_read_b64_tr_b16 v[132:133], v245 offset:16384
    v_mfma_f32_16x16x32_bf16 a[52:55], v[36:39], v[84:87], a[52:55]
    v_mfma_f32_16x16x32_bf16 a[48:51], v[36:39], v[80:83], a[48:51]
    ds_read_b64_tr_b16 v[134:135], v245 offset:18432
    v_mfma_f32_16x16x32_bf16 a[44:47], v[36:39], v[76:79], a[44:47]
    buffer_load_dwordx4 v[168:171], v1, s[12:15], s36 offen offset:1024 sc1
    v_mfma_f32_16x16x32_bf16 a[40:43], v[36:39], v[72:75], a[40:43]
    ds_read_b128 v[100:103], v255 offset:2048
    v_mfma_f32_16x16x32_bf16 a[36:39], v[36:39], v[68:71], a[36:39]
    v_mfma_f32_16x16x32_bf16 a[32:35], v[36:39], v[64:67], a[32:35]
    ds_read_b64_tr_b16 v[136:137], v246 offset:16384
    v_mfma_f32_16x16x32_bf16 a[64:67], v[40:43], v[64:67], a[64:67]
    v_mfma_f32_16x16x32_bf16 a[68:71], v[40:43], v[68:71], a[68:71]
    ds_read_b64_tr_b16 v[138:139], v246 offset:18432
    v_mfma_f32_16x16x32_bf16 a[72:75], v[40:43], v[72:75], a[72:75]
    buffer_load_dwordx4 v4, s[12:15], s39 offen offset:1024 lds
    v_mfma_f32_16x16x32_bf16 a[76:79], v[40:43], v[76:79], a[76:79]
    ds_read_b128 v[104:107], v255 offset:4096
    v_mfma_f32_16x16x32_bf16 a[80:83], v[40:43], v[80:83], a[80:83]
    buffer_load_dwordx4 v[172:175], v5, s[12:15], s36 offen offset:1024 sc1
    v_mfma_f32_16x16x32_bf16 a[84:87], v[40:43], v[84:87], a[84:87]
    ds_read_b64_tr_b16 v[140:141], v247 offset:16384
    v_mfma_f32_16x16x32_bf16 a[88:91], v[40:43], v[88:91], a[88:91]
    v_mfma_f32_16x16x32_bf16 a[92:95], v[40:43], v[92:95], a[92:95]
    ds_read_b64_tr_b16 v[142:143], v247 offset:18432
    v_mfma_f32_16x16x32_bf16 a[124:127], v[44:47], v[92:95], a[124:127]
    buffer_load_dwordx4 v[176:179], v1, s[12:15], s36 offen offset:2048 sc1
    v_mfma_f32_16x16x32_bf16 a[120:123], v[44:47], v[88:91], a[120:123]
    ds_read_b128 v[108:111], v255 offset:6144
    v_mfma_f32_16x16x32_bf16 a[116:119], v[44:47], v[84:87], a[116:119]
    v_mfma_f32_16x16x32_bf16 a[112:115], v[44:47], v[80:83], a[112:115]
    ds_read_b64_tr_b16 v[144:145], v248 offset:16384
    v_mfma_f32_16x16x32_bf16 a[108:111], v[44:47], v[76:79], a[108:111]
    v_mfma_f32_16x16x32_bf16 a[104:107], v[44:47], v[72:75], a[104:107]
    ds_read_b64_tr_b16 v[146:147], v248 offset:18432
    v_mfma_f32_16x16x32_bf16 a[100:103], v[44:47], v[68:71], a[100:103]
    buffer_load_dwordx4 v[180:183], v5, s[12:15], s36 offen offset:2048 sc1
    v_mfma_f32_16x16x32_bf16 a[96:99], v[44:47], v[64:67], a[96:99]
    ds_read_b128 v[112:115], v255 offset:8192
    v_mfma_f32_16x16x32_bf16 a[128:131], v[48:51], v[64:67], a[128:131]
    buffer_load_dwordx4 v4, s[12:15], s39 offen offset:2048 lds
    v_mfma_f32_16x16x32_bf16 a[132:135], v[48:51], v[68:71], a[132:135]
    ds_read_b64_tr_b16 v[148:149], v249 offset:16384
    v_mfma_f32_16x16x32_bf16 a[136:139], v[48:51], v[72:75], a[136:139]
    v_mfma_f32_16x16x32_bf16 a[140:143], v[48:51], v[76:79], a[140:143]
    ds_read_b64_tr_b16 v[150:151], v249 offset:18432
    v_mfma_f32_16x16x32_bf16 a[144:147], v[48:51], v[80:83], a[144:147]
    buffer_load_dwordx4 v[184:187], v1, s[12:15], s36 offen offset:3072 sc1
    v_mfma_f32_16x16x32_bf16 a[148:151], v[48:51], v[84:87], a[148:151]
    ds_read_b128 v[116:119], v255 offset:10240
    v_mfma_f32_16x16x32_bf16 a[152:155], v[48:51], v[88:91], a[152:155]
    v_mfma_f32_16x16x32_bf16 a[156:159], v[48:51], v[92:95], a[156:159]
    ds_read_b64_tr_b16 v[152:153], v250 offset:16384
    v_mfma_f32_16x16x32_bf16 a[188:191], v[52:55], v[92:95], a[188:191]
    v_mfma_f32_16x16x32_bf16 a[184:187], v[52:55], v[88:91], a[184:187]
    ds_read_b64_tr_b16 v[154:155], v250 offset:18432
    v_mfma_f32_16x16x32_bf16 a[180:183], v[52:55], v[84:87], a[180:183]
    buffer_load_dwordx4 v[188:191], v5, s[12:15], s36 offen offset:3072 sc1
    v_mfma_f32_16x16x32_bf16 a[176:179], v[52:55], v[80:83], a[176:179]
    ds_read_b128 v[120:123], v255 offset:12288
    v_mfma_f32_16x16x32_bf16 a[172:175], v[52:55], v[76:79], a[172:175]
    v_mfma_f32_16x16x32_bf16 a[168:171], v[52:55], v[72:75], a[168:171]
    ds_read_b64_tr_b16 v[156:157], v251 offset:16384
    v_mfma_f32_16x16x32_bf16 a[164:167], v[52:55], v[68:71], a[164:167]
    buffer_load_dwordx4 v4, s[12:15], s39 offen offset:3072 lds
    v_mfma_f32_16x16x32_bf16 a[160:163], v[52:55], v[64:67], a[160:163]
    ds_read_b64_tr_b16 v[158:159], v251 offset:18432
    v_mfma_f32_16x16x32_bf16 a[192:195], v[56:59], v[64:67], a[192:195]
    buffer_load_dwordx4 v[192:195], v1, s[12:15], s35 offen offset:0 sc1
    v_mfma_f32_16x16x32_bf16 a[196:199], v[56:59], v[68:71], a[196:199]
    ds_read_b128 v[124:127], v255 offset:14336
    v_mfma_f32_16x16x32_bf16 a[200:203], v[56:59], v[72:75], a[200:203]
    v_mfma_f32_16x16x32_bf16 a[204:207], v[56:59], v[76:79], a[204:207]
    v_mfma_f32_16x16x32_bf16 a[208:211], v[56:59], v[80:83], a[208:211]
    v_mfma_f32_16x16x32_bf16 a[212:215], v[56:59], v[84:87], a[212:215]
    v_mfma_f32_16x16x32_bf16 a[216:219], v[56:59], v[88:91], a[216:219]
    buffer_load_dwordx4 v[196:199], v5, s[12:15], s35 offen offset:0 sc1
    v_mfma_f32_16x16x32_bf16 a[220:223], v[56:59], v[92:95], a[220:223]
    v_mfma_f32_16x16x32_bf16 a[252:255], v[60:63], v[92:95], a[252:255]
    v_mfma_f32_16x16x32_bf16 a[248:251], v[60:63], v[88:91], a[248:251]
    v_mfma_f32_16x16x32_bf16 a[244:247], v[60:63], v[84:87], a[244:247]
    v_mfma_f32_16x16x32_bf16 a[240:243], v[60:63], v[80:83], a[240:243]
    v_mfma_f32_16x16x32_bf16 a[236:239], v[60:63], v[76:79], a[236:239]
    v_mfma_f32_16x16x32_bf16 a[232:235], v[60:63], v[72:75], a[232:235]
    v_mfma_f32_16x16x32_bf16 a[228:231], v[60:63], v[68:71], a[228:231]
    v_mfma_f32_16x16x32_bf16 a[224:227], v[60:63], v[64:67], a[224:227]
    s_waitcnt vmcnt(27) lgkmcnt(0)
    s_barrier
    v_mfma_f32_16x16x32_bf16 a[0:3], v[96:99], v[128:131], a[0:3]
    s_add_u32 s25, s25, 32768
    v_mfma_f32_16x16x32_bf16 a[4:7], v[96:99], v[132:135], a[4:7]
    s_cmp_eq_u32 s25, 163840
    s_cselect_b32 s25, 65536, s25
    v_mfma_f32_16x16x32_bf16 a[8:11], v[96:99], v[136:139], a[8:11]
    v_mfma_f32_16x16x32_bf16 a[12:15], v[96:99], v[140:143], a[12:15]
    ds_read_b64_tr_b16 v[64:65], v244 offset:32768
    s_add_u32 s39, s38, 49152
    s_add_u32 m0, s24, 16384
    v_mfma_f32_16x16x32_bf16 a[16:19], v[96:99], v[144:147], a[16:19]
    buffer_load_dwordx4 v4, s[12:15], s39 offen offset:0 lds
    v_mfma_f32_16x16x32_bf16 a[20:23], v[96:99], v[148:151], a[20:23]
    v_add_u32 v254, s25, v252
    ds_read_b64_tr_b16 v[66:67], v244 offset:34816
    v_mfma_f32_16x16x32_bf16 a[24:27], v[96:99], v[152:155], a[24:27]
    v_add_u32 v255, s25, v253
    v_mfma_f32_16x16x32_bf16 a[28:31], v[96:99], v[156:159], a[28:31]
    ds_read_b128 v[32:35], v254 offset:0
    v_mfma_f32_16x16x32_bf16 a[60:63], v[100:103], v[156:159], a[60:63]
    buffer_load_dwordx4 v[200:203], v1, s[12:15], s35 offen offset:1024 sc1
    v_mfma_f32_16x16x32_bf16 a[56:59], v[100:103], v[152:155], a[56:59]
    ds_read_b64_tr_b16 v[68:69], v245 offset:32768
    v_mfma_f32_16x16x32_bf16 a[52:55], v[100:103], v[148:151], a[52:55]
    buffer_load_dwordx4 v4, s[12:15], s39 offen offset:1024 lds
    v_mfma_f32_16x16x32_bf16 a[48:51], v[100:103], v[144:147], a[48:51]
    ds_read_b64_tr_b16 v[70:71], v245 offset:34816
    v_mfma_f32_16x16x32_bf16 a[44:47], v[100:103], v[140:143], a[44:47]
    buffer_load_dwordx4 v[204:207], v5, s[12:15], s35 offen offset:1024 sc1
    v_mfma_f32_16x16x32_bf16 a[40:43], v[100:103], v[136:139], a[40:43]
    ds_read_b128 v[36:39], v254 offset:2048
    s_getreg_b32 s3, hwreg(HW_REG_XCC_ID, 0, 4)
    v_mfma_f32_16x16x32_bf16 a[36:39], v[100:103], v[132:135], a[36:39]
    s_waitcnt vmcnt(30)
    v_mfma_f32_16x16x32_bf16 a[32:35], v[100:103], v[128:131], a[32:35]
    ds_read_b64_tr_b16 v[72:73], v246 offset:32768
    v_mfma_f32_16x16x32_bf16 a[64:67], v[104:107], v[128:131], a[64:67]
    buffer_load_dwordx4 v4, s[12:15], s39 offen offset:2048 lds
    v_mfma_f32_16x16x32_bf16 a[68:71], v[104:107], v[132:135], a[68:71]
    ds_read_b64_tr_b16 v[74:75], v246 offset:34816
    s_add_u32 s3, s3, 1
    v_mfma_f32_16x16x32_bf16 a[72:75], v[104:107], v[136:139], a[72:75]
    v_mfma_f32_16x16x32_bf16 a[76:79], v[104:107], v[140:143], a[76:79]
    ds_read_b128 v[40:43], v254 offset:4096
    v_mfma_f32_16x16x32_bf16 a[80:83], v[104:107], v[144:147], a[80:83]
    v_cmp_ne_u32 vcc, s3, v28
    v_mfma_f32_16x16x32_bf16 a[84:87], v[104:107], v[148:151], a[84:87]
    ds_read_b64_tr_b16 v[76:77], v247 offset:32768
    v_mfma_f32_16x16x32_bf16 a[88:91], v[104:107], v[152:155], a[88:91]
    buffer_load_dwordx4 v4, s[12:15], s39 offen offset:3072 lds
    v_mfma_f32_16x16x32_bf16 a[92:95], v[104:107], v[156:159], a[92:95]
    ds_read_b64_tr_b16 v[78:79], v247 offset:34816
    v_mov_b32 v28, 268435456
    v_mfma_f32_16x16x32_bf16 a[124:127], v[108:111], v[156:159], a[124:127]
    v_mfma_f32_16x16x32_bf16 a[120:123], v[108:111], v[152:155], a[120:123]
    ds_read_b128 v[44:47], v254 offset:6144
    v_mfma_f32_16x16x32_bf16 a[116:119], v[108:111], v[148:151], a[116:119]
    s_nop 0
    v_mfma_f32_16x16x32_bf16 a[112:115], v[108:111], v[144:147], a[112:115]
    ds_read_b64_tr_b16 v[80:81], v248 offset:32768
    v_mfma_f32_16x16x32_bf16 a[108:111], v[108:111], v[140:143], a[108:111]
    s_cmp_eq_u64 vcc, 0
    s_cselect_b32 s92, 1, 0
    s_cselect_b64 vcc, -1, 0
    v_mfma_f32_16x16x32_bf16 a[104:107], v[108:111], v[136:139], a[104:107]
    ds_read_b64_tr_b16 v[82:83], v248 offset:34816
    v_mfma_f32_16x16x32_bf16 a[100:103], v[108:111], v[132:135], a[100:103]
    v_mfma_f32_16x16x32_bf16 a[96:99], v[108:111], v[128:131], a[96:99]
    ds_read_b128 v[48:51], v254 offset:8192
    s_add_u32 s39, s38, 65536
    s_add_u32 m0, s24, 131072
    v_mfma_f32_16x16x32_bf16 a[128:131], v[112:115], v[128:131], a[128:131]
    buffer_load_dwordx4 v4, s[12:15], s39 offen offset:0 lds
    v_mfma_f32_16x16x32_bf16 a[132:135], v[112:115], v[132:135], a[132:135]
    ds_read_b64_tr_b16 v[84:85], v249 offset:32768
    v_mfma_f32_16x16x32_bf16 a[136:139], v[112:115], v[136:139], a[136:139]
    v_cndmask_b32 v30, v28, v31, vcc
    v_mfma_f32_16x16x32_bf16 a[140:143], v[112:115], v[140:143], a[140:143]
    ds_read_b64_tr_b16 v[86:87], v249 offset:34816
    v_mfma_f32_16x16x32_bf16 a[144:147], v[112:115], v[144:147], a[144:147]
    v_mfma_f32_16x16x32_bf16 a[148:151], v[112:115], v[148:151], a[148:151]
    ds_read_b128 v[52:55], v254 offset:10240
    v_cndmask_b32 v29, v31, v28, vcc
    v_mfma_f32_16x16x32_bf16 a[152:155], v[112:115], v[152:155], a[152:155]
    buffer_load_dwordx4 v4, s[12:15], s39 offen offset:1024 lds
    v_mfma_f32_16x16x32_bf16 a[156:159], v[112:115], v[156:159], a[156:159]
    ds_read_b64_tr_b16 v[88:89], v250 offset:32768
    v_mfma_f32_16x16x32_bf16 a[188:191], v[116:119], v[156:159], a[188:191]
    s_and_b32 s3, s49, 7
    v_mfma_f32_16x16x32_bf16 a[184:187], v[116:119], v[152:155], a[184:187]
    ds_read_b64_tr_b16 v[90:91], v250 offset:34816
    v_mfma_f32_16x16x32_bf16 a[180:183], v[116:119], v[148:151], a[180:183]
    v_mfma_f32_16x16x32_bf16 a[176:179], v[116:119], v[144:147], a[176:179]
    ds_read_b128 v[56:59], v254 offset:12288
    s_lshl_b32 s3, s3, 13
    v_mfma_f32_16x16x32_bf16 a[172:175], v[116:119], v[140:143], a[172:175]
    buffer_load_dwordx4 v4, s[12:15], s39 offen offset:2048 lds
    v_mfma_f32_16x16x32_bf16 a[168:171], v[116:119], v[136:139], a[168:171]
    ds_read_b64_tr_b16 v[92:93], v251 offset:32768
    v_mfma_f32_16x16x32_bf16 a[164:167], v[116:119], v[132:135], a[164:167]
    s_add_u32 s3, s3, s38
    v_mfma_f32_16x16x32_bf16 a[160:163], v[116:119], v[128:131], a[160:163]
    ds_read_b64_tr_b16 v[94:95], v251 offset:34816
    v_mfma_f32_16x16x32_bf16 a[192:195], v[120:123], v[128:131], a[192:195]
    s_add_u32 s3, s3, 163840
    v_mfma_f32_16x16x32_bf16 a[196:199], v[120:123], v[132:135], a[196:199]
    ds_read_b128 v[60:63], v254 offset:14336
    v_mfma_f32_16x16x32_bf16 a[200:203], v[120:123], v[136:139], a[200:203]
    buffer_load_dwordx4 v4, s[12:15], s39 offen offset:3072 lds
    v_mfma_f32_16x16x32_bf16 a[204:207], v[120:123], v[140:143], a[204:207]
    v_lshlrev_b32 v24, 3, v1
    v_mfma_f32_16x16x32_bf16 a[208:211], v[120:123], v[144:147], a[208:211]
    v_mfma_f32_16x16x32_bf16 a[212:215], v[120:123], v[148:151], a[212:215]
    v_mfma_f32_16x16x32_bf16 a[216:219], v[120:123], v[152:155], a[216:219]
    buffer_load_dword v24, v24, s[12:15], s3 offen
    v_mfma_f32_16x16x32_bf16 a[220:223], v[120:123], v[156:159], a[220:223]
    v_mfma_f32_16x16x32_bf16 a[252:255], v[124:127], v[156:159], a[252:255]
    v_mfma_f32_16x16x32_bf16 a[248:251], v[124:127], v[152:155], a[248:251]
    v_mfma_f32_16x16x32_bf16 a[244:247], v[124:127], v[148:151], a[244:247]
    v_mfma_f32_16x16x32_bf16 a[240:243], v[124:127], v[144:147], a[240:243]
    v_mfma_f32_16x16x32_bf16 a[236:239], v[124:127], v[140:143], a[236:239]
    v_mfma_f32_16x16x32_bf16 a[232:235], v[124:127], v[136:139], a[232:235]
    v_mfma_f32_16x16x32_bf16 a[228:231], v[124:127], v[132:135], a[228:231]
    v_mfma_f32_16x16x32_bf16 a[224:227], v[124:127], v[128:131], a[224:227]
    s_waitcnt vmcnt(33) lgkmcnt(0)
    s_barrier
    v_mfma_f32_16x16x32_bf16 a[0:3], v[32:35], v[64:67], a[0:3]
    v_mfma_f32_16x16x32_bf16 a[4:7], v[32:35], v[68:71], a[4:7]
    v_mfma_f32_16x16x32_bf16 a[8:11], v[32:35], v[72:75], a[8:11]
    v_mfma_f32_16x16x32_bf16 a[12:15], v[32:35], v[76:79], a[12:15]
    ds_read_b64_tr_b16 v[128:129], v244 offset:49152
    s_add_u32 s39, s38, 81920
    s_add_u32 m0, s24, 147456
    v_mfma_f32_16x16x32_bf16 a[16:19], v[32:35], v[80:83], a[16:19]
    buffer_load_dwordx4 v4, s[12:15], s39 offen offset:0 lds
    v_mfma_f32_16x16x32_bf16 a[20:23], v[32:35], v[84:87], a[20:23]
    ds_read_b64_tr_b16 v[130:131], v244 offset:51200
    v_mfma_f32_16x16x32_bf16 a[24:27], v[32:35], v[88:91], a[24:27]
    v_mfma_f32_16x16x32_bf16 a[28:31], v[32:35], v[92:95], a[28:31]
    ds_read_b128 v[96:99], v255 offset:0
    v_mfma_f32_16x16x32_bf16 a[60:63], v[36:39], v[92:95], a[60:63]
    v_mfma_f32_16x16x32_bf16 a[56:59], v[36:39], v[88:91], a[56:59]
    ds_read_b64_tr_b16 v[132:133], v245 offset:49152
    v_mfma_f32_16x16x32_bf16 a[52:55], v[36:39], v[84:87], a[52:55]
    buffer_load_dwordx4 v4, s[12:15], s39 offen offset:1024 lds
    v_mfma_f32_16x16x32_bf16 a[48:51], v[36:39], v[80:83], a[48:51]
    ds_read_b64_tr_b16 v[134:135], v245 offset:51200
    v_mfma_f32_16x16x32_bf16 a[44:47], v[36:39], v[76:79], a[44:47]
    v_mfma_f32_16x16x32_bf16 a[40:43], v[36:39], v[72:75], a[40:43]
    ds_read_b128 v[100:103], v255 offset:2048
    v_mfma_f32_16x16x32_bf16 a[36:39], v[36:39], v[68:71], a[36:39]
    buffer_load_dwordx4 v[32:35], v1, s[12:15], s35 offen offset:2048 sc1
    v_mfma_f32_16x16x32_bf16 a[32:35], v[36:39], v[64:67], a[32:35]
    ds_read_b64_tr_b16 v[136:137], v246 offset:49152
    v_mfma_f32_16x16x32_bf16 a[64:67], v[40:43], v[64:67], a[64:67]
    buffer_load_dwordx4 v4, s[12:15], s39 offen offset:2048 lds
    v_mfma_f32_16x16x32_bf16 a[68:71], v[40:43], v[68:71], a[68:71]
    ds_read_b64_tr_b16 v[138:139], v246 offset:51200
    v_mfma_f32_16x16x32_bf16 a[72:75], v[40:43], v[72:75], a[72:75]
    v_mfma_f32_16x16x32_bf16 a[76:79], v[40:43], v[76:79], a[76:79]
    ds_read_b128 v[104:107], v255 offset:4096
    v_mfma_f32_16x16x32_bf16 a[80:83], v[40:43], v[80:83], a[80:83]
    v_mfma_f32_16x16x32_bf16 a[84:87], v[40:43], v[84:87], a[84:87]
    ds_read_b64_tr_b16 v[140:141], v247 offset:49152
    v_mfma_f32_16x16x32_bf16 a[88:91], v[40:43], v[88:91], a[88:91]
    buffer_load_dwordx4 v4, s[12:15], s39 offen offset:3072 lds
    buffer_load_dwordx4 v[36:39], v5, s[12:15], s35 offen offset:2048 sc1
    v_mfma_f32_16x16x32_bf16 a[92:95], v[40:43], v[92:95], a[92:95]
    ds_read_b64_tr_b16 v[142:143], v247 offset:51200
    v_mfma_f32_16x16x32_bf16 a[124:127], v[44:47], v[92:95], a[124:127]
    v_mfma_f32_16x16x32_bf16 a[120:123], v[44:47], v[88:91], a[120:123]
    ds_read_b128 v[108:111], v255 offset:6144
    v_mfma_f32_16x16x32_bf16 a[116:119], v[44:47], v[84:87], a[116:119]
    v_mfma_f32_16x16x32_bf16 a[112:115], v[44:47], v[80:83], a[112:115]
    ds_read_b64_tr_b16 v[144:145], v248 offset:49152
    v_mfma_f32_16x16x32_bf16 a[108:111], v[44:47], v[76:79], a[108:111]
    v_mfma_f32_16x16x32_bf16 a[104:107], v[44:47], v[72:75], a[104:107]
    ds_read_b64_tr_b16 v[146:147], v248 offset:51200
    v_mfma_f32_16x16x32_bf16 a[100:103], v[44:47], v[68:71], a[100:103]
    buffer_load_dwordx4 v[40:43], v1, s[12:15], s35 offen offset:3072 sc1
    v_mfma_f32_16x16x32_bf16 a[96:99], v[44:47], v[64:67], a[96:99]
    ds_read_b128 v[112:115], v255 offset:8192
    s_add_u32 s39, s38, 98304
    s_add_u32 m0, s24, 32768
    v_mfma_f32_16x16x32_bf16 a[128:131], v[48:51], v[64:67], a[128:131]
    buffer_load_dwordx4 v4, s[12:15], s39 offen offset:0 lds
    v_mfma_f32_16x16x32_bf16 a[132:135], v[48:51], v[68:71], a[132:135]
    ds_read_b64_tr_b16 v[148:149], v249 offset:49152
    v_mfma_f32_16x16x32_bf16 a[136:139], v[48:51], v[72:75], a[136:139]
    v_mfma_f32_16x16x32_bf16 a[140:143], v[48:51], v[76:79], a[140:143]
    ds_read_b64_tr_b16 v[150:151], v249 offset:51200
    v_mfma_f32_16x16x32_bf16 a[144:147], v[48:51], v[80:83], a[144:147]
    v_mfma_f32_16x16x32_bf16 a[148:151], v[48:51], v[84:87], a[148:151]
    ds_read_b128 v[116:119], v255 offset:10240
    v_mfma_f32_16x16x32_bf16 a[152:155], v[48:51], v[88:91], a[152:155]
    buffer_load_dwordx4 v4, s[12:15], s39 offen offset:1024 lds
    buffer_load_dwordx4 v[44:47], v5, s[12:15], s35 offen offset:3072 sc1
    v_mfma_f32_16x16x32_bf16 a[156:159], v[48:51], v[92:95], a[156:159]
    ds_read_b64_tr_b16 v[152:153], v250 offset:49152
    v_mfma_f32_16x16x32_bf16 a[188:191], v[52:55], v[92:95], a[188:191]
    v_mfma_f32_16x16x32_bf16 a[184:187], v[52:55], v[88:91], a[184:187]
    ds_read_b64_tr_b16 v[154:155], v250 offset:51200
    v_mfma_f32_16x16x32_bf16 a[180:183], v[52:55], v[84:87], a[180:183]
    v_mfma_f32_16x16x32_bf16 a[176:179], v[52:55], v[80:83], a[176:179]
    ds_read_b128 v[120:123], v255 offset:12288
    v_mfma_f32_16x16x32_bf16 a[172:175], v[52:55], v[76:79], a[172:175]
    buffer_load_dwordx4 v4, s[12:15], s39 offen offset:2048 lds
    v_mfma_f32_16x16x32_bf16 a[168:171], v[52:55], v[72:75], a[168:171]
    ds_read_b64_tr_b16 v[156:157], v251 offset:49152
    v_mfma_f32_16x16x32_bf16 a[164:167], v[52:55], v[68:71], a[164:167]
    buffer_load_dwordx4 v[48:51], v1, s[12:15], s72 offen offset:0 sc1
    v_mfma_f32_16x16x32_bf16 a[160:163], v[52:55], v[64:67], a[160:163]
    ds_read_b64_tr_b16 v[158:159], v251 offset:51200
    v_mfma_f32_16x16x32_bf16 a[192:195], v[56:59], v[64:67], a[192:195]
    v_mfma_f32_16x16x32_bf16 a[196:199], v[56:59], v[68:71], a[196:199]
    ds_read_b128 v[124:127], v255 offset:14336
    v_mfma_f32_16x16x32_bf16 a[200:203], v[56:59], v[72:75], a[200:203]
    buffer_load_dwordx4 v4, s[12:15], s39 offen offset:3072 lds
    v_mfma_f32_16x16x32_bf16 a[204:207], v[56:59], v[76:79], a[204:207]
    v_mfma_f32_16x16x32_bf16 a[208:211], v[56:59], v[80:83], a[208:211]
    v_mfma_f32_16x16x32_bf16 a[212:215], v[56:59], v[84:87], a[212:215]
    v_mfma_f32_16x16x32_bf16 a[216:219], v[56:59], v[88:91], a[216:219]
    buffer_load_dwordx4 v[52:55], v5, s[12:15], s72 offen offset:0 sc1
    v_mfma_f32_16x16x32_bf16 a[220:223], v[56:59], v[92:95], a[220:223]
    v_mfma_f32_16x16x32_bf16 a[252:255], v[60:63], v[92:95], a[252:255]
    v_mfma_f32_16x16x32_bf16 a[248:251], v[60:63], v[88:91], a[248:251]
    v_mfma_f32_16x16x32_bf16 a[244:247], v[60:63], v[84:87], a[244:247]
    v_mfma_f32_16x16x32_bf16 a[240:243], v[60:63], v[80:83], a[240:243]
    v_mfma_f32_16x16x32_bf16 a[236:239], v[60:63], v[76:79], a[236:239]
    buffer_load_dwordx4 v[56:59], v1, s[12:15], s72 offen offset:1024 sc1
    v_mfma_f32_16x16x32_bf16 a[232:235], v[60:63], v[72:75], a[232:235]
    v_mfma_f32_16x16x32_bf16 a[228:231], v[60:63], v[68:71], a[228:231]
    v_mfma_f32_16x16x32_bf16 a[224:227], v[60:63], v[64:67], a[224:227]
    s_waitcnt lgkmcnt(0)
    s_barrier
    v_mfma_f32_16x16x32_bf16 a[0:3], v[96:99], v[128:131], a[0:3]
    v_mfma_f32_16x16x32_bf16 a[4:7], v[96:99], v[132:135], a[4:7]
    v_mfma_f32_16x16x32_bf16 a[8:11], v[96:99], v[136:139], a[8:11]
    v_mfma_f32_16x16x32_bf16 a[12:15], v[96:99], v[140:143], a[12:15]
    s_add_u32 s39, s38, 114688
    s_add_u32 m0, s24, 49152
    v_mfma_f32_16x16x32_bf16 a[16:19], v[96:99], v[144:147], a[16:19]
    buffer_load_dwordx4 v4, s[12:15], s39 offen offset:0 lds
    v_mfma_f32_16x16x32_bf16 a[20:23], v[96:99], v[148:151], a[20:23]
    v_mfma_f32_16x16x32_bf16 a[24:27], v[96:99], v[152:155], a[24:27]
    v_mfma_f32_16x16x32_bf16 a[28:31], v[96:99], v[156:159], a[28:31]
    v_mfma_f32_16x16x32_bf16 a[60:63], v[100:103], v[156:159], a[60:63]
    v_mfma_f32_16x16x32_bf16 a[56:59], v[100:103], v[152:155], a[56:59]
    v_mfma_f32_16x16x32_bf16 a[52:55], v[100:103], v[148:151], a[52:55]
    buffer_load_dwordx4 v4, s[12:15], s39 offen offset:1024 lds
    v_mfma_f32_16x16x32_bf16 a[48:51], v[100:103], v[144:147], a[48:51]
    v_mfma_f32_16x16x32_bf16 a[44:47], v[100:103], v[140:143], a[44:47]
    v_mfma_f32_16x16x32_bf16 a[40:43], v[100:103], v[136:139], a[40:43]
    v_mfma_f32_16x16x32_bf16 a[36:39], v[100:103], v[132:135], a[36:39]
    v_mfma_f32_16x16x32_bf16 a[32:35], v[100:103], v[128:131], a[32:35]
    v_mfma_f32_16x16x32_bf16 a[64:67], v[104:107], v[128:131], a[64:67]
    buffer_load_dwordx4 v4, s[12:15], s39 offen offset:2048 lds
    v_mfma_f32_16x16x32_bf16 a[68:71], v[104:107], v[132:135], a[68:71]
    v_mfma_f32_16x16x32_bf16 a[72:75], v[104:107], v[136:139], a[72:75]
    v_mfma_f32_16x16x32_bf16 a[76:79], v[104:107], v[140:143], a[76:79]
    buffer_load_dwordx4 v[60:63], v5, s[12:15], s72 offen offset:1024 sc1
    v_mfma_f32_16x16x32_bf16 a[80:83], v[104:107], v[144:147], a[80:83]
    v_accvgpr_read_b32 v8, a0
    v_accvgpr_read_b32 v9, a1
    v_mfma_f32_16x16x32_bf16 a[84:87], v[104:107], v[148:151], a[84:87]
    v_accvgpr_read_b32 v10, a2
    v_accvgpr_read_b32 v11, a3
    v_mfma_f32_16x16x32_bf16 a[88:91], v[104:107], v[152:155], a[88:91]
    buffer_load_dwordx4 v4, s[12:15], s39 offen offset:3072 lds
    v_mfma_f32_16x16x32_bf16 a[92:95], v[104:107], v[156:159], a[92:95]
    v_accvgpr_read_b32 v12, a32
    v_accvgpr_read_b32 v13, a33
    v_mfma_f32_16x16x32_bf16 a[124:127], v[108:111], v[156:159], a[124:127]
    v_accvgpr_read_b32 v14, a34
    v_accvgpr_read_b32 v15, a35
    v_mfma_f32_16x16x32_bf16 a[120:123], v[108:111], v[152:155], a[120:123]
    v_cvt_pk_bf16_f32 v208, v8, v9
    v_cvt_pk_bf16_f32 v209, v10, v11
    v_mfma_f32_16x16x32_bf16 a[116:119], v[108:111], v[148:151], a[116:119]
    v_cvt_pk_bf16_f32 v210, v12, v13
    v_cvt_pk_bf16_f32 v211, v14, v15
    v_mfma_f32_16x16x32_bf16 a[112:115], v[108:111], v[144:147], a[112:115]
    v_accvgpr_read_b32 v8, a4
    v_accvgpr_read_b32 v9, a5
    v_mfma_f32_16x16x32_bf16 a[108:111], v[108:111], v[140:143], a[108:111]
    v_accvgpr_read_b32 v10, a6
    v_accvgpr_read_b32 v11, a7
    v_mfma_f32_16x16x32_bf16 a[104:107], v[108:111], v[136:139], a[104:107]
    v_accvgpr_read_b32 v12, a36
    v_accvgpr_read_b32 v13, a37
    v_mfma_f32_16x16x32_bf16 a[100:103], v[108:111], v[132:135], a[100:103]
    v_accvgpr_read_b32 v14, a38
    v_accvgpr_read_b32 v15, a39
    v_mfma_f32_16x16x32_bf16 a[96:99], v[108:111], v[128:131], a[96:99]
    s_add_u32 s39, s38, 131072
    s_add_u32 m0, s24, 65536
    v_mfma_f32_16x16x32_bf16 a[128:131], v[112:115], v[128:131], a[128:131]
    buffer_load_dwordx4 v4, s[12:15], s39 offen offset:0 lds
    v_mfma_f32_16x16x32_bf16 a[132:135], v[112:115], v[132:135], a[132:135]
    v_cvt_pk_bf16_f32 v212, v8, v9
    v_cvt_pk_bf16_f32 v213, v10, v11
    v_mfma_f32_16x16x32_bf16 a[136:139], v[112:115], v[136:139], a[136:139]
    v_cvt_pk_bf16_f32 v214, v12, v13
    v_cvt_pk_bf16_f32 v215, v14, v15
    v_mfma_f32_16x16x32_bf16 a[140:143], v[112:115], v[140:143], a[140:143]
    s_add_u32 s90, s91, 0
    v_mfma_f32_16x16x32_bf16 a[144:147], v[112:115], v[144:147], a[144:147]
    buffer_store_dwordx4 v[208:211], v1, s[12:15], s90 offen offset:0 sc1
    v_mfma_f32_16x16x32_bf16 a[148:151], v[112:115], v[148:151], a[148:151]
    v_accvgpr_read_b32 v8, a8
    v_accvgpr_read_b32 v9, a9
    v_mfma_f32_16x16x32_bf16 a[152:155], v[112:115], v[152:155], a[152:155]
    buffer_load_dwordx4 v4, s[12:15], s39 offen offset:1024 lds
    v_mfma_f32_16x16x32_bf16 a[156:159], v[112:115], v[156:159], a[156:159]
    v_accvgpr_read_b32 v10, a10
    v_accvgpr_read_b32 v11, a11
    v_mfma_f32_16x16x32_bf16 a[188:191], v[116:119], v[156:159], a[188:191]
    v_accvgpr_read_b32 v12, a40
    v_accvgpr_read_b32 v13, a41
    v_mfma_f32_16x16x32_bf16 a[184:187], v[116:119], v[152:155], a[184:187]
    v_accvgpr_read_b32 v14, a42
    v_accvgpr_read_b32 v15, a43
    v_mfma_f32_16x16x32_bf16 a[180:183], v[116:119], v[148:151], a[180:183]
    v_cvt_pk_bf16_f32 v216, v8, v9
    v_cvt_pk_bf16_f32 v217, v10, v11
    v_mfma_f32_16x16x32_bf16 a[176:179], v[116:119], v[144:147], a[176:179]
    v_cvt_pk_bf16_f32 v218, v12, v13
    v_cvt_pk_bf16_f32 v219, v14, v15
    v_mfma_f32_16x16x32_bf16 a[172:175], v[116:119], v[140:143], a[172:175]
    buffer_load_dwordx4 v4, s[12:15], s39 offen offset:2048 lds
    v_mfma_f32_16x16x32_bf16 a[168:171], v[116:119], v[136:139], a[168:171]
    v_accvgpr_read_b32 v8, a12
    v_accvgpr_read_b32 v9, a13
    v_mfma_f32_16x16x32_bf16 a[164:167], v[116:119], v[132:135], a[164:167]
    v_accvgpr_read_b32 v10, a14
    v_accvgpr_read_b32 v11, a15
    v_mfma_f32_16x16x32_bf16 a[160:163], v[116:119], v[128:131], a[160:163]
    v_accvgpr_read_b32 v12, a44
    v_accvgpr_read_b32 v13, a45
    v_mfma_f32_16x16x32_bf16 a[192:195], v[120:123], v[128:131], a[192:195]
    v_accvgpr_read_b32 v14, a46
    v_accvgpr_read_b32 v15, a47
    v_mfma_f32_16x16x32_bf16 a[196:199], v[120:123], v[132:135], a[196:199]
    v_cvt_pk_bf16_f32 v220, v8, v9
    v_cvt_pk_bf16_f32 v221, v10, v11
    v_mfma_f32_16x16x32_bf16 a[200:203], v[120:123], v[136:139], a[200:203]
    buffer_load_dwordx4 v4, s[12:15], s39 offen offset:3072 lds
    v_mfma_f32_16x16x32_bf16 a[204:207], v[120:123], v[140:143], a[204:207]
    v_cvt_pk_bf16_f32 v222, v12, v13
    v_cvt_pk_bf16_f32 v223, v14, v15
    v_mfma_f32_16x16x32_bf16 a[208:211], v[120:123], v[144:147], a[208:211]
    buffer_store_dwordx4 v[212:215], v1, s[12:15], s90 offen offset:1024 sc1
    v_mfma_f32_16x16x32_bf16 a[212:215], v[120:123], v[148:151], a[212:215]
    v_accvgpr_read_b32 v8, a16
    v_accvgpr_read_b32 v9, a17
    v_mfma_f32_16x16x32_bf16 a[216:219], v[120:123], v[152:155], a[216:219]
    v_accvgpr_read_b32 v10, a18
    v_accvgpr_read_b32 v11, a19
    v_mfma_f32_16x16x32_bf16 a[220:223], v[120:123], v[156:159], a[220:223]
    v_accvgpr_read_b32 v12, a48
    v_accvgpr_read_b32 v13, a49
    v_mfma_f32_16x16x32_bf16 a[252:255], v[124:127], v[156:159], a[252:255]
    v_accvgpr_read_b32 v14, a50
    v_accvgpr_read_b32 v15, a51
    v_mfma_f32_16x16x32_bf16 a[248:251], v[124:127], v[152:155], a[248:251]
    v_cvt_pk_bf16_f32 v224, v8, v9
    v_cvt_pk_bf16_f32 v225, v10, v11
    v_mfma_f32_16x16x32_bf16 a[244:247], v[124:127], v[148:151], a[244:247]
    v_cvt_pk_bf16_f32 v226, v12, v13
    v_cvt_pk_bf16_f32 v227, v14, v15
    v_mfma_f32_16x16x32_bf16 a[240:243], v[124:127], v[144:147], a[240:243]
    v_accvgpr_read_b32 v8, a20
    v_accvgpr_read_b32 v9, a21
    v_mfma_f32_16x16x32_bf16 a[236:239], v[124:127], v[140:143], a[236:239]
    v_accvgpr_read_b32 v10, a22
    v_accvgpr_read_b32 v11, a23
    v_mfma_f32_16x16x32_bf16 a[232:235], v[124:127], v[136:139], a[232:235]
    v_accvgpr_read_b32 v12, a52
    v_accvgpr_read_b32 v13, a53
    v_mfma_f32_16x16x32_bf16 a[228:231], v[124:127], v[132:135], a[228:231]
    v_accvgpr_read_b32 v14, a54
    v_accvgpr_read_b32 v15, a55
    v_cvt_pk_bf16_f32 v228, v8, v9
    v_cvt_pk_bf16_f32 v229, v10, v11
    v_cvt_pk_bf16_f32 v230, v12, v13
    v_cvt_pk_bf16_f32 v231, v14, v15
    buffer_store_dwordx4 v[216:219], v1, s[12:15], s90 offen offset:2048 sc1
    v_mfma_f32_16x16x32_bf16 a[224:227], v[124:127], v[128:131], a[224:227]
    v_accvgpr_read_b32 v112, a24
    v_accvgpr_read_b32 v113, a25
    v_accvgpr_read_b32 v114, a26
    v_accvgpr_read_b32 v115, a27
    v_accvgpr_read_b32 v116, a56
    v_accvgpr_read_b32 v117, a57
    v_accvgpr_read_b32 v118, a58
    v_accvgpr_read_b32 v119, a59
    v_cvt_pk_bf16_f32 v232, v112, v113
    v_cvt_pk_bf16_f32 v233, v114, v115
    v_cvt_pk_bf16_f32 v234, v116, v117
    v_cvt_pk_bf16_f32 v235, v118, v119
    v_accvgpr_read_b32 v120, a28
    v_accvgpr_read_b32 v121, a29
    v_accvgpr_read_b32 v122, a30
    v_accvgpr_read_b32 v123, a31
    v_accvgpr_read_b32 v124, a60
    v_accvgpr_read_b32 v125, a61
    v_accvgpr_read_b32 v126, a62
    v_accvgpr_read_b32 v127, a63
    v_cvt_pk_bf16_f32 v236, v120, v121
    v_cvt_pk_bf16_f32 v237, v122, v123
    v_cvt_pk_bf16_f32 v238, v124, v125
    v_cvt_pk_bf16_f32 v239, v126, v127
    v_accvgpr_read_b32 v96, a64
    v_accvgpr_read_b32 v97, a65
    v_accvgpr_read_b32 v98, a66
    v_accvgpr_read_b32 v99, a67
    v_accvgpr_read_b32 v100, a96
    v_accvgpr_read_b32 v101, a97
    v_accvgpr_read_b32 v102, a98
    v_accvgpr_read_b32 v103, a99
    v_cvt_pk_bf16_f32 v240, v96, v97
    v_cvt_pk_bf16_f32 v241, v98, v99
    v_cvt_pk_bf16_f32 v242, v100, v101
    v_cvt_pk_bf16_f32 v243, v102, v103
    buffer_store_dwordx4 v[220:223], v1, s[12:15], s90 offen offset:3072 sc1
    v_accvgpr_read_b32 v104, a68
    v_accvgpr_read_b32 v105, a69
    v_accvgpr_read_b32 v106, a70
    v_accvgpr_read_b32 v107, a71
    v_accvgpr_read_b32 v108, a100
    v_accvgpr_read_b32 v109, a101
    v_accvgpr_read_b32 v110, a102
    v_accvgpr_read_b32 v111, a103
    v_cvt_pk_bf16_f32 v244, v104, v105
    v_cvt_pk_bf16_f32 v245, v106, v107
    v_cvt_pk_bf16_f32 v246, v108, v109
    v_cvt_pk_bf16_f32 v247, v110, v111
    v_accvgpr_read_b32 v112, a72
    v_accvgpr_read_b32 v113, a73
    v_accvgpr_read_b32 v114, a74
    v_accvgpr_read_b32 v115, a75
    v_accvgpr_read_b32 v116, a104
    v_accvgpr_read_b32 v117, a105
    v_accvgpr_read_b32 v118, a106
    v_accvgpr_read_b32 v119, a107
    v_cvt_pk_bf16_f32 v248, v112, v113
    v_cvt_pk_bf16_f32 v249, v114, v115
    v_cvt_pk_bf16_f32 v250, v116, v117
    v_cvt_pk_bf16_f32 v251, v118, v119
    v_accvgpr_read_b32 v120, a76
    v_accvgpr_read_b32 v121, a77
    v_accvgpr_read_b32 v122, a78
    v_accvgpr_read_b32 v123, a79
    v_accvgpr_read_b32 v124, a108
    v_accvgpr_read_b32 v125, a109
    v_accvgpr_read_b32 v126, a110
    v_accvgpr_read_b32 v127, a111
    v_cvt_pk_bf16_f32 v252, v120, v121
    v_cvt_pk_bf16_f32 v253, v122, v123
    v_cvt_pk_bf16_f32 v254, v124, v125
    v_cvt_pk_bf16_f32 v255, v126, v127
    v_accvgpr_read_b32 v96, a80
    v_accvgpr_read_b32 v97, a81
    v_accvgpr_read_b32 v98, a82
    v_accvgpr_read_b32 v99, a83
    v_accvgpr_read_b32 v100, a112
    v_accvgpr_read_b32 v101, a113
    v_accvgpr_read_b32 v102, a114
    v_accvgpr_read_b32 v103, a115
    v_cvt_pk_bf16_f32 v208, v96, v97
    v_cvt_pk_bf16_f32 v209, v98, v99
    v_cvt_pk_bf16_f32 v210, v100, v101
    v_cvt_pk_bf16_f32 v211, v102, v103
    v_accvgpr_read_b32 v104, a84
    v_accvgpr_read_b32 v105, a85
    v_accvgpr_read_b32 v106, a86
    v_accvgpr_read_b32 v107, a87
    v_accvgpr_read_b32 v108, a116
    v_accvgpr_read_b32 v109, a117
    v_accvgpr_read_b32 v110, a118
    v_accvgpr_read_b32 v111, a119
    v_cvt_pk_bf16_f32 v212, v104, v105
    v_cvt_pk_bf16_f32 v213, v106, v107
    v_cvt_pk_bf16_f32 v214, v108, v109
    v_cvt_pk_bf16_f32 v215, v110, v111
    s_add_u32 s90, s91, 4096
    buffer_store_dwordx4 v[224:227], v1, s[12:15], s90 offen offset:0 sc1
    v_accvgpr_read_b32 v112, a88
    v_accvgpr_read_b32 v113, a89
    v_accvgpr_read_b32 v114, a90
    v_accvgpr_read_b32 v115, a91
    v_accvgpr_read_b32 v116, a120
    v_accvgpr_read_b32 v117, a121
    v_accvgpr_read_b32 v118, a122
    v_accvgpr_read_b32 v119, a123
    v_cvt_pk_bf16_f32 v216, v112, v113
    v_cvt_pk_bf16_f32 v217, v114, v115
    v_cvt_pk_bf16_f32 v218, v116, v117
    v_cvt_pk_bf16_f32 v219, v118, v119
    v_accvgpr_read_b32 v120, a92
    v_accvgpr_read_b32 v121, a93
    v_accvgpr_read_b32 v122, a94
    v_accvgpr_read_b32 v123, a95
    v_accvgpr_read_b32 v124, a124
    v_accvgpr_read_b32 v125, a125
    v_accvgpr_read_b32 v126, a126
    v_accvgpr_read_b32 v127, a127
    v_cvt_pk_bf16_f32 v220, v120, v121
    v_cvt_pk_bf16_f32 v221, v122, v123
    v_cvt_pk_bf16_f32 v222, v124, v125
    v_cvt_pk_bf16_f32 v223, v126, v127
    v_add_u32 v6, 0x10000, v1
    v_add_u32 v13, 0x20000, v1
    v_mov_b32 v14, 1
    s_cmp_lt_u32 s68, 14
    s_cselect_b32 s3, 8, 0
    v_min_u32 v15, 1, v2
    v_add_u32 v15, s3, v15
    v_mul_u32_u24 v15, 6144, v15
    s_waitcnt vmcnt(14)
    s_barrier
    ds_read_b128 v[96:99], v6 offset:32768
    ds_read_b128 v[100:103], v6 offset:33792
    ds_read_b128 v[104:107], v6 offset:34816
    ds_read_b128 v[108:111], v6 offset:35840
    ds_read_b128 v[112:115], v6 offset:36864
    ds_read_b128 v[116:119], v6 offset:37888
    ds_read_b128 v[120:123], v6 offset:38912
    ds_read_b128 v[124:127], v6 offset:39936
    s_waitcnt lgkmcnt(4)
    v_mfma_f32_16x16x32_bf16 a[0:3], v[96:99], v[160:163], 0
    ds_read_b128 v[128:131], v6 offset:40960
    v_mfma_f32_16x16x32_bf16 a[4:7], v[96:99], v[164:167], 0
    s_add_u32 s39, s38, 147456
    s_add_u32 m0, s24, 81920
    v_mfma_f32_16x16x32_bf16 a[8:11], v[100:103], v[160:163], 0
    ds_read_b128 v[132:135], v6 offset:41984
    v_mfma_f32_16x16x32_bf16 a[12:15], v[100:103], v[164:167], 0
    buffer_load_dwordx4 v4, s[12:15], s39 offen offset:0 lds
    v_mfma_f32_16x16x32_bf16 a[16:19], v[104:107], v[160:163], 0
    ds_read_b128 v[136:139], v6 offset:43008
    v_mfma_f32_16x16x32_bf16 a[20:23], v[104:107], v[164:167], 0
    buffer_load_dwordx4 v[64:67], v1, s[12:15], s72 offen offset:2048 sc1
    v_mfma_f32_16x16x32_bf16 a[24:27], v[108:111], v[160:163], 0
    ds_read_b128 v[140:143], v6 offset:44032
    v_mfma_f32_16x16x32_bf16 a[28:31], v[108:111], v[164:167], 0
    s_waitcnt lgkmcnt(4)
    v_mfma_f32_16x16x32_bf16 a[32:35], v[112:115], v[160:163], 0
    ds_read_b128 v[144:147], v6 offset:45056
    v_mfma_f32_16x16x32_bf16 a[36:39], v[112:115], v[164:167], 0
    buffer_store_dwordx4 v[228:231], v1, s[12:15], s90 offen offset:1024 sc1
    v_mfma_f32_16x16x32_bf16 a[40:43], v[116:119], v[160:163], 0
    ds_read_b128 v[148:151], v6 offset:46080
    s_lshl_b32 s86, s31, 2
    v_mfma_f32_16x16x32_bf16 a[44:47], v[116:119], v[164:167], 0
    buffer_load_dwordx4 v4, s[12:15], s39 offen offset:1024 lds
    v_mfma_f32_16x16x32_bf16 a[48:51], v[120:123], v[160:163], 0
    ds_read_b128 v[152:155], v6 offset:47104
    s_sub_u32 s34, 28, s86
    v_mfma_f32_16x16x32_bf16 a[52:55], v[120:123], v[164:167], 0
    buffer_load_dwordx4 v[68:71], v5, s[12:15], s72 offen offset:2048 sc1
    v_mfma_f32_16x16x32_bf16 a[56:59], v[124:127], v[160:163], 0
    ds_read_b128 v[156:159], v6 offset:48128
    s_add_u32 s35, s86, 4
    v_mfma_f32_16x16x32_bf16 a[60:63], v[124:127], v[164:167], 0
    s_waitcnt lgkmcnt(4)
    v_mfma_f32_16x16x32_bf16 a[64:67], v[128:131], v[160:163], 0
    ds_read_b128 v[96:99], v6 offset:49152
    v_mfma_f32_16x16x32_bf16 a[68:71], v[128:131], v[164:167], 0
    s_cmp_eq_u32 s32, 1
    s_cselect_b32 s87, 36, 32
    v_mfma_f32_16x16x32_bf16 a[72:75], v[132:135], v[160:163], 0
    ds_read_b128 v[100:103], v6 offset:50176
    v_mfma_f32_16x16x32_bf16 a[76:79], v[132:135], v[164:167], 0
    buffer_load_dwordx4 v4, s[12:15], s39 offen offset:2048 lds
    v_mfma_f32_16x16x32_bf16 a[80:83], v[136:139], v[160:163], 0
    ds_read_b128 v[104:107], v6 offset:51200
    v_mfma_f32_16x16x32_bf16 a[84:87], v[136:139], v[164:167], 0
    buffer_load_dwordx4 v[72:75], v1, s[12:15], s72 offen offset:3072 sc1
    v_mfma_f32_16x16x32_bf16 a[88:91], v[140:143], v[160:163], 0
    ds_read_b128 v[108:111], v6 offset:52224
    v_mfma_f32_16x16x32_bf16 a[92:95], v[140:143], v[164:167], 0
    s_waitcnt lgkmcnt(4)
    v_mfma_f32_16x16x32_bf16 a[96:99], v[144:147], v[160:163], 0
    ds_read_b128 v[112:115], v6 offset:53248
    v_mfma_f32_16x16x32_bf16 a[100:103], v[144:147], v[164:167], 0
    s_cmp_lt_u32 s68, 14
    s_cselect_b32 s34, s34, s87
    s_cselect_b32 s35, s35, 0
    s_cselect_b32 s87, 1225728, 0
    v_mfma_f32_16x16x32_bf16 a[104:107], v[148:151], v[160:163], 0
    ds_read_b128 v[116:119], v6 offset:54272
    s_mov_b32 s37, 0x47800000
    v_mfma_f32_16x16x32_bf16 a[108:111], v[148:151], v[164:167], 0
    buffer_load_dwordx4 v4, s[12:15], s39 offen offset:3072 lds
    v_mfma_f32_16x16x32_bf16 a[112:115], v[152:155], v[160:163], 0
    ds_read_b128 v[120:123], v6 offset:55296
    v_mfma_f32_16x16x32_bf16 a[116:119], v[152:155], v[164:167], 0
    buffer_load_dwordx4 v[76:79], v5, s[12:15], s72 offen offset:3072 sc1
    v_mfma_f32_16x16x32_bf16 a[120:123], v[156:159], v[160:163], 0
    ds_read_b128 v[124:127], v6 offset:56320
    v_mfma_f32_16x16x32_bf16 a[124:127], v[156:159], v[164:167], 0
    s_waitcnt lgkmcnt(4)
    v_mfma_f32_16x16x32_bf16 a[0:3], v[96:99], v[168:171], a[0:3]
    ds_read_b128 v[128:131], v6 offset:57344
    v_mfma_f32_16x16x32_bf16 a[4:7], v[96:99], v[172:175], a[4:7]
    buffer_store_dwordx4 v[232:235], v1, s[12:15], s90 offen offset:2048 sc1
    v_mfma_f32_16x16x32_bf16 a[8:11], v[100:103], v[168:171], a[8:11]
    ds_read_b128 v[132:135], v6 offset:58368
    s_mul_i32 s88, s30, 2181376
    v_mfma_f32_16x16x32_bf16 a[12:15], v[100:103], v[172:175], a[12:15]
    s_add_u32 s88, s88, 117440512
    s_add_u32 s25, s88, s87
    v_mfma_f32_16x16x32_bf16 a[16:19], v[104:107], v[168:171], a[16:19]
    ds_read_b128 v[136:139], v6 offset:59392
    s_sub_u32 s89, s34, 1
    v_mfma_f32_16x16x32_bf16 a[20:23], v[104:107], v[172:175], a[20:23]
    buffer_load_dwordx4 v[80:83], v1, s[12:15], s73 offen offset:0 sc1
    v_mfma_f32_16x16x32_bf16 a[24:27], v[108:111], v[168:171], a[24:27]
    ds_read_b128 v[140:143], v6 offset:60416
    v_subrev_u32 v9, 0, v2
    v_mfma_f32_16x16x32_bf16 a[28:31], v[108:111], v[172:175], a[28:31]
    v_min_i32 v10, s89, v9
    s_waitcnt lgkmcnt(4)
    v_mfma_f32_16x16x32_bf16 a[32:35], v[112:115], v[168:171], a[32:35]
    ds_read_b128 v[144:147], v6 offset:61440
    v_mfma_f32_16x16x32_bf16 a[36:39], v[112:115], v[172:175], a[36:39]
    buffer_store_dwordx4 v[236:239], v1, s[12:15], s90 offen offset:3072 sc1
    v_mfma_f32_16x16x32_bf16 a[40:43], v[116:119], v[168:171], a[40:43]
    ds_read_b128 v[148:151], v6 offset:62464
    v_subrev_u32 v11, 1, v9
    v_mfma_f32_16x16x32_bf16 a[44:47], v[116:119], v[172:175], a[44:47]
    v_max_i32 v11, 0, v11
    v_min_i32 v11, s89, v11
    v_mfma_f32_16x16x32_bf16 a[48:51], v[120:123], v[168:171], a[48:51]
    ds_read_b128 v[152:155], v6 offset:63488
    v_mul_i32_i24 v10, 34048, v10
    v_mfma_f32_16x16x32_bf16 a[52:55], v[120:123], v[172:175], a[52:55]
    buffer_load_dwordx4 v[84:87], v5, s[12:15], s73 offen offset:0 sc1
    v_mfma_f32_16x16x32_bf16 a[56:59], v[124:127], v[168:171], a[56:59]
    ds_read_b128 v[156:159], v6 offset:64512
    v_mul_i32_i24 v11, 34048, v11
    v_mfma_f32_16x16x32_bf16 a[60:63], v[124:127], v[172:175], a[60:63]
    v_add_u32 v10, s25, v10
    s_waitcnt lgkmcnt(4)
    v_mfma_f32_16x16x32_bf16 a[64:67], v[128:131], v[168:171], a[64:67]
    ds_read_b128 v[96:99], v1 offset:0
    s_add_u32 s90, s91, 34048
    v_mfma_f32_16x16x32_bf16 a[68:71], v[128:131], v[172:175], a[68:71]
    buffer_store_dwordx4 v[240:243], v1, s[12:15], s90 offen offset:0 sc1
    v_mfma_f32_16x16x32_bf16 a[72:75], v[132:135], v[168:171], a[72:75]
    ds_read_b128 v[100:103], v1 offset:1024
    v_add_u32 v11, s25, v11
    v_mfma_f32_16x16x32_bf16 a[76:79], v[132:135], v[172:175], a[76:79]
    v_add_u32 v11, 0x4000, v11
    v_mfma_f32_16x16x32_bf16 a[80:83], v[136:139], v[168:171], a[80:83]
    ds_read_b128 v[104:107], v1 offset:2048
    v_mfma_f32_16x16x32_bf16 a[84:87], v[136:139], v[172:175], a[84:87]
    buffer_load_dwordx4 v[88:91], v1, s[12:15], s73 offen offset:1024 sc1
    v_mfma_f32_16x16x32_bf16 a[88:91], v[140:143], v[168:171], a[88:91]
    ds_read_b128 v[108:111], v1 offset:3072
    v_mov_b32 v7, v10
    v_mfma_f32_16x16x32_bf16 a[92:95], v[140:143], v[172:175], a[92:95]
    v_mov_b32 v8, v11
    s_waitcnt lgkmcnt(4)
    v_mfma_f32_16x16x32_bf16 a[96:99], v[144:147], v[168:171], a[96:99]
    ds_read_b128 v[112:115], v1 offset:4096
    s_add_u32 s86, s86, 3
    v_mfma_f32_16x16x32_bf16 a[100:103], v[144:147], v[172:175], a[100:103]
    v_mfma_f32_16x16x32_bf16 a[104:107], v[148:151], v[168:171], a[104:107]
    ds_read_b128 v[116:119], v1 offset:5120
    s_mul_i32 s86, s86, 34048
    v_mfma_f32_16x16x32_bf16 a[108:111], v[148:151], v[172:175], a[108:111]
    buffer_load_dwordx4 v[92:95], v5, s[12:15], s73 offen offset:1024 sc1
    v_mfma_f32_16x16x32_bf16 a[112:115], v[152:155], v[168:171], a[112:115]
    ds_read_b128 v[120:123], v1 offset:6144
    v_mfma_f32_16x16x32_bf16 a[116:119], v[152:155], v[172:175], a[116:119]
    v_mfma_f32_16x16x32_bf16 a[120:123], v[156:159], v[168:171], a[120:123]
    ds_read_b128 v[124:127], v1 offset:7168
    v_mfma_f32_16x16x32_bf16 a[124:127], v[156:159], v[172:175], a[124:127]
    s_waitcnt lgkmcnt(4)
    v_mfma_f32_16x16x32_bf16 a[0:3], v[96:99], v[176:179], a[0:3]
    ds_read_b128 v[128:131], v1 offset:8192
    v_mfma_f32_16x16x32_bf16 a[4:7], v[96:99], v[180:183], a[4:7]
    buffer_store_dwordx4 v[244:247], v1, s[12:15], s90 offen offset:1024 sc1
    v_mfma_f32_16x16x32_bf16 a[8:11], v[100:103], v[176:179], a[8:11]
    ds_read_b128 v[132:135], v1 offset:9216
    s_add_u32 s25, s88, s86
    v_mfma_f32_16x16x32_bf16 a[12:15], v[100:103], v[180:183], a[12:15]
    s_sub_u32 s89, s35, 1
    v_subrev_u32 v9, s34, v2
    v_mfma_f32_16x16x32_bf16 a[16:19], v[104:107], v[176:179], a[16:19]
    ds_read_b128 v[136:139], v1 offset:10240
    v_min_i32 v10, s89, v9
    v_mfma_f32_16x16x32_bf16 a[20:23], v[104:107], v[180:183], a[20:23]
    v_subrev_u32 v11, 1, v9
    v_max_i32 v11, 0, v11
    v_mfma_f32_16x16x32_bf16 a[24:27], v[108:111], v[176:179], a[24:27]
    ds_read_b128 v[140:143], v1 offset:11264
    v_min_i32 v11, s89, v11
    v_mfma_f32_16x16x32_bf16 a[28:31], v[108:111], v[180:183], a[28:31]
    v_mul_i32_i24 v10, -34048, v10
    s_waitcnt lgkmcnt(4)
    v_mfma_f32_16x16x32_bf16 a[32:35], v[112:115], v[176:179], a[32:35]
    ds_read_b128 v[144:147], v1 offset:12288
    v_mul_i32_i24 v11, -34048, v11
    v_mfma_f32_16x16x32_bf16 a[36:39], v[112:115], v[180:183], a[36:39]
    v_add_u32 v10, s25, v10
    v_add_u32 v11, s25, v11
    v_mfma_f32_16x16x32_bf16 a[40:43], v[116:119], v[176:179], a[40:43]
    ds_read_b128 v[148:151], v1 offset:13312
    v_add_u32 v11, 0x4000, v11
    v_mfma_f32_16x16x32_bf16 a[44:47], v[116:119], v[180:183], a[44:47]
    buffer_store_dwordx4 v[248:251], v1, s[12:15], s90 offen offset:2048 sc1
    v_mfma_f32_16x16x32_bf16 a[48:51], v[120:123], v[176:179], a[48:51]
    ds_read_b128 v[152:155], v1 offset:14336
    v_cmp_le_i32 vcc, 0, v9
    v_mfma_f32_16x16x32_bf16 a[52:55], v[120:123], v[180:183], a[52:55]
    s_nop 1
    v_cndmask_b32 v7, v7, v10, vcc
    v_mfma_f32_16x16x32_bf16 a[56:59], v[124:127], v[176:179], a[56:59]
    ds_read_b128 v[156:159], v1 offset:15360
    v_cmp_le_i32 vcc, 1, v9
    v_mfma_f32_16x16x32_bf16 a[60:63], v[124:127], v[180:183], a[60:63]
    s_nop 1
    s_waitcnt lgkmcnt(4)
    v_mfma_f32_16x16x32_bf16 a[64:67], v[128:131], v[176:179], a[64:67]
    ds_read_b128 v[96:99], v1 offset:16384
    v_cndmask_b32 v8, v8, v11, vcc
    v_mfma_f32_16x16x32_bf16 a[68:71], v[128:131], v[180:183], a[68:71]
    s_add_u32 s69, s34, s35
    s_add_u32 s69, s69, 1
    v_mfma_f32_16x16x32_bf16 a[72:75], v[132:135], v[176:179], a[72:75]
    ds_read_b128 v[100:103], v1 offset:17408
    s_mul_i32 s25, s30, 229376
    v_mfma_f32_16x16x32_bf16 a[76:79], v[132:135], v[180:183], a[76:79]
    s_add_u32 s25, s25, 39845888
    v_mfma_f32_16x16x32_bf16 a[80:83], v[136:139], v[176:179], a[80:83]
    ds_read_b128 v[104:107], v1 offset:18432
    v_subrev_u32 v9, s69, v2
    v_mfma_f32_16x16x32_bf16 a[84:87], v[136:139], v[180:183], a[84:87]
    v_min_i32 v10, 6, v9
    v_mfma_f32_16x16x32_bf16 a[88:91], v[140:143], v[176:179], a[88:91]
    ds_read_b128 v[108:111], v1 offset:19456
    v_mfma_f32_16x16x32_bf16 a[92:95], v[140:143], v[180:183], a[92:95]
    s_waitcnt lgkmcnt(4)
    v_mfma_f32_16x16x32_bf16 a[96:99], v[144:147], v[176:179], a[96:99]
    ds_read_b128 v[112:115], v1 offset:20480
    v_mfma_f32_16x16x32_bf16 a[100:103], v[144:147], v[180:183], a[100:103]
    buffer_store_dwordx4 v[252:255], v1, s[12:15], s90 offen offset:3072 sc1
    v_mfma_f32_16x16x32_bf16 a[104:107], v[148:151], v[176:179], a[104:107]
    ds_read_b128 v[116:119], v1 offset:21504
    v_subrev_u32 v11, 0, v9
    v_mfma_f32_16x16x32_bf16 a[108:111], v[148:151], v[180:183], a[108:111]
    v_max_i32 v11, 0, v11
    v_min_i32 v11, 6, v11
    v_mfma_f32_16x16x32_bf16 a[112:115], v[152:155], v[176:179], a[112:115]
    ds_read_b128 v[120:123], v1 offset:22528
    v_mul_i32_i24 v10, 32768, v10
    v_mfma_f32_16x16x32_bf16 a[116:119], v[152:155], v[180:183], a[116:119]
    v_mul_i32_i24 v11, 32768, v11
    v_add_u32 v10, s25, v10
    v_mfma_f32_16x16x32_bf16 a[120:123], v[156:159], v[176:179], a[120:123]
    ds_read_b128 v[124:127], v1 offset:23552
    v_add_u32 v11, s25, v11
    v_mfma_f32_16x16x32_bf16 a[124:127], v[156:159], v[180:183], a[124:127]
    v_add_u32 v11, 0x4000, v11
    s_waitcnt lgkmcnt(4)
    v_mfma_f32_16x16x32_bf16 a[0:3], v[96:99], v[184:187], a[0:3]
    ds_read_b128 v[128:131], v1 offset:24576
    v_cmp_le_i32 vcc, 0, v9
    v_mfma_f32_16x16x32_bf16 a[4:7], v[96:99], v[188:191], a[4:7]
    s_nop 1
    v_cndmask_b32 v7, v7, v10, vcc
    v_mfma_f32_16x16x32_bf16 a[8:11], v[100:103], v[184:187], a[8:11]
    ds_read_b128 v[132:135], v1 offset:25600
    v_cmp_le_i32 vcc, 0, v9
    v_mfma_f32_16x16x32_bf16 a[12:15], v[100:103], v[188:191], a[12:15]
    s_add_u32 s90, s91, 38144
    v_mfma_f32_16x16x32_bf16 a[16:19], v[104:107], v[184:187], a[16:19]
    ds_read_b128 v[136:139], v1 offset:26624
    v_mfma_f32_16x16x32_bf16 a[20:23], v[104:107], v[188:191], a[20:23]
    buffer_store_dwordx4 v[208:211], v1, s[12:15], s90 offen offset:0 sc1
    v_mfma_f32_16x16x32_bf16 a[24:27], v[108:111], v[184:187], a[24:27]
    ds_read_b128 v[140:143], v1 offset:27648
    s_nop 1
    v_mfma_f32_16x16x32_bf16 a[28:31], v[108:111], v[188:191], a[28:31]
    v_cndmask_b32 v8, v8, v11, vcc
    s_waitcnt lgkmcnt(4)
    v_mfma_f32_16x16x32_bf16 a[32:35], v[112:115], v[184:187], a[32:35]
    ds_read_b128 v[144:147], v1 offset:28672
    s_and_b32 s86, s68, 1
    v_mfma_f32_16x16x32_bf16 a[36:39], v[112:115], v[188:191], a[36:39]
    s_lshl_b32 s78, s67, 1
    s_add_u32 s78, s78, s86
    v_mfma_f32_16x16x32_bf16 a[40:43], v[116:119], v[184:187], a[40:43]
    ds_read_b128 v[148:151], v1 offset:29696
    s_lshr_b32 s79, s68, 1
    v_mfma_f32_16x16x32_bf16 a[44:47], v[116:119], v[188:191], a[44:47]
    s_add_u32 s69, s69, 7
    s_min_u32 s25, s79, 13
    v_mfma_f32_16x16x32_bf16 a[48:51], v[120:123], v[184:187], a[48:51]
    ds_read_b128 v[152:155], v1 offset:30720
    s_mul_i32 s25, s25, 229376
    v_mfma_f32_16x16x32_bf16 a[52:55], v[120:123], v[188:191], a[52:55]
    s_add_u32 s25, s25, 44040192
    v_mfma_f32_16x16x32_bf16 a[56:59], v[124:127], v[184:187], a[56:59]
    ds_read_b128 v[156:159], v1 offset:31744
    v_subrev_u32 v9, s69, v2
    v_mfma_f32_16x16x32_bf16 a[60:63], v[124:127], v[188:191], a[60:63]
    v_min_i32 v10, 6, v9
    s_waitcnt lgkmcnt(4)
    v_mfma_f32_16x16x32_bf16 a[64:67], v[128:131], v[184:187], a[64:67]
    ds_read_b128 v[96:99], v13 offset:0
    v_mfma_f32_16x16x32_bf16 a[68:71], v[128:131], v[188:191], a[68:71]
    buffer_store_dwordx4 v[212:215], v1, s[12:15], s90 offen offset:1024 sc1
    v_mfma_f32_16x16x32_bf16 a[72:75], v[132:135], v[184:187], a[72:75]
    ds_read_b128 v[100:103], v13 offset:1024
    v_subrev_u32 v11, 0, v9
    v_mfma_f32_16x16x32_bf16 a[76:79], v[132:135], v[188:191], a[76:79]
    v_max_i32 v11, 0, v11
    v_min_i32 v11, 6, v11
    v_mfma_f32_16x16x32_bf16 a[80:83], v[136:139], v[184:187], a[80:83]
    ds_read_b128 v[104:107], v13 offset:2048
    v_mul_i32_i24 v10, 32768, v10
    v_mfma_f32_16x16x32_bf16 a[84:87], v[136:139], v[188:191], a[84:87]
    v_mul_i32_i24 v11, 32768, v11
    v_mfma_f32_16x16x32_bf16 a[88:91], v[140:143], v[184:187], a[88:91]
    ds_read_b128 v[108:111], v13 offset:3072
    v_add_u32 v10, s25, v10
    v_mfma_f32_16x16x32_bf16 a[92:95], v[140:143], v[188:191], a[92:95]
    v_add_u32 v11, s25, v11
    s_waitcnt lgkmcnt(4)
    v_mfma_f32_16x16x32_bf16 a[96:99], v[144:147], v[184:187], a[96:99]
    ds_read_b128 v[112:115], v13 offset:4096
    v_add_u32 v11, 0x4000, v11
    v_mfma_f32_16x16x32_bf16 a[100:103], v[144:147], v[188:191], a[100:103]
    v_cmp_le_i32 vcc, 0, v9
    s_nop 1
    v_mfma_f32_16x16x32_bf16 a[104:107], v[148:151], v[184:187], a[104:107]
    ds_read_b128 v[116:119], v13 offset:5120
    v_cndmask_b32 v7, v7, v10, vcc
    v_mfma_f32_16x16x32_bf16 a[108:111], v[148:151], v[188:191], a[108:111]
    v_cmp_le_i32 vcc, 0, v9
    v_mfma_f32_16x16x32_bf16 a[112:115], v[152:155], v[184:187], a[112:115]
    ds_read_b128 v[120:123], v13 offset:6144
    v_mfma_f32_16x16x32_bf16 a[116:119], v[152:155], v[188:191], a[116:119]
    v_mfma_f32_16x16x32_bf16 a[120:123], v[156:159], v[184:187], a[120:123]
    ds_read_b128 v[124:127], v13 offset:7168
    v_mfma_f32_16x16x32_bf16 a[124:127], v[156:159], v[188:191], a[124:127]
    s_waitcnt lgkmcnt(4)
    s_waitcnt vmcnt(25)
    s_barrier
    v_mfma_f32_16x16x32_bf16 a[0:3], v[96:99], v[192:195], a[0:3]
    ds_read_b128 v[128:131], v13 offset:8192
    v_mfma_f32_16x16x32_bf16 a[4:7], v[96:99], v[196:199], a[4:7]
    s_add_u32 s39, s38, 163840
    s_add_u32 m0, s24, 0
    v_mfma_f32_16x16x32_bf16 a[8:11], v[100:103], v[192:195], a[8:11]
    ds_read_b128 v[132:135], v13 offset:9216
    v_mfma_f32_16x16x32_bf16 a[12:15], v[100:103], v[196:199], a[12:15]
    buffer_load_dwordx4 v4, s[12:15], s39 offen offset:0 lds
    v_mfma_f32_16x16x32_bf16 a[16:19], v[104:107], v[192:195], a[16:19]
    ds_read_b128 v[136:139], v13 offset:10240
    v_mfma_f32_16x16x32_bf16 a[20:23], v[104:107], v[196:199], a[20:23]
    v_mfma_f32_16x16x32_bf16 a[24:27], v[108:111], v[192:195], a[24:27]
    ds_read_b128 v[140:143], v13 offset:11264
    v_mfma_f32_16x16x32_bf16 a[28:31], v[108:111], v[196:199], a[28:31]
    s_waitcnt lgkmcnt(4)
    v_mfma_f32_16x16x32_bf16 a[32:35], v[112:115], v[192:195], a[32:35]
    ds_read_b128 v[144:147], v13 offset:12288
    v_mfma_f32_16x16x32_bf16 a[36:39], v[112:115], v[196:199], a[36:39]
    v_mfma_f32_16x16x32_bf16 a[40:43], v[116:119], v[192:195], a[40:43]
    ds_read_b128 v[148:151], v13 offset:13312
    v_mfma_f32_16x16x32_bf16 a[44:47], v[116:119], v[196:199], a[44:47]
    buffer_load_dwordx4 v4, s[12:15], s39 offen offset:1024 lds
    v_mfma_f32_16x16x32_bf16 a[48:51], v[120:123], v[192:195], a[48:51]
    ds_read_b128 v[152:155], v13 offset:14336
    v_mfma_f32_16x16x32_bf16 a[52:55], v[120:123], v[196:199], a[52:55]
    buffer_store_dwordx4 v[216:219], v1, s[12:15], s90 offen offset:2048 sc1
    v_mfma_f32_16x16x32_bf16 a[56:59], v[124:127], v[192:195], a[56:59]
    ds_read_b128 v[156:159], v13 offset:15360
    v_mfma_f32_16x16x32_bf16 a[60:63], v[124:127], v[196:199], a[60:63]
    s_waitcnt lgkmcnt(4)
    v_mfma_f32_16x16x32_bf16 a[64:67], v[128:131], v[192:195], a[64:67]
    ds_read_b128 v[96:99], v13 offset:16384
    v_mfma_f32_16x16x32_bf16 a[68:71], v[128:131], v[196:199], a[68:71]
    v_mfma_f32_16x16x32_bf16 a[72:75], v[132:135], v[192:195], a[72:75]
    ds_read_b128 v[100:103], v13 offset:17408
    v_mfma_f32_16x16x32_bf16 a[76:79], v[132:135], v[196:199], a[76:79]
    buffer_load_dwordx4 v4, s[12:15], s39 offen offset:2048 lds
    v_mfma_f32_16x16x32_bf16 a[80:83], v[136:139], v[192:195], a[80:83]
    ds_read_b128 v[104:107], v13 offset:18432
    v_mfma_f32_16x16x32_bf16 a[84:87], v[136:139], v[196:199], a[84:87]
    v_mfma_f32_16x16x32_bf16 a[88:91], v[140:143], v[192:195], a[88:91]
    ds_read_b128 v[108:111], v13 offset:19456
    v_mfma_f32_16x16x32_bf16 a[92:95], v[140:143], v[196:199], a[92:95]
    s_waitcnt lgkmcnt(4)
    v_mfma_f32_16x16x32_bf16 a[96:99], v[144:147], v[192:195], a[96:99]
    ds_read_b128 v[112:115], v13 offset:20480
    v_mfma_f32_16x16x32_bf16 a[100:103], v[144:147], v[196:199], a[100:103]
    buffer_store_dwordx4 v[220:223], v1, s[12:15], s90 offen offset:3072 sc1
    v_mfma_f32_16x16x32_bf16 a[104:107], v[148:151], v[192:195], a[104:107]
    ds_read_b128 v[116:119], v13 offset:21504
    v_mfma_f32_16x16x32_bf16 a[108:111], v[148:151], v[196:199], a[108:111]
    buffer_load_dwordx4 v4, s[12:15], s39 offen offset:3072 lds
    v_mfma_f32_16x16x32_bf16 a[112:115], v[152:155], v[192:195], a[112:115]
    ds_read_b128 v[120:123], v13 offset:22528
    v_accvgpr_read_b32 v16, a128
    v_mfma_f32_16x16x32_bf16 a[116:119], v[152:155], v[196:199], a[116:119]
    v_accvgpr_read_b32 v17, a129
    v_mfma_f32_16x16x32_bf16 a[120:123], v[156:159], v[192:195], a[120:123]
    ds_read_b128 v[124:127], v13 offset:23552
    v_accvgpr_read_b32 v18, a130
    v_mfma_f32_16x16x32_bf16 a[124:127], v[156:159], v[196:199], a[124:127]
    v_accvgpr_read_b32 v19, a131
    s_waitcnt lgkmcnt(4)
    v_mfma_f32_16x16x32_bf16 a[0:3], v[96:99], v[200:203], a[0:3]
    ds_read_b128 v[128:131], v13 offset:24576
    v_accvgpr_read_b32 v20, a160
    v_mfma_f32_16x16x32_bf16 a[4:7], v[96:99], v[204:207], a[4:7]
    s_add_u32 s39, s38, 180224
    s_add_u32 m0, s24, 16384
    v_mfma_f32_16x16x32_bf16 a[8:11], v[100:103], v[200:203], a[8:11]
    ds_read_b128 v[132:135], v13 offset:25600
    v_accvgpr_read_b32 v21, a161
    v_mfma_f32_16x16x32_bf16 a[12:15], v[100:103], v[204:207], a[12:15]
    buffer_load_dwordx4 v4, s[12:15], s39 offen offset:0 lds
    v_mfma_f32_16x16x32_bf16 a[16:19], v[104:107], v[200:203], a[16:19]
    ds_read_b128 v[136:139], v13 offset:26624
    v_accvgpr_read_b32 v22, a162
    v_mfma_f32_16x16x32_bf16 a[20:23], v[104:107], v[204:207], a[20:23]
    v_accvgpr_read_b32 v23, a163
    v_cvt_pk_bf16_f32 v224, v16, v17
    v_mfma_f32_16x16x32_bf16 a[24:27], v[108:111], v[200:203], a[24:27]
    ds_read_b128 v[140:143], v13 offset:27648
    v_cvt_pk_bf16_f32 v225, v18, v19
    v_mfma_f32_16x16x32_bf16 a[28:31], v[108:111], v[204:207], a[28:31]
    v_cvt_pk_bf16_f32 v226, v20, v21
    s_waitcnt lgkmcnt(4)
    v_mfma_f32_16x16x32_bf16 a[32:35], v[112:115], v[200:203], a[32:35]
    ds_read_b128 v[144:147], v13 offset:28672
    v_cvt_pk_bf16_f32 v227, v22, v23
    v_mfma_f32_16x16x32_bf16 a[36:39], v[112:115], v[204:207], a[36:39]
    s_add_u32 s90, s91, 68096
    v_mfma_f32_16x16x32_bf16 a[40:43], v[116:119], v[200:203], a[40:43]
    ds_read_b128 v[148:151], v13 offset:29696
    v_mfma_f32_16x16x32_bf16 a[44:47], v[116:119], v[204:207], a[44:47]
    buffer_load_dwordx4 v4, s[12:15], s39 offen offset:1024 lds
    v_mfma_f32_16x16x32_bf16 a[48:51], v[120:123], v[200:203], a[48:51]
    ds_read_b128 v[152:155], v13 offset:30720
    v_mfma_f32_16x16x32_bf16 a[52:55], v[120:123], v[204:207], a[52:55]
    buffer_store_dwordx4 v[224:227], v1, s[12:15], s90 offen offset:0 sc1
    v_mfma_f32_16x16x32_bf16 a[56:59], v[124:127], v[200:203], a[56:59]
    ds_read_b128 v[156:159], v13 offset:31744
    v_accvgpr_read_b32 v16, a132
    v_mfma_f32_16x16x32_bf16 a[60:63], v[124:127], v[204:207], a[60:63]
    v_accvgpr_read_b32 v17, a133
    s_waitcnt lgkmcnt(4)
    v_mfma_f32_16x16x32_bf16 a[64:67], v[128:131], v[200:203], a[64:67]
    ds_read_b128 v[96:99], v1 offset:32768
    v_accvgpr_read_b32 v18, a134
    v_mfma_f32_16x16x32_bf16 a[68:71], v[128:131], v[204:207], a[68:71]
    v_accvgpr_read_b32 v19, a135
    v_accvgpr_read_b32 v20, a164
    v_mfma_f32_16x16x32_bf16 a[72:75], v[132:135], v[200:203], a[72:75]
    ds_read_b128 v[100:103], v1 offset:33792
    v_accvgpr_read_b32 v21, a165
    v_mfma_f32_16x16x32_bf16 a[76:79], v[132:135], v[204:207], a[76:79]
    buffer_load_dwordx4 v4, s[12:15], s39 offen offset:2048 lds
    v_mfma_f32_16x16x32_bf16 a[80:83], v[136:139], v[200:203], a[80:83]
    ds_read_b128 v[104:107], v1 offset:34816
    v_accvgpr_read_b32 v22, a166
    v_mfma_f32_16x16x32_bf16 a[84:87], v[136:139], v[204:207], a[84:87]
    v_accvgpr_read_b32 v23, a167
    v_cvt_pk_bf16_f32 v228, v16, v17
    v_mfma_f32_16x16x32_bf16 a[88:91], v[140:143], v[200:203], a[88:91]
    ds_read_b128 v[108:111], v1 offset:35840
    v_cvt_pk_bf16_f32 v229, v18, v19
    v_mfma_f32_16x16x32_bf16 a[92:95], v[140:143], v[204:207], a[92:95]
    v_cvt_pk_bf16_f32 v230, v20, v21
    s_waitcnt lgkmcnt(4)
    v_mfma_f32_16x16x32_bf16 a[96:99], v[144:147], v[200:203], a[96:99]
    ds_read_b128 v[112:115], v1 offset:36864
    v_cvt_pk_bf16_f32 v231, v22, v23
    v_mfma_f32_16x16x32_bf16 a[100:103], v[144:147], v[204:207], a[100:103]
    v_mfma_f32_16x16x32_bf16 a[104:107], v[148:151], v[200:203], a[104:107]
    ds_read_b128 v[116:119], v1 offset:37888
    v_mfma_f32_16x16x32_bf16 a[108:111], v[148:151], v[204:207], a[108:111]
    buffer_load_dwordx4 v4, s[12:15], s39 offen offset:3072 lds
    v_mfma_f32_16x16x32_bf16 a[112:115], v[152:155], v[200:203], a[112:115]
    ds_read_b128 v[120:123], v1 offset:38912
    v_mfma_f32_16x16x32_bf16 a[116:119], v[152:155], v[204:207], a[116:119]
    buffer_store_dwordx4 v[228:231], v1, s[12:15], s90 offen offset:1024 sc1
    v_mfma_f32_16x16x32_bf16 a[120:123], v[156:159], v[200:203], a[120:123]
    ds_read_b128 v[124:127], v1 offset:39936
    v_mfma_f32_16x16x32_bf16 a[124:127], v[156:159], v[204:207], a[124:127]
    s_waitcnt lgkmcnt(4)
    s_waitcnt vmcnt(17)
    s_barrier
    v_mfma_f32_16x16x32_bf16 a[0:3], v[96:99], v[32:35], a[0:3]
    ds_read_b128 v[128:131], v1 offset:40960
    v_accvgpr_read_b32 v16, a136
    v_mfma_f32_16x16x32_bf16 a[4:7], v[96:99], v[36:39], a[4:7]
    s_add_u32 s39, s38, 196608
    s_add_u32 m0, s24, 131072
    v_mfma_f32_16x16x32_bf16 a[8:11], v[100:103], v[32:35], a[8:11]
    ds_read_b128 v[132:135], v1 offset:41984
    v_accvgpr_read_b32 v17, a137
    v_mfma_f32_16x16x32_bf16 a[12:15], v[100:103], v[36:39], a[12:15]
    buffer_load_dwordx4 v4, s[12:15], s39 offen offset:0 lds
    v_mfma_f32_16x16x32_bf16 a[16:19], v[104:107], v[32:35], a[16:19]
    ds_read_b128 v[136:139], v1 offset:43008
    v_accvgpr_read_b32 v18, a138
    v_mfma_f32_16x16x32_bf16 a[20:23], v[104:107], v[36:39], a[20:23]
    v_accvgpr_read_b32 v19, a139
    v_accvgpr_read_b32 v20, a168
    v_mfma_f32_16x16x32_bf16 a[24:27], v[108:111], v[32:35], a[24:27]
    ds_read_b128 v[140:143], v1 offset:44032
    v_accvgpr_read_b32 v21, a169
    v_mfma_f32_16x16x32_bf16 a[28:31], v[108:111], v[36:39], a[28:31]
    v_accvgpr_read_b32 v22, a170
    s_waitcnt lgkmcnt(4)
    v_mfma_f32_16x16x32_bf16 a[32:35], v[112:115], v[32:35], a[32:35]
    ds_read_b128 v[144:147], v1 offset:45056
    v_accvgpr_read_b32 v23, a171
    v_mfma_f32_16x16x32_bf16 a[36:39], v[112:115], v[36:39], a[36:39]
    v_cvt_pk_bf16_f32 v232, v16, v17
    v_cvt_pk_bf16_f32 v233, v18, v19
    v_mfma_f32_16x16x32_bf16 a[40:43], v[116:119], v[32:35], a[40:43]
    ds_read_b128 v[148:151], v1 offset:46080
    v_cvt_pk_bf16_f32 v234, v20, v21
    v_mfma_f32_16x16x32_bf16 a[44:47], v[116:119], v[36:39], a[44:47]
    buffer_load_dwordx4 v4, s[12:15], s39 offen offset:1024 lds
    v_mfma_f32_16x16x32_bf16 a[48:51], v[120:123], v[32:35], a[48:51]
    ds_read_b128 v[152:155], v1 offset:47104
    v_cvt_pk_bf16_f32 v235, v22, v23
    v_mfma_f32_16x16x32_bf16 a[52:55], v[120:123], v[36:39], a[52:55]
    buffer_store_dwordx4 v[232:235], v1, s[12:15], s90 offen offset:2048 sc1
    v_mfma_f32_16x16x32_bf16 a[56:59], v[124:127], v[32:35], a[56:59]
    ds_read_b128 v[156:159], v1 offset:48128
    v_accvgpr_read_b32 v16, a140
    v_mfma_f32_16x16x32_bf16 a[60:63], v[124:127], v[36:39], a[60:63]
    v_accvgpr_read_b32 v17, a141
    s_waitcnt lgkmcnt(4)
    v_mfma_f32_16x16x32_bf16 a[64:67], v[128:131], v[32:35], a[64:67]
    ds_read_b128 v[96:99], v1 offset:49152
    v_accvgpr_read_b32 v18, a142
    v_mfma_f32_16x16x32_bf16 a[68:71], v[128:131], v[36:39], a[68:71]
    v_accvgpr_read_b32 v19, a143
    v_accvgpr_read_b32 v20, a172
    v_mfma_f32_16x16x32_bf16 a[72:75], v[132:135], v[32:35], a[72:75]
    ds_read_b128 v[100:103], v1 offset:50176
    v_accvgpr_read_b32 v21, a173
    v_mfma_f32_16x16x32_bf16 a[76:79], v[132:135], v[36:39], a[76:79]
    buffer_load_dwordx4 v4, s[12:15], s39 offen offset:2048 lds
    v_mfma_f32_16x16x32_bf16 a[80:83], v[136:139], v[32:35], a[80:83]
    ds_read_b128 v[104:107], v1 offset:51200
    v_accvgpr_read_b32 v22, a174
    v_mfma_f32_16x16x32_bf16 a[84:87], v[136:139], v[36:39], a[84:87]
    v_accvgpr_read_b32 v23, a175
    v_cvt_pk_bf16_f32 v236, v16, v17
    v_mfma_f32_16x16x32_bf16 a[88:91], v[140:143], v[32:35], a[88:91]
    ds_read_b128 v[108:111], v1 offset:52224
    v_cvt_pk_bf16_f32 v237, v18, v19
    v_mfma_f32_16x16x32_bf16 a[92:95], v[140:143], v[36:39], a[92:95]
    v_cvt_pk_bf16_f32 v238, v20, v21
    s_waitcnt lgkmcnt(4)
    v_mfma_f32_16x16x32_bf16 a[96:99], v[144:147], v[32:35], a[96:99]
    ds_read_b128 v[112:115], v1 offset:53248
    v_cvt_pk_bf16_f32 v239, v22, v23
    v_mfma_f32_16x16x32_bf16 a[100:103], v[144:147], v[36:39], a[100:103]
    buffer_store_dwordx4 v[236:239], v1, s[12:15], s90 offen offset:3072 sc1
    v_mfma_f32_16x16x32_bf16 a[104:107], v[148:151], v[32:35], a[104:107]
    ds_read_b128 v[116:119], v1 offset:54272
    v_accvgpr_read_b32 v16, a144
    v_mfma_f32_16x16x32_bf16 a[108:111], v[148:151], v[36:39], a[108:111]
    buffer_load_dwordx4 v4, s[12:15], s39 offen offset:3072 lds
    v_mfma_f32_16x16x32_bf16 a[112:115], v[152:155], v[32:35], a[112:115]
    ds_read_b128 v[120:123], v1 offset:55296
    v_accvgpr_read_b32 v17, a145
    v_mfma_f32_16x16x32_bf16 a[116:119], v[152:155], v[36:39], a[116:119]
    v_accvgpr_read_b32 v18, a146
    v_accvgpr_read_b32 v19, a147
    v_mfma_f32_16x16x32_bf16 a[120:123], v[156:159], v[32:35], a[120:123]
    ds_read_b128 v[124:127], v1 offset:56320
    v_accvgpr_read_b32 v20, a176
    v_mfma_f32_16x16x32_bf16 a[124:127], v[156:159], v[36:39], a[124:127]
    v_accvgpr_read_b32 v21, a177
    s_waitcnt lgkmcnt(4)
    v_mfma_f32_16x16x32_bf16 a[0:3], v[96:99], v[40:43], a[0:3]
    ds_read_b128 v[128:131], v1 offset:57344
    v_accvgpr_read_b32 v22, a178
    v_mfma_f32_16x16x32_bf16 a[4:7], v[96:99], v[44:47], a[4:7]
    s_add_u32 s39, s38, 212992
    s_add_u32 m0, s24, 147456
    v_mfma_f32_16x16x32_bf16 a[8:11], v[100:103], v[40:43], a[8:11]
    ds_read_b128 v[132:135], v1 offset:58368
    v_accvgpr_read_b32 v23, a179
    v_mfma_f32_16x16x32_bf16 a[12:15], v[100:103], v[44:47], a[12:15]
    buffer_load_dwordx4 v4, s[12:15], s39 offen offset:0 lds
    v_mfma_f32_16x16x32_bf16 a[16:19], v[104:107], v[40:43], a[16:19]
    ds_read_b128 v[136:139], v1 offset:59392
    v_cvt_pk_bf16_f32 v240, v16, v17
    v_mfma_f32_16x16x32_bf16 a[20:23], v[104:107], v[44:47], a[20:23]
    v_cvt_pk_bf16_f32 v241, v18, v19
    v_cvt_pk_bf16_f32 v242, v20, v21
    v_mfma_f32_16x16x32_bf16 a[24:27], v[108:111], v[40:43], a[24:27]
    ds_read_b128 v[140:143], v1 offset:60416
    v_cvt_pk_bf16_f32 v243, v22, v23
    v_mfma_f32_16x16x32_bf16 a[28:31], v[108:111], v[44:47], a[28:31]
    s_add_u32 s90, s91, 72192
    s_waitcnt lgkmcnt(4)
    v_mfma_f32_16x16x32_bf16 a[32:35], v[112:115], v[40:43], a[32:35]
    ds_read_b128 v[144:147], v1 offset:61440
    v_mfma_f32_16x16x32_bf16 a[36:39], v[112:115], v[44:47], a[36:39]
    buffer_store_dwordx4 v[240:243], v1, s[12:15], s90 offen offset:0 sc1
    v_mfma_f32_16x16x32_bf16 a[40:43], v[116:119], v[40:43], a[40:43]
    ds_read_b128 v[148:151], v1 offset:62464
    v_accvgpr_read_b32 v16, a148
    v_mfma_f32_16x16x32_bf16 a[44:47], v[116:119], v[44:47], a[44:47]
    buffer_load_dwordx4 v4, s[12:15], s39 offen offset:1024 lds
    v_mfma_f32_16x16x32_bf16 a[48:51], v[120:123], v[40:43], a[48:51]
    ds_read_b128 v[152:155], v1 offset:63488
    v_accvgpr_read_b32 v17, a149
    v_mfma_f32_16x16x32_bf16 a[52:55], v[120:123], v[44:47], a[52:55]
    v_accvgpr_read_b32 v18, a150
    v_accvgpr_read_b32 v19, a151
    v_mfma_f32_16x16x32_bf16 a[56:59], v[124:127], v[40:43], a[56:59]
    ds_read_b128 v[156:159], v1 offset:64512
    v_accvgpr_read_b32 v20, a180
    v_mfma_f32_16x16x32_bf16 a[60:63], v[124:127], v[44:47], a[60:63]
    v_accvgpr_read_b32 v21, a181
    s_waitcnt lgkmcnt(4)
    v_mfma_f32_16x16x32_bf16 a[64:67], v[128:131], v[40:43], a[64:67]
    ds_read_b128 v[96:99], v6 offset:0
    v_accvgpr_read_b32 v22, a182
    v_mfma_f32_16x16x32_bf16 a[68:71], v[128:131], v[44:47], a[68:71]
    v_accvgpr_read_b32 v23, a183
    v_cvt_pk_bf16_f32 v244, v16, v17
    v_mfma_f32_16x16x32_bf16 a[72:75], v[132:135], v[40:43], a[72:75]
    ds_read_b128 v[100:103], v6 offset:1024
    v_cvt_pk_bf16_f32 v245, v18, v19
    v_mfma_f32_16x16x32_bf16 a[76:79], v[132:135], v[44:47], a[76:79]
    buffer_load_dwordx4 v4, s[12:15], s39 offen offset:2048 lds
    v_mfma_f32_16x16x32_bf16 a[80:83], v[136:139], v[40:43], a[80:83]
    ds_read_b128 v[104:107], v6 offset:2048
    v_cvt_pk_bf16_f32 v246, v20, v21
    v_mfma_f32_16x16x32_bf16 a[84:87], v[136:139], v[44:47], a[84:87]
    v_cvt_pk_bf16_f32 v247, v22, v23
    v_mfma_f32_16x16x32_bf16 a[88:91], v[140:143], v[40:43], a[88:91]
    ds_read_b128 v[108:111], v6 offset:3072
    v_mfma_f32_16x16x32_bf16 a[92:95], v[140:143], v[44:47], a[92:95]
    s_waitcnt lgkmcnt(4)
    v_mfma_f32_16x16x32_bf16 a[96:99], v[144:147], v[40:43], a[96:99]
    ds_read_b128 v[112:115], v6 offset:4096
    v_mfma_f32_16x16x32_bf16 a[100:103], v[144:147], v[44:47], a[100:103]
    buffer_store_dwordx4 v[244:247], v1, s[12:15], s90 offen offset:1024 sc1
    v_mfma_f32_16x16x32_bf16 a[104:107], v[148:151], v[40:43], a[104:107]
    ds_read_b128 v[116:119], v6 offset:5120
    v_accvgpr_read_b32 v16, a152
    v_mfma_f32_16x16x32_bf16 a[108:111], v[148:151], v[44:47], a[108:111]
    buffer_load_dwordx4 v4, s[12:15], s39 offen offset:3072 lds
    v_mfma_f32_16x16x32_bf16 a[112:115], v[152:155], v[40:43], a[112:115]
    ds_read_b128 v[120:123], v6 offset:6144
    v_accvgpr_read_b32 v17, a153
    v_mfma_f32_16x16x32_bf16 a[116:119], v[152:155], v[44:47], a[116:119]
    v_accvgpr_read_b32 v18, a154
    v_accvgpr_read_b32 v19, a155
    v_mfma_f32_16x16x32_bf16 a[120:123], v[156:159], v[40:43], a[120:123]
    ds_read_b128 v[124:127], v6 offset:7168
    v_accvgpr_read_b32 v20, a184
    v_accvgpr_read_b32 v21, a185
    v_accvgpr_read_b32 v22, a186
    v_accvgpr_read_b32 v23, a187
    v_cvt_pk_bf16_f32 v248, v16, v17
    v_cvt_pk_bf16_f32 v249, v18, v19
    v_cvt_pk_bf16_f32 v250, v20, v21
    v_cvt_pk_bf16_f32 v251, v22, v23
    buffer_store_dwordx4 v[248:251], v1, s[12:15], s90 offen offset:2048 sc1
    v_mfma_f32_16x16x32_bf16 a[124:127], v[156:159], v[44:47], a[124:127]
    s_waitcnt lgkmcnt(4)
    v_mfma_f32_16x16x32_bf16 a[0:3], v[96:99], v[48:51], a[0:3]
    ds_read_b128 v[128:131], v6 offset:8192
    v_accvgpr_read_b32 v16, a156
    v_mfma_f32_16x16x32_bf16 a[4:7], v[96:99], v[52:55], a[4:7]
    v_accvgpr_read_b32 v17, a157
    v_accvgpr_read_b32 v18, a158
    v_mfma_f32_16x16x32_bf16 a[8:11], v[100:103], v[48:51], a[8:11]
    ds_read_b128 v[132:135], v6 offset:9216
    v_accvgpr_read_b32 v19, a159
    v_mfma_f32_16x16x32_bf16 a[12:15], v[100:103], v[52:55], a[12:15]
    v_accvgpr_read_b32 v20, a188
    v_accvgpr_read_b32 v21, a189
    v_mfma_f32_16x16x32_bf16 a[16:19], v[104:107], v[48:51], a[16:19]
    ds_read_b128 v[136:139], v6 offset:10240
    v_accvgpr_read_b32 v22, a190
    v_mfma_f32_16x16x32_bf16 a[20:23], v[104:107], v[52:55], a[20:23]
    v_accvgpr_read_b32 v23, a191
    v_mfma_f32_16x16x32_bf16 a[24:27], v[108:111], v[48:51], a[24:27]
    ds_read_b128 v[140:143], v6 offset:11264
    v_cvt_pk_bf16_f32 v252, v16, v17
    v_mfma_f32_16x16x32_bf16 a[28:31], v[108:111], v[52:55], a[28:31]
    v_cvt_pk_bf16_f32 v253, v18, v19
    s_waitcnt lgkmcnt(4)
    v_mfma_f32_16x16x32_bf16 a[32:35], v[112:115], v[48:51], a[32:35]
    ds_read_b128 v[144:147], v6 offset:12288
    v_cvt_pk_bf16_f32 v254, v20, v21
    v_mfma_f32_16x16x32_bf16 a[36:39], v[112:115], v[52:55], a[36:39]
    v_cvt_pk_bf16_f32 v255, v22, v23
    v_mfma_f32_16x16x32_bf16 a[40:43], v[116:119], v[48:51], a[40:43]
    ds_read_b128 v[148:151], v6 offset:13312
    v_mfma_f32_16x16x32_bf16 a[44:47], v[116:119], v[52:55], a[44:47]
    buffer_store_dwordx4 v[252:255], v1, s[12:15], s90 offen offset:3072 sc1
    v_mfma_f32_16x16x32_bf16 a[48:51], v[120:123], v[48:51], a[48:51]
    ds_read_b128 v[152:155], v6 offset:14336
    v_accvgpr_read_b32 v16, a192
    v_mfma_f32_16x16x32_bf16 a[52:55], v[120:123], v[52:55], a[52:55]
    v_accvgpr_read_b32 v17, a193
    v_mfma_f32_16x16x32_bf16 a[56:59], v[124:127], v[48:51], a[56:59]
    ds_read_b128 v[156:159], v6 offset:15360
    v_accvgpr_read_b32 v18, a194
    v_mfma_f32_16x16x32_bf16 a[60:63], v[124:127], v[52:55], a[60:63]
    s_waitcnt lgkmcnt(4)
    v_mfma_f32_16x16x32_bf16 a[64:67], v[128:131], v[48:51], a[64:67]
    ds_read_b128 v[96:99], v6 offset:16384
    v_accvgpr_read_b32 v19, a195
    v_mfma_f32_16x16x32_bf16 a[68:71], v[128:131], v[52:55], a[68:71]
    v_accvgpr_read_b32 v20, a224
    v_mfma_f32_16x16x32_bf16 a[72:75], v[132:135], v[48:51], a[72:75]
    ds_read_b128 v[100:103], v6 offset:17408
    v_accvgpr_read_b32 v21, a225
    v_mfma_f32_16x16x32_bf16 a[76:79], v[132:135], v[52:55], a[76:79]
    v_accvgpr_read_b32 v22, a226
    v_mfma_f32_16x16x32_bf16 a[80:83], v[136:139], v[48:51], a[80:83]
    ds_read_b128 v[104:107], v6 offset:18432
    v_accvgpr_read_b32 v23, a227
    v_mfma_f32_16x16x32_bf16 a[84:87], v[136:139], v[52:55], a[84:87]
    v_cvt_pk_bf16_f32 v208, v16, v17
    v_mfma_f32_16x16x32_bf16 a[88:91], v[140:143], v[48:51], a[88:91]
    ds_read_b128 v[108:111], v6 offset:19456
    v_cvt_pk_bf16_f32 v209, v18, v19
    v_mfma_f32_16x16x32_bf16 a[92:95], v[140:143], v[52:55], a[92:95]
    v_cvt_pk_bf16_f32 v210, v20, v21
    s_waitcnt lgkmcnt(4)
    v_mfma_f32_16x16x32_bf16 a[96:99], v[144:147], v[48:51], a[96:99]
    ds_read_b128 v[112:115], v6 offset:20480
    v_cvt_pk_bf16_f32 v211, v22, v23
    v_mfma_f32_16x16x32_bf16 a[100:103], v[144:147], v[52:55], a[100:103]
    s_add_u32 s90, s91, 102144
    v_mfma_f32_16x16x32_bf16 a[104:107], v[148:151], v[48:51], a[104:107]
    ds_read_b128 v[116:119], v6 offset:21504
    v_mfma_f32_16x16x32_bf16 a[108:111], v[148:151], v[52:55], a[108:111]
    buffer_store_dwordx4 v[208:211], v1, s[12:15], s90 offen offset:0 sc1
    v_mfma_f32_16x16x32_bf16 a[112:115], v[152:155], v[48:51], a[112:115]
    ds_read_b128 v[120:123], v6 offset:22528
    v_mfma_f32_16x16x32_bf16 a[116:119], v[152:155], v[52:55], a[116:119]
    v_accvgpr_read_b32 v16, a196
    v_mfma_f32_16x16x32_bf16 a[120:123], v[156:159], v[48:51], a[120:123]
    ds_read_b128 v[124:127], v6 offset:23552
    v_accvgpr_read_b32 v17, a197
    v_mfma_f32_16x16x32_bf16 a[124:127], v[156:159], v[52:55], a[124:127]
    v_accvgpr_read_b32 v18, a198
    s_waitcnt lgkmcnt(4)
    v_mfma_f32_16x16x32_bf16 a[0:3], v[96:99], v[56:59], a[0:3]
    ds_read_b128 v[128:131], v6 offset:24576
    v_accvgpr_read_b32 v19, a199
    v_mfma_f32_16x16x32_bf16 a[4:7], v[96:99], v[60:63], a[4:7]
    v_accvgpr_read_b32 v20, a228
    v_mfma_f32_16x16x32_bf16 a[8:11], v[100:103], v[56:59], a[8:11]
    ds_read_b128 v[132:135], v6 offset:25600
    v_accvgpr_read_b32 v21, a229
    v_mfma_f32_16x16x32_bf16 a[12:15], v[100:103], v[60:63], a[12:15]
    v_accvgpr_read_b32 v22, a230
    v_mfma_f32_16x16x32_bf16 a[16:19], v[104:107], v[56:59], a[16:19]
    ds_read_b128 v[136:139], v6 offset:26624
    v_mfma_f32_16x16x32_bf16 a[20:23], v[104:107], v[60:63], a[20:23]
    v_accvgpr_read_b32 v23, a231
    v_mfma_f32_16x16x32_bf16 a[24:27], v[108:111], v[56:59], a[24:27]
    ds_read_b128 v[140:143], v6 offset:27648
    v_cvt_pk_bf16_f32 v212, v16, v17
    v_mfma_f32_16x16x32_bf16 a[28:31], v[108:111], v[60:63], a[28:31]
    v_cvt_pk_bf16_f32 v213, v18, v19
    s_waitcnt lgkmcnt(4)
    v_mfma_f32_16x16x32_bf16 a[32:35], v[112:115], v[56:59], a[32:35]
    ds_read_b128 v[144:147], v6 offset:28672
    v_cvt_pk_bf16_f32 v214, v20, v21
    v_mfma_f32_16x16x32_bf16 a[36:39], v[112:115], v[60:63], a[36:39]
    v_cvt_pk_bf16_f32 v215, v22, v23
    v_mfma_f32_16x16x32_bf16 a[40:43], v[116:119], v[56:59], a[40:43]
    ds_read_b128 v[148:151], v6 offset:29696
    v_mfma_f32_16x16x32_bf16 a[44:47], v[116:119], v[60:63], a[44:47]
    buffer_store_dwordx4 v[212:215], v1, s[12:15], s90 offen offset:1024 sc1
    v_mfma_f32_16x16x32_bf16 a[48:51], v[120:123], v[56:59], a[48:51]
    ds_read_b128 v[152:155], v6 offset:30720
    v_accvgpr_read_b32 v16, a200
    v_mfma_f32_16x16x32_bf16 a[52:55], v[120:123], v[60:63], a[52:55]
    v_accvgpr_read_b32 v17, a201
    v_mfma_f32_16x16x32_bf16 a[56:59], v[124:127], v[56:59], a[56:59]
    ds_read_b128 v[156:159], v6 offset:31744
    v_accvgpr_read_b32 v18, a202
    v_mfma_f32_16x16x32_bf16 a[60:63], v[124:127], v[60:63], a[60:63]
    s_waitcnt vmcnt(17) lgkmcnt(4)
    s_barrier
    v_mfma_f32_16x16x32_bf16 a[64:67], v[128:131], v[56:59], a[64:67]
    ds_read_b128 v[96:99], v1 offset:0
    v_accvgpr_read_b32 v19, a203
    v_mfma_f32_16x16x32_bf16 a[68:71], v[128:131], v[60:63], a[68:71]
    buffer_store_dword v14, v30, s[12:15], s93 offen offset:4
    v_mfma_f32_16x16x32_bf16 a[72:75], v[132:135], v[56:59], a[72:75]
    ds_read_b128 v[100:103], v1 offset:1024
    v_accvgpr_read_b32 v20, a232
    v_mfma_f32_16x16x32_bf16 a[76:79], v[132:135], v[60:63], a[76:79]
    buffer_store_dword v14, v29, s[12:15], s93 offen offset:4 sc1
    v_mfma_f32_16x16x32_bf16 a[80:83], v[136:139], v[56:59], a[80:83]
    ds_read_b128 v[104:107], v1 offset:2048
    v_accvgpr_read_b32 v21, a233
    v_mfma_f32_16x16x32_bf16 a[84:87], v[136:139], v[60:63], a[84:87]
    v_accvgpr_read_b32 v22, a234
    v_accvgpr_read_b32 v23, a235
    v_mfma_f32_16x16x32_bf16 a[88:91], v[140:143], v[56:59], a[88:91]
    ds_read_b128 v[108:111], v1 offset:3072
    v_cvt_pk_bf16_f32 v216, v16, v17
    v_mfma_f32_16x16x32_bf16 a[92:95], v[140:143], v[60:63], a[92:95]
    v_cvt_pk_bf16_f32 v217, v18, v19
    s_waitcnt lgkmcnt(4)
    v_mfma_f32_16x16x32_bf16 a[96:99], v[144:147], v[56:59], a[96:99]
    ds_read_b128 v[112:115], v1 offset:4096
    v_cvt_pk_bf16_f32 v218, v20, v21
    v_mfma_f32_16x16x32_bf16 a[100:103], v[144:147], v[60:63], a[100:103]
    v_cvt_pk_bf16_f32 v219, v22, v23
    v_mfma_f32_16x16x32_bf16 a[104:107], v[148:151], v[56:59], a[104:107]
    ds_read_b128 v[116:119], v1 offset:5120
    v_mfma_f32_16x16x32_bf16 a[108:111], v[148:151], v[60:63], a[108:111]
    buffer_store_dwordx4 v[216:219], v1, s[12:15], s90 offen offset:2048 sc1
    v_mfma_f32_16x16x32_bf16 a[112:115], v[152:155], v[56:59], a[112:115]
    ds_read_b128 v[120:123], v1 offset:6144
    v_mfma_f32_16x16x32_bf16 a[116:119], v[152:155], v[60:63], a[116:119]
    v_mfma_f32_16x16x32_bf16 a[120:123], v[156:159], v[56:59], a[120:123]
    ds_read_b128 v[124:127], v1 offset:7168
    v_mfma_f32_16x16x32_bf16 a[124:127], v[156:159], v[60:63], a[124:127]
    s_waitcnt lgkmcnt(4)
    v_mfma_f32_16x16x32_bf16 a[0:3], v[96:99], v[64:67], a[0:3]
    ds_read_b128 v[128:131], v1 offset:8192
    v_accvgpr_read_b32 v16, a204
    v_mfma_f32_16x16x32_bf16 a[4:7], v[96:99], v[68:71], a[4:7]
    v_accvgpr_read_b32 v17, a205
    v_accvgpr_read_b32 v18, a206
    v_mfma_f32_16x16x32_bf16 a[8:11], v[100:103], v[64:67], a[8:11]
    ds_read_b128 v[132:135], v1 offset:9216
    v_accvgpr_read_b32 v19, a207
    v_mfma_f32_16x16x32_bf16 a[12:15], v[100:103], v[68:71], a[12:15]
    v_accvgpr_read_b32 v20, a236
    v_accvgpr_read_b32 v21, a237
    v_mfma_f32_16x16x32_bf16 a[16:19], v[104:107], v[64:67], a[16:19]
    ds_read_b128 v[136:139], v1 offset:10240
    v_accvgpr_read_b32 v22, a238
    v_mfma_f32_16x16x32_bf16 a[20:23], v[104:107], v[68:71], a[20:23]
    v_accvgpr_read_b32 v23, a239
    v_cvt_pk_bf16_f32 v220, v16, v17
    v_mfma_f32_16x16x32_bf16 a[24:27], v[108:111], v[64:67], a[24:27]
    ds_read_b128 v[140:143], v1 offset:11264
    v_cvt_pk_bf16_f32 v221, v18, v19
    v_mfma_f32_16x16x32_bf16 a[28:31], v[108:111], v[68:71], a[28:31]
    v_cvt_pk_bf16_f32 v222, v20, v21
    s_waitcnt lgkmcnt(4)
    v_mfma_f32_16x16x32_bf16 a[32:35], v[112:115], v[64:67], a[32:35]
    ds_read_b128 v[144:147], v1 offset:12288
    v_cvt_pk_bf16_f32 v223, v22, v23
    v_mfma_f32_16x16x32_bf16 a[36:39], v[112:115], v[68:71], a[36:39]
    buffer_store_dwordx4 v[220:223], v1, s[12:15], s90 offen offset:3072 sc1
    v_mfma_f32_16x16x32_bf16 a[40:43], v[116:119], v[64:67], a[40:43]
    ds_read_b128 v[148:151], v1 offset:13312
    v_accvgpr_read_b32 v16, a208
    v_mfma_f32_16x16x32_bf16 a[44:47], v[116:119], v[68:71], a[44:47]
    v_accvgpr_read_b32 v17, a209
    v_accvgpr_read_b32 v18, a210
    v_mfma_f32_16x16x32_bf16 a[48:51], v[120:123], v[64:67], a[48:51]
    ds_read_b128 v[152:155], v1 offset:14336
    v_accvgpr_read_b32 v19, a211
    v_mfma_f32_16x16x32_bf16 a[52:55], v[120:123], v[68:71], a[52:55]
    v_accvgpr_read_b32 v20, a240
    v_mfma_f32_16x16x32_bf16 a[56:59], v[124:127], v[64:67], a[56:59]
    ds_read_b128 v[156:159], v1 offset:15360
    v_accvgpr_read_b32 v21, a241
    v_mfma_f32_16x16x32_bf16 a[60:63], v[124:127], v[68:71], a[60:63]
    v_accvgpr_read_b32 v22, a242
    s_waitcnt lgkmcnt(4)
    v_mfma_f32_16x16x32_bf16 a[64:67], v[128:131], v[64:67], a[64:67]
    ds_read_b128 v[96:99], v1 offset:16384
    v_accvgpr_read_b32 v23, a243
    v_mfma_f32_16x16x32_bf16 a[68:71], v[128:131], v[68:71], a[68:71]
    v_cvt_pk_bf16_f32 v224, v16, v17
    v_cvt_pk_bf16_f32 v225, v18, v19
    v_mfma_f32_16x16x32_bf16 a[72:75], v[132:135], v[64:67], a[72:75]
    ds_read_b128 v[100:103], v1 offset:17408
    v_cvt_pk_bf16_f32 v226, v20, v21
    v_mfma_f32_16x16x32_bf16 a[76:79], v[132:135], v[68:71], a[76:79]
    v_cvt_pk_bf16_f32 v227, v22, v23
    v_mfma_f32_16x16x32_bf16 a[80:83], v[136:139], v[64:67], a[80:83]
    ds_read_b128 v[104:107], v1 offset:18432
    s_add_u32 s90, s91, 106240
    v_mfma_f32_16x16x32_bf16 a[84:87], v[136:139], v[68:71], a[84:87]
    buffer_store_dwordx4 v[224:227], v1, s[12:15], s90 offen offset:0 sc1
    v_mfma_f32_16x16x32_bf16 a[88:91], v[140:143], v[64:67], a[88:91]
    ds_read_b128 v[108:111], v1 offset:19456
    v_accvgpr_read_b32 v16, a212
    v_mfma_f32_16x16x32_bf16 a[92:95], v[140:143], v[68:71], a[92:95]
    v_accvgpr_read_b32 v17, a213
    s_waitcnt lgkmcnt(4)
    v_mfma_f32_16x16x32_bf16 a[96:99], v[144:147], v[64:67], a[96:99]
    ds_read_b128 v[112:115], v1 offset:20480
    v_accvgpr_read_b32 v18, a214
    v_mfma_f32_16x16x32_bf16 a[100:103], v[144:147], v[68:71], a[100:103]
    v_accvgpr_read_b32 v19, a215
    v_mfma_f32_16x16x32_bf16 a[104:107], v[148:151], v[64:67], a[104:107]
    ds_read_b128 v[116:119], v1 offset:21504
    v_accvgpr_read_b32 v20, a244
    v_mfma_f32_16x16x32_bf16 a[108:111], v[148:151], v[68:71], a[108:111]
    v_accvgpr_read_b32 v21, a245
    v_mfma_f32_16x16x32_bf16 a[112:115], v[152:155], v[64:67], a[112:115]
    ds_read_b128 v[120:123], v1 offset:22528
    v_accvgpr_read_b32 v22, a246
    v_mfma_f32_16x16x32_bf16 a[116:119], v[152:155], v[68:71], a[116:119]
    v_accvgpr_read_b32 v23, a247
    v_mfma_f32_16x16x32_bf16 a[120:123], v[156:159], v[64:67], a[120:123]
    ds_read_b128 v[124:127], v1 offset:23552
    v_cvt_pk_bf16_f32 v228, v16, v17
    v_mfma_f32_16x16x32_bf16 a[124:127], v[156:159], v[68:71], a[124:127]
    v_cvt_pk_bf16_f32 v229, v18, v19
    s_waitcnt lgkmcnt(4)
    v_mfma_f32_16x16x32_bf16 a[0:3], v[96:99], v[72:75], a[0:3]
    ds_read_b128 v[128:131], v1 offset:24576
    v_cvt_pk_bf16_f32 v230, v20, v21
    v_mfma_f32_16x16x32_bf16 a[4:7], v[96:99], v[76:79], a[4:7]
    v_cvt_pk_bf16_f32 v231, v22, v23
    v_mfma_f32_16x16x32_bf16 a[8:11], v[100:103], v[72:75], a[8:11]
    ds_read_b128 v[132:135], v1 offset:25600
    v_mfma_f32_16x16x32_bf16 a[12:15], v[100:103], v[76:79], a[12:15]
    buffer_store_dwordx4 v[228:231], v1, s[12:15], s90 offen offset:1024 sc1
    v_mfma_f32_16x16x32_bf16 a[16:19], v[104:107], v[72:75], a[16:19]
    ds_read_b128 v[136:139], v1 offset:26624
    v_accvgpr_read_b32 v16, a216
    v_mfma_f32_16x16x32_bf16 a[20:23], v[104:107], v[76:79], a[20:23]
    v_accvgpr_read_b32 v17, a217
    v_accvgpr_read_b32 v18, a218
    v_mfma_f32_16x16x32_bf16 a[24:27], v[108:111], v[72:75], a[24:27]
    ds_read_b128 v[140:143], v1 offset:27648
    v_accvgpr_read_b32 v19, a219
    v_mfma_f32_16x16x32_bf16 a[28:31], v[108:111], v[76:79], a[28:31]
    v_accvgpr_read_b32 v20, a248
    s_waitcnt lgkmcnt(4)
    v_mfma_f32_16x16x32_bf16 a[32:35], v[112:115], v[72:75], a[32:35]
    ds_read_b128 v[144:147], v1 offset:28672
    v_accvgpr_read_b32 v21, a249
    v_mfma_f32_16x16x32_bf16 a[36:39], v[112:115], v[76:79], a[36:39]
    v_accvgpr_read_b32 v22, a250
    v_accvgpr_read_b32 v23, a251
    v_mfma_f32_16x16x32_bf16 a[40:43], v[116:119], v[72:75], a[40:43]
    ds_read_b128 v[148:151], v1 offset:29696
    v_cvt_pk_bf16_f32 v232, v16, v17
    v_mfma_f32_16x16x32_bf16 a[44:47], v[116:119], v[76:79], a[44:47]
    v_cvt_pk_bf16_f32 v233, v18, v19
    v_mfma_f32_16x16x32_bf16 a[48:51], v[120:123], v[72:75], a[48:51]
    ds_read_b128 v[152:155], v1 offset:30720
    v_cvt_pk_bf16_f32 v234, v20, v21
    v_mfma_f32_16x16x32_bf16 a[52:55], v[120:123], v[76:79], a[52:55]
    v_cvt_pk_bf16_f32 v235, v22, v23
    v_mfma_f32_16x16x32_bf16 a[56:59], v[124:127], v[72:75], a[56:59]
    ds_read_b128 v[156:159], v1 offset:31744
    v_mfma_f32_16x16x32_bf16 a[60:63], v[124:127], v[76:79], a[60:63]
    s_waitcnt vmcnt(10) lgkmcnt(4)
    s_barrier
    v_mfma_f32_16x16x32_bf16 a[64:67], v[128:131], v[72:75], a[64:67]
    ds_read_b128 v[96:99], v13 offset:0
    v_mfma_f32_16x16x32_bf16 a[68:71], v[128:131], v[76:79], a[68:71]
    buffer_store_dwordx4 v[232:235], v1, s[12:15], s90 offen offset:2048 sc1
    v_mfma_f32_16x16x32_bf16 a[72:75], v[132:135], v[72:75], a[72:75]
    ds_read_b128 v[100:103], v13 offset:1024
    v_accvgpr_read_b32 v16, a220
    v_mfma_f32_16x16x32_bf16 a[76:79], v[132:135], v[76:79], a[76:79]
    v_accvgpr_read_b32 v17, a221
    v_accvgpr_read_b32 v18, a222
    v_mfma_f32_16x16x32_bf16 a[80:83], v[136:139], v[72:75], a[80:83]
    ds_read_b128 v[104:107], v13 offset:2048
    v_accvgpr_read_b32 v19, a223
    v_mfma_f32_16x16x32_bf16 a[84:87], v[136:139], v[76:79], a[84:87]
    v_accvgpr_read_b32 v20, a252
    v_accvgpr_read_b32 v21, a253
    v_mfma_f32_16x16x32_bf16 a[88:91], v[140:143], v[72:75], a[88:91]
    ds_read_b128 v[108:111], v13 offset:3072
    v_accvgpr_read_b32 v22, a254
    v_mfma_f32_16x16x32_bf16 a[92:95], v[140:143], v[76:79], a[92:95]
    v_accvgpr_read_b32 v23, a255
    s_waitcnt lgkmcnt(4)
    v_mfma_f32_16x16x32_bf16 a[96:99], v[144:147], v[72:75], a[96:99]
    ds_read_b128 v[112:115], v13 offset:4096
    v_cvt_pk_bf16_f32 v236, v16, v17
    v_mfma_f32_16x16x32_bf16 a[100:103], v[144:147], v[76:79], a[100:103]
    v_cvt_pk_bf16_f32 v237, v18, v19
    v_cvt_pk_bf16_f32 v238, v20, v21
    v_mfma_f32_16x16x32_bf16 a[104:107], v[148:151], v[72:75], a[104:107]
    ds_read_b128 v[116:119], v13 offset:5120
    v_cvt_pk_bf16_f32 v239, v22, v23
    v_mfma_f32_16x16x32_bf16 a[108:111], v[148:151], v[76:79], a[108:111]
    buffer_store_dwordx4 v[236:239], v1, s[12:15], s90 offen offset:3072 sc1
    v_mfma_f32_16x16x32_bf16 a[112:115], v[152:155], v[72:75], a[112:115]
    ds_read_b128 v[120:123], v13 offset:6144
    v_mfma_f32_16x16x32_bf16 a[116:119], v[152:155], v[76:79], a[116:119]
    v_mfma_f32_16x16x32_bf16 a[120:123], v[156:159], v[72:75], a[120:123]
    ds_read_b128 v[124:127], v13 offset:7168
    v_mfma_f32_16x16x32_bf16 a[124:127], v[156:159], v[76:79], a[124:127]
    s_waitcnt lgkmcnt(4)
    v_mfma_f32_16x16x32_bf16 a[0:3], v[96:99], v[80:83], a[0:3]
    ds_read_b128 v[128:131], v13 offset:8192
    s_nop 1
    v_mfma_f32_16x16x32_bf16 a[4:7], v[96:99], v[84:87], a[4:7]
    v_cndmask_b32 v8, v8, v11, vcc
    v_mfma_f32_16x16x32_bf16 a[8:11], v[100:103], v[80:83], a[8:11]
    ds_read_b128 v[132:135], v13 offset:9216
    v_mfma_f32_16x16x32_bf16 a[12:15], v[100:103], v[84:87], a[12:15]
    v_mfma_f32_16x16x32_bf16 a[16:19], v[104:107], v[80:83], a[16:19]
    ds_read_b128 v[136:139], v13 offset:10240
    v_lshrrev_b32 v9, 4, v2
    v_mfma_f32_16x16x32_bf16 a[20:23], v[104:107], v[84:87], a[20:23]
    v_mfma_f32_16x16x32_bf16 a[24:27], v[108:111], v[80:83], a[24:27]
    ds_read_b128 v[140:143], v13 offset:11264
    v_mfma_f32_16x16x32_bf16 a[28:31], v[108:111], v[84:87], a[28:31]
    s_waitcnt lgkmcnt(4)
    v_mfma_f32_16x16x32_bf16 a[32:35], v[112:115], v[80:83], a[32:35]
    ds_read_b128 v[144:147], v13 offset:12288
    v_lshlrev_b32 v9, 2, v9
    v_mfma_f32_16x16x32_bf16 a[36:39], v[112:115], v[84:87], a[36:39]
    v_mfma_f32_16x16x32_bf16 a[40:43], v[116:119], v[80:83], a[40:43]
    ds_read_b128 v[148:151], v13 offset:13312
    v_mfma_f32_16x16x32_bf16 a[44:47], v[116:119], v[84:87], a[44:47]
    v_and_b32 v10, 15, v2
    v_mfma_f32_16x16x32_bf16 a[48:51], v[120:123], v[80:83], a[48:51]
    ds_read_b128 v[152:155], v13 offset:14336
    v_mfma_f32_16x16x32_bf16 a[52:55], v[120:123], v[84:87], a[52:55]
    v_mfma_f32_16x16x32_bf16 a[56:59], v[124:127], v[80:83], a[56:59]
    ds_read_b128 v[156:159], v13 offset:15360
    v_add_u32 v11, 0, v9
    v_mfma_f32_16x16x32_bf16 a[60:63], v[124:127], v[84:87], a[60:63]
    s_waitcnt lgkmcnt(4)
    v_mfma_f32_16x16x32_bf16 a[64:67], v[128:131], v[80:83], a[64:67]
    ds_read_b128 v[96:99], v13 offset:16384
    v_mfma_f32_16x16x32_bf16 a[68:71], v[128:131], v[84:87], a[68:71]
    v_cmp_gt_u32 s[70:71], v11, v10
    v_mfma_f32_16x16x32_bf16 a[72:75], v[132:135], v[80:83], a[72:75]
    ds_read_b128 v[100:103], v13 offset:17408
    v_mfma_f32_16x16x32_bf16 a[76:79], v[132:135], v[84:87], a[76:79]
    v_mfma_f32_16x16x32_bf16 a[80:83], v[136:139], v[80:83], a[80:83]
    ds_read_b128 v[104:107], v13 offset:18432
    v_add_u32 v11, 1, v9
    v_mfma_f32_16x16x32_bf16 a[84:87], v[136:139], v[84:87], a[84:87]
    v_mfma_f32_16x16x32_bf16 a[88:91], v[140:143], v[80:83], a[88:91]
    ds_read_b128 v[108:111], v13 offset:19456
    v_mfma_f32_16x16x32_bf16 a[92:95], v[140:143], v[84:87], a[92:95]
    v_cmp_gt_u32 s[72:73], v11, v10
    s_waitcnt lgkmcnt(4)
    v_mfma_f32_16x16x32_bf16 a[96:99], v[144:147], v[80:83], a[96:99]
    ds_read_b128 v[112:115], v13 offset:20480
    v_mfma_f32_16x16x32_bf16 a[100:103], v[144:147], v[84:87], a[100:103]
    v_mfma_f32_16x16x32_bf16 a[104:107], v[148:151], v[80:83], a[104:107]
    ds_read_b128 v[116:119], v13 offset:21504
    v_add_u32 v11, 2, v9
    v_mfma_f32_16x16x32_bf16 a[108:111], v[148:151], v[84:87], a[108:111]
    v_mfma_f32_16x16x32_bf16 a[112:115], v[152:155], v[80:83], a[112:115]
    ds_read_b128 v[120:123], v13 offset:22528
    v_mfma_f32_16x16x32_bf16 a[116:119], v[152:155], v[84:87], a[116:119]
    buffer_load_dword v12, v15, s[12:15], s94 offen offset:4 sc1
    v_mfma_f32_16x16x32_bf16 a[120:123], v[156:159], v[80:83], a[120:123]
    ds_read_b128 v[124:127], v13 offset:23552
    v_cmp_gt_u32 s[74:75], v11, v10
    v_mfma_f32_16x16x32_bf16 a[124:127], v[156:159], v[84:87], a[124:127]
    s_waitcnt lgkmcnt(4)
    v_mfma_f32_16x16x32_bf16 a[0:3], v[96:99], v[88:91], a[0:3]
    ds_read_b128 v[128:131], v13 offset:24576
    v_mfma_f32_16x16x32_bf16 a[4:7], v[96:99], v[92:95], a[4:7]
    v_add_u32 v11, 3, v9
    v_mfma_f32_16x16x32_bf16 a[8:11], v[100:103], v[88:91], a[8:11]
    ds_read_b128 v[132:135], v13 offset:25600
    v_mfma_f32_16x16x32_bf16 a[12:15], v[100:103], v[92:95], a[12:15]
    v_mfma_f32_16x16x32_bf16 a[16:19], v[104:107], v[88:91], a[16:19]
    ds_read_b128 v[136:139], v13 offset:26624
    v_cmp_gt_u32 s[76:77], v11, v10
    v_mfma_f32_16x16x32_bf16 a[20:23], v[104:107], v[92:95], a[20:23]
    v_mfma_f32_16x16x32_bf16 a[24:27], v[108:111], v[88:91], a[24:27]
    ds_read_b128 v[140:143], v13 offset:27648
    v_mfma_f32_16x16x32_bf16 a[28:31], v[108:111], v[92:95], a[28:31]
    s_waitcnt lgkmcnt(4)
    v_mfma_f32_16x16x32_bf16 a[32:35], v[112:115], v[88:91], a[32:35]
    ds_read_b128 v[144:147], v13 offset:28672
    v_mfma_f32_16x16x32_bf16 a[36:39], v[112:115], v[92:95], a[36:39]
    v_mfma_f32_16x16x32_bf16 a[40:43], v[116:119], v[88:91], a[40:43]
    ds_read_b128 v[148:151], v13 offset:29696
    v_mfma_f32_16x16x32_bf16 a[44:47], v[116:119], v[92:95], a[44:47]
    v_readlane_b32 s27, v8, 1
    v_mfma_f32_16x16x32_bf16 a[48:51], v[120:123], v[88:91], a[48:51]
    ds_read_b128 v[152:155], v13 offset:30720
    v_mfma_f32_16x16x32_bf16 a[52:55], v[120:123], v[92:95], a[52:55]
    v_readlane_b32 s23, v7, 0
    s_add_u32 m0, s24, 32768
    v_mfma_f32_16x16x32_bf16 a[56:59], v[124:127], v[88:91], a[56:59]
    ds_read_b128 v[156:159], v13 offset:31744
    v_mfma_f32_16x16x32_bf16 a[60:63], v[124:127], v[92:95], a[60:63]
    s_waitcnt vmcnt(0) lgkmcnt(4)
    s_barrier
    v_mfma_f32_16x16x32_bf16 a[64:67], v[128:131], v[88:91], a[64:67]
    buffer_store_dword v14, v30, s[12:15], s93 offen offset:8
    v_mfma_f32_16x16x32_bf16 a[68:71], v[128:131], v[92:95], a[68:71]
    v_cmp_ne_u32 vcc, 1, v12
    v_mfma_f32_16x16x32_bf16 a[72:75], v[132:135], v[88:91], a[72:75]
    buffer_store_dword v14, v29, s[12:15], s93 offen offset:8 sc1
    v_mfma_f32_16x16x32_bf16 a[76:79], v[132:135], v[92:95], a[76:79]
    s_cbranch_vccnz QV_spin
QV_spinback:
    v_mfma_f32_16x16x32_bf16 a[80:83], v[136:139], v[88:91], a[80:83]
    buffer_load_dwordx4 v4, s[12:15], s23 offen offset:0 lds
    v_mfma_f32_16x16x32_bf16 a[84:87], v[136:139], v[92:95], a[84:87]
    buffer_load_dwordx4 v4, s[12:15], s23 offen offset:1024 lds
    v_mfma_f32_16x16x32_bf16 a[88:91], v[140:143], v[88:91], a[88:91]
    buffer_load_dwordx4 v4, s[12:15], s23 offen offset:2048 lds
    v_mfma_f32_16x16x32_bf16 a[92:95], v[140:143], v[92:95], a[92:95]
    buffer_load_dwordx4 v4, s[12:15], s23 offen offset:3072 lds
    s_waitcnt lgkmcnt(0)
    v_mfma_f32_16x16x32_bf16 a[96:99], v[144:147], v[88:91], a[96:99]
    s_add_u32 m0, s24, 114688
    v_readlane_b32 s23, v7, 1
    v_mfma_f32_16x16x32_bf16 a[100:103], v[144:147], v[92:95], a[100:103]
    buffer_load_dwordx4 v4, s[12:15], s27 offen offset:0 lds
    v_mfma_f32_16x16x32_bf16 a[104:107], v[148:151], v[88:91], a[104:107]
    buffer_load_dwordx4 v4, s[12:15], s27 offen offset:1024 lds
    v_mfma_f32_16x16x32_bf16 a[108:111], v[148:151], v[92:95], a[108:111]
    buffer_load_dwordx4 v4, s[12:15], s27 offen offset:2048 lds
    v_mfma_f32_16x16x32_bf16 a[112:115], v[152:155], v[88:91], a[112:115]
    buffer_load_dwordx4 v4, s[12:15], s27 offen offset:3072 lds
    v_mfma_f32_16x16x32_bf16 a[116:119], v[152:155], v[92:95], a[116:119]
    s_add_u32 m0, s24, 49152
    v_mfma_f32_16x16x32_bf16 a[120:123], v[156:159], v[88:91], a[120:123]
    buffer_load_dwordx4 v4, s[12:15], s23 offen offset:0 lds
    v_mfma_f32_16x16x32_bf16 a[124:127], v[156:159], v[92:95], a[124:127]
    buffer_load_dwordx4 v4, s[12:15], s23 offen offset:1024 lds
    buffer_load_dwordx4 v4, s[12:15], s23 offen offset:2048 lds
    buffer_load_dwordx4 v4, s[12:15], s23 offen offset:3072 lds
G_done:
    s_xor_b32 s87, s32, 1
    s_cmp_eq_u32 s31, 7
    s_cselect_b32 s86, 0, s32
    s_cselect_b32 s87, 0, s87
    s_lshl_b32 s25, s30, 3
    s_add_u32 s25, s25, s31
    s_lshl_b32 s25, s25, 2
    s_add_u32 s25, s25, s66
    s_mul_i32 s25, s25, 17408
    s_add_u32 s25, s25, 0
    s_cmp_eq_u32 s86, 1
    s_cselect_b32 s25, s25, 268435456
    s_cselect_b32 s39, 4096, 0
    v_min_u32 v9, 15, v2
    v_mul_u32_u24 v9, 6144, v9
    s_xor_b32 s29, s2, 128
    s_mul_i32 s29, s29, 384
    s_add_u32 s29, s29, 111149056
    v_accvgpr_read_b32 v32, a0
    v_accvgpr_read_b32 v33, a8
    v_accvgpr_read_b32 v34, a16
    v_accvgpr_read_b32 v35, a24
    v_accvgpr_read_b32 v36, a1
    v_accvgpr_read_b32 v37, a9
    v_accvgpr_read_b32 v38, a17
    v_accvgpr_read_b32 v39, a25
    v_cvt_pk_bf16_f32 v40, v32, v33
    v_cvt_pk_bf16_f32 v41, v34, v35
    v_cvt_pk_bf16_f32 v42, v36, v37
    v_cvt_pk_bf16_f32 v43, v38, v39
    buffer_store_dwordx4 v[40:43], v1, s[12:15], s25 offen offset:0 sc1
    v_accvgpr_write_b32 a128, v40
    v_accvgpr_write_b32 a129, v41
    v_accvgpr_write_b32 a130, v42
    v_accvgpr_write_b32 a131, v43
    v_accvgpr_read_b32 v44, a2
    v_accvgpr_read_b32 v45, a10
    v_accvgpr_read_b32 v46, a18
    v_accvgpr_read_b32 v47, a26
    v_accvgpr_read_b32 v48, a3
    v_accvgpr_read_b32 v49, a11
    v_accvgpr_read_b32 v50, a19
    v_accvgpr_read_b32 v51, a27
    v_cvt_pk_bf16_f32 v52, v44, v45
    v_cvt_pk_bf16_f32 v53, v46, v47
    v_cvt_pk_bf16_f32 v54, v48, v49
    v_cvt_pk_bf16_f32 v55, v50, v51
    buffer_store_dwordx4 v[52:55], v1, s[12:15], s25 offen offset:1024 sc1
    v_accvgpr_write_b32 a132, v52
    v_accvgpr_write_b32 a133, v53
    v_accvgpr_write_b32 a134, v54
    v_accvgpr_write_b32 a135, v55
    v_accvgpr_read_b32 v56, a32
    v_accvgpr_read_b32 v57, a40
    v_accvgpr_read_b32 v58, a48
    v_accvgpr_read_b32 v59, a56
    v_accvgpr_read_b32 v60, a33
    v_accvgpr_read_b32 v61, a41
    v_accvgpr_read_b32 v62, a49
    v_accvgpr_read_b32 v63, a57
    v_cvt_pk_bf16_f32 v64, v56, v57
    v_cvt_pk_bf16_f32 v65, v58, v59
    v_cvt_pk_bf16_f32 v66, v60, v61
    v_cvt_pk_bf16_f32 v67, v62, v63
    buffer_store_dwordx4 v[64:67], v1, s[12:15], s25 offen offset:2048 sc1
    v_accvgpr_write_b32 a136, v64
    v_accvgpr_write_b32 a137, v65
    v_accvgpr_write_b32 a138, v66
    v_accvgpr_write_b32 a139, v67
    v_accvgpr_read_b32 v68, a34
    v_accvgpr_read_b32 v69, a42
    v_accvgpr_read_b32 v70, a50
    v_accvgpr_read_b32 v71, a58
    v_accvgpr_read_b32 v72, a35
    v_accvgpr_read_b32 v73, a43
    v_accvgpr_read_b32 v74, a51
    v_accvgpr_read_b32 v75, a59
    v_cvt_pk_bf16_f32 v76, v68, v69
    v_cvt_pk_bf16_f32 v77, v70, v71
    v_cvt_pk_bf16_f32 v78, v72, v73
    v_cvt_pk_bf16_f32 v79, v74, v75
    buffer_store_dwordx4 v[76:79], v1, s[12:15], s25 offen offset:3072 sc1
    v_accvgpr_write_b32 a140, v76
    v_accvgpr_write_b32 a141, v77
    v_accvgpr_write_b32 a142, v78
    v_accvgpr_write_b32 a143, v79
    v_accvgpr_read_b32 v32, a64
    v_accvgpr_read_b32 v33, a72
    v_accvgpr_read_b32 v34, a80
    v_accvgpr_read_b32 v35, a88
    v_accvgpr_read_b32 v36, a65
    v_accvgpr_read_b32 v37, a73
    v_accvgpr_read_b32 v38, a81
    v_accvgpr_read_b32 v39, a89
    v_cvt_pk_bf16_f32 v40, v32, v33
    v_cvt_pk_bf16_f32 v41, v34, v35
    v_cvt_pk_bf16_f32 v42, v36, v37
    v_cvt_pk_bf16_f32 v43, v38, v39
    s_add_u32 s25, s25, s39
    buffer_store_dwordx4 v[40:43], v1, s[12:15], s25 offen offset:0 sc1
    v_accvgpr_write_b32 a144, v40
    v_accvgpr_write_b32 a145, v41
    v_accvgpr_write_b32 a146, v42
    v_accvgpr_write_b32 a147, v43
    v_accvgpr_read_b32 v44, a66
    v_accvgpr_read_b32 v45, a74
    v_accvgpr_read_b32 v46, a82
    v_accvgpr_read_b32 v47, a90
    v_accvgpr_read_b32 v48, a67
    v_accvgpr_read_b32 v49, a75
    v_accvgpr_read_b32 v50, a83
    v_accvgpr_read_b32 v51, a91
    v_cvt_pk_bf16_f32 v52, v44, v45
    v_cvt_pk_bf16_f32 v53, v46, v47
    v_cvt_pk_bf16_f32 v54, v48, v49
    v_cvt_pk_bf16_f32 v55, v50, v51
    buffer_store_dwordx4 v[52:55], v1, s[12:15], s25 offen offset:1024 sc1
    v_accvgpr_write_b32 a148, v52
    v_accvgpr_write_b32 a149, v53
    v_accvgpr_write_b32 a150, v54
    v_accvgpr_write_b32 a151, v55
    v_accvgpr_read_b32 v56, a96
    v_accvgpr_read_b32 v57, a104
    v_accvgpr_read_b32 v58, a112
    v_accvgpr_read_b32 v59, a120
    v_accvgpr_read_b32 v60, a97
    v_accvgpr_read_b32 v61, a105
    v_accvgpr_read_b32 v62, a113
    v_accvgpr_read_b32 v63, a121
    v_cvt_pk_bf16_f32 v64, v56, v57
    v_cvt_pk_bf16_f32 v65, v58, v59
    v_cvt_pk_bf16_f32 v66, v60, v61
    v_cvt_pk_bf16_f32 v67, v62, v63
    buffer_store_dwordx4 v[64:67], v1, s[12:15], s25 offen offset:2048 sc1
    v_accvgpr_write_b32 a152, v64
    v_accvgpr_write_b32 a153, v65
    v_accvgpr_write_b32 a154, v66
    v_accvgpr_write_b32 a155, v67
    v_accvgpr_read_b32 v68, a98
    v_accvgpr_read_b32 v69, a106
    v_accvgpr_read_b32 v70, a114
    v_accvgpr_read_b32 v71, a122
    v_accvgpr_read_b32 v72, a99
    v_accvgpr_read_b32 v73, a107
    v_accvgpr_read_b32 v74, a115
    v_accvgpr_read_b32 v75, a123
    v_cvt_pk_bf16_f32 v76, v68, v69
    v_cvt_pk_bf16_f32 v77, v70, v71
    v_cvt_pk_bf16_f32 v78, v72, v73
    v_cvt_pk_bf16_f32 v79, v74, v75
    buffer_store_dwordx4 v[76:79], v1, s[12:15], s25 offen offset:3072 sc1
    v_accvgpr_write_b32 a156, v76
    v_accvgpr_write_b32 a157, v77
    v_accvgpr_write_b32 a158, v78
    v_accvgpr_write_b32 a159, v79
    buffer_load_dword v10, v9, s[12:15], s94 offen offset:8 sc1
    v_accvgpr_read_b32 v32, a4
    v_accvgpr_read_b32 v33, a12
    v_accvgpr_read_b32 v34, a20
    v_accvgpr_read_b32 v35, a28
    v_accvgpr_read_b32 v36, a5
    v_accvgpr_read_b32 v37, a13
    v_accvgpr_read_b32 v38, a21
    v_accvgpr_read_b32 v39, a29
    v_cvt_pk_bf16_f32 v40, v32, v33
    v_cvt_pk_bf16_f32 v41, v34, v35
    v_cvt_pk_bf16_f32 v42, v36, v37
    v_cvt_pk_bf16_f32 v43, v38, v39
    s_add_u32 s25, s25, s39
    buffer_store_dwordx4 v[40:43], v1, s[12:15], s25 offen offset:0 sc1
    v_accvgpr_write_b32 a160, v40
    v_accvgpr_write_b32 a161, v41
    v_accvgpr_write_b32 a162, v42
    v_accvgpr_write_b32 a163, v43
    v_accvgpr_read_b32 v44, a6
    v_accvgpr_read_b32 v45, a14
    v_accvgpr_read_b32 v46, a22
    v_accvgpr_read_b32 v47, a30
    v_accvgpr_read_b32 v48, a7
    v_accvgpr_read_b32 v49, a15
    v_accvgpr_read_b32 v50, a23
    v_accvgpr_read_b32 v51, a31
    v_cvt_pk_bf16_f32 v52, v44, v45
    v_cvt_pk_bf16_f32 v53, v46, v47
    v_cvt_pk_bf16_f32 v54, v48, v49
    v_cvt_pk_bf16_f32 v55, v50, v51
    buffer_store_dwordx4 v[52:55], v1, s[12:15], s25 offen offset:1024 sc1
    v_accvgpr_write_b32 a164, v52
    v_accvgpr_write_b32 a165, v53
    v_accvgpr_write_b32 a166, v54
    v_accvgpr_write_b32 a167, v55
    v_accvgpr_read_b32 v56, a36
    v_accvgpr_read_b32 v57, a44
    v_accvgpr_read_b32 v58, a52
    v_accvgpr_read_b32 v59, a60
    v_accvgpr_read_b32 v60, a37
    v_accvgpr_read_b32 v61, a45
    v_accvgpr_read_b32 v62, a53
    v_accvgpr_read_b32 v63, a61
    v_cvt_pk_bf16_f32 v64, v56, v57
    v_cvt_pk_bf16_f32 v65, v58, v59
    v_cvt_pk_bf16_f32 v66, v60, v61
    v_cvt_pk_bf16_f32 v67, v62, v63
    buffer_store_dwordx4 v[64:67], v1, s[12:15], s25 offen offset:2048 sc1
    v_accvgpr_write_b32 a168, v64
    v_accvgpr_write_b32 a169, v65
    v_accvgpr_write_b32 a170, v66
    v_accvgpr_write_b32 a171, v67
    v_accvgpr_read_b32 v68, a38
    v_accvgpr_read_b32 v69, a46
    v_accvgpr_read_b32 v70, a54
    v_accvgpr_read_b32 v71, a62
    v_accvgpr_read_b32 v72, a39
    v_accvgpr_read_b32 v73, a47
    v_accvgpr_read_b32 v74, a55
    v_accvgpr_read_b32 v75, a63
    v_cvt_pk_bf16_f32 v76, v68, v69
    v_cvt_pk_bf16_f32 v77, v70, v71
    v_cvt_pk_bf16_f32 v78, v72, v73
    v_cvt_pk_bf16_f32 v79, v74, v75
    buffer_store_dwordx4 v[76:79], v1, s[12:15], s25 offen offset:3072 sc1
    v_accvgpr_write_b32 a172, v76
    v_accvgpr_write_b32 a173, v77
    v_accvgpr_write_b32 a174, v78
    v_accvgpr_write_b32 a175, v79
    v_accvgpr_read_b32 v32, a68
    v_accvgpr_read_b32 v33, a76
    v_accvgpr_read_b32 v34, a84
    v_accvgpr_read_b32 v35, a92
    v_accvgpr_read_b32 v36, a69
    v_accvgpr_read_b32 v37, a77
    v_accvgpr_read_b32 v38, a85
    v_accvgpr_read_b32 v39, a93
    v_cvt_pk_bf16_f32 v40, v32, v33
    v_cvt_pk_bf16_f32 v41, v34, v35
    v_cvt_pk_bf16_f32 v42, v36, v37
    v_cvt_pk_bf16_f32 v43, v38, v39
    s_add_u32 s25, s25, s39
    buffer_store_dwordx4 v[40:43], v1, s[12:15], s25 offen offset:0 sc1
    v_accvgpr_write_b32 a176, v40
    v_accvgpr_write_b32 a177, v41
    v_accvgpr_write_b32 a178, v42
    v_accvgpr_write_b32 a179, v43
    v_accvgpr_read_b32 v44, a70
    v_accvgpr_read_b32 v45, a78
    v_accvgpr_read_b32 v46, a86
    v_accvgpr_read_b32 v47, a94
    v_accvgpr_read_b32 v48, a71
    v_accvgpr_read_b32 v49, a79
    v_accvgpr_read_b32 v50, a87
    v_accvgpr_read_b32 v51, a95
    v_cvt_pk_bf16_f32 v52, v44, v45
    v_cvt_pk_bf16_f32 v53, v46, v47
    v_cvt_pk_bf16_f32 v54, v48, v49
    v_cvt_pk_bf16_f32 v55, v50, v51
    buffer_store_dwordx4 v[52:55], v1, s[12:15], s25 offen offset:1024 sc1
    v_accvgpr_write_b32 a180, v52
    v_accvgpr_write_b32 a181, v53
    v_accvgpr_write_b32 a182, v54
    v_accvgpr_write_b32 a183, v55
    v_accvgpr_read_b32 v56, a100
    v_accvgpr_read_b32 v57, a108
    v_accvgpr_read_b32 v58, a116
    v_accvgpr_read_b32 v59, a124
    v_accvgpr_read_b32 v60, a101
    v_accvgpr_read_b32 v61, a109
    v_accvgpr_read_b32 v62, a117
    v_accvgpr_read_b32 v63, a125
    v_cvt_pk_bf16_f32 v64, v56, v57
    v_cvt_pk_bf16_f32 v65, v58, v59
    v_cvt_pk_bf16_f32 v66, v60, v61
    v_cvt_pk_bf16_f32 v67, v62, v63
    buffer_store_dwordx4 v[64:67], v1, s[12:15], s25 offen offset:2048 sc1
    v_accvgpr_write_b32 a184, v64
    v_accvgpr_write_b32 a185, v65
    v_accvgpr_write_b32 a186, v66
    v_accvgpr_write_b32 a187, v67
    v_accvgpr_read_b32 v68, a102
    v_accvgpr_read_b32 v69, a110
    v_accvgpr_read_b32 v70, a118
    v_accvgpr_read_b32 v71, a126
    v_accvgpr_read_b32 v72, a103
    v_accvgpr_read_b32 v73, a111
    v_accvgpr_read_b32 v74, a119
    v_accvgpr_read_b32 v75, a127
    v_cvt_pk_bf16_f32 v76, v68, v69
    v_cvt_pk_bf16_f32 v77, v70, v71
    v_cvt_pk_bf16_f32 v78, v72, v73
    v_cvt_pk_bf16_f32 v79, v74, v75
    buffer_store_dwordx4 v[76:79], v1, s[12:15], s25 offen offset:3072 sc1
    v_accvgpr_write_b32 a188, v76
    v_accvgpr_write_b32 a189, v77
    v_accvgpr_write_b32 a190, v78
    v_accvgpr_write_b32 a191, v79
    v_mov_b64 v[128:129], 0
    v_mov_b64 v[130:131], 0
    v_mov_b64 v[132:133], 0
    v_mov_b64 v[134:135], 0
    v_mov_b64 v[136:137], 0
    v_mov_b64 v[138:139], 0
    v_mov_b64 v[140:141], 0
    v_mov_b64 v[142:143], 0
    v_mov_b64 v[144:145], 0
    v_mov_b64 v[146:147], 0
    v_mov_b64 v[148:149], 0
    v_mov_b64 v[150:151], 0
    v_mov_b64 v[152:153], 0
    v_mov_b64 v[154:155], 0
    v_mov_b64 v[156:157], 0
    v_mov_b64 v[158:159], 0
    v_mov_b64 v[160:161], 0
    v_mov_b64 v[162:163], 0
    v_mov_b64 v[164:165], 0
    v_mov_b64 v[166:167], 0
    v_mov_b64 v[168:169], 0
    v_mov_b64 v[170:171], 0
    v_mov_b64 v[172:173], 0
    v_mov_b64 v[174:175], 0
    v_mov_b64 v[176:177], 0
    v_mov_b64 v[178:179], 0
    v_mov_b64 v[180:181], 0
    v_mov_b64 v[182:183], 0
    v_mov_b64 v[184:185], 0
    v_mov_b64 v[186:187], 0
    v_mov_b64 v[188:189], 0
    v_mov_b64 v[190:191], 0
    v_mov_b64 v[192:193], 0
    v_mov_b64 v[194:195], 0
    v_mov_b64 v[196:197], 0
    v_mov_b64 v[198:199], 0
    v_mov_b64 v[200:201], 0
    v_mov_b64 v[202:203], 0
    v_mov_b64 v[204:205], 0
    v_mov_b64 v[206:207], 0
    v_mov_b64 v[208:209], 0
    v_mov_b64 v[210:211], 0
    v_mov_b64 v[212:213], 0
    v_mov_b64 v[214:215], 0
    v_mov_b64 v[216:217], 0
    v_mov_b64 v[218:219], 0
    v_mov_b64 v[220:221], 0
    v_mov_b64 v[222:223], 0
    v_mov_b64 v[224:225], 0
    v_mov_b64 v[226:227], 0
    v_mov_b64 v[228:229], 0
    v_mov_b64 v[230:231], 0
    v_mov_b64 v[232:233], 0
    v_mov_b64 v[234:235], 0
    v_mov_b64 v[236:237], 0
    v_mov_b64 v[238:239], 0
    v_mov_b64 v[240:241], 0
    v_mov_b64 v[242:243], 0
    v_mov_b64 v[244:245], 0
    v_mov_b64 v[246:247], 0
    v_mov_b64 v[248:249], 0
    v_mov_b64 v[250:251], 0
    v_mov_b64 v[252:253], 0
    v_mov_b64 v[254:255], 0
    v_mov_b32 v96, 0
    v_mov_b32 v97, 0
    v_mov_b32 v98, 0
    v_mov_b32 v99, 0
    v_mov_b32 v100, 0
    v_mov_b32 v101, 0
    v_mov_b32 v102, 0
    v_mov_b32 v103, 0
    v_mov_b32 v104, 0
    v_mov_b32 v105, 0
    v_mov_b32 v106, 0
    v_mov_b32 v107, 0
    v_mov_b32 v108, 0
    v_mov_b32 v109, 0
    v_mov_b32 v110, 0
    v_mov_b32 v111, 0
    s_waitcnt vmcnt(8)
    v_cmp_ne_u32 vcc, 1, v10
    s_nop 2
    s_cbranch_vccz AT_kvok
    s_mov_b32 s3, 0x20000
fkv_poll_1:
    buffer_load_dword v10, v9, s[12:15], s94 offen offset:8 sc1
    s_waitcnt vmcnt(0)
    v_cmp_ne_u32 vcc, 1, v10
    s_sub_u32 s3, s3, 1
    s_cbranch_scc1 fkv_pdone_2
    s_nop 1
    s_cbranch_vccnz fkv_poll_1
fkv_pdone_2:
AT_kvok:
    v_readlane_b32 s23, v7, 2
    v_readlane_b32 s27, v8, 2
    s_mov_b32 m0, s24
    v_add_u32 v5, 0x8000, v1
    v_add_u32 v6, 0x18000, v1
    s_mov_b32 s22, s24
    s_mov_b32 s20, 3
    buffer_load_dwordx4 v4, s[12:15], s23 offen offset:0 lds
    buffer_load_dwordx4 v4, s[12:15], s23 offen offset:1024 lds
    buffer_load_dwordx4 v4, s[12:15], s23 offen offset:2048 lds
    buffer_load_dwordx4 v4, s[12:15], s23 offen offset:3072 lds
    s_add_u32 m0, s24, 65536
    s_nop 0
    buffer_load_dwordx4 v4, s[12:15], s27 offen offset:0 lds
    buffer_load_dwordx4 v4, s[12:15], s27 offen offset:1024 lds
    buffer_load_dwordx4 v4, s[12:15], s27 offen offset:2048 lds
    buffer_load_dwordx4 v4, s[12:15], s27 offen offset:3072 lds
    s_lshl_b32 s3, s2, 2
    s_add_u32 s3, s3, 111280128
    buffer_store_dword v14, v31, s[12:15], s3 offen sc1
    s_cmp_eq_u32 s86, 1
    s_cbranch_scc0 AT_notA
    s_waitcnt vmcnt(9)
    s_barrier
    buffer_store_dword v14, v30, s[12:15], s93 offen offset:12
    buffer_store_dword v14, v29, s[12:15], s93 offen offset:12 sc1
    ds_read_b128 a[192:195], v5 offset:0
    ds_read_b128 a[196:199], v5 offset:1024
    ds_read_b128 a[200:203], v5 offset:2048
    ds_read_b128 a[204:207], v5 offset:3072
    ds_read_b128 a[208:211], v5 offset:4096
    ds_read_b128 a[212:215], v5 offset:5120
    ds_read_b128 a[216:219], v5 offset:6144
    ds_read_b128 a[220:223], v5 offset:7168
    s_call_b64 s[82:83], AT_qkfirst
    s_add_u32 s25, s25, 4096
    buffer_store_dwordx2 v[16:17], v1, s[12:15], s25 offen sc1
    s_add_u32 s21, s20, 2
    s_call_b64 s[82:83], AT_full
    buffer_store_dword v14, v30, s[12:15], s93 offen offset:32
    buffer_store_dword v14, v29, s[12:15], s93 offen offset:32 sc1
    s_add_u32 s21, s20, 30
    s_call_b64 s[82:83], AT_full
    buffer_load_dword v120, v1, s[44:47], s48 offen
    s_lshl_b32 s3, s66, 2
    s_add_u32 s29, s29, s3
    buffer_load_dword v116, off, s[12:15], s29 offset:48 sc1
    s_add_u32 s21, s20, 2
    s_call_b64 s[82:83], AT_full
    v_readfirstlane_b32 s39, v116
    s_cmp_eq_u32 s39, 1
    s_cbranch_scc0 AT_A_late
    s_lshl_b32 s25, s30, 3
    s_add_u32 s25, s25, s31
    s_lshl_b32 s25, s25, 2
    s_add_u32 s25, s25, s66
    s_mul_i32 s25, s25, 17408
    s_add_u32 s25, s25, 58720256
    buffer_load_dwordx4 a[64:67], v1, s[12:15], s25 offen offset:0 sc1
    buffer_load_dwordx4 a[68:71], v1, s[12:15], s25 offen offset:1024 sc1
    buffer_load_dwordx4 a[72:75], v1, s[12:15], s25 offen offset:2048 sc1
    buffer_load_dwordx4 a[76:79], v1, s[12:15], s25 offen offset:3072 sc1
    s_add_u32 s25, s25, 4096
    buffer_load_dwordx4 a[80:83], v1, s[12:15], s25 offen offset:0 sc1
    buffer_load_dwordx4 a[84:87], v1, s[12:15], s25 offen offset:1024 sc1
    buffer_load_dwordx4 a[88:91], v1, s[12:15], s25 offen offset:2048 sc1
    buffer_load_dwordx4 a[92:95], v1, s[12:15], s25 offen offset:3072 sc1
    s_add_u32 s25, s25, 4096
    buffer_load_dwordx4 a[96:99], v1, s[12:15], s25 offen offset:0 sc1
    buffer_load_dwordx4 a[100:103], v1, s[12:15], s25 offen offset:1024 sc1
    buffer_load_dwordx4 a[104:107], v1, s[12:15], s25 offen offset:2048 sc1
    buffer_load_dwordx4 a[108:111], v1, s[12:15], s25 offen offset:3072 sc1
    s_add_u32 s25, s25, 4096
    buffer_load_dwordx4 a[112:115], v1, s[12:15], s25 offen offset:0 sc1
    buffer_load_dwordx4 a[116:119], v1, s[12:15], s25 offen offset:1024 sc1
    buffer_load_dwordx4 a[120:123], v1, s[12:15], s25 offen offset:2048 sc1
    buffer_load_dwordx4 a[124:127], v1, s[12:15], s25 offen offset:3072 sc1
    s_add_u32 s25, s25, 4096
    buffer_load_dwordx4 v[112:115], v1, s[12:15], s25 offen offset:0 sc1
    s_add_u32 s21, s20, 1
    s_call_b64 s[82:83], AT_full
    s_branch AT_A_last
AT_A_late:
    buffer_load_dword v116, off, s[12:15], s29 offset:48 sc1
    s_add_u32 s21, s20, 1
    s_call_b64 s[82:83], AT_full
    s_waitcnt vmcnt(8)
    v_readfirstlane_b32 s39, v116
    s_cmp_eq_u32 s39, 1
    s_cbranch_scc0 AT_A_last
    s_lshl_b32 s25, s30, 3
    s_add_u32 s25, s25, s31
    s_lshl_b32 s25, s25, 2
    s_add_u32 s25, s25, s66
    s_mul_i32 s25, s25, 17408
    s_add_u32 s25, s25, 58720256
    buffer_load_dwordx4 a[64:67], v1, s[12:15], s25 offen offset:0 sc1
    buffer_load_dwordx4 a[68:71], v1, s[12:15], s25 offen offset:1024 sc1
    buffer_load_dwordx4 a[72:75], v1, s[12:15], s25 offen offset:2048 sc1
    buffer_load_dwordx4 a[76:79], v1, s[12:15], s25 offen offset:3072 sc1
    s_add_u32 s25, s25, 4096
    buffer_load_dwordx4 a[80:83], v1, s[12:15], s25 offen offset:0 sc1
    buffer_load_dwordx4 a[84:87], v1, s[12:15], s25 offen offset:1024 sc1
    buffer_load_dwordx4 a[88:91], v1, s[12:15], s25 offen offset:2048 sc1
    buffer_load_dwordx4 a[92:95], v1, s[12:15], s25 offen offset:3072 sc1
    s_add_u32 s25, s25, 4096
    buffer_load_dwordx4 a[96:99], v1, s[12:15], s25 offen offset:0 sc1
    buffer_load_dwordx4 a[100:103], v1, s[12:15], s25 offen offset:1024 sc1
    buffer_load_dwordx4 a[104:107], v1, s[12:15], s25 offen offset:2048 sc1
    buffer_load_dwordx4 a[108:111], v1, s[12:15], s25 offen offset:3072 sc1
    s_add_u32 s25, s25, 4096
    buffer_load_dwordx4 a[112:115], v1, s[12:15], s25 offen offset:0 sc1
    buffer_load_dwordx4 a[116:119], v1, s[12:15], s25 offen offset:1024 sc1
    buffer_load_dwordx4 a[120:123], v1, s[12:15], s25 offen offset:2048 sc1
    buffer_load_dwordx4 a[124:127], v1, s[12:15], s25 offen offset:3072 sc1
    s_add_u32 s25, s25, 4096
    buffer_load_dwordx4 v[112:115], v1, s[12:15], s25 offen offset:0 sc1
AT_A_last:
    s_mov_b32 s3, 111280128
    buffer_load_dwordx4 v[124:127], v1, s[12:15], s3 offen sc1
    s_call_b64 s[82:83], AT_pvlast
    s_cmp_eq_u32 s39, 1
    s_cbranch_scc1 AT_A_have
    s_mov_b32 s3, 0x20000
fo_poll_3:
    buffer_load_dword v9, off, s[12:15], s29 offset:48 sc1
    s_waitcnt vmcnt(0)
    v_cmp_ne_u32 vcc, 1, v9
    s_sub_u32 s3, s3, 1
    s_cbranch_scc1 fo_pdone_4
    s_nop 1
    s_cbranch_vccnz fo_poll_3
fo_pdone_4:
    s_lshl_b32 s25, s30, 3
    s_add_u32 s25, s25, s31
    s_lshl_b32 s25, s25, 2
    s_add_u32 s25, s25, s66
    s_mul_i32 s25, s25, 17408
    s_add_u32 s25, s25, 58720256
    buffer_load_dwordx4 a[64:67], v1, s[12:15], s25 offen offset:0 sc1
    buffer_load_dwordx4 a[68:71], v1, s[12:15], s25 offen offset:1024 sc1
    buffer_load_dwordx4 a[72:75], v1, s[12:15], s25 offen offset:2048 sc1
    buffer_load_dwordx4 a[76:79], v1, s[12:15], s25 offen offset:3072 sc1
    s_add_u32 s25, s25, 4096
    buffer_load_dwordx4 a[80:83], v1, s[12:15], s25 offen offset:0 sc1
    buffer_load_dwordx4 a[84:87], v1, s[12:15], s25 offen offset:1024 sc1
    buffer_load_dwordx4 a[88:91], v1, s[12:15], s25 offen offset:2048 sc1
    buffer_load_dwordx4 a[92:95], v1, s[12:15], s25 offen offset:3072 sc1
    s_add_u32 s25, s25, 4096
    buffer_load_dwordx4 a[96:99], v1, s[12:15], s25 offen offset:0 sc1
    buffer_load_dwordx4 a[100:103], v1, s[12:15], s25 offen offset:1024 sc1
    buffer_load_dwordx4 a[104:107], v1, s[12:15], s25 offen offset:2048 sc1
    buffer_load_dwordx4 a[108:111], v1, s[12:15], s25 offen offset:3072 sc1
    s_add_u32 s25, s25, 4096
    buffer_load_dwordx4 a[112:115], v1, s[12:15], s25 offen offset:0 sc1
    buffer_load_dwordx4 a[116:119], v1, s[12:15], s25 offen offset:1024 sc1
    buffer_load_dwordx4 a[120:123], v1, s[12:15], s25 offen offset:2048 sc1
    buffer_load_dwordx4 a[124:127], v1, s[12:15], s25 offen offset:3072 sc1
    s_add_u32 s25, s25, 4096
    buffer_load_dwordx4 v[112:115], v1, s[12:15], s25 offen offset:0 sc1
    s_waitcnt vmcnt(0)
AT_A_have:
    v_mov_b32 v9, v18
    v_mov_b32 v10, v19
    s_nop 0
    v_permlane16_swap_b32 v18, v9
    v_permlane16_swap_b32 v19, v10
    s_nop 0
    v_add_f32 v18, v18, v9
    v_add_f32 v19, v19, v10
    v_mov_b32 v9, v18
    v_mov_b32 v10, v19
    s_nop 0
    v_permlane32_swap_b32 v18, v9
    v_permlane32_swap_b32 v19, v10
    s_nop 0
    v_add_f32 v18, v18, v9
    v_add_f32 v19, v19, v10
    v_lshrrev_b32 v9, 4, v2
    v_and_b32 v10, 15, v2
    v_lshlrev_b32 v9, 2, v9
    v_sub_u32 v9, v10, v9
    v_and_b32 v10, 1, v9
    v_lshlrev_b32 v10, 4, v10
    v_mov_b32 v11, 0x3f80
    v_lshlrev_b32 v10, v10, v11
    v_lshrrev_b32 v9, 1, v9
    v_cmp_eq_u32 vcc, 0, v9
    v_mov_b64 v[96:97], 0
    v_mov_b64 v[100:101], 0
    v_cndmask_b32 v98, 0, v10, vcc
    v_cmp_eq_u32 vcc, 1, v9
    s_waitcnt vmcnt(9)
    v_add_f32 v26, v18, v114
    v_cndmask_b32 v99, 0, v10, vcc
    v_cmp_ne_u64 vcc, v[16:17], v[112:113]
    v_add_f32 v27, v19, v115
    v_rcp_f32 v26, v26
    v_rcp_f32 v27, v27
    s_cbranch_vccnz AT_A_gen
    v_mfma_f32_16x16x32_bf16 v[128:131], v[98:101], a[64:67], v[128:131]
    v_mfma_f32_16x16x32_bf16 v[136:139], v[96:99], a[64:67], v[136:139]
    v_mfma_f32_16x16x32_bf16 v[144:147], v[98:101], a[68:71], v[144:147]
    v_mfma_f32_16x16x32_bf16 v[152:155], v[96:99], a[68:71], v[152:155]
    v_mfma_f32_16x16x32_bf16 v[160:163], v[98:101], a[72:75], v[160:163]
    v_mfma_f32_16x16x32_bf16 v[168:171], v[96:99], a[72:75], v[168:171]
    v_mfma_f32_16x16x32_bf16 v[176:179], v[98:101], a[76:79], v[176:179]
    s_nop 1
    v_cvt_pk_bf16_f32 v32, v128, v129
    v_cvt_pk_bf16_f32 v33, v130, v131
    v_mfma_f32_16x16x32_bf16 v[184:187], v[96:99], a[76:79], v[184:187]
    v_cvt_pk_bf16_f32 v34, v136, v137
    v_cvt_pk_bf16_f32 v35, v138, v139
    v_mfma_f32_16x16x32_bf16 v[192:195], v[98:101], a[80:83], v[192:195]
    v_cvt_pk_bf16_f32 v36, v144, v145
    v_cvt_pk_bf16_f32 v37, v146, v147
    v_mfma_f32_16x16x32_bf16 v[200:203], v[96:99], a[80:83], v[200:203]
    v_cvt_pk_bf16_f32 v38, v152, v153
    v_cvt_pk_bf16_f32 v39, v154, v155
    v_mfma_f32_16x16x32_bf16 v[208:211], v[98:101], a[84:87], v[208:211]
    v_cvt_pk_bf16_f32 v40, v160, v161
    v_cvt_pk_bf16_f32 v41, v162, v163
    v_mfma_f32_16x16x32_bf16 v[216:219], v[96:99], a[84:87], v[216:219]
    v_cvt_pk_bf16_f32 v42, v168, v169
    v_cvt_pk_bf16_f32 v43, v170, v171
    v_mfma_f32_16x16x32_bf16 v[224:227], v[98:101], a[88:91], v[224:227]
    v_cvt_pk_bf16_f32 v44, v176, v177
    v_cvt_pk_bf16_f32 v45, v178, v179
    v_mfma_f32_16x16x32_bf16 v[232:235], v[96:99], a[88:91], v[232:235]
    v_cvt_pk_bf16_f32 v46, v184, v185
    v_cvt_pk_bf16_f32 v47, v186, v187
    v_mfma_f32_16x16x32_bf16 v[240:243], v[98:101], a[92:95], v[240:243]
    v_cvt_pk_bf16_f32 v48, v192, v193
    v_cvt_pk_bf16_f32 v49, v194, v195
    v_mfma_f32_16x16x32_bf16 v[248:251], v[96:99], a[92:95], v[248:251]
    v_cvt_pk_bf16_f32 v50, v200, v201
    v_cvt_pk_bf16_f32 v51, v202, v203
    v_mfma_f32_16x16x32_bf16 v[132:135], v[98:101], a[96:99], v[132:135]
    v_cvt_pk_bf16_f32 v52, v208, v209
    v_cvt_pk_bf16_f32 v53, v210, v211
    v_mfma_f32_16x16x32_bf16 v[140:143], v[96:99], a[96:99], v[140:143]
    v_cvt_pk_bf16_f32 v54, v216, v217
    v_cvt_pk_bf16_f32 v55, v218, v219
    v_mfma_f32_16x16x32_bf16 v[148:151], v[98:101], a[100:103], v[148:151]
    v_cvt_pk_bf16_f32 v56, v224, v225
    v_cvt_pk_bf16_f32 v57, v226, v227
    v_mfma_f32_16x16x32_bf16 v[156:159], v[96:99], a[100:103], v[156:159]
    v_cvt_pk_bf16_f32 v58, v232, v233
    v_cvt_pk_bf16_f32 v59, v234, v235
    v_mfma_f32_16x16x32_bf16 v[164:167], v[98:101], a[104:107], v[164:167]
    v_cvt_pk_bf16_f32 v60, v240, v241
    v_cvt_pk_bf16_f32 v61, v242, v243
    v_mfma_f32_16x16x32_bf16 v[172:175], v[96:99], a[104:107], v[172:175]
    v_cvt_pk_bf16_f32 v62, v248, v249
    v_cvt_pk_bf16_f32 v63, v250, v251
    v_mfma_f32_16x16x32_bf16 v[180:183], v[98:101], a[108:111], v[180:183]
    v_cvt_pk_bf16_f32 v64, v132, v133
    v_cvt_pk_bf16_f32 v65, v134, v135
    v_mfma_f32_16x16x32_bf16 v[188:191], v[96:99], a[108:111], v[188:191]
    v_cvt_pk_bf16_f32 v66, v140, v141
    v_cvt_pk_bf16_f32 v67, v142, v143
    v_mfma_f32_16x16x32_bf16 v[196:199], v[98:101], a[112:115], v[196:199]
    v_cvt_pk_bf16_f32 v68, v148, v149
    v_cvt_pk_bf16_f32 v69, v150, v151
    v_mfma_f32_16x16x32_bf16 v[204:207], v[96:99], a[112:115], v[204:207]
    v_cvt_pk_bf16_f32 v70, v156, v157
    v_cvt_pk_bf16_f32 v71, v158, v159
    v_mfma_f32_16x16x32_bf16 v[212:215], v[98:101], a[116:119], v[212:215]
    v_cvt_pk_bf16_f32 v72, v164, v165
    v_cvt_pk_bf16_f32 v73, v166, v167
    v_mfma_f32_16x16x32_bf16 v[220:223], v[96:99], a[116:119], v[220:223]
    v_cvt_pk_bf16_f32 v74, v172, v173
    v_cvt_pk_bf16_f32 v75, v174, v175
    v_mfma_f32_16x16x32_bf16 v[228:231], v[98:101], a[120:123], v[228:231]
    v_cvt_pk_bf16_f32 v76, v180, v181
    v_cvt_pk_bf16_f32 v77, v182, v183
    v_mfma_f32_16x16x32_bf16 v[236:239], v[96:99], a[120:123], v[236:239]
    v_cvt_pk_bf16_f32 v78, v188, v189
    v_cvt_pk_bf16_f32 v79, v190, v191
    v_mfma_f32_16x16x32_bf16 v[244:247], v[98:101], a[124:127], v[244:247]
    v_cvt_pk_bf16_f32 v80, v196, v197
    v_cvt_pk_bf16_f32 v81, v198, v199
    v_mfma_f32_16x16x32_bf16 v[252:255], v[96:99], a[124:127], v[252:255]
    v_cvt_pk_bf16_f32 v82, v204, v205
    v_cvt_pk_bf16_f32 v83, v206, v207
    v_cvt_pk_bf16_f32 v84, v212, v213
    v_cvt_pk_bf16_f32 v85, v214, v215
    v_cvt_pk_bf16_f32 v86, v220, v221
    v_cvt_pk_bf16_f32 v87, v222, v223
    v_cvt_pk_bf16_f32 v88, v228, v229
    v_cvt_pk_bf16_f32 v89, v230, v231
    v_cvt_pk_bf16_f32 v90, v236, v237
    v_cvt_pk_bf16_f32 v91, v238, v239
    v_cvt_pk_bf16_f32 v92, v244, v245
    v_cvt_pk_bf16_f32 v93, v246, v247
    v_cvt_pk_bf16_f32 v94, v252, v253
    v_cvt_pk_bf16_f32 v95, v254, v255
    s_branch AT_oproj_start
AT_A_gen:
    v_min_f32 v9, v16, v112
    v_sub_f32 v10, v9, v16
    v_sub_f32 v11, v9, v112
    v_exp_f32 v10, v10
    v_exp_f32 v11, v11
    s_nop 0
    v_mul_f32 v9, v11, v114
    v_fma_f32 v9, v10, v18, v9
    v_rcp_f32 v9, v9
    s_nop 0
    v_mul_f32 v22, v10, v9
    v_mul_f32 v24, v11, v9
    v_mov_b32 v26, 1.0
    v_min_f32 v9, v17, v113
    v_sub_f32 v10, v9, v17
    v_sub_f32 v11, v9, v113
    v_exp_f32 v10, v10
    v_exp_f32 v11, v11
    s_nop 0
    v_mul_f32 v9, v11, v115
    v_fma_f32 v9, v10, v19, v9
    v_rcp_f32 v9, v9
    s_nop 0
    v_mul_f32 v23, v10, v9
    v_mul_f32 v25, v11, v9
    v_mov_b32 v27, 1.0
    v_accvgpr_read_b32 v97, a64
    v_accvgpr_read_b32 v99, a65
    v_accvgpr_read_b32 v101, a66
    v_accvgpr_read_b32 v103, a67
    v_pk_mul_f32 v[128:129], v[128:129], v[22:23] op_sel:[0,0] op_sel_hi:[1,0]
    v_pk_mul_f32 v[130:131], v[130:131], v[22:23] op_sel:[0,0] op_sel_hi:[1,0]
    v_pk_mul_f32 v[136:137], v[136:137], v[22:23] op_sel:[0,0] op_sel_hi:[1,0]
    v_pk_mul_f32 v[138:139], v[138:139], v[22:23] op_sel:[0,0] op_sel_hi:[1,0]
    v_lshlrev_b32 v96, 16, v97
    v_and_b32 v97, 0xffff0000, v97
    v_lshlrev_b32 v98, 16, v99
    v_and_b32 v99, 0xffff0000, v99
    v_lshlrev_b32 v100, 16, v101
    v_and_b32 v101, 0xffff0000, v101
    v_lshlrev_b32 v102, 16, v103
    v_and_b32 v103, 0xffff0000, v103
    v_pk_fma_f32 v[128:129], v[96:97], v[24:25], v[128:129] op_sel:[0,0,0] op_sel_hi:[1,0,1]
    v_pk_fma_f32 v[130:131], v[98:99], v[24:25], v[130:131] op_sel:[0,0,0] op_sel_hi:[1,0,1]
    v_pk_fma_f32 v[136:137], v[100:101], v[24:25], v[136:137] op_sel:[0,0,0] op_sel_hi:[1,0,1]
    v_pk_fma_f32 v[138:139], v[102:103], v[24:25], v[138:139] op_sel:[0,0,0] op_sel_hi:[1,0,1]
    v_cvt_pk_bf16_f32 v32, v128, v129
    v_cvt_pk_bf16_f32 v33, v130, v131
    v_cvt_pk_bf16_f32 v34, v136, v137
    v_cvt_pk_bf16_f32 v35, v138, v139
    v_accvgpr_read_b32 v97, a68
    v_accvgpr_read_b32 v99, a69
    v_accvgpr_read_b32 v101, a70
    v_accvgpr_read_b32 v103, a71
    v_pk_mul_f32 v[144:145], v[144:145], v[22:23] op_sel:[0,0] op_sel_hi:[1,0]
    v_pk_mul_f32 v[146:147], v[146:147], v[22:23] op_sel:[0,0] op_sel_hi:[1,0]
    v_pk_mul_f32 v[152:153], v[152:153], v[22:23] op_sel:[0,0] op_sel_hi:[1,0]
    v_pk_mul_f32 v[154:155], v[154:155], v[22:23] op_sel:[0,0] op_sel_hi:[1,0]
    v_lshlrev_b32 v96, 16, v97
    v_and_b32 v97, 0xffff0000, v97
    v_lshlrev_b32 v98, 16, v99
    v_and_b32 v99, 0xffff0000, v99
    v_lshlrev_b32 v100, 16, v101
    v_and_b32 v101, 0xffff0000, v101
    v_lshlrev_b32 v102, 16, v103
    v_and_b32 v103, 0xffff0000, v103
    v_pk_fma_f32 v[144:145], v[96:97], v[24:25], v[144:145] op_sel:[0,0,0] op_sel_hi:[1,0,1]
    v_pk_fma_f32 v[146:147], v[98:99], v[24:25], v[146:147] op_sel:[0,0,0] op_sel_hi:[1,0,1]
    v_pk_fma_f32 v[152:153], v[100:101], v[24:25], v[152:153] op_sel:[0,0,0] op_sel_hi:[1,0,1]
    v_pk_fma_f32 v[154:155], v[102:103], v[24:25], v[154:155] op_sel:[0,0,0] op_sel_hi:[1,0,1]
    v_cvt_pk_bf16_f32 v36, v144, v145
    v_cvt_pk_bf16_f32 v37, v146, v147
    v_cvt_pk_bf16_f32 v38, v152, v153
    v_cvt_pk_bf16_f32 v39, v154, v155
    v_accvgpr_read_b32 v97, a72
    v_accvgpr_read_b32 v99, a73
    v_accvgpr_read_b32 v101, a74
    v_accvgpr_read_b32 v103, a75
    v_pk_mul_f32 v[160:161], v[160:161], v[22:23] op_sel:[0,0] op_sel_hi:[1,0]
    v_pk_mul_f32 v[162:163], v[162:163], v[22:23] op_sel:[0,0] op_sel_hi:[1,0]
    v_pk_mul_f32 v[168:169], v[168:169], v[22:23] op_sel:[0,0] op_sel_hi:[1,0]
    v_pk_mul_f32 v[170:171], v[170:171], v[22:23] op_sel:[0,0] op_sel_hi:[1,0]
    v_lshlrev_b32 v96, 16, v97
    v_and_b32 v97, 0xffff0000, v97
    v_lshlrev_b32 v98, 16, v99
    v_and_b32 v99, 0xffff0000, v99
    v_lshlrev_b32 v100, 16, v101
    v_and_b32 v101, 0xffff0000, v101
    v_lshlrev_b32 v102, 16, v103
    v_and_b32 v103, 0xffff0000, v103
    v_pk_fma_f32 v[160:161], v[96:97], v[24:25], v[160:161] op_sel:[0,0,0] op_sel_hi:[1,0,1]
    v_pk_fma_f32 v[162:163], v[98:99], v[24:25], v[162:163] op_sel:[0,0,0] op_sel_hi:[1,0,1]
    v_pk_fma_f32 v[168:169], v[100:101], v[24:25], v[168:169] op_sel:[0,0,0] op_sel_hi:[1,0,1]
    v_pk_fma_f32 v[170:171], v[102:103], v[24:25], v[170:171] op_sel:[0,0,0] op_sel_hi:[1,0,1]
    v_cvt_pk_bf16_f32 v40, v160, v161
    v_cvt_pk_bf16_f32 v41, v162, v163
    v_cvt_pk_bf16_f32 v42, v168, v169
    v_cvt_pk_bf16_f32 v43, v170, v171
    v_accvgpr_read_b32 v97, a76
    v_accvgpr_read_b32 v99, a77
    v_accvgpr_read_b32 v101, a78
    v_accvgpr_read_b32 v103, a79
    v_pk_mul_f32 v[176:177], v[176:177], v[22:23] op_sel:[0,0] op_sel_hi:[1,0]
    v_pk_mul_f32 v[178:179], v[178:179], v[22:23] op_sel:[0,0] op_sel_hi:[1,0]
    v_pk_mul_f32 v[184:185], v[184:185], v[22:23] op_sel:[0,0] op_sel_hi:[1,0]
    v_pk_mul_f32 v[186:187], v[186:187], v[22:23] op_sel:[0,0] op_sel_hi:[1,0]
    v_lshlrev_b32 v96, 16, v97
    v_and_b32 v97, 0xffff0000, v97
    v_lshlrev_b32 v98, 16, v99
    v_and_b32 v99, 0xffff0000, v99
    v_lshlrev_b32 v100, 16, v101
    v_and_b32 v101, 0xffff0000, v101
    v_lshlrev_b32 v102, 16, v103
    v_and_b32 v103, 0xffff0000, v103
    v_pk_fma_f32 v[176:177], v[96:97], v[24:25], v[176:177] op_sel:[0,0,0] op_sel_hi:[1,0,1]
    v_pk_fma_f32 v[178:179], v[98:99], v[24:25], v[178:179] op_sel:[0,0,0] op_sel_hi:[1,0,1]
    v_pk_fma_f32 v[184:185], v[100:101], v[24:25], v[184:185] op_sel:[0,0,0] op_sel_hi:[1,0,1]
    v_pk_fma_f32 v[186:187], v[102:103], v[24:25], v[186:187] op_sel:[0,0,0] op_sel_hi:[1,0,1]
    v_cvt_pk_bf16_f32 v44, v176, v177
    v_cvt_pk_bf16_f32 v45, v178, v179
    v_cvt_pk_bf16_f32 v46, v184, v185
    v_cvt_pk_bf16_f32 v47, v186, v187
    v_accvgpr_read_b32 v97, a80
    v_accvgpr_read_b32 v99, a81
    v_accvgpr_read_b32 v101, a82
    v_accvgpr_read_b32 v103, a83
    v_pk_mul_f32 v[192:193], v[192:193], v[22:23] op_sel:[0,0] op_sel_hi:[1,0]
    v_pk_mul_f32 v[194:195], v[194:195], v[22:23] op_sel:[0,0] op_sel_hi:[1,0]
    v_pk_mul_f32 v[200:201], v[200:201], v[22:23] op_sel:[0,0] op_sel_hi:[1,0]
    v_pk_mul_f32 v[202:203], v[202:203], v[22:23] op_sel:[0,0] op_sel_hi:[1,0]
    v_lshlrev_b32 v96, 16, v97
    v_and_b32 v97, 0xffff0000, v97
    v_lshlrev_b32 v98, 16, v99
    v_and_b32 v99, 0xffff0000, v99
    v_lshlrev_b32 v100, 16, v101
    v_and_b32 v101, 0xffff0000, v101
    v_lshlrev_b32 v102, 16, v103
    v_and_b32 v103, 0xffff0000, v103
    v_pk_fma_f32 v[192:193], v[96:97], v[24:25], v[192:193] op_sel:[0,0,0] op_sel_hi:[1,0,1]
    v_pk_fma_f32 v[194:195], v[98:99], v[24:25], v[194:195] op_sel:[0,0,0] op_sel_hi:[1,0,1]
    v_pk_fma_f32 v[200:201], v[100:101], v[24:25], v[200:201] op_sel:[0,0,0] op_sel_hi:[1,0,1]
    v_pk_fma_f32 v[202:203], v[102:103], v[24:25], v[202:203] op_sel:[0,0,0] op_sel_hi:[1,0,1]
    v_cvt_pk_bf16_f32 v48, v192, v193
    v_cvt_pk_bf16_f32 v49, v194, v195
    v_cvt_pk_bf16_f32 v50, v200, v201
    v_cvt_pk_bf16_f32 v51, v202, v203
    v_accvgpr_read_b32 v97, a84
    v_accvgpr_read_b32 v99, a85
    v_accvgpr_read_b32 v101, a86
    v_accvgpr_read_b32 v103, a87
    v_pk_mul_f32 v[208:209], v[208:209], v[22:23] op_sel:[0,0] op_sel_hi:[1,0]
    v_pk_mul_f32 v[210:211], v[210:211], v[22:23] op_sel:[0,0] op_sel_hi:[1,0]
    v_pk_mul_f32 v[216:217], v[216:217], v[22:23] op_sel:[0,0] op_sel_hi:[1,0]
    v_pk_mul_f32 v[218:219], v[218:219], v[22:23] op_sel:[0,0] op_sel_hi:[1,0]
    v_lshlrev_b32 v96, 16, v97
    v_and_b32 v97, 0xffff0000, v97
    v_lshlrev_b32 v98, 16, v99
    v_and_b32 v99, 0xffff0000, v99
    v_lshlrev_b32 v100, 16, v101
    v_and_b32 v101, 0xffff0000, v101
    v_lshlrev_b32 v102, 16, v103
    v_and_b32 v103, 0xffff0000, v103
    v_pk_fma_f32 v[208:209], v[96:97], v[24:25], v[208:209] op_sel:[0,0,0] op_sel_hi:[1,0,1]
    v_pk_fma_f32 v[210:211], v[98:99], v[24:25], v[210:211] op_sel:[0,0,0] op_sel_hi:[1,0,1]
    v_pk_fma_f32 v[216:217], v[100:101], v[24:25], v[216:217] op_sel:[0,0,0] op_sel_hi:[1,0,1]
    v_pk_fma_f32 v[218:219], v[102:103], v[24:25], v[218:219] op_sel:[0,0,0] op_sel_hi:[1,0,1]
    v_cvt_pk_bf16_f32 v52, v208, v209
    v_cvt_pk_bf16_f32 v53, v210, v211
    v_cvt_pk_bf16_f32 v54, v216, v217
    v_cvt_pk_bf16_f32 v55, v218, v219
    v_accvgpr_read_b32 v97, a88
    v_accvgpr_read_b32 v99, a89
    v_accvgpr_read_b32 v101, a90
    v_accvgpr_read_b32 v103, a91
    v_pk_mul_f32 v[224:225], v[224:225], v[22:23] op_sel:[0,0] op_sel_hi:[1,0]
    v_pk_mul_f32 v[226:227], v[226:227], v[22:23] op_sel:[0,0] op_sel_hi:[1,0]
    v_pk_mul_f32 v[232:233], v[232:233], v[22:23] op_sel:[0,0] op_sel_hi:[1,0]
    v_pk_mul_f32 v[234:235], v[234:235], v[22:23] op_sel:[0,0] op_sel_hi:[1,0]
    v_lshlrev_b32 v96, 16, v97
    v_and_b32 v97, 0xffff0000, v97
    v_lshlrev_b32 v98, 16, v99
    v_and_b32 v99, 0xffff0000, v99
    v_lshlrev_b32 v100, 16, v101
    v_and_b32 v101, 0xffff0000, v101
    v_lshlrev_b32 v102, 16, v103
    v_and_b32 v103, 0xffff0000, v103
    v_pk_fma_f32 v[224:225], v[96:97], v[24:25], v[224:225] op_sel:[0,0,0] op_sel_hi:[1,0,1]
    v_pk_fma_f32 v[226:227], v[98:99], v[24:25], v[226:227] op_sel:[0,0,0] op_sel_hi:[1,0,1]
    v_pk_fma_f32 v[232:233], v[100:101], v[24:25], v[232:233] op_sel:[0,0,0] op_sel_hi:[1,0,1]
    v_pk_fma_f32 v[234:235], v[102:103], v[24:25], v[234:235] op_sel:[0,0,0] op_sel_hi:[1,0,1]
    v_cvt_pk_bf16_f32 v56, v224, v225
    v_cvt_pk_bf16_f32 v57, v226, v227
    v_cvt_pk_bf16_f32 v58, v232, v233
    v_cvt_pk_bf16_f32 v59, v234, v235
    v_accvgpr_read_b32 v97, a92
    v_accvgpr_read_b32 v99, a93
    v_accvgpr_read_b32 v101, a94
    v_accvgpr_read_b32 v103, a95
    v_pk_mul_f32 v[240:241], v[240:241], v[22:23] op_sel:[0,0] op_sel_hi:[1,0]
    v_pk_mul_f32 v[242:243], v[242:243], v[22:23] op_sel:[0,0] op_sel_hi:[1,0]
    v_pk_mul_f32 v[248:249], v[248:249], v[22:23] op_sel:[0,0] op_sel_hi:[1,0]
    v_pk_mul_f32 v[250:251], v[250:251], v[22:23] op_sel:[0,0] op_sel_hi:[1,0]
    v_lshlrev_b32 v96, 16, v97
    v_and_b32 v97, 0xffff0000, v97
    v_lshlrev_b32 v98, 16, v99
    v_and_b32 v99, 0xffff0000, v99
    v_lshlrev_b32 v100, 16, v101
    v_and_b32 v101, 0xffff0000, v101
    v_lshlrev_b32 v102, 16, v103
    v_and_b32 v103, 0xffff0000, v103
    v_pk_fma_f32 v[240:241], v[96:97], v[24:25], v[240:241] op_sel:[0,0,0] op_sel_hi:[1,0,1]
    v_pk_fma_f32 v[242:243], v[98:99], v[24:25], v[242:243] op_sel:[0,0,0] op_sel_hi:[1,0,1]
    v_pk_fma_f32 v[248:249], v[100:101], v[24:25], v[248:249] op_sel:[0,0,0] op_sel_hi:[1,0,1]
    v_pk_fma_f32 v[250:251], v[102:103], v[24:25], v[250:251] op_sel:[0,0,0] op_sel_hi:[1,0,1]
    v_cvt_pk_bf16_f32 v60, v240, v241
    v_cvt_pk_bf16_f32 v61, v242, v243
    v_cvt_pk_bf16_f32 v62, v248, v249
    v_cvt_pk_bf16_f32 v63, v250, v251
    v_accvgpr_read_b32 v97, a96
    v_accvgpr_read_b32 v99, a97
    v_accvgpr_read_b32 v101, a98
    v_accvgpr_read_b32 v103, a99
    v_pk_mul_f32 v[132:133], v[132:133], v[22:23] op_sel:[0,1] op_sel_hi:[1,1]
    v_pk_mul_f32 v[134:135], v[134:135], v[22:23] op_sel:[0,1] op_sel_hi:[1,1]
    v_pk_mul_f32 v[140:141], v[140:141], v[22:23] op_sel:[0,1] op_sel_hi:[1,1]
    v_pk_mul_f32 v[142:143], v[142:143], v[22:23] op_sel:[0,1] op_sel_hi:[1,1]
    v_lshlrev_b32 v96, 16, v97
    v_and_b32 v97, 0xffff0000, v97
    v_lshlrev_b32 v98, 16, v99
    v_and_b32 v99, 0xffff0000, v99
    v_lshlrev_b32 v100, 16, v101
    v_and_b32 v101, 0xffff0000, v101
    v_lshlrev_b32 v102, 16, v103
    v_and_b32 v103, 0xffff0000, v103
    v_pk_fma_f32 v[132:133], v[96:97], v[24:25], v[132:133] op_sel:[0,1,0] op_sel_hi:[1,1,1]
    v_pk_fma_f32 v[134:135], v[98:99], v[24:25], v[134:135] op_sel:[0,1,0] op_sel_hi:[1,1,1]
    v_pk_fma_f32 v[140:141], v[100:101], v[24:25], v[140:141] op_sel:[0,1,0] op_sel_hi:[1,1,1]
    v_pk_fma_f32 v[142:143], v[102:103], v[24:25], v[142:143] op_sel:[0,1,0] op_sel_hi:[1,1,1]
    v_cvt_pk_bf16_f32 v64, v132, v133
    v_cvt_pk_bf16_f32 v65, v134, v135
    v_cvt_pk_bf16_f32 v66, v140, v141
    v_cvt_pk_bf16_f32 v67, v142, v143
    v_accvgpr_read_b32 v97, a100
    v_accvgpr_read_b32 v99, a101
    v_accvgpr_read_b32 v101, a102
    v_accvgpr_read_b32 v103, a103
    v_pk_mul_f32 v[148:149], v[148:149], v[22:23] op_sel:[0,1] op_sel_hi:[1,1]
    v_pk_mul_f32 v[150:151], v[150:151], v[22:23] op_sel:[0,1] op_sel_hi:[1,1]
    v_pk_mul_f32 v[156:157], v[156:157], v[22:23] op_sel:[0,1] op_sel_hi:[1,1]
    v_pk_mul_f32 v[158:159], v[158:159], v[22:23] op_sel:[0,1] op_sel_hi:[1,1]
    v_lshlrev_b32 v96, 16, v97
    v_and_b32 v97, 0xffff0000, v97
    v_lshlrev_b32 v98, 16, v99
    v_and_b32 v99, 0xffff0000, v99
    v_lshlrev_b32 v100, 16, v101
    v_and_b32 v101, 0xffff0000, v101
    v_lshlrev_b32 v102, 16, v103
    v_and_b32 v103, 0xffff0000, v103
    v_pk_fma_f32 v[148:149], v[96:97], v[24:25], v[148:149] op_sel:[0,1,0] op_sel_hi:[1,1,1]
    v_pk_fma_f32 v[150:151], v[98:99], v[24:25], v[150:151] op_sel:[0,1,0] op_sel_hi:[1,1,1]
    v_pk_fma_f32 v[156:157], v[100:101], v[24:25], v[156:157] op_sel:[0,1,0] op_sel_hi:[1,1,1]
    v_pk_fma_f32 v[158:159], v[102:103], v[24:25], v[158:159] op_sel:[0,1,0] op_sel_hi:[1,1,1]
    v_cvt_pk_bf16_f32 v68, v148, v149
    v_cvt_pk_bf16_f32 v69, v150, v151
    v_cvt_pk_bf16_f32 v70, v156, v157
    v_cvt_pk_bf16_f32 v71, v158, v159
    v_accvgpr_read_b32 v97, a104
    v_accvgpr_read_b32 v99, a105
    v_accvgpr_read_b32 v101, a106
    v_accvgpr_read_b32 v103, a107
    v_pk_mul_f32 v[164:165], v[164:165], v[22:23] op_sel:[0,1] op_sel_hi:[1,1]
    v_pk_mul_f32 v[166:167], v[166:167], v[22:23] op_sel:[0,1] op_sel_hi:[1,1]
    v_pk_mul_f32 v[172:173], v[172:173], v[22:23] op_sel:[0,1] op_sel_hi:[1,1]
    v_pk_mul_f32 v[174:175], v[174:175], v[22:23] op_sel:[0,1] op_sel_hi:[1,1]
    v_lshlrev_b32 v96, 16, v97
    v_and_b32 v97, 0xffff0000, v97
    v_lshlrev_b32 v98, 16, v99
    v_and_b32 v99, 0xffff0000, v99
    v_lshlrev_b32 v100, 16, v101
    v_and_b32 v101, 0xffff0000, v101
    v_lshlrev_b32 v102, 16, v103
    v_and_b32 v103, 0xffff0000, v103
    v_pk_fma_f32 v[164:165], v[96:97], v[24:25], v[164:165] op_sel:[0,1,0] op_sel_hi:[1,1,1]
    v_pk_fma_f32 v[166:167], v[98:99], v[24:25], v[166:167] op_sel:[0,1,0] op_sel_hi:[1,1,1]
    v_pk_fma_f32 v[172:173], v[100:101], v[24:25], v[172:173] op_sel:[0,1,0] op_sel_hi:[1,1,1]
    v_pk_fma_f32 v[174:175], v[102:103], v[24:25], v[174:175] op_sel:[0,1,0] op_sel_hi:[1,1,1]
    v_cvt_pk_bf16_f32 v72, v164, v165
    v_cvt_pk_bf16_f32 v73, v166, v167
    v_cvt_pk_bf16_f32 v74, v172, v173
    v_cvt_pk_bf16_f32 v75, v174, v175
    v_accvgpr_read_b32 v97, a108
    v_accvgpr_read_b32 v99, a109
    v_accvgpr_read_b32 v101, a110
    v_accvgpr_read_b32 v103, a111
    v_pk_mul_f32 v[180:181], v[180:181], v[22:23] op_sel:[0,1] op_sel_hi:[1,1]
    v_pk_mul_f32 v[182:183], v[182:183], v[22:23] op_sel:[0,1] op_sel_hi:[1,1]
    v_pk_mul_f32 v[188:189], v[188:189], v[22:23] op_sel:[0,1] op_sel_hi:[1,1]
    v_pk_mul_f32 v[190:191], v[190:191], v[22:23] op_sel:[0,1] op_sel_hi:[1,1]
    v_lshlrev_b32 v96, 16, v97
    v_and_b32 v97, 0xffff0000, v97
    v_lshlrev_b32 v98, 16, v99
    v_and_b32 v99, 0xffff0000, v99
    v_lshlrev_b32 v100, 16, v101
    v_and_b32 v101, 0xffff0000, v101
    v_lshlrev_b32 v102, 16, v103
    v_and_b32 v103, 0xffff0000, v103
    v_pk_fma_f32 v[180:181], v[96:97], v[24:25], v[180:181] op_sel:[0,1,0] op_sel_hi:[1,1,1]
    v_pk_fma_f32 v[182:183], v[98:99], v[24:25], v[182:183] op_sel:[0,1,0] op_sel_hi:[1,1,1]
    v_pk_fma_f32 v[188:189], v[100:101], v[24:25], v[188:189] op_sel:[0,1,0] op_sel_hi:[1,1,1]
    v_pk_fma_f32 v[190:191], v[102:103], v[24:25], v[190:191] op_sel:[0,1,0] op_sel_hi:[1,1,1]
    v_cvt_pk_bf16_f32 v76, v180, v181
    v_cvt_pk_bf16_f32 v77, v182, v183
    v_cvt_pk_bf16_f32 v78, v188, v189
    v_cvt_pk_bf16_f32 v79, v190, v191
    v_accvgpr_read_b32 v97, a112
    v_accvgpr_read_b32 v99, a113
    v_accvgpr_read_b32 v101, a114
    v_accvgpr_read_b32 v103, a115
    v_pk_mul_f32 v[196:197], v[196:197], v[22:23] op_sel:[0,1] op_sel_hi:[1,1]
    v_pk_mul_f32 v[198:199], v[198:199], v[22:23] op_sel:[0,1] op_sel_hi:[1,1]
    v_pk_mul_f32 v[204:205], v[204:205], v[22:23] op_sel:[0,1] op_sel_hi:[1,1]
    v_pk_mul_f32 v[206:207], v[206:207], v[22:23] op_sel:[0,1] op_sel_hi:[1,1]
    v_lshlrev_b32 v96, 16, v97
    v_and_b32 v97, 0xffff0000, v97
    v_lshlrev_b32 v98, 16, v99
    v_and_b32 v99, 0xffff0000, v99
    v_lshlrev_b32 v100, 16, v101
    v_and_b32 v101, 0xffff0000, v101
    v_lshlrev_b32 v102, 16, v103
    v_and_b32 v103, 0xffff0000, v103
    v_pk_fma_f32 v[196:197], v[96:97], v[24:25], v[196:197] op_sel:[0,1,0] op_sel_hi:[1,1,1]
    v_pk_fma_f32 v[198:199], v[98:99], v[24:25], v[198:199] op_sel:[0,1,0] op_sel_hi:[1,1,1]
    v_pk_fma_f32 v[204:205], v[100:101], v[24:25], v[204:205] op_sel:[0,1,0] op_sel_hi:[1,1,1]
    v_pk_fma_f32 v[206:207], v[102:103], v[24:25], v[206:207] op_sel:[0,1,0] op_sel_hi:[1,1,1]
    v_cvt_pk_bf16_f32 v80, v196, v197
    v_cvt_pk_bf16_f32 v81, v198, v199
    v_cvt_pk_bf16_f32 v82, v204, v205
    v_cvt_pk_bf16_f32 v83, v206, v207
    v_accvgpr_read_b32 v97, a116
    v_accvgpr_read_b32 v99, a117
    v_accvgpr_read_b32 v101, a118
    v_accvgpr_read_b32 v103, a119
    v_pk_mul_f32 v[212:213], v[212:213], v[22:23] op_sel:[0,1] op_sel_hi:[1,1]
    v_pk_mul_f32 v[214:215], v[214:215], v[22:23] op_sel:[0,1] op_sel_hi:[1,1]
    v_pk_mul_f32 v[220:221], v[220:221], v[22:23] op_sel:[0,1] op_sel_hi:[1,1]
    v_pk_mul_f32 v[222:223], v[222:223], v[22:23] op_sel:[0,1] op_sel_hi:[1,1]
    v_lshlrev_b32 v96, 16, v97
    v_and_b32 v97, 0xffff0000, v97
    v_lshlrev_b32 v98, 16, v99
    v_and_b32 v99, 0xffff0000, v99
    v_lshlrev_b32 v100, 16, v101
    v_and_b32 v101, 0xffff0000, v101
    v_lshlrev_b32 v102, 16, v103
    v_and_b32 v103, 0xffff0000, v103
    v_pk_fma_f32 v[212:213], v[96:97], v[24:25], v[212:213] op_sel:[0,1,0] op_sel_hi:[1,1,1]
    v_pk_fma_f32 v[214:215], v[98:99], v[24:25], v[214:215] op_sel:[0,1,0] op_sel_hi:[1,1,1]
    v_pk_fma_f32 v[220:221], v[100:101], v[24:25], v[220:221] op_sel:[0,1,0] op_sel_hi:[1,1,1]
    v_pk_fma_f32 v[222:223], v[102:103], v[24:25], v[222:223] op_sel:[0,1,0] op_sel_hi:[1,1,1]
    v_cvt_pk_bf16_f32 v84, v212, v213
    v_cvt_pk_bf16_f32 v85, v214, v215
    v_cvt_pk_bf16_f32 v86, v220, v221
    v_cvt_pk_bf16_f32 v87, v222, v223
    v_accvgpr_read_b32 v97, a120
    v_accvgpr_read_b32 v99, a121
    v_accvgpr_read_b32 v101, a122
    v_accvgpr_read_b32 v103, a123
    v_pk_mul_f32 v[228:229], v[228:229], v[22:23] op_sel:[0,1] op_sel_hi:[1,1]
    v_pk_mul_f32 v[230:231], v[230:231], v[22:23] op_sel:[0,1] op_sel_hi:[1,1]
    v_pk_mul_f32 v[236:237], v[236:237], v[22:23] op_sel:[0,1] op_sel_hi:[1,1]
    v_pk_mul_f32 v[238:239], v[238:239], v[22:23] op_sel:[0,1] op_sel_hi:[1,1]
    v_lshlrev_b32 v96, 16, v97
    v_and_b32 v97, 0xffff0000, v97
    v_lshlrev_b32 v98, 16, v99
    v_and_b32 v99, 0xffff0000, v99
    v_lshlrev_b32 v100, 16, v101
    v_and_b32 v101, 0xffff0000, v101
    v_lshlrev_b32 v102, 16, v103
    v_and_b32 v103, 0xffff0000, v103
    v_pk_fma_f32 v[228:229], v[96:97], v[24:25], v[228:229] op_sel:[0,1,0] op_sel_hi:[1,1,1]
    v_pk_fma_f32 v[230:231], v[98:99], v[24:25], v[230:231] op_sel:[0,1,0] op_sel_hi:[1,1,1]
    v_pk_fma_f32 v[236:237], v[100:101], v[24:25], v[236:237] op_sel:[0,1,0] op_sel_hi:[1,1,1]
    v_pk_fma_f32 v[238:239], v[102:103], v[24:25], v[238:239] op_sel:[0,1,0] op_sel_hi:[1,1,1]
    v_cvt_pk_bf16_f32 v88, v228, v229
    v_cvt_pk_bf16_f32 v89, v230, v231
    v_cvt_pk_bf16_f32 v90, v236, v237
    v_cvt_pk_bf16_f32 v91, v238, v239
    v_accvgpr_read_b32 v97, a124
    v_accvgpr_read_b32 v99, a125
    v_accvgpr_read_b32 v101, a126
    v_accvgpr_read_b32 v103, a127
    v_pk_mul_f32 v[244:245], v[244:245], v[22:23] op_sel:[0,1] op_sel_hi:[1,1]
    v_pk_mul_f32 v[246:247], v[246:247], v[22:23] op_sel:[0,1] op_sel_hi:[1,1]
    v_pk_mul_f32 v[252:253], v[252:253], v[22:23] op_sel:[0,1] op_sel_hi:[1,1]
    v_pk_mul_f32 v[254:255], v[254:255], v[22:23] op_sel:[0,1] op_sel_hi:[1,1]
    v_lshlrev_b32 v96, 16, v97
    v_and_b32 v97, 0xffff0000, v97
    v_lshlrev_b32 v98, 16, v99
    v_and_b32 v99, 0xffff0000, v99
    v_lshlrev_b32 v100, 16, v101
    v_and_b32 v101, 0xffff0000, v101
    v_lshlrev_b32 v102, 16, v103
    v_and_b32 v103, 0xffff0000, v103
    v_pk_fma_f32 v[244:245], v[96:97], v[24:25], v[244:245] op_sel:[0,1,0] op_sel_hi:[1,1,1]
    v_pk_fma_f32 v[246:247], v[98:99], v[24:25], v[246:247] op_sel:[0,1,0] op_sel_hi:[1,1,1]
    v_pk_fma_f32 v[252:253], v[100:101], v[24:25], v[252:253] op_sel:[0,1,0] op_sel_hi:[1,1,1]
    v_pk_fma_f32 v[254:255], v[102:103], v[24:25], v[254:255] op_sel:[0,1,0] op_sel_hi:[1,1,1]
    v_cvt_pk_bf16_f32 v92, v244, v245
    v_cvt_pk_bf16_f32 v93, v246, v247
    v_cvt_pk_bf16_f32 v94, v252, v253
    v_cvt_pk_bf16_f32 v95, v254, v255
    s_branch AT_oproj_start
AT_notA:
    s_cmp_eq_u32 s87, 1
    s_cbranch_scc1 AT_B
    s_barrier
    ds_read_b128 a[192:195], v5 offset:0
    ds_read_b128 a[196:199], v5 offset:1024
    ds_read_b128 a[200:203], v5 offset:2048
    ds_read_b128 a[204:207], v5 offset:3072
    ds_read_b128 a[208:211], v5 offset:4096
    ds_read_b128 a[212:215], v5 offset:5120
    ds_read_b128 a[216:219], v5 offset:6144
    ds_read_b128 a[220:223], v5 offset:7168
    s_branch AT_seg1
AT_B:
    v_accvgpr_mov_b32 a64, a128
    v_accvgpr_mov_b32 a65, a129
    v_accvgpr_mov_b32 a66, a130
    v_accvgpr_mov_b32 a67, a131
    v_accvgpr_mov_b32 a68, a132
    v_accvgpr_mov_b32 a69, a133
    v_accvgpr_mov_b32 a70, a134
    v_accvgpr_mov_b32 a71, a135
    v_accvgpr_mov_b32 a72, a136
    v_accvgpr_mov_b32 a73, a137
    v_accvgpr_mov_b32 a74, a138
    v_accvgpr_mov_b32 a75, a139
    v_accvgpr_mov_b32 a76, a140
    v_accvgpr_mov_b32 a77, a141
    v_accvgpr_mov_b32 a78, a142
    v_accvgpr_mov_b32 a79, a143
    v_accvgpr_mov_b32 a80, a144
    v_accvgpr_mov_b32 a81, a145
    v_accvgpr_mov_b32 a82, a146
    v_accvgpr_mov_b32 a83, a147
    v_accvgpr_mov_b32 a84, a148
    v_accvgpr_mov_b32 a85, a149
    v_accvgpr_mov_b32 a86, a150
    v_accvgpr_mov_b32 a87, a151
    v_accvgpr_mov_b32 a88, a152
    v_accvgpr_mov_b32 a89, a153
    v_accvgpr_mov_b32 a90, a154
    v_accvgpr_mov_b32 a91, a155
    v_accvgpr_mov_b32 a92, a156
    v_accvgpr_mov_b32 a93, a157
    v_accvgpr_mov_b32 a94, a158
    v_accvgpr_mov_b32 a95, a159
    v_accvgpr_mov_b32 a96, a160
    v_accvgpr_mov_b32 a97, a161
    v_accvgpr_mov_b32 a98, a162
    v_accvgpr_mov_b32 a99, a163
    v_accvgpr_mov_b32 a100, a164
    v_accvgpr_mov_b32 a101, a165
    v_accvgpr_mov_b32 a102, a166
    v_accvgpr_mov_b32 a103, a167
    v_accvgpr_mov_b32 a104, a168
    v_accvgpr_mov_b32 a105, a169
    v_accvgpr_mov_b32 a106, a170
    v_accvgpr_mov_b32 a107, a171
    v_accvgpr_mov_b32 a108, a172
    v_accvgpr_mov_b32 a109, a173
    v_accvgpr_mov_b32 a110, a174
    v_accvgpr_mov_b32 a111, a175
    v_accvgpr_mov_b32 a112, a176
    v_accvgpr_mov_b32 a113, a177
    v_accvgpr_mov_b32 a114, a178
    v_accvgpr_mov_b32 a115, a179
    v_accvgpr_mov_b32 a116, a180
    v_accvgpr_mov_b32 a117, a181
    v_accvgpr_mov_b32 a118, a182
    v_accvgpr_mov_b32 a119, a183
    v_accvgpr_mov_b32 a120, a184
    v_accvgpr_mov_b32 a121, a185
    v_accvgpr_mov_b32 a122, a186
    v_accvgpr_mov_b32 a123, a187
    v_accvgpr_mov_b32 a124, a188
    v_accvgpr_mov_b32 a125, a189
    v_accvgpr_mov_b32 a126, a190
    v_accvgpr_mov_b32 a127, a191
    s_mov_b32 s3, 0x20000
fq_poll_5:
    buffer_load_dword v9, off, s[12:15], s29 offset:12 sc1
    s_waitcnt vmcnt(0)
    v_cmp_ne_u32 vcc, 1, v9
    s_sub_u32 s3, s3, 1
    s_cbranch_scc1 fq_pdone_6
    s_nop 1
    s_cbranch_vccnz fq_poll_5
fq_pdone_6:
    s_lshl_b32 s25, s30, 3
    s_add_u32 s25, s25, s31
    s_lshl_b32 s25, s25, 2
    s_add_u32 s25, s25, s66
    s_mul_i32 s25, s25, 17408
    s_add_u32 s25, s25, 0
    buffer_load_dwordx4 a[128:131], v1, s[12:15], s25 offen offset:0 sc1
    buffer_load_dwordx4 a[132:135], v1, s[12:15], s25 offen offset:1024 sc1
    buffer_load_dwordx4 a[136:139], v1, s[12:15], s25 offen offset:2048 sc1
    buffer_load_dwordx4 a[140:143], v1, s[12:15], s25 offen offset:3072 sc1
    s_add_u32 s25, s25, 4096
    buffer_load_dwordx4 a[144:147], v1, s[12:15], s25 offen offset:0 sc1
    buffer_load_dwordx4 a[148:151], v1, s[12:15], s25 offen offset:1024 sc1
    buffer_load_dwordx4 a[152:155], v1, s[12:15], s25 offen offset:2048 sc1
    buffer_load_dwordx4 a[156:159], v1, s[12:15], s25 offen offset:3072 sc1
    s_add_u32 s25, s25, 4096
    buffer_load_dwordx4 a[160:163], v1, s[12:15], s25 offen offset:0 sc1
    buffer_load_dwordx4 a[164:167], v1, s[12:15], s25 offen offset:1024 sc1
    buffer_load_dwordx4 a[168:171], v1, s[12:15], s25 offen offset:2048 sc1
    buffer_load_dwordx4 a[172:175], v1, s[12:15], s25 offen offset:3072 sc1
    s_add_u32 s25, s25, 4096
    buffer_load_dwordx4 a[176:179], v1, s[12:15], s25 offen offset:0 sc1
    buffer_load_dwordx4 a[180:183], v1, s[12:15], s25 offen offset:1024 sc1
    buffer_load_dwordx4 a[184:187], v1, s[12:15], s25 offen offset:2048 sc1
    buffer_load_dwordx4 a[188:191], v1, s[12:15], s25 offen offset:3072 sc1
    s_barrier
    ds_read_b128 a[192:195], v5 offset:0
    ds_read_b128 a[196:199], v5 offset:1024
    ds_read_b128 a[200:203], v5 offset:2048
    ds_read_b128 a[204:207], v5 offset:3072
    ds_read_b128 a[208:211], v5 offset:4096
    ds_read_b128 a[212:215], v5 offset:5120
    ds_read_b128 a[216:219], v5 offset:6144
    ds_read_b128 a[220:223], v5 offset:7168
    s_waitcnt vmcnt(0)
AT_seg1:
    s_add_u32 s25, s34, s66
    s_cmp_eq_u32 s25, 4
    s_cbranch_scc1 AT_s1_single
    s_call_b64 s[82:83], AT_qkfirst
    s_sub_u32 s25, s25, 5
    s_cmp_lt_i32 s25, 1
    s_cbranch_scc1 skip_7
    s_add_u32 s21, s20, s25
    s_call_b64 s[82:83], AT_full
skip_7:
    v_mov_b32 v9, 0xff3fffff
    v_cndmask_b32 v96, v16, v9, s[70:71]
    v_cndmask_b32 v97, v16, v9, s[72:73]
    v_cndmask_b32 v98, v16, v9, s[74:75]
    v_cndmask_b32 v99, v16, v9, s[76:77]
    v_mov_b32 v104, v9
    v_mov_b32 v105, v9
    v_mov_b32 v106, v9
    v_mov_b32 v107, v9
    v_cndmask_b32 v108, v17, v9, s[70:71]
    v_cndmask_b32 v109, v17, v9, s[72:73]
    v_cndmask_b32 v110, v17, v9, s[74:75]
    v_cndmask_b32 v111, v17, v9, s[76:77]
    s_add_u32 s21, s20, 1
    s_call_b64 s[82:83], AT_full
    s_branch AT_s1_last
AT_s1_single:
    v_mov_b32 v9, 0xff3fffff
    v_cndmask_b32 v96, 0, v9, s[70:71]
    v_cndmask_b32 v97, 0, v9, s[72:73]
    v_cndmask_b32 v98, 0, v9, s[74:75]
    v_cndmask_b32 v99, 0, v9, s[76:77]
    v_mov_b32 v100, 0
    v_mov_b32 v101, 0
    v_mov_b32 v102, 0
    v_mov_b32 v103, 0
    v_mov_b32 v104, v9
    v_mov_b32 v105, v9
    v_mov_b32 v106, v9
    v_mov_b32 v107, v9
    v_cndmask_b32 v108, 0, v9, s[70:71]
    v_cndmask_b32 v109, 0, v9, s[72:73]
    v_cndmask_b32 v110, 0, v9, s[74:75]
    v_cndmask_b32 v111, 0, v9, s[76:77]
    s_call_b64 s[82:83], AT_qkfirst
AT_s1_last:
    s_lshl_b32 s25, s30, 3
    s_add_u32 s25, s25, s31
    s_lshl_b32 s25, s25, 2
    s_add_u32 s25, s25, s66
    s_mul_i32 s25, s25, 17408
    s_add_u32 s25, s25, 16384
    buffer_load_dword v114, off, s[12:15], s29 offset:32 sc1
    buffer_load_dwordx2 v[112:113], v1, s[12:15], s25 offen sc1
    s_mov_b32 s3, 111280128
    buffer_load_dwordx4 v[124:127], v1, s[12:15], s3 offen sc1
    s_call_b64 s[82:83], AT_pvlast
    s_nop 3
    v_mov_b32 v9, v18
    v_mov_b32 v10, v19
    s_nop 0
    v_permlane16_swap_b32 v18, v9
    v_permlane16_swap_b32 v19, v10
    s_nop 0
    v_add_f32 v18, v18, v9
    v_add_f32 v19, v19, v10
    v_mov_b32 v9, v18
    v_mov_b32 v10, v19
    s_nop 0
    v_permlane32_swap_b32 v18, v9
    v_permlane32_swap_b32 v19, v10
    s_nop 0
    v_add_f32 v18, v18, v9
    v_add_f32 v19, v19, v10
    s_cmp_eq_u32 s87, 1
    s_cbranch_scc1 AT_B_gap
    s_lshl_b32 s80, s30, 3
    s_add_u32 s80, s80, s31
    s_lshl_b32 s80, s80, 2
    s_add_u32 s80, s80, s66
    s_mul_i32 s80, s80, 17408
    s_add_u32 s80, s80, 0
    s_cmp_eq_u32 s32, 1
    s_cselect_b32 s3, 58720256, 0
    s_add_u32 s80, s80, s3
    v_lshlrev_b32 v121, 3, v1
    s_add_u32 s3, s80, 8192
    buffer_load_dword v122, v121, s[12:15], s80 offen
    buffer_load_dword v123, v121, s[12:15], s3 offen
    buffer_load_dword v120, v1, s[44:47], s48 offen
    v_rcp_f32 v26, v18
    v_rcp_f32 v27, v19
    v_cvt_pk_bf16_f32 v32, v128, v129
    v_cvt_pk_bf16_f32 v33, v130, v131
    v_cvt_pk_bf16_f32 v34, v136, v137
    v_cvt_pk_bf16_f32 v35, v138, v139
    v_cvt_pk_bf16_f32 v36, v144, v145
    v_cvt_pk_bf16_f32 v37, v146, v147
    v_cvt_pk_bf16_f32 v38, v152, v153
    v_cvt_pk_bf16_f32 v39, v154, v155
    v_cvt_pk_bf16_f32 v40, v160, v161
    v_cvt_pk_bf16_f32 v41, v162, v163
    v_cvt_pk_bf16_f32 v42, v168, v169
    v_cvt_pk_bf16_f32 v43, v170, v171
    v_cvt_pk_bf16_f32 v44, v176, v177
    v_cvt_pk_bf16_f32 v45, v178, v179
    v_cvt_pk_bf16_f32 v46, v184, v185
    v_cvt_pk_bf16_f32 v47, v186, v187
    v_cvt_pk_bf16_f32 v48, v192, v193
    v_cvt_pk_bf16_f32 v49, v194, v195
    v_cvt_pk_bf16_f32 v50, v200, v201
    v_cvt_pk_bf16_f32 v51, v202, v203
    v_cvt_pk_bf16_f32 v52, v208, v209
    v_cvt_pk_bf16_f32 v53, v210, v211
    v_cvt_pk_bf16_f32 v54, v216, v217
    v_cvt_pk_bf16_f32 v55, v218, v219
    v_cvt_pk_bf16_f32 v56, v224, v225
    v_cvt_pk_bf16_f32 v57, v226, v227
    v_cvt_pk_bf16_f32 v58, v232, v233
    v_cvt_pk_bf16_f32 v59, v234, v235
    v_cvt_pk_bf16_f32 v60, v240, v241
    v_cvt_pk_bf16_f32 v61, v242, v243
    v_cvt_pk_bf16_f32 v62, v248, v249
    v_cvt_pk_bf16_f32 v63, v250, v251
    v_cvt_pk_bf16_f32 v64, v132, v133
    v_cvt_pk_bf16_f32 v65, v134, v135
    v_cvt_pk_bf16_f32 v66, v140, v141
    v_cvt_pk_bf16_f32 v67, v142, v143
    v_cvt_pk_bf16_f32 v68, v148, v149
    v_cvt_pk_bf16_f32 v69, v150, v151
    v_cvt_pk_bf16_f32 v70, v156, v157
    v_cvt_pk_bf16_f32 v71, v158, v159
    v_cvt_pk_bf16_f32 v72, v164, v165
    v_cvt_pk_bf16_f32 v73, v166, v167
    v_cvt_pk_bf16_f32 v74, v172, v173
    v_cvt_pk_bf16_f32 v75, v174, v175
    v_cvt_pk_bf16_f32 v76, v180, v181
    v_cvt_pk_bf16_f32 v77, v182, v183
    v_cvt_pk_bf16_f32 v78, v188, v189
    v_cvt_pk_bf16_f32 v79, v190, v191
    v_cvt_pk_bf16_f32 v80, v196, v197
    v_cvt_pk_bf16_f32 v81, v198, v199
    v_cvt_pk_bf16_f32 v82, v204, v205
    v_cvt_pk_bf16_f32 v83, v206, v207
    v_cvt_pk_bf16_f32 v84, v212, v213
    v_cvt_pk_bf16_f32 v85, v214, v215
    v_cvt_pk_bf16_f32 v86, v220, v221
    v_cvt_pk_bf16_f32 v87, v222, v223
    v_cvt_pk_bf16_f32 v88, v228, v229
    v_cvt_pk_bf16_f32 v89, v230, v231
    v_cvt_pk_bf16_f32 v90, v236, v237
    v_cvt_pk_bf16_f32 v91, v238, v239
    v_cvt_pk_bf16_f32 v92, v244, v245
    v_cvt_pk_bf16_f32 v93, v246, v247
    v_cvt_pk_bf16_f32 v94, v252, v253
    v_cvt_pk_bf16_f32 v95, v254, v255
    s_sub_u32 s25, 3, s66
    s_cmp_lt_i32 s25, 1
    s_cbranch_scc1 skip_8
    s_add_u32 s21, s20, s25
    s_call_b64 s[82:83], AT_idle
skip_8:
    s_branch AT_oproj_start
AT_B_gap:
    s_waitcnt vmcnt(9)
    v_readfirstlane_b32 s3, v114
    s_cmp_eq_u32 s3, 1
    s_cbranch_scc1 AT_B_havem
    buffer_load_dword v114, off, s[12:15], s29 offset:32 sc1
    buffer_load_dwordx2 v[112:113], v1, s[12:15], s25 offen sc1
    s_waitcnt vmcnt(0)
AT_B_havem:
    s_lshl_b32 s25, s30, 3
    s_add_u32 s25, s25, s31
    s_lshl_b32 s25, s25, 2
    s_add_u32 s25, s25, s66
    s_mul_i32 s25, s25, 17408
    s_add_u32 s25, s25, 58720256
    s_mov_b32 s3, 0x42700000
    v_cmp_eq_u32 s[88:89], 1, v114
    v_sub_f32 v9, v112, v16
    v_cmp_ge_f32 vcc, s3, abs(v9)
    s_nop 1
    s_and_b64 vcc, vcc, s[88:89]
    v_cndmask_b32 v9, 0, v9, vcc
    v_cndmask_b32 v16, v16, v112, vcc
    v_exp_f32 v22, v9
    s_nop 0
    v_mul_f32 v18, v18, v22
    v_sub_f32 v9, v113, v17
    v_cmp_ge_f32 vcc, s3, abs(v9)
    s_nop 1
    s_and_b64 vcc, vcc, s[88:89]
    v_cndmask_b32 v9, 0, v9, vcc
    v_cndmask_b32 v17, v17, v113, vcc
    v_exp_f32 v23, v9
    s_nop 0
    v_mul_f32 v19, v19, v23
    v_pk_mul_f32 v[128:129], v[128:129], v[22:23] op_sel:[0,0] op_sel_hi:[1,0]
    v_pk_mul_f32 v[130:131], v[130:131], v[22:23] op_sel:[0,0] op_sel_hi:[1,0]
    v_pk_mul_f32 v[136:137], v[136:137], v[22:23] op_sel:[0,0] op_sel_hi:[1,0]
    v_pk_mul_f32 v[138:139], v[138:139], v[22:23] op_sel:[0,0] op_sel_hi:[1,0]
    v_cvt_pk_bf16_f32 v32, v128, v129
    v_cvt_pk_bf16_f32 v33, v130, v131
    v_cvt_pk_bf16_f32 v34, v136, v137
    v_cvt_pk_bf16_f32 v35, v138, v139
    buffer_store_dwordx4 v[32:35], v1, s[12:15], s25 offen offset:0 sc1
    v_pk_mul_f32 v[144:145], v[144:145], v[22:23] op_sel:[0,0] op_sel_hi:[1,0]
    v_pk_mul_f32 v[146:147], v[146:147], v[22:23] op_sel:[0,0] op_sel_hi:[1,0]
    v_pk_mul_f32 v[152:153], v[152:153], v[22:23] op_sel:[0,0] op_sel_hi:[1,0]
    v_pk_mul_f32 v[154:155], v[154:155], v[22:23] op_sel:[0,0] op_sel_hi:[1,0]
    v_cvt_pk_bf16_f32 v36, v144, v145
    v_cvt_pk_bf16_f32 v37, v146, v147
    v_cvt_pk_bf16_f32 v38, v152, v153
    v_cvt_pk_bf16_f32 v39, v154, v155
    buffer_store_dwordx4 v[36:39], v1, s[12:15], s25 offen offset:1024 sc1
    v_pk_mul_f32 v[160:161], v[160:161], v[22:23] op_sel:[0,0] op_sel_hi:[1,0]
    v_pk_mul_f32 v[162:163], v[162:163], v[22:23] op_sel:[0,0] op_sel_hi:[1,0]
    v_pk_mul_f32 v[168:169], v[168:169], v[22:23] op_sel:[0,0] op_sel_hi:[1,0]
    v_pk_mul_f32 v[170:171], v[170:171], v[22:23] op_sel:[0,0] op_sel_hi:[1,0]
    v_cvt_pk_bf16_f32 v40, v160, v161
    v_cvt_pk_bf16_f32 v41, v162, v163
    v_cvt_pk_bf16_f32 v42, v168, v169
    v_cvt_pk_bf16_f32 v43, v170, v171
    buffer_store_dwordx4 v[40:43], v1, s[12:15], s25 offen offset:2048 sc1
    v_pk_mul_f32 v[176:177], v[176:177], v[22:23] op_sel:[0,0] op_sel_hi:[1,0]
    v_pk_mul_f32 v[178:179], v[178:179], v[22:23] op_sel:[0,0] op_sel_hi:[1,0]
    v_pk_mul_f32 v[184:185], v[184:185], v[22:23] op_sel:[0,0] op_sel_hi:[1,0]
    v_pk_mul_f32 v[186:187], v[186:187], v[22:23] op_sel:[0,0] op_sel_hi:[1,0]
    v_cvt_pk_bf16_f32 v44, v176, v177
    v_cvt_pk_bf16_f32 v45, v178, v179
    v_cvt_pk_bf16_f32 v46, v184, v185
    v_cvt_pk_bf16_f32 v47, v186, v187
    buffer_store_dwordx4 v[44:47], v1, s[12:15], s25 offen offset:3072 sc1
    v_pk_mul_f32 v[192:193], v[192:193], v[22:23] op_sel:[0,0] op_sel_hi:[1,0]
    v_pk_mul_f32 v[194:195], v[194:195], v[22:23] op_sel:[0,0] op_sel_hi:[1,0]
    v_pk_mul_f32 v[200:201], v[200:201], v[22:23] op_sel:[0,0] op_sel_hi:[1,0]
    v_pk_mul_f32 v[202:203], v[202:203], v[22:23] op_sel:[0,0] op_sel_hi:[1,0]
    v_cvt_pk_bf16_f32 v48, v192, v193
    v_cvt_pk_bf16_f32 v49, v194, v195
    v_cvt_pk_bf16_f32 v50, v200, v201
    v_cvt_pk_bf16_f32 v51, v202, v203
    s_add_u32 s25, s25, 4096
    buffer_store_dwordx4 v[48:51], v1, s[12:15], s25 offen offset:0 sc1
    v_pk_mul_f32 v[208:209], v[208:209], v[22:23] op_sel:[0,0] op_sel_hi:[1,0]
    v_pk_mul_f32 v[210:211], v[210:211], v[22:23] op_sel:[0,0] op_sel_hi:[1,0]
    v_pk_mul_f32 v[216:217], v[216:217], v[22:23] op_sel:[0,0] op_sel_hi:[1,0]
    v_pk_mul_f32 v[218:219], v[218:219], v[22:23] op_sel:[0,0] op_sel_hi:[1,0]
    v_cvt_pk_bf16_f32 v52, v208, v209
    v_cvt_pk_bf16_f32 v53, v210, v211
    v_cvt_pk_bf16_f32 v54, v216, v217
    v_cvt_pk_bf16_f32 v55, v218, v219
    buffer_store_dwordx4 v[52:55], v1, s[12:15], s25 offen offset:1024 sc1
    v_pk_mul_f32 v[224:225], v[224:225], v[22:23] op_sel:[0,0] op_sel_hi:[1,0]
    v_pk_mul_f32 v[226:227], v[226:227], v[22:23] op_sel:[0,0] op_sel_hi:[1,0]
    v_pk_mul_f32 v[232:233], v[232:233], v[22:23] op_sel:[0,0] op_sel_hi:[1,0]
    v_pk_mul_f32 v[234:235], v[234:235], v[22:23] op_sel:[0,0] op_sel_hi:[1,0]
    v_cvt_pk_bf16_f32 v56, v224, v225
    v_cvt_pk_bf16_f32 v57, v226, v227
    v_cvt_pk_bf16_f32 v58, v232, v233
    v_cvt_pk_bf16_f32 v59, v234, v235
    buffer_store_dwordx4 v[56:59], v1, s[12:15], s25 offen offset:2048 sc1
    v_pk_mul_f32 v[240:241], v[240:241], v[22:23] op_sel:[0,0] op_sel_hi:[1,0]
    v_pk_mul_f32 v[242:243], v[242:243], v[22:23] op_sel:[0,0] op_sel_hi:[1,0]
    v_pk_mul_f32 v[248:249], v[248:249], v[22:23] op_sel:[0,0] op_sel_hi:[1,0]
    v_pk_mul_f32 v[250:251], v[250:251], v[22:23] op_sel:[0,0] op_sel_hi:[1,0]
    v_cvt_pk_bf16_f32 v60, v240, v241
    v_cvt_pk_bf16_f32 v61, v242, v243
    v_cvt_pk_bf16_f32 v62, v248, v249
    v_cvt_pk_bf16_f32 v63, v250, v251
    buffer_store_dwordx4 v[60:63], v1, s[12:15], s25 offen offset:3072 sc1
    v_pk_mul_f32 v[132:133], v[132:133], v[22:23] op_sel:[0,1] op_sel_hi:[1,1]
    v_pk_mul_f32 v[134:135], v[134:135], v[22:23] op_sel:[0,1] op_sel_hi:[1,1]
    v_pk_mul_f32 v[140:141], v[140:141], v[22:23] op_sel:[0,1] op_sel_hi:[1,1]
    v_pk_mul_f32 v[142:143], v[142:143], v[22:23] op_sel:[0,1] op_sel_hi:[1,1]
    v_cvt_pk_bf16_f32 v64, v132, v133
    v_cvt_pk_bf16_f32 v65, v134, v135
    v_cvt_pk_bf16_f32 v66, v140, v141
    v_cvt_pk_bf16_f32 v67, v142, v143
    s_add_u32 s25, s25, 4096
    buffer_store_dwordx4 v[64:67], v1, s[12:15], s25 offen offset:0 sc1
    v_pk_mul_f32 v[148:149], v[148:149], v[22:23] op_sel:[0,1] op_sel_hi:[1,1]
    v_pk_mul_f32 v[150:151], v[150:151], v[22:23] op_sel:[0,1] op_sel_hi:[1,1]
    v_pk_mul_f32 v[156:157], v[156:157], v[22:23] op_sel:[0,1] op_sel_hi:[1,1]
    v_pk_mul_f32 v[158:159], v[158:159], v[22:23] op_sel:[0,1] op_sel_hi:[1,1]
    v_cvt_pk_bf16_f32 v68, v148, v149
    v_cvt_pk_bf16_f32 v69, v150, v151
    v_cvt_pk_bf16_f32 v70, v156, v157
    v_cvt_pk_bf16_f32 v71, v158, v159
    v_pk_mul_f32 v[164:165], v[164:165], v[22:23] op_sel:[0,1] op_sel_hi:[1,1]
    v_pk_mul_f32 v[166:167], v[166:167], v[22:23] op_sel:[0,1] op_sel_hi:[1,1]
    v_pk_mul_f32 v[172:173], v[172:173], v[22:23] op_sel:[0,1] op_sel_hi:[1,1]
    v_pk_mul_f32 v[174:175], v[174:175], v[22:23] op_sel:[0,1] op_sel_hi:[1,1]
    v_cvt_pk_bf16_f32 v72, v164, v165
    v_cvt_pk_bf16_f32 v73, v166, v167
    v_cvt_pk_bf16_f32 v74, v172, v173
    v_cvt_pk_bf16_f32 v75, v174, v175
    v_pk_mul_f32 v[180:181], v[180:181], v[22:23] op_sel:[0,1] op_sel_hi:[1,1]
    v_pk_mul_f32 v[182:183], v[182:183], v[22:23] op_sel:[0,1] op_sel_hi:[1,1]
    v_pk_mul_f32 v[188:189], v[188:189], v[22:23] op_sel:[0,1] op_sel_hi:[1,1]
    v_pk_mul_f32 v[190:191], v[190:191], v[22:23] op_sel:[0,1] op_sel_hi:[1,1]
    v_cvt_pk_bf16_f32 v76, v180, v181
    v_cvt_pk_bf16_f32 v77, v182, v183
    v_cvt_pk_bf16_f32 v78, v188, v189
    v_cvt_pk_bf16_f32 v79, v190, v191
    v_pk_mul_f32 v[196:197], v[196:197], v[22:23] op_sel:[0,1] op_sel_hi:[1,1]
    v_pk_mul_f32 v[198:199], v[198:199], v[22:23] op_sel:[0,1] op_sel_hi:[1,1]
    v_pk_mul_f32 v[204:205], v[204:205], v[22:23] op_sel:[0,1] op_sel_hi:[1,1]
    v_pk_mul_f32 v[206:207], v[206:207], v[22:23] op_sel:[0,1] op_sel_hi:[1,1]
    v_cvt_pk_bf16_f32 v80, v196, v197
    v_cvt_pk_bf16_f32 v81, v198, v199
    v_cvt_pk_bf16_f32 v82, v204, v205
    v_cvt_pk_bf16_f32 v83, v206, v207
    v_pk_mul_f32 v[212:213], v[212:213], v[22:23] op_sel:[0,1] op_sel_hi:[1,1]
    v_pk_mul_f32 v[214:215], v[214:215], v[22:23] op_sel:[0,1] op_sel_hi:[1,1]
    v_pk_mul_f32 v[220:221], v[220:221], v[22:23] op_sel:[0,1] op_sel_hi:[1,1]
    v_pk_mul_f32 v[222:223], v[222:223], v[22:23] op_sel:[0,1] op_sel_hi:[1,1]
    v_cvt_pk_bf16_f32 v84, v212, v213
    v_cvt_pk_bf16_f32 v85, v214, v215
    v_cvt_pk_bf16_f32 v86, v220, v221
    v_cvt_pk_bf16_f32 v87, v222, v223
    v_pk_mul_f32 v[228:229], v[228:229], v[22:23] op_sel:[0,1] op_sel_hi:[1,1]
    v_pk_mul_f32 v[230:231], v[230:231], v[22:23] op_sel:[0,1] op_sel_hi:[1,1]
    v_pk_mul_f32 v[236:237], v[236:237], v[22:23] op_sel:[0,1] op_sel_hi:[1,1]
    v_pk_mul_f32 v[238:239], v[238:239], v[22:23] op_sel:[0,1] op_sel_hi:[1,1]
    v_cvt_pk_bf16_f32 v88, v228, v229
    v_cvt_pk_bf16_f32 v89, v230, v231
    v_cvt_pk_bf16_f32 v90, v236, v237
    v_cvt_pk_bf16_f32 v91, v238, v239
    v_pk_mul_f32 v[244:245], v[244:245], v[22:23] op_sel:[0,1] op_sel_hi:[1,1]
    v_pk_mul_f32 v[246:247], v[246:247], v[22:23] op_sel:[0,1] op_sel_hi:[1,1]
    v_pk_mul_f32 v[252:253], v[252:253], v[22:23] op_sel:[0,1] op_sel_hi:[1,1]
    v_pk_mul_f32 v[254:255], v[254:255], v[22:23] op_sel:[0,1] op_sel_hi:[1,1]
    v_cvt_pk_bf16_f32 v92, v244, v245
    v_cvt_pk_bf16_f32 v93, v246, v247
    v_cvt_pk_bf16_f32 v94, v252, v253
    v_cvt_pk_bf16_f32 v95, v254, v255
    s_add_u32 s21, s20, 1
    s_call_b64 s[82:83], AT_idle
    buffer_store_dwordx4 v[68:71], v1, s[12:15], s25 offen offset:1024 sc1
    v_accvgpr_mov_b32 a128, a64
    v_accvgpr_mov_b32 a129, a65
    v_accvgpr_mov_b32 a130, a66
    v_accvgpr_mov_b32 a131, a67
    v_accvgpr_mov_b32 a132, a68
    v_accvgpr_mov_b32 a133, a69
    v_accvgpr_mov_b32 a134, a70
    v_accvgpr_mov_b32 a135, a71
    buffer_store_dwordx4 v[72:75], v1, s[12:15], s25 offen offset:2048 sc1
    v_accvgpr_mov_b32 a136, a72
    v_accvgpr_mov_b32 a137, a73
    v_accvgpr_mov_b32 a138, a74
    v_accvgpr_mov_b32 a139, a75
    v_accvgpr_mov_b32 a140, a76
    v_accvgpr_mov_b32 a141, a77
    v_accvgpr_mov_b32 a142, a78
    v_accvgpr_mov_b32 a143, a79
    buffer_store_dwordx4 v[76:79], v1, s[12:15], s25 offen offset:3072 sc1
    v_accvgpr_mov_b32 a144, a80
    v_accvgpr_mov_b32 a145, a81
    v_accvgpr_mov_b32 a146, a82
    v_accvgpr_mov_b32 a147, a83
    v_accvgpr_mov_b32 a148, a84
    v_accvgpr_mov_b32 a149, a85
    v_accvgpr_mov_b32 a150, a86
    v_accvgpr_mov_b32 a151, a87
    s_add_u32 s25, s25, 4096
    buffer_store_dwordx4 v[80:83], v1, s[12:15], s25 offen offset:0 sc1
    v_accvgpr_mov_b32 a152, a88
    v_accvgpr_mov_b32 a153, a89
    v_accvgpr_mov_b32 a154, a90
    v_accvgpr_mov_b32 a155, a91
    v_accvgpr_mov_b32 a156, a92
    v_accvgpr_mov_b32 a157, a93
    v_accvgpr_mov_b32 a158, a94
    v_accvgpr_mov_b32 a159, a95
    buffer_store_dwordx4 v[84:87], v1, s[12:15], s25 offen offset:1024 sc1
    v_accvgpr_mov_b32 a160, a96
    v_accvgpr_mov_b32 a161, a97
    v_accvgpr_mov_b32 a162, a98
    v_accvgpr_mov_b32 a163, a99
    v_accvgpr_mov_b32 a164, a100
    v_accvgpr_mov_b32 a165, a101
    v_accvgpr_mov_b32 a166, a102
    v_accvgpr_mov_b32 a167, a103
    buffer_store_dwordx4 v[88:91], v1, s[12:15], s25 offen offset:2048 sc1
    v_accvgpr_mov_b32 a168, a104
    v_accvgpr_mov_b32 a169, a105
    v_accvgpr_mov_b32 a170, a106
    v_accvgpr_mov_b32 a171, a107
    v_accvgpr_mov_b32 a172, a108
    v_accvgpr_mov_b32 a173, a109
    v_accvgpr_mov_b32 a174, a110
    v_accvgpr_mov_b32 a175, a111
    buffer_store_dwordx4 v[92:95], v1, s[12:15], s25 offen offset:3072 sc1
    v_accvgpr_mov_b32 a176, a112
    v_accvgpr_mov_b32 a177, a113
    v_accvgpr_mov_b32 a178, a114
    v_accvgpr_mov_b32 a179, a115
    v_accvgpr_mov_b32 a180, a116
    v_accvgpr_mov_b32 a181, a117
    v_accvgpr_mov_b32 a182, a118
    v_accvgpr_mov_b32 a183, a119
    s_add_u32 s25, s25, 4096
    buffer_store_dwordx4 v[16:19], v1, s[12:15], s25 offen offset:0 sc1
    v_accvgpr_mov_b32 a184, a120
    v_accvgpr_mov_b32 a185, a121
    v_accvgpr_mov_b32 a186, a122
    v_accvgpr_mov_b32 a187, a123
    v_accvgpr_mov_b32 a188, a124
    v_accvgpr_mov_b32 a189, a125
    v_accvgpr_mov_b32 a190, a126
    v_accvgpr_mov_b32 a191, a127
    v_mov_b64 v[128:129], 0
    v_mov_b64 v[130:131], 0
    v_mov_b64 v[132:133], 0
    v_mov_b64 v[134:135], 0
    v_mov_b64 v[136:137], 0
    v_mov_b64 v[138:139], 0
    v_mov_b64 v[140:141], 0
    v_mov_b64 v[142:143], 0
    v_mov_b64 v[144:145], 0
    v_mov_b64 v[146:147], 0
    v_mov_b64 v[148:149], 0
    v_mov_b64 v[150:151], 0
    v_mov_b64 v[152:153], 0
    v_mov_b64 v[154:155], 0
    v_mov_b64 v[156:157], 0
    v_mov_b64 v[158:159], 0
    v_mov_b64 v[160:161], 0
    v_mov_b64 v[162:163], 0
    v_mov_b64 v[164:165], 0
    v_mov_b64 v[166:167], 0
    v_mov_b64 v[168:169], 0
    v_mov_b64 v[170:171], 0
    v_mov_b64 v[172:173], 0
    v_mov_b64 v[174:175], 0
    v_mov_b64 v[176:177], 0
    v_mov_b64 v[178:179], 0
    v_mov_b64 v[180:181], 0
    v_mov_b64 v[182:183], 0
    v_mov_b64 v[184:185], 0
    v_mov_b64 v[186:187], 0
    v_mov_b64 v[188:189], 0
    v_mov_b64 v[190:191], 0
    v_mov_b64 v[192:193], 0
    v_mov_b64 v[194:195], 0
    v_mov_b64 v[196:197], 0
    v_mov_b64 v[198:199], 0
    v_mov_b64 v[200:201], 0
    v_mov_b64 v[202:203], 0
    v_mov_b64 v[204:205], 0
    v_mov_b64 v[206:207], 0
    v_mov_b64 v[208:209], 0
    v_mov_b64 v[210:211], 0
    v_mov_b64 v[212:213], 0
    v_mov_b64 v[214:215], 0
    v_mov_b64 v[216:217], 0
    v_mov_b64 v[218:219], 0
    v_mov_b64 v[220:221], 0
    v_mov_b64 v[222:223], 0
    v_mov_b64 v[224:225], 0
    v_mov_b64 v[226:227], 0
    v_mov_b64 v[228:229], 0
    v_mov_b64 v[230:231], 0
    v_mov_b64 v[232:233], 0
    v_mov_b64 v[234:235], 0
    v_mov_b64 v[236:237], 0
    v_mov_b64 v[238:239], 0
    v_mov_b64 v[240:241], 0
    v_mov_b64 v[242:243], 0
    v_mov_b64 v[244:245], 0
    v_mov_b64 v[246:247], 0
    v_mov_b64 v[248:249], 0
    v_mov_b64 v[250:251], 0
    v_mov_b64 v[252:253], 0
    v_mov_b64 v[254:255], 0
    v_mov_b32 v9, 0xff3fffff
    v_cndmask_b32 v96, 0, v9, s[70:71]
    v_cndmask_b32 v97, 0, v9, s[72:73]
    v_cndmask_b32 v98, 0, v9, s[74:75]
    v_cndmask_b32 v99, 0, v9, s[76:77]
    v_mov_b32 v100, 0
    v_mov_b32 v101, 0
    v_mov_b32 v102, 0
    v_mov_b32 v103, 0
    v_mov_b32 v104, v9
    v_mov_b32 v105, v9
    v_mov_b32 v106, v9
    v_mov_b32 v107, v9
    v_cndmask_b32 v108, 0, v9, s[70:71]
    v_cndmask_b32 v109, 0, v9, s[72:73]
    v_cndmask_b32 v110, 0, v9, s[74:75]
    v_cndmask_b32 v111, 0, v9, s[76:77]
    s_lshl_b32 s3, s66, 2
    s_add_u32 s3, s3, s93
    s_cmp_eq_u32 s92, 1
    s_cselect_b32 s28, s3, 268435456
    s_cselect_b32 s3, 268435456, s3
    s_waitcnt vmcnt(0)
    s_mov_b64 exec, 1
    buffer_store_dword v14, off, s[12:15], s28 offset:48
    buffer_store_dword v14, off, s[12:15], s3 offset:48 sc1
    s_mov_b64 exec, -1
    s_add_u32 s21, s20, 1
    s_call_b64 s[82:83], AT_idle
AT_seg2:
    s_call_b64 s[82:83], AT_qkfirst
    s_sub_u32 s25, s35, s66
    s_sub_u32 s25, s25, 1
    s_cmp_lt_i32 s25, 1
    s_cbranch_scc1 skip_9
    s_add_u32 s21, s20, s25
    s_call_b64 s[82:83], AT_full
skip_9:
    s_lshl_b32 s80, s30, 3
    s_add_u32 s80, s80, s31
    s_lshl_b32 s80, s80, 2
    s_add_u32 s80, s80, s66
    s_mul_i32 s80, s80, 17408
    s_add_u32 s80, s80, 0
    s_cmp_eq_u32 s32, 1
    s_cselect_b32 s3, 58720256, 0
    s_add_u32 s80, s80, s3
    v_lshlrev_b32 v121, 3, v1
    s_add_u32 s3, s80, 8192
    buffer_load_dword v122, v121, s[12:15], s80 offen
    buffer_load_dword v123, v121, s[12:15], s3 offen
    buffer_load_dword v120, v1, s[44:47], s48 offen
    s_mov_b32 s3, 111280128
    buffer_load_dwordx4 v[124:127], v1, s[12:15], s3 offen sc1
    s_call_b64 s[82:83], AT_pvlast
    v_mov_b32 v9, v18
    v_mov_b32 v10, v19
    s_nop 0
    v_permlane16_swap_b32 v18, v9
    v_permlane16_swap_b32 v19, v10
    s_nop 0
    v_add_f32 v18, v18, v9
    v_add_f32 v19, v19, v10
    v_mov_b32 v9, v18
    v_mov_b32 v10, v19
    s_nop 0
    v_permlane32_swap_b32 v18, v9
    v_permlane32_swap_b32 v19, v10
    s_nop 0
    v_add_f32 v18, v18, v9
    v_add_f32 v19, v19, v10
    v_rcp_f32 v26, v18
    v_rcp_f32 v27, v19
    v_cvt_pk_bf16_f32 v32, v128, v129
    v_cvt_pk_bf16_f32 v33, v130, v131
    v_cvt_pk_bf16_f32 v34, v136, v137
    v_cvt_pk_bf16_f32 v35, v138, v139
    v_cvt_pk_bf16_f32 v36, v144, v145
    v_cvt_pk_bf16_f32 v37, v146, v147
    v_cvt_pk_bf16_f32 v38, v152, v153
    v_cvt_pk_bf16_f32 v39, v154, v155
    v_cvt_pk_bf16_f32 v40, v160, v161
    v_cvt_pk_bf16_f32 v41, v162, v163
    v_cvt_pk_bf16_f32 v42, v168, v169
    v_cvt_pk_bf16_f32 v43, v170, v171
    v_cvt_pk_bf16_f32 v44, v176, v177
    v_cvt_pk_bf16_f32 v45, v178, v179
    v_cvt_pk_bf16_f32 v46, v184, v185
    v_cvt_pk_bf16_f32 v47, v186, v187
    v_cvt_pk_bf16_f32 v48, v192, v193
    v_cvt_pk_bf16_f32 v49, v194, v195
    v_cvt_pk_bf16_f32 v50, v200, v201
    v_cvt_pk_bf16_f32 v51, v202, v203
    v_cvt_pk_bf16_f32 v52, v208, v209
    v_cvt_pk_bf16_f32 v53, v210, v211
    v_cvt_pk_bf16_f32 v54, v216, v217
    v_cvt_pk_bf16_f32 v55, v218, v219
    v_cvt_pk_bf16_f32 v56, v224, v225
    v_cvt_pk_bf16_f32 v57, v226, v227
    v_cvt_pk_bf16_f32 v58, v232, v233
    v_cvt_pk_bf16_f32 v59, v234, v235
    v_cvt_pk_bf16_f32 v60, v240, v241
    v_cvt_pk_bf16_f32 v61, v242, v243
    v_cvt_pk_bf16_f32 v62, v248, v249
    v_cvt_pk_bf16_f32 v63, v250, v251
    v_cvt_pk_bf16_f32 v64, v132, v133
    v_cvt_pk_bf16_f32 v65, v134, v135
    v_cvt_pk_bf16_f32 v66, v140, v141
    v_cvt_pk_bf16_f32 v67, v142, v143
    v_cvt_pk_bf16_f32 v68, v148, v149
    v_cvt_pk_bf16_f32 v69, v150, v151
    v_cvt_pk_bf16_f32 v70, v156, v157
    v_cvt_pk_bf16_f32 v71, v158, v159
    v_cvt_pk_bf16_f32 v72, v164, v165
    v_cvt_pk_bf16_f32 v73, v166, v167
    v_cvt_pk_bf16_f32 v74, v172, v173
    v_cvt_pk_bf16_f32 v75, v174, v175
    v_cvt_pk_bf16_f32 v76, v180, v181
    v_cvt_pk_bf16_f32 v77, v182, v183
    v_cvt_pk_bf16_f32 v78, v188, v189
    v_cvt_pk_bf16_f32 v79, v190, v191
    v_cvt_pk_bf16_f32 v80, v196, v197
    v_cvt_pk_bf16_f32 v81, v198, v199
    v_cvt_pk_bf16_f32 v82, v204, v205
    v_cvt_pk_bf16_f32 v83, v206, v207
    v_cvt_pk_bf16_f32 v84, v212, v213
    v_cvt_pk_bf16_f32 v85, v214, v215
    v_cvt_pk_bf16_f32 v86, v220, v221
    v_cvt_pk_bf16_f32 v87, v222, v223
    v_cvt_pk_bf16_f32 v88, v228, v229
    v_cvt_pk_bf16_f32 v89, v230, v231
    v_cvt_pk_bf16_f32 v90, v236, v237
    v_cvt_pk_bf16_f32 v91, v238, v239
    v_cvt_pk_bf16_f32 v92, v244, v245
    v_cvt_pk_bf16_f32 v93, v246, v247
    v_cvt_pk_bf16_f32 v94, v252, v253
    v_cvt_pk_bf16_f32 v95, v254, v255
AT_oproj_start:
    s_waitcnt vmcnt(8)
    v_and_b32 v124, v124, v125
    v_and_b32 v126, v126, v127
    v_and_b32 v124, v124, v126
    v_cmp_ne_u32 vcc, 1, v124

    s_min_u32 s86, s79, 13
    s_lshr_b32 s86, s86, 1
    s_mul_i32 s86, s86, 229376
    s_mul_i32 s3, s66, 28672
    s_add_u32 s86, s86, s3
    s_add_u32 s86, s86, 48234496
    s_cbranch_vccnz OP_pk
OP_pkback:
    s_waitcnt lgkmcnt(4)
    v_mfma_f32_16x16x32_bf16 v[160:163], a[192:195], v[32:35], 0
    ds_read_b128 a[224:227], v5 offset:24576
    s_xor_b32 s22, s22, 0x8000
    v_mfma_f32_16x16x32_bf16 v[164:167], a[192:195], v[64:67], 0
    s_add_u32 s89, s86, 0
    s_lshl_b32 s80, s30, 3
    v_mfma_f32_16x16x32_bf16 v[168:171], a[196:199], v[32:35], 0
    ds_read_b128 a[228:231], v5 offset:25600
    v_readlane_b32 s23, v7, s20
    v_mfma_f32_16x16x32_bf16 v[172:175], a[196:199], v[64:67], 0
    buffer_load_dwordx4 a[112:115], v1, s[12:15], s89 offen offset:0 sc1
    v_mfma_f32_16x16x32_bf16 v[176:179], a[200:203], v[32:35], 0
    ds_read_b128 a[232:235], v5 offset:26624
    s_add_u32 m0, s22, 0
    v_mfma_f32_16x16x32_bf16 v[180:183], a[200:203], v[64:67], 0
    buffer_load_dwordx4 v4, s[12:15], s23 offen offset:0 lds
    v_mfma_f32_16x16x32_bf16 v[184:187], a[204:207], v[32:35], 0
    ds_read_b128 a[236:239], v5 offset:27648
    s_add_u32 s80, s80, s31
    v_mfma_f32_16x16x32_bf16 v[188:191], a[204:207], v[64:67], 0
    s_lshl_b32 s80, s80, 2
    s_waitcnt lgkmcnt(4)
    v_mfma_f32_16x16x32_bf16 v[160:163], a[208:211], v[36:39], v[160:163]
    ds_read_b128 a[240:243], v5 offset:28672
    s_add_u32 s80, s80, s66
    v_mfma_f32_16x16x32_bf16 v[164:167], a[208:211], v[68:71], v[164:167]
    buffer_load_dwordx4 a[116:119], v1, s[12:15], s89 offen offset:1024 sc1
    v_mfma_f32_16x16x32_bf16 v[168:171], a[212:215], v[36:39], v[168:171]
    ds_read_b128 a[244:247], v5 offset:29696
    s_mul_i32 s80, s80, 17408
    v_mfma_f32_16x16x32_bf16 v[172:175], a[212:215], v[68:71], v[172:175]
    s_add_u32 s80, s80, 0
    v_mfma_f32_16x16x32_bf16 v[176:179], a[216:219], v[36:39], v[176:179]
    ds_read_b128 a[248:251], v5 offset:30720
    v_mfma_f32_16x16x32_bf16 v[180:183], a[216:219], v[68:71], v[180:183]
    buffer_load_dwordx4 v4, s[12:15], s23 offen offset:1024 lds
    v_mfma_f32_16x16x32_bf16 v[184:187], a[220:223], v[36:39], v[184:187]
    ds_read_b128 a[252:255], v5 offset:31744
    v_mfma_f32_16x16x32_bf16 v[188:191], a[220:223], v[68:71], v[188:191]
    s_waitcnt lgkmcnt(4)
    v_mfma_f32_16x16x32_bf16 v[160:163], a[224:227], v[40:43], v[160:163]
    ds_read_b128 a[192:195], v6 offset:16384
    v_mfma_f32_16x16x32_bf16 v[164:167], a[224:227], v[72:75], v[164:167]
    buffer_load_dwordx4 a[120:123], v1, s[12:15], s89 offen offset:2048 sc1
    v_mfma_f32_16x16x32_bf16 v[168:171], a[228:231], v[40:43], v[168:171]
    ds_read_b128 a[196:199], v6 offset:17408
    v_mfma_f32_16x16x32_bf16 v[172:175], a[228:231], v[72:75], v[172:175]
    s_cmp_eq_u32 s32, 1
    s_cselect_b32 s3, 58720256, 0
    v_mfma_f32_16x16x32_bf16 v[176:179], a[232:235], v[40:43], v[176:179]
    ds_read_b128 a[200:203], v6 offset:18432
    s_add_u32 s80, s80, s3
    v_mfma_f32_16x16x32_bf16 v[180:183], a[232:235], v[72:75], v[180:183]
    buffer_load_dwordx4 v4, s[12:15], s23 offen offset:2048 lds
    v_mfma_f32_16x16x32_bf16 v[184:187], a[236:239], v[40:43], v[184:187]
    ds_read_b128 a[204:207], v6 offset:19456
    s_add_u32 s81, s80, 557056
    v_mfma_f32_16x16x32_bf16 v[188:191], a[236:239], v[72:75], v[188:191]
    s_sub_u32 s3, s80, 557056
    s_waitcnt lgkmcnt(4)
    v_mfma_f32_16x16x32_bf16 v[160:163], a[240:243], v[44:47], v[160:163]
    ds_read_b128 a[208:211], v6 offset:20480
    v_mfma_f32_16x16x32_bf16 v[164:167], a[240:243], v[76:79], v[164:167]
    buffer_load_dwordx4 a[124:127], v1, s[12:15], s89 offen offset:3072 sc1
    v_mfma_f32_16x16x32_bf16 v[168:171], a[244:247], v[44:47], v[168:171]
    ds_read_b128 a[212:215], v6 offset:21504
    v_mfma_f32_16x16x32_bf16 v[172:175], a[244:247], v[76:79], v[172:175]
    s_bitcmp1_b32 s30, 0
    s_cselect_b32 s81, s3, s81
    s_cselect_b32 s3, 2048, 0
    v_mfma_f32_16x16x32_bf16 v[176:179], a[248:251], v[44:47], v[176:179]
    ds_read_b128 a[216:219], v6 offset:22528
    s_mul_i32 s36, s67, 2131200
    v_mfma_f32_16x16x32_bf16 v[180:183], a[248:251], v[76:79], v[180:183]
    buffer_load_dwordx4 v4, s[12:15], s23 offen offset:3072 lds
    v_mfma_f32_16x16x32_bf16 v[184:187], a[252:255], v[44:47], v[184:187]
    ds_read_b128 a[220:223], v6 offset:23552
    v_xor_b32 v5, 0x8000, v5
    v_mfma_f32_16x16x32_bf16 v[188:191], a[252:255], v[76:79], v[188:191]
    s_add_u32 s89, s86, 4096
    s_waitcnt lgkmcnt(4)
    v_mfma_f32_16x16x32_bf16 v[160:163], a[192:195], v[48:51], v[160:163]
    ds_read_b128 a[224:227], v6 offset:24576
    s_add_u32 s36, s36, s3
    v_mfma_f32_16x16x32_bf16 v[164:167], a[192:195], v[80:83], v[164:167]
    buffer_load_dwordx4 a[128:131], v1, s[12:15], s89 offen offset:0 sc1
    v_mfma_f32_16x16x32_bf16 v[168:171], a[196:199], v[48:51], v[168:171]
    ds_read_b128 a[228:231], v6 offset:25600
    s_mul_i32 s3, s26, 33280
    v_mfma_f32_16x16x32_bf16 v[172:175], a[196:199], v[80:83], v[172:175]
    s_add_u32 s36, s36, s3
    s_add_u32 s36, s36, 69218304
    v_mfma_f32_16x16x32_bf16 v[176:179], a[200:203], v[48:51], v[176:179]
    ds_read_b128 a[232:235], v6 offset:26624
    v_readlane_b32 s27, v8, s20
    v_mfma_f32_16x16x32_bf16 v[180:183], a[200:203], v[80:83], v[180:183]
    buffer_load_dwordx4 a[132:135], v1, s[12:15], s89 offen offset:1024 sc1
    v_mfma_f32_16x16x32_bf16 v[184:187], a[204:207], v[48:51], v[184:187]
    ds_read_b128 a[236:239], v6 offset:27648
    v_add_u32 v22, 16640, v1
    v_mfma_f32_16x16x32_bf16 v[188:191], a[204:207], v[80:83], v[188:191]
    s_xor_b32 s29, s2, 8
    s_waitcnt lgkmcnt(4)
    v_mfma_f32_16x16x32_bf16 v[160:163], a[208:211], v[52:55], v[160:163]
    ds_read_b128 a[240:243], v6 offset:28672
    s_mul_i32 s29, s29, 384
    v_mfma_f32_16x16x32_bf16 v[164:167], a[208:211], v[84:87], v[164:167]
    buffer_load_dwordx4 a[136:139], v1, s[12:15], s89 offen offset:2048 sc1
    v_mfma_f32_16x16x32_bf16 v[168:171], a[212:215], v[52:55], v[168:171]
    ds_read_b128 a[244:247], v6 offset:29696
    s_lshl_b32 s3, s66, 2
    v_mfma_f32_16x16x32_bf16 v[172:175], a[212:215], v[84:87], v[172:175]
    s_add_u32 s29, s29, s3
    s_add_u32 s29, s29, 111149056
    v_mfma_f32_16x16x32_bf16 v[176:179], a[216:219], v[52:55], v[176:179]
    ds_read_b128 a[248:251], v6 offset:30720
    s_add_u32 s3, s3, s93
    v_mfma_f32_16x16x32_bf16 v[180:183], a[216:219], v[84:87], v[180:183]
    buffer_load_dwordx4 a[140:143], v1, s[12:15], s89 offen offset:3072 sc1
    v_mfma_f32_16x16x32_bf16 v[184:187], a[220:223], v[52:55], v[184:187]
    ds_read_b128 a[252:255], v6 offset:31744
    s_add_u32 m0, s22, 65536
    v_mfma_f32_16x16x32_bf16 v[188:191], a[220:223], v[84:87], v[188:191]
    s_waitcnt vmcnt(20) lgkmcnt(4)
    s_barrier
    v_mfma_f32_16x16x32_bf16 v[160:163], a[224:227], v[56:59], v[160:163]
    ds_read_b128 a[192:195], v5 offset:0
    v_xor_b32 v6, 0x8000, v6
    v_mfma_f32_16x16x32_bf16 v[164:167], a[224:227], v[88:91], v[164:167]
    buffer_load_dwordx4 v4, s[12:15], s27 offen offset:0 lds
    v_mfma_f32_16x16x32_bf16 v[168:171], a[228:231], v[56:59], v[168:171]
    ds_read_b128 a[196:199], v5 offset:1024
    v_mfma_f32_16x16x32_bf16 v[172:175], a[228:231], v[88:91], v[172:175]
    s_cmp_eq_u32 s92, 1
    s_cselect_b32 s34, s3, 268435456
    v_mfma_f32_16x16x32_bf16 v[176:179], a[232:235], v[56:59], v[176:179]
    ds_read_b128 a[200:203], v5 offset:2048
    v_mfma_f32_16x16x32_bf16 v[180:183], a[232:235], v[88:91], v[180:183]
    buffer_load_dwordx4 v4, s[12:15], s27 offen offset:1024 lds
    v_mfma_f32_16x16x32_bf16 v[184:187], a[236:239], v[56:59], v[184:187]
    ds_read_b128 a[204:207], v5 offset:3072
    v_mfma_f32_16x16x32_bf16 v[188:191], a[236:239], v[88:91], v[188:191]
    s_waitcnt lgkmcnt(4)
    v_mfma_f32_16x16x32_bf16 v[160:163], a[240:243], v[60:63], v[160:163]
    ds_read_b128 a[208:211], v5 offset:4096
    v_mfma_f32_16x16x32_bf16 v[164:167], a[240:243], v[92:95], v[164:167]
    buffer_load_dwordx4 v4, s[12:15], s27 offen offset:2048 lds
    v_mfma_f32_16x16x32_bf16 v[168:171], a[244:247], v[60:63], v[168:171]
    ds_read_b128 a[212:215], v5 offset:5120
    v_mfma_f32_16x16x32_bf16 v[172:175], a[244:247], v[92:95], v[172:175]
    s_cmp_eq_u32 s92, 1
    s_cselect_b32 s35, 268435456, s3
    v_mfma_f32_16x16x32_bf16 v[176:179], a[248:251], v[60:63], v[176:179]
    ds_read_b128 a[216:219], v5 offset:6144
    s_add_u32 s20, s20, 1
    v_mfma_f32_16x16x32_bf16 v[180:183], a[248:251], v[92:95], v[180:183]
    buffer_load_dwordx4 v4, s[12:15], s27 offen offset:3072 lds
    v_mfma_f32_16x16x32_bf16 v[184:187], a[252:255], v[60:63], v[184:187]
    ds_read_b128 a[220:223], v5 offset:7168
    v_cmp_eq_u32 vcc, 0, v2
    v_mov_b32 v28, 268435456
    s_nop 0
    v_cndmask_b32 v28, v28, 0, vcc
    v_mfma_f32_16x16x32_bf16 v[188:191], a[252:255], v[92:95], v[188:191]
    s_waitcnt lgkmcnt(4)
    v_mfma_f32_16x16x32_bf16 v[128:131], a[192:195], v[32:35], 0
    ds_read_b128 a[224:227], v5 offset:8192
    v_readlane_b32 s23, v7, s20
    v_mfma_f32_16x16x32_bf16 v[132:135], a[192:195], v[64:67], 0
    v_mfma_f32_16x16x32_bf16 v[136:139], a[196:199], v[32:35], 0
    ds_read_b128 a[228:231], v5 offset:9216
    v_mfma_f32_16x16x32_bf16 v[140:143], a[196:199], v[64:67], 0
    v_mul_f32 v160, v160, v26
    v_mul_f32 v168, v168, v26
    v_mfma_f32_16x16x32_bf16 v[144:147], a[200:203], v[32:35], 0
    ds_read_b128 a[232:235], v5 offset:10240
    s_add_u32 m0, s22, 16384
    v_mfma_f32_16x16x32_bf16 v[148:151], a[200:203], v[64:67], 0
    buffer_load_dwordx4 v4, s[12:15], s23 offen offset:0 lds
    v_mfma_f32_16x16x32_bf16 v[152:155], a[204:207], v[32:35], 0
    ds_read_b128 a[236:239], v5 offset:11264
    v_cvt_pk_bf16_f32 v96, v160, v168
    v_mfma_f32_16x16x32_bf16 v[156:159], a[204:207], v[64:67], 0
    v_mul_f32 v176, v176, v26
    s_waitcnt lgkmcnt(4)
    v_mfma_f32_16x16x32_bf16 v[128:131], a[208:211], v[36:39], v[128:131]
    ds_read_b128 a[240:243], v5 offset:12288
    v_mul_f32 v184, v184, v26
    v_mfma_f32_16x16x32_bf16 v[132:135], a[208:211], v[68:71], v[132:135]
    buffer_load_dwordx4 v4, s[12:15], s23 offen offset:1024 lds
    v_mfma_f32_16x16x32_bf16 v[136:139], a[212:215], v[36:39], v[136:139]
    ds_read_b128 a[244:247], v5 offset:13312
    v_cvt_pk_bf16_f32 v97, v176, v184
    v_mfma_f32_16x16x32_bf16 v[140:143], a[212:215], v[68:71], v[140:143]
    v_mul_f32 v161, v161, v26
    v_mul_f32 v169, v169, v26
    v_mfma_f32_16x16x32_bf16 v[144:147], a[216:219], v[36:39], v[144:147]
    ds_read_b128 a[248:251], v5 offset:14336
    v_cvt_pk_bf16_f32 v98, v161, v169
    v_mfma_f32_16x16x32_bf16 v[148:151], a[216:219], v[68:71], v[148:151]
    buffer_load_dwordx4 v4, s[12:15], s23 offen offset:2048 lds
    v_mfma_f32_16x16x32_bf16 v[152:155], a[220:223], v[36:39], v[152:155]
    ds_read_b128 a[252:255], v5 offset:15360
    v_mul_f32 v177, v177, v26
    v_mfma_f32_16x16x32_bf16 v[156:159], a[220:223], v[68:71], v[156:159]
    v_mul_f32 v185, v185, v26
    s_waitcnt lgkmcnt(4)
    v_mfma_f32_16x16x32_bf16 v[128:131], a[224:227], v[40:43], v[128:131]
    ds_read_b128 a[192:195], v6 offset:0
    v_cvt_pk_bf16_f32 v99, v177, v185
    v_mfma_f32_16x16x32_bf16 v[132:135], a[224:227], v[72:75], v[132:135]
    buffer_load_dwordx4 v4, s[12:15], s23 offen offset:3072 lds
    v_mfma_f32_16x16x32_bf16 v[136:139], a[228:231], v[40:43], v[136:139]
    ds_read_b128 a[196:199], v6 offset:1024
    v_mul_f32 v162, v162, v26
    v_mfma_f32_16x16x32_bf16 v[140:143], a[228:231], v[72:75], v[140:143]
    v_mul_f32 v170, v170, v26
    v_cvt_pk_bf16_f32 v100, v162, v170
    v_mfma_f32_16x16x32_bf16 v[144:147], a[232:235], v[40:43], v[144:147]
    ds_read_b128 a[200:203], v6 offset:2048
    v_mul_f32 v178, v178, v26
    v_mfma_f32_16x16x32_bf16 v[148:151], a[232:235], v[72:75], v[148:151]
    buffer_store_dwordx4 v[96:99], v1, s[12:15], s80 offen offset:0
    v_mfma_f32_16x16x32_bf16 v[152:155], a[236:239], v[40:43], v[152:155]
    ds_read_b128 a[204:207], v6 offset:3072
    v_mul_f32 v186, v186, v26
    v_mfma_f32_16x16x32_bf16 v[156:159], a[236:239], v[72:75], v[156:159]
    v_cvt_pk_bf16_f32 v101, v178, v186
    s_waitcnt lgkmcnt(4)
    v_mfma_f32_16x16x32_bf16 v[128:131], a[240:243], v[44:47], v[128:131]
    ds_read_b128 a[208:211], v6 offset:4096
    v_mul_f32 v163, v163, v26
    v_mfma_f32_16x16x32_bf16 v[132:135], a[240:243], v[76:79], v[132:135]
    v_mul_f32 v171, v171, v26
    v_cvt_pk_bf16_f32 v102, v163, v171
    v_mfma_f32_16x16x32_bf16 v[136:139], a[244:247], v[44:47], v[136:139]
    ds_read_b128 a[212:215], v6 offset:5120
    v_mul_f32 v179, v179, v26
    v_mfma_f32_16x16x32_bf16 v[140:143], a[244:247], v[76:79], v[140:143]
    v_mul_f32 v187, v187, v26
    v_cvt_pk_bf16_f32 v103, v179, v187
    v_mfma_f32_16x16x32_bf16 v[144:147], a[248:251], v[44:47], v[144:147]
    ds_read_b128 a[216:219], v6 offset:6144
    v_mul_f32 v164, v164, v27
    v_mfma_f32_16x16x32_bf16 v[148:151], a[248:251], v[76:79], v[148:151]
    buffer_store_dwordx4 v[100:103], v1, s[12:15], s80 offen offset:1024
    v_mfma_f32_16x16x32_bf16 v[152:155], a[252:255], v[44:47], v[152:155]
    ds_read_b128 a[220:223], v6 offset:7168
    v_mul_f32 v172, v172, v27
    v_mfma_f32_16x16x32_bf16 v[156:159], a[252:255], v[76:79], v[156:159]
    v_cvt_pk_bf16_f32 v104, v164, v172
    s_waitcnt lgkmcnt(4)
    v_mfma_f32_16x16x32_bf16 v[128:131], a[192:195], v[48:51], v[128:131]
    ds_read_b128 a[224:227], v6 offset:8192
    v_mul_f32 v180, v180, v27
    v_mfma_f32_16x16x32_bf16 v[132:135], a[192:195], v[80:83], v[132:135]
    v_mul_f32 v188, v188, v27
    v_cvt_pk_bf16_f32 v105, v180, v188
    v_mfma_f32_16x16x32_bf16 v[136:139], a[196:199], v[48:51], v[136:139]
    ds_read_b128 a[228:231], v6 offset:9216
    v_mul_f32 v165, v165, v27
    v_mfma_f32_16x16x32_bf16 v[140:143], a[196:199], v[80:83], v[140:143]
    v_mul_f32 v173, v173, v27
    v_cvt_pk_bf16_f32 v106, v165, v173
    v_mfma_f32_16x16x32_bf16 v[144:147], a[200:203], v[48:51], v[144:147]
    ds_read_b128 a[232:235], v6 offset:10240
    v_readlane_b32 s27, v8, s20
    v_mfma_f32_16x16x32_bf16 v[148:151], a[200:203], v[80:83], v[148:151]
    v_mul_f32 v181, v181, v27
    v_mul_f32 v189, v189, v27
    v_cvt_pk_bf16_f32 v107, v181, v189
    buffer_store_dwordx4 v[104:107], v1, s[12:15], s80 offen offset:2048
    v_mfma_f32_16x16x32_bf16 v[152:155], a[204:207], v[48:51], v[152:155]
    ds_read_b128 a[236:239], v6 offset:11264
    v_mul_f32 v166, v166, v27
    v_mfma_f32_16x16x32_bf16 v[156:159], a[204:207], v[80:83], v[156:159]
    v_mul_f32 v174, v174, v27
    s_waitcnt lgkmcnt(4)
    v_mfma_f32_16x16x32_bf16 v[128:131], a[208:211], v[52:55], v[128:131]
    ds_read_b128 a[240:243], v6 offset:12288
    v_cvt_pk_bf16_f32 v108, v166, v174
    v_mfma_f32_16x16x32_bf16 v[132:135], a[208:211], v[84:87], v[132:135]
    v_mul_f32 v182, v182, v27
    v_mul_f32 v190, v190, v27
    v_mfma_f32_16x16x32_bf16 v[136:139], a[212:215], v[52:55], v[136:139]
    ds_read_b128 a[244:247], v6 offset:13312
    v_cvt_pk_bf16_f32 v109, v182, v190
    v_mfma_f32_16x16x32_bf16 v[140:143], a[212:215], v[84:87], v[140:143]
    v_mul_f32 v167, v167, v27
    v_mul_f32 v175, v175, v27
    v_mfma_f32_16x16x32_bf16 v[144:147], a[216:219], v[52:55], v[144:147]
    ds_read_b128 a[248:251], v6 offset:14336
    v_cvt_pk_bf16_f32 v110, v167, v175
    v_mfma_f32_16x16x32_bf16 v[148:151], a[216:219], v[84:87], v[148:151]
    v_mul_f32 v183, v183, v27
    v_mul_f32 v191, v191, v27
    v_cvt_pk_bf16_f32 v111, v183, v191
    buffer_store_dwordx4 v[108:111], v1, s[12:15], s80 offen offset:3072
    v_mfma_f32_16x16x32_bf16 v[152:155], a[220:223], v[52:55], v[152:155]
    ds_read_b128 a[252:255], v6 offset:15360
    s_add_u32 m0, s22, 81920
    v_mfma_f32_16x16x32_bf16 v[156:159], a[220:223], v[84:87], v[156:159]
    s_waitcnt vmcnt(24) lgkmcnt(4)
    s_barrier
    v_mfma_f32_16x16x32_bf16 v[128:131], a[224:227], v[56:59], v[128:131]
    ds_read_b128 a[192:195], v5 offset:16384
    s_lshl_b32 s25, s78, 4
    v_mfma_f32_16x16x32_bf16 v[132:135], a[224:227], v[88:91], v[132:135]
    buffer_load_dwordx4 v4, s[12:15], s27 offen offset:0 lds
    v_mfma_f32_16x16x32_bf16 v[136:139], a[228:231], v[56:59], v[136:139]
    ds_read_b128 a[196:199], v5 offset:17408
    s_add_u32 s25, s25, s79
    v_mfma_f32_16x16x32_bf16 v[140:143], a[228:231], v[88:91], v[140:143]
    s_mov_b32 s8, s40
    s_mov_b32 s9, s41
    v_mfma_f32_16x16x32_bf16 v[144:147], a[232:235], v[56:59], v[144:147]
    ds_read_b128 a[200:203], v5 offset:18432
    s_mov_b32 s10, 1835008
    v_mfma_f32_16x16x32_bf16 v[148:151], a[232:235], v[88:91], v[148:151]
    buffer_load_dwordx4 v4, s[12:15], s27 offen offset:1024 lds
    v_mfma_f32_16x16x32_bf16 v[152:155], a[236:239], v[56:59], v[152:155]
    ds_read_b128 a[204:207], v5 offset:19456
    s_mov_b32 s11, 0x00020000
    v_mfma_f32_16x16x32_bf16 v[156:159], a[236:239], v[88:91], v[156:159]
    v_cmp_gt_u32 vcc, 56, v2
    s_waitcnt lgkmcnt(4)
    v_mfma_f32_16x16x32_bf16 v[128:131], a[240:243], v[60:63], v[128:131]
    ds_read_b128 a[208:211], v5 offset:20480
    v_mov_b32 v10, 0x7fffffff
    v_mfma_f32_16x16x32_bf16 v[132:135], a[240:243], v[92:95], v[132:135]
    buffer_load_dwordx4 v4, s[12:15], s27 offen offset:2048 lds
    v_mfma_f32_16x16x32_bf16 v[136:139], a[244:247], v[60:63], v[136:139]
    ds_read_b128 a[212:215], v5 offset:21504
    s_lshl_b32 s3, s25, 2
    v_mfma_f32_16x16x32_bf16 v[140:143], a[244:247], v[92:95], v[140:143]
    s_add_u32 s3, s3, s66
    v_mfma_f32_16x16x32_bf16 v[144:147], a[248:251], v[60:63], v[144:147]
    ds_read_b128 a[216:219], v5 offset:22528
    s_add_u32 s20, s20, 1
    v_mfma_f32_16x16x32_bf16 v[148:151], a[248:251], v[92:95], v[148:151]
    buffer_load_dwordx4 v4, s[12:15], s27 offen offset:3072 lds
    v_mfma_f32_16x16x32_bf16 v[152:155], a[252:255], v[60:63], v[152:155]
    ds_read_b128 a[220:223], v5 offset:23552
    v_cndmask_b32 v10, v10, v1, vcc
    v_mfma_f32_16x16x32_bf16 v[156:159], a[252:255], v[92:95], v[156:159]
    s_mul_i32 s3, s3, 1792
    s_waitcnt lgkmcnt(4)
    v_mfma_f32_16x16x32_bf16 v[160:163], a[192:195], v[32:35], 0
    ds_read_b128 a[224:227], v5 offset:24576
    s_xor_b32 s22, s22, 0x8000
    v_mfma_f32_16x16x32_bf16 v[164:167], a[192:195], v[64:67], 0
    buffer_load_dwordx4 v[112:115], v10, s[8:11], s3 offen
    v_mfma_f32_16x16x32_bf16 v[168:171], a[196:199], v[32:35], 0
    ds_read_b128 a[228:231], v5 offset:25600
    v_readlane_b32 s23, v7, s20
    v_mfma_f32_16x16x32_bf16 v[172:175], a[196:199], v[64:67], 0
    s_add_u32 s80, s80, 4096
    v_mul_f32 v128, v128, v26
    v_mfma_f32_16x16x32_bf16 v[176:179], a[200:203], v[32:35], 0
    ds_read_b128 a[232:235], v5 offset:26624
    s_add_u32 m0, s22, 0
    v_mfma_f32_16x16x32_bf16 v[180:183], a[200:203], v[64:67], 0
    buffer_load_dwordx4 v4, s[12:15], s23 offen offset:0 lds
    v_mfma_f32_16x16x32_bf16 v[184:187], a[204:207], v[32:35], 0
    ds_read_b128 a[236:239], v5 offset:27648
    v_mul_f32 v136, v136, v26
    v_mfma_f32_16x16x32_bf16 v[188:191], a[204:207], v[64:67], 0
    v_cvt_pk_bf16_f32 v96, v128, v136
    s_waitcnt lgkmcnt(4)
    v_mfma_f32_16x16x32_bf16 v[160:163], a[208:211], v[36:39], v[160:163]
    ds_read_b128 a[240:243], v5 offset:28672
    v_mul_f32 v144, v144, v26
    v_mfma_f32_16x16x32_bf16 v[164:167], a[208:211], v[68:71], v[164:167]
    buffer_load_dwordx4 v4, s[12:15], s23 offen offset:1024 lds
    v_mfma_f32_16x16x32_bf16 v[168:171], a[212:215], v[36:39], v[168:171]
    ds_read_b128 a[244:247], v5 offset:29696
    v_mov_b32 v15, 1
    v_mfma_f32_16x16x32_bf16 v[172:175], a[212:215], v[68:71], v[172:175]
    s_waitcnt vmcnt(7)
    s_cmp_eq_u32 s92, 1
    s_cbranch_scc0 OP_w0
OP_wb0:
    buffer_store_dword v15, v28, s[12:15], s34 offen offset:64
    buffer_store_dword v15, v28, s[12:15], s35 offen offset:64 sc1
    v_mfma_f32_16x16x32_bf16 v[176:179], a[216:219], v[36:39], v[176:179]
    ds_read_b128 a[248:251], v5 offset:30720
    v_mul_f32 v152, v152, v26
    v_mfma_f32_16x16x32_bf16 v[180:183], a[216:219], v[68:71], v[180:183]
    buffer_load_dwordx4 v4, s[12:15], s23 offen offset:2048 lds
    v_mfma_f32_16x16x32_bf16 v[184:187], a[220:223], v[36:39], v[184:187]
    ds_read_b128 a[252:255], v5 offset:31744
    v_cvt_pk_bf16_f32 v97, v144, v152
    v_mfma_f32_16x16x32_bf16 v[188:191], a[220:223], v[68:71], v[188:191]
    v_mul_f32 v129, v129, v26
    s_waitcnt lgkmcnt(4)
    v_mfma_f32_16x16x32_bf16 v[160:163], a[224:227], v[40:43], v[160:163]
    ds_read_b128 a[192:195], v6 offset:16384
    v_mul_f32 v137, v137, v26
    v_mfma_f32_16x16x32_bf16 v[164:167], a[224:227], v[72:75], v[164:167]
    buffer_load_dwordx4 v4, s[12:15], s23 offen offset:3072 lds
    v_mfma_f32_16x16x32_bf16 v[168:171], a[228:231], v[40:43], v[168:171]
    ds_read_b128 a[196:199], v6 offset:17408
    v_cvt_pk_bf16_f32 v98, v129, v137
    v_mfma_f32_16x16x32_bf16 v[172:175], a[228:231], v[72:75], v[172:175]
    v_mul_f32 v145, v145, v26
    v_mul_f32 v153, v153, v26
    v_mfma_f32_16x16x32_bf16 v[176:179], a[232:235], v[40:43], v[176:179]
    ds_read_b128 a[200:203], v6 offset:18432
    v_cvt_pk_bf16_f32 v99, v145, v153
    v_mfma_f32_16x16x32_bf16 v[180:183], a[232:235], v[72:75], v[180:183]
    v_mul_f32 v130, v130, v26
    v_mul_f32 v138, v138, v26
    v_mfma_f32_16x16x32_bf16 v[184:187], a[236:239], v[40:43], v[184:187]
    ds_read_b128 a[204:207], v6 offset:19456
    v_cvt_pk_bf16_f32 v100, v130, v138
    v_mfma_f32_16x16x32_bf16 v[188:191], a[236:239], v[72:75], v[188:191]
    v_mul_f32 v146, v146, v26
    s_waitcnt lgkmcnt(4)
    v_mfma_f32_16x16x32_bf16 v[160:163], a[240:243], v[44:47], v[160:163]
    ds_read_b128 a[208:211], v6 offset:20480
    v_mul_f32 v154, v154, v26
    v_mfma_f32_16x16x32_bf16 v[164:167], a[240:243], v[76:79], v[164:167]
    buffer_store_dwordx4 v[96:99], v1, s[12:15], s80 offen offset:0
    v_mfma_f32_16x16x32_bf16 v[168:171], a[244:247], v[44:47], v[168:171]
    ds_read_b128 a[212:215], v6 offset:21504
    v_cvt_pk_bf16_f32 v101, v146, v154
    v_mfma_f32_16x16x32_bf16 v[172:175], a[244:247], v[76:79], v[172:175]
    v_mul_f32 v131, v131, v26
    v_mul_f32 v139, v139, v26
    v_mfma_f32_16x16x32_bf16 v[176:179], a[248:251], v[44:47], v[176:179]
    ds_read_b128 a[216:219], v6 offset:22528
    v_cvt_pk_bf16_f32 v102, v131, v139
    v_mfma_f32_16x16x32_bf16 v[180:183], a[248:251], v[76:79], v[180:183]
    v_mul_f32 v147, v147, v26
    v_mul_f32 v155, v155, v26
    v_mfma_f32_16x16x32_bf16 v[184:187], a[252:255], v[44:47], v[184:187]
    ds_read_b128 a[220:223], v6 offset:23552
    v_xor_b32 v5, 0x8000, v5
    v_mfma_f32_16x16x32_bf16 v[188:191], a[252:255], v[76:79], v[188:191]
    v_cvt_pk_bf16_f32 v103, v147, v155
    s_waitcnt lgkmcnt(4)
    v_mfma_f32_16x16x32_bf16 v[160:163], a[192:195], v[48:51], v[160:163]
    ds_read_b128 a[224:227], v6 offset:24576
    v_mul_f32 v132, v132, v27
    v_mfma_f32_16x16x32_bf16 v[164:167], a[192:195], v[80:83], v[164:167]
    buffer_store_dwordx4 v[100:103], v1, s[12:15], s80 offen offset:1024
    v_mfma_f32_16x16x32_bf16 v[168:171], a[196:199], v[48:51], v[168:171]
    ds_read_b128 a[228:231], v6 offset:25600
    v_mul_f32 v140, v140, v27
    v_mfma_f32_16x16x32_bf16 v[172:175], a[196:199], v[80:83], v[172:175]
    v_cvt_pk_bf16_f32 v104, v132, v140
    v_mul_f32 v148, v148, v27
    v_mfma_f32_16x16x32_bf16 v[176:179], a[200:203], v[48:51], v[176:179]
    ds_read_b128 a[232:235], v6 offset:26624
    v_readlane_b32 s27, v8, s20
    v_mfma_f32_16x16x32_bf16 v[180:183], a[200:203], v[80:83], v[180:183]
    v_mul_f32 v156, v156, v27
    v_cvt_pk_bf16_f32 v105, v148, v156
    v_mfma_f32_16x16x32_bf16 v[184:187], a[204:207], v[48:51], v[184:187]
    ds_read_b128 a[236:239], v6 offset:27648
    v_mul_f32 v133, v133, v27
    v_mfma_f32_16x16x32_bf16 v[188:191], a[204:207], v[80:83], v[188:191]
    v_mul_f32 v141, v141, v27
    s_waitcnt lgkmcnt(4)
    v_mfma_f32_16x16x32_bf16 v[160:163], a[208:211], v[52:55], v[160:163]
    ds_read_b128 a[240:243], v6 offset:28672
    v_cvt_pk_bf16_f32 v106, v133, v141
    v_mfma_f32_16x16x32_bf16 v[164:167], a[208:211], v[84:87], v[164:167]
    v_mul_f32 v149, v149, v27
    v_mul_f32 v157, v157, v27
    v_cvt_pk_bf16_f32 v107, v149, v157
    buffer_store_dwordx4 v[104:107], v1, s[12:15], s80 offen offset:2048
    v_mfma_f32_16x16x32_bf16 v[168:171], a[212:215], v[52:55], v[168:171]
    ds_read_b128 a[244:247], v6 offset:29696
    v_mul_f32 v134, v134, v27
    v_mfma_f32_16x16x32_bf16 v[172:175], a[212:215], v[84:87], v[172:175]
    v_mul_f32 v142, v142, v27
    v_cvt_pk_bf16_f32 v108, v134, v142
    v_mfma_f32_16x16x32_bf16 v[176:179], a[216:219], v[52:55], v[176:179]
    ds_read_b128 a[248:251], v6 offset:30720
    v_mul_f32 v150, v150, v27
    v_mfma_f32_16x16x32_bf16 v[180:183], a[216:219], v[84:87], v[180:183]
    v_mul_f32 v158, v158, v27
    v_cvt_pk_bf16_f32 v109, v150, v158
    v_mfma_f32_16x16x32_bf16 v[184:187], a[220:223], v[52:55], v[184:187]
    ds_read_b128 a[252:255], v6 offset:31744
    s_add_u32 m0, s22, 65536
    v_mfma_f32_16x16x32_bf16 v[188:191], a[220:223], v[84:87], v[188:191]
    s_waitcnt vmcnt(22) lgkmcnt(4)
    s_barrier
    v_mfma_f32_16x16x32_bf16 v[160:163], a[224:227], v[56:59], v[160:163]
    ds_read_b128 a[192:195], v5 offset:0
    v_xor_b32 v6, 0x8000, v6
    v_mfma_f32_16x16x32_bf16 v[164:167], a[224:227], v[88:91], v[164:167]
    buffer_load_dwordx4 v4, s[12:15], s27 offen offset:0 lds
    v_mfma_f32_16x16x32_bf16 v[168:171], a[228:231], v[56:59], v[168:171]
    ds_read_b128 a[196:199], v5 offset:1024
    v_mul_f32 v135, v135, v27
    v_mfma_f32_16x16x32_bf16 v[172:175], a[228:231], v[88:91], v[172:175]
    v_mul_f32 v143, v143, v27
    v_cvt_pk_bf16_f32 v110, v135, v143
    v_mul_f32 v151, v151, v27
    v_mul_f32 v159, v159, v27
    v_cvt_pk_bf16_f32 v111, v151, v159
    buffer_store_dwordx4 v[108:111], v1, s[12:15], s80 offen offset:3072
    v_mfma_f32_16x16x32_bf16 v[176:179], a[232:235], v[56:59], v[176:179]
    ds_read_b128 a[200:203], v5 offset:2048
    v_mfma_f32_16x16x32_bf16 v[180:183], a[232:235], v[88:91], v[180:183]
    buffer_load_dwordx4 v4, s[12:15], s27 offen offset:1024 lds
    v_mfma_f32_16x16x32_bf16 v[184:187], a[236:239], v[56:59], v[184:187]
    ds_read_b128 a[204:207], v5 offset:3072
    v_mfma_f32_16x16x32_bf16 v[188:191], a[236:239], v[88:91], v[188:191]
    s_waitcnt lgkmcnt(4)
    v_mfma_f32_16x16x32_bf16 v[160:163], a[240:243], v[60:63], v[160:163]
    ds_read_b128 a[208:211], v5 offset:4096
    v_mfma_f32_16x16x32_bf16 v[164:167], a[240:243], v[92:95], v[164:167]
    buffer_load_dwordx4 v4, s[12:15], s27 offen offset:2048 lds
    v_mfma_f32_16x16x32_bf16 v[168:171], a[244:247], v[60:63], v[168:171]
    ds_read_b128 a[212:215], v5 offset:5120
    v_mfma_f32_16x16x32_bf16 v[172:175], a[244:247], v[92:95], v[172:175]
    buffer_load_dwordx4 v[116:119], v10, s[8:11], s3 offen offset:896
    v_mfma_f32_16x16x32_bf16 v[176:179], a[248:251], v[60:63], v[176:179]
    ds_read_b128 a[216:219], v5 offset:6144
    s_add_u32 s20, s20, 1
    v_mfma_f32_16x16x32_bf16 v[180:183], a[248:251], v[92:95], v[180:183]
    buffer_load_dwordx4 v4, s[12:15], s27 offen offset:3072 lds
    v_mfma_f32_16x16x32_bf16 v[184:187], a[252:255], v[60:63], v[184:187]
    ds_read_b128 a[220:223], v5 offset:7168
    v_mfma_f32_16x16x32_bf16 v[188:191], a[252:255], v[92:95], v[188:191]
    s_waitcnt lgkmcnt(4)
    v_mfma_f32_16x16x32_bf16 v[128:131], a[192:195], v[32:35], 0
    ds_read_b128 a[224:227], v5 offset:8192
    v_readlane_b32 s23, v7, s20
    v_mfma_f32_16x16x32_bf16 v[132:135], a[192:195], v[64:67], 0
    v_mfma_f32_16x16x32_bf16 v[136:139], a[196:199], v[32:35], 0
    ds_read_b128 a[228:231], v5 offset:9216
    s_add_u32 s80, s80, 4096
    v_mfma_f32_16x16x32_bf16 v[140:143], a[196:199], v[64:67], 0
    v_mul_f32 v160, v160, v26
    v_mul_f32 v168, v168, v26
    v_mfma_f32_16x16x32_bf16 v[144:147], a[200:203], v[32:35], 0
    ds_read_b128 a[232:235], v5 offset:10240
    s_add_u32 m0, s22, 16384
    v_mfma_f32_16x16x32_bf16 v[148:151], a[200:203], v[64:67], 0
    buffer_load_dwordx4 v4, s[12:15], s23 offen offset:0 lds
    v_mfma_f32_16x16x32_bf16 v[152:155], a[204:207], v[32:35], 0
    ds_read_b128 a[236:239], v5 offset:11264
    v_cvt_pk_bf16_f32 v96, v160, v168
    v_mfma_f32_16x16x32_bf16 v[156:159], a[204:207], v[64:67], 0
    v_mul_f32 v176, v176, v26
    s_waitcnt lgkmcnt(4)
    v_mfma_f32_16x16x32_bf16 v[128:131], a[208:211], v[36:39], v[128:131]
    ds_read_b128 a[240:243], v5 offset:12288
    v_mul_f32 v184, v184, v26
    v_mfma_f32_16x16x32_bf16 v[132:135], a[208:211], v[68:71], v[132:135]
    buffer_load_dwordx4 v4, s[12:15], s23 offen offset:1024 lds
    v_mfma_f32_16x16x32_bf16 v[136:139], a[212:215], v[36:39], v[136:139]
    ds_read_b128 a[244:247], v5 offset:13312
    v_mov_b32 v15, 2
    v_mfma_f32_16x16x32_bf16 v[140:143], a[212:215], v[68:71], v[140:143]
    s_waitcnt vmcnt(6)
    s_cmp_eq_u32 s92, 1
    s_cbranch_scc0 OP_w1
OP_wb1:
    buffer_store_dword v15, v28, s[12:15], s34 offen offset:64
    buffer_store_dword v15, v28, s[12:15], s35 offen offset:64 sc1
    v_mfma_f32_16x16x32_bf16 v[144:147], a[216:219], v[36:39], v[144:147]
    ds_read_b128 a[248:251], v5 offset:14336
    v_cvt_pk_bf16_f32 v97, v176, v184
    v_mfma_f32_16x16x32_bf16 v[148:151], a[216:219], v[68:71], v[148:151]
    buffer_load_dwordx4 v4, s[12:15], s23 offen offset:2048 lds
    v_mfma_f32_16x16x32_bf16 v[152:155], a[220:223], v[36:39], v[152:155]
    ds_read_b128 a[252:255], v5 offset:15360
    v_mul_f32 v161, v161, v26
    v_mfma_f32_16x16x32_bf16 v[156:159], a[220:223], v[68:71], v[156:159]
    v_mul_f32 v169, v169, v26
    s_waitcnt lgkmcnt(4)
    v_mfma_f32_16x16x32_bf16 v[128:131], a[224:227], v[40:43], v[128:131]
    ds_read_b128 a[192:195], v6 offset:0
    v_cvt_pk_bf16_f32 v98, v161, v169
    v_mfma_f32_16x16x32_bf16 v[132:135], a[224:227], v[72:75], v[132:135]
    buffer_load_dwordx4 v4, s[12:15], s23 offen offset:3072 lds
    v_mfma_f32_16x16x32_bf16 v[136:139], a[228:231], v[40:43], v[136:139]
    ds_read_b128 a[196:199], v6 offset:1024
    v_mul_f32 v177, v177, v26
    v_mfma_f32_16x16x32_bf16 v[140:143], a[228:231], v[72:75], v[140:143]
    buffer_load_dword v13, off, s[12:15], s29 offset:64 sc1
    v_mfma_f32_16x16x32_bf16 v[144:147], a[232:235], v[40:43], v[144:147]
    ds_read_b128 a[200:203], v6 offset:2048
    v_mul_f32 v185, v185, v26
    v_mfma_f32_16x16x32_bf16 v[148:151], a[232:235], v[72:75], v[148:151]
    v_cvt_pk_bf16_f32 v99, v177, v185
    v_mul_f32 v162, v162, v26
    v_mfma_f32_16x16x32_bf16 v[152:155], a[236:239], v[40:43], v[152:155]
    ds_read_b128 a[204:207], v6 offset:3072
    v_mul_f32 v170, v170, v26
    v_mfma_f32_16x16x32_bf16 v[156:159], a[236:239], v[72:75], v[156:159]
    v_cvt_pk_bf16_f32 v100, v162, v170
    s_waitcnt lgkmcnt(4)
    v_mfma_f32_16x16x32_bf16 v[128:131], a[240:243], v[44:47], v[128:131]
    ds_read_b128 a[208:211], v6 offset:4096
    v_mul_f32 v178, v178, v26
    v_mfma_f32_16x16x32_bf16 v[132:135], a[240:243], v[76:79], v[132:135]
    buffer_store_dwordx4 v[96:99], v1, s[12:15], s80 offen offset:0
    v_mfma_f32_16x16x32_bf16 v[136:139], a[244:247], v[44:47], v[136:139]
    ds_read_b128 a[212:215], v6 offset:5120
    v_mul_f32 v186, v186, v26
    v_mfma_f32_16x16x32_bf16 v[140:143], a[244:247], v[76:79], v[140:143]
    v_cvt_pk_bf16_f32 v101, v178, v186
    v_mul_f32 v163, v163, v26
    v_mfma_f32_16x16x32_bf16 v[144:147], a[248:251], v[44:47], v[144:147]
    ds_read_b128 a[216:219], v6 offset:6144
    v_mul_f32 v171, v171, v26
    v_mfma_f32_16x16x32_bf16 v[148:151], a[248:251], v[76:79], v[148:151]
    v_cvt_pk_bf16_f32 v102, v163, v171
    v_mul_f32 v179, v179, v26
    v_mfma_f32_16x16x32_bf16 v[152:155], a[252:255], v[44:47], v[152:155]
    ds_read_b128 a[220:223], v6 offset:7168
    v_mul_f32 v187, v187, v26
    v_mfma_f32_16x16x32_bf16 v[156:159], a[252:255], v[76:79], v[156:159]
    v_cvt_pk_bf16_f32 v103, v179, v187
    s_waitcnt lgkmcnt(4)
    v_mfma_f32_16x16x32_bf16 v[128:131], a[192:195], v[48:51], v[128:131]
    ds_read_b128 a[224:227], v6 offset:8192
    v_mul_f32 v164, v164, v27
    v_mfma_f32_16x16x32_bf16 v[132:135], a[192:195], v[80:83], v[132:135]
    buffer_store_dwordx4 v[100:103], v1, s[12:15], s80 offen offset:1024
    v_mfma_f32_16x16x32_bf16 v[136:139], a[196:199], v[48:51], v[136:139]
    ds_read_b128 a[228:231], v6 offset:9216
    v_mul_f32 v172, v172, v27
    v_mfma_f32_16x16x32_bf16 v[140:143], a[196:199], v[80:83], v[140:143]
    v_cvt_pk_bf16_f32 v104, v164, v172
    v_mul_f32 v180, v180, v27
    v_mfma_f32_16x16x32_bf16 v[144:147], a[200:203], v[48:51], v[144:147]
    ds_read_b128 a[232:235], v6 offset:10240
    v_readlane_b32 s27, v8, s20
    v_mfma_f32_16x16x32_bf16 v[148:151], a[200:203], v[80:83], v[148:151]
    v_mul_f32 v188, v188, v27
    v_cvt_pk_bf16_f32 v105, v180, v188
    v_mfma_f32_16x16x32_bf16 v[152:155], a[204:207], v[48:51], v[152:155]
    ds_read_b128 a[236:239], v6 offset:11264
    v_mul_f32 v165, v165, v27
    v_mfma_f32_16x16x32_bf16 v[156:159], a[204:207], v[80:83], v[156:159]
    v_mul_f32 v173, v173, v27
    s_waitcnt lgkmcnt(4)
    v_mfma_f32_16x16x32_bf16 v[128:131], a[208:211], v[52:55], v[128:131]
    ds_read_b128 a[240:243], v6 offset:12288
    v_cvt_pk_bf16_f32 v106, v165, v173
    v_mfma_f32_16x16x32_bf16 v[132:135], a[208:211], v[84:87], v[132:135]
    v_mul_f32 v181, v181, v27
    v_mul_f32 v189, v189, v27
    v_cvt_pk_bf16_f32 v107, v181, v189
    buffer_store_dwordx4 v[104:107], v1, s[12:15], s80 offen offset:2048
    v_mfma_f32_16x16x32_bf16 v[136:139], a[212:215], v[52:55], v[136:139]
    ds_read_b128 a[244:247], v6 offset:13312
    v_mul_f32 v166, v166, v27
    v_mfma_f32_16x16x32_bf16 v[140:143], a[212:215], v[84:87], v[140:143]
    v_mul_f32 v174, v174, v27
    v_cvt_pk_bf16_f32 v108, v166, v174
    v_mfma_f32_16x16x32_bf16 v[144:147], a[216:219], v[52:55], v[144:147]
    ds_read_b128 a[248:251], v6 offset:14336
    v_mul_f32 v182, v182, v27
    v_mfma_f32_16x16x32_bf16 v[148:151], a[216:219], v[84:87], v[148:151]
    v_mul_f32 v190, v190, v27
    v_cvt_pk_bf16_f32 v109, v182, v190
    v_mfma_f32_16x16x32_bf16 v[152:155], a[220:223], v[52:55], v[152:155]
    ds_read_b128 a[252:255], v6 offset:15360
    s_add_u32 m0, s22, 81920
    v_mfma_f32_16x16x32_bf16 v[156:159], a[220:223], v[84:87], v[156:159]
    s_waitcnt vmcnt(26) lgkmcnt(4)
    s_barrier
    v_mfma_f32_16x16x32_bf16 v[128:131], a[224:227], v[56:59], v[128:131]
    ds_read_b128 a[192:195], v5 offset:16384
    v_mul_f32 v167, v167, v27
    v_mfma_f32_16x16x32_bf16 v[132:135], a[224:227], v[88:91], v[132:135]
    buffer_load_dwordx4 v4, s[12:15], s27 offen offset:0 lds
    v_mfma_f32_16x16x32_bf16 v[136:139], a[228:231], v[56:59], v[136:139]
    ds_read_b128 a[196:199], v5 offset:17408
    v_mul_f32 v175, v175, v27
    v_mfma_f32_16x16x32_bf16 v[140:143], a[228:231], v[88:91], v[140:143]
    v_cvt_pk_bf16_f32 v110, v167, v175
    v_mul_f32 v183, v183, v27
    v_mul_f32 v191, v191, v27
    v_cvt_pk_bf16_f32 v111, v183, v191
    buffer_store_dwordx4 v[108:111], v1, s[12:15], s80 offen offset:3072
    v_mfma_f32_16x16x32_bf16 v[144:147], a[232:235], v[56:59], v[144:147]
    ds_read_b128 a[200:203], v5 offset:18432
    v_mfma_f32_16x16x32_bf16 v[148:151], a[232:235], v[88:91], v[148:151]
    buffer_load_dwordx4 v4, s[12:15], s27 offen offset:1024 lds
    v_mfma_f32_16x16x32_bf16 v[152:155], a[236:239], v[56:59], v[152:155]
    ds_read_b128 a[204:207], v5 offset:19456
    v_mfma_f32_16x16x32_bf16 v[156:159], a[236:239], v[88:91], v[156:159]
    s_waitcnt lgkmcnt(4)
    v_mfma_f32_16x16x32_bf16 v[128:131], a[240:243], v[60:63], v[128:131]
    ds_read_b128 a[208:211], v5 offset:20480
    v_mfma_f32_16x16x32_bf16 v[132:135], a[240:243], v[92:95], v[132:135]
    buffer_load_dwordx4 v4, s[12:15], s27 offen offset:2048 lds
    v_mfma_f32_16x16x32_bf16 v[136:139], a[244:247], v[60:63], v[136:139]
    ds_read_b128 a[212:215], v5 offset:21504
    v_mfma_f32_16x16x32_bf16 v[140:143], a[244:247], v[92:95], v[140:143]
    v_mfma_f32_16x16x32_bf16 v[144:147], a[248:251], v[60:63], v[144:147]
    ds_read_b128 a[216:219], v5 offset:22528
    s_add_u32 s20, s20, 1
    v_mfma_f32_16x16x32_bf16 v[148:151], a[248:251], v[92:95], v[148:151]
    buffer_load_dwordx4 v4, s[12:15], s27 offen offset:3072 lds
    v_mfma_f32_16x16x32_bf16 v[152:155], a[252:255], v[60:63], v[152:155]
    ds_read_b128 a[220:223], v5 offset:23552
    v_mfma_f32_16x16x32_bf16 v[156:159], a[252:255], v[92:95], v[156:159]
    s_waitcnt lgkmcnt(4)
    v_mfma_f32_16x16x32_bf16 v[160:163], a[192:195], v[32:35], 0
    ds_read_b128 a[224:227], v5 offset:24576
    s_xor_b32 s22, s22, 0x8000
    v_mfma_f32_16x16x32_bf16 v[164:167], a[192:195], v[64:67], 0
    s_waitcnt vmcnt(8)
    v_cmp_gt_u32 vcc, 1, v13
    v_mfma_f32_16x16x32_bf16 v[168:171], a[196:199], v[32:35], 0
    ds_read_b128 a[228:231], v5 offset:25600
    v_readlane_b32 s23, v7, s20
    v_mfma_f32_16x16x32_bf16 v[172:175], a[196:199], v[64:67], 0
    s_cmp_eq_u32 s92, 1
    s_cbranch_scc0 OP_x0
    s_cbranch_vccnz OP_x0
OP_xb0:
    v_mfma_f32_16x16x32_bf16 v[176:179], a[200:203], v[32:35], 0
    ds_read_b128 a[232:235], v5 offset:26624
    v_mul_f32 v128, v128, v26
    v_mfma_f32_16x16x32_bf16 v[180:183], a[200:203], v[64:67], 0
    buffer_load_dwordx4 v[192:195], v1, s[12:15], s81 offen offset:0 sc1
    v_mfma_f32_16x16x32_bf16 v[184:187], a[204:207], v[32:35], 0
    ds_read_b128 a[236:239], v5 offset:27648
    v_mul_f32 v136, v136, v26
    v_mfma_f32_16x16x32_bf16 v[188:191], a[204:207], v[64:67], 0
    v_cvt_pk_bf16_f32 v96, v128, v136
    s_waitcnt lgkmcnt(4)
    v_mfma_f32_16x16x32_bf16 v[160:163], a[208:211], v[36:39], v[160:163]
    ds_read_b128 a[240:243], v5 offset:28672
    v_mul_f32 v144, v144, v26
    v_mfma_f32_16x16x32_bf16 v[164:167], a[208:211], v[68:71], v[164:167]
    buffer_load_dwordx4 v[196:199], v1, s[12:15], s81 offen offset:1024 sc1
    v_mfma_f32_16x16x32_bf16 v[168:171], a[212:215], v[36:39], v[168:171]
    ds_read_b128 a[244:247], v5 offset:29696
    v_mov_b32 v15, 3
    v_mfma_f32_16x16x32_bf16 v[172:175], a[212:215], v[68:71], v[172:175]
    s_waitcnt vmcnt(5)
    s_cmp_eq_u32 s92, 1
    s_cbranch_scc0 OP_w2
OP_wb2:
    buffer_store_dword v15, v28, s[12:15], s34 offen offset:64
    buffer_store_dword v15, v28, s[12:15], s35 offen offset:64 sc1
    v_mfma_f32_16x16x32_bf16 v[176:179], a[216:219], v[36:39], v[176:179]
    ds_read_b128 a[248:251], v5 offset:30720
    v_mul_f32 v152, v152, v26
    v_mfma_f32_16x16x32_bf16 v[180:183], a[216:219], v[68:71], v[180:183]
    buffer_load_dwordx4 v[200:203], v1, s[12:15], s81 offen offset:2048 sc1
    v_mfma_f32_16x16x32_bf16 v[184:187], a[220:223], v[36:39], v[184:187]
    ds_read_b128 a[252:255], v5 offset:31744
    v_cvt_pk_bf16_f32 v97, v144, v152
    v_mfma_f32_16x16x32_bf16 v[188:191], a[220:223], v[68:71], v[188:191]
    v_mul_f32 v129, v129, v26
    s_waitcnt lgkmcnt(4)
    v_mfma_f32_16x16x32_bf16 v[160:163], a[224:227], v[40:43], v[160:163]
    ds_read_b128 a[192:195], v6 offset:16384
    v_mul_f32 v137, v137, v26
    v_mfma_f32_16x16x32_bf16 v[164:167], a[224:227], v[72:75], v[164:167]
    buffer_load_dwordx4 v[204:207], v1, s[12:15], s81 offen offset:3072 sc1
    v_mfma_f32_16x16x32_bf16 v[168:171], a[228:231], v[40:43], v[168:171]
    ds_read_b128 a[196:199], v6 offset:17408
    v_cvt_pk_bf16_f32 v98, v129, v137
    v_mfma_f32_16x16x32_bf16 v[172:175], a[228:231], v[72:75], v[172:175]
    buffer_load_dword v13, off, s[12:15], s29 offset:64 sc1
    v_mfma_f32_16x16x32_bf16 v[176:179], a[232:235], v[40:43], v[176:179]
    ds_read_b128 a[200:203], v6 offset:18432
    v_mul_f32 v145, v145, v26
    v_mfma_f32_16x16x32_bf16 v[180:183], a[232:235], v[72:75], v[180:183]
    v_mul_f32 v153, v153, v26
    v_cvt_pk_bf16_f32 v99, v145, v153
    v_mfma_f32_16x16x32_bf16 v[184:187], a[236:239], v[40:43], v[184:187]
    ds_read_b128 a[204:207], v6 offset:19456
    v_mul_f32 v130, v130, v26
    v_mfma_f32_16x16x32_bf16 v[188:191], a[236:239], v[72:75], v[188:191]
    s_add_u32 s81, s81, 4096
    s_waitcnt lgkmcnt(4)
    v_mfma_f32_16x16x32_bf16 v[160:163], a[240:243], v[44:47], v[160:163]
    ds_read_b128 a[208:211], v6 offset:20480
    s_add_u32 m0, s22, 0
    v_mfma_f32_16x16x32_bf16 v[164:167], a[240:243], v[76:79], v[164:167]
    buffer_load_dwordx4 v4, s[12:15], s23 offen offset:0 lds
    v_mfma_f32_16x16x32_bf16 v[168:171], a[244:247], v[44:47], v[168:171]
    ds_read_b128 a[212:215], v6 offset:21504
    v_mul_f32 v138, v138, v26
    v_mfma_f32_16x16x32_bf16 v[172:175], a[244:247], v[76:79], v[172:175]
    v_cvt_pk_bf16_f32 v100, v130, v138
    v_mul_f32 v146, v146, v26
    v_mfma_f32_16x16x32_bf16 v[176:179], a[248:251], v[44:47], v[176:179]
    ds_read_b128 a[216:219], v6 offset:22528
    v_mul_f32 v154, v154, v26
    v_mfma_f32_16x16x32_bf16 v[180:183], a[248:251], v[76:79], v[180:183]
    buffer_store_dwordx4 v[96:99], v1, s[12:15], s36 offen offset:0 sc1
    v_mfma_f32_16x16x32_bf16 v[184:187], a[252:255], v[44:47], v[184:187]
    ds_read_b128 a[220:223], v6 offset:23552
    v_xor_b32 v5, 0x8000, v5
    v_mfma_f32_16x16x32_bf16 v[188:191], a[252:255], v[76:79], v[188:191]
    v_cvt_pk_bf16_f32 v101, v146, v154
    s_waitcnt lgkmcnt(4)
    v_mfma_f32_16x16x32_bf16 v[160:163], a[192:195], v[48:51], v[160:163]
    ds_read_b128 a[224:227], v6 offset:24576
    v_mul_f32 v131, v131, v26
    v_mfma_f32_16x16x32_bf16 v[164:167], a[192:195], v[80:83], v[164:167]
    buffer_load_dwordx4 v4, s[12:15], s23 offen offset:1024 lds
    v_mfma_f32_16x16x32_bf16 v[168:171], a[196:199], v[48:51], v[168:171]
    ds_read_b128 a[228:231], v6 offset:25600
    v_mul_f32 v139, v139, v26
    v_mfma_f32_16x16x32_bf16 v[172:175], a[196:199], v[80:83], v[172:175]
    v_cvt_pk_bf16_f32 v102, v131, v139
    v_mul_f32 v147, v147, v26
    v_mfma_f32_16x16x32_bf16 v[176:179], a[200:203], v[48:51], v[176:179]
    ds_read_b128 a[232:235], v6 offset:26624
    v_readlane_b32 s27, v8, s20
    v_mfma_f32_16x16x32_bf16 v[180:183], a[200:203], v[80:83], v[180:183]
    v_mul_f32 v155, v155, v26
    v_cvt_pk_bf16_f32 v103, v147, v155
    v_mfma_f32_16x16x32_bf16 v[184:187], a[204:207], v[48:51], v[184:187]
    ds_read_b128 a[236:239], v6 offset:27648
    v_mul_f32 v132, v132, v27
    v_mfma_f32_16x16x32_bf16 v[188:191], a[204:207], v[80:83], v[188:191]
    v_mul_f32 v140, v140, v27
    s_waitcnt lgkmcnt(4)
    v_mfma_f32_16x16x32_bf16 v[160:163], a[208:211], v[52:55], v[160:163]
    ds_read_b128 a[240:243], v6 offset:28672
    v_cvt_pk_bf16_f32 v104, v132, v140
    v_mfma_f32_16x16x32_bf16 v[164:167], a[208:211], v[84:87], v[164:167]
    buffer_load_dwordx4 v4, s[12:15], s23 offen offset:2048 lds
    v_mfma_f32_16x16x32_bf16 v[168:171], a[212:215], v[52:55], v[168:171]
    ds_read_b128 a[244:247], v6 offset:29696
    v_mul_f32 v148, v148, v27
    v_mfma_f32_16x16x32_bf16 v[172:175], a[212:215], v[84:87], v[172:175]
    buffer_load_dwordx4 v4, s[12:15], s23 offen offset:3072 lds
    v_mfma_f32_16x16x32_bf16 v[176:179], a[216:219], v[52:55], v[176:179]
    ds_read_b128 a[248:251], v6 offset:30720
    v_mul_f32 v156, v156, v27
    v_mfma_f32_16x16x32_bf16 v[180:183], a[216:219], v[84:87], v[180:183]
    buffer_store_dwordx4 v[100:103], v1, s[12:15], s36 offen offset:1024 sc1
    v_mfma_f32_16x16x32_bf16 v[184:187], a[220:223], v[52:55], v[184:187]
    ds_read_b128 a[252:255], v6 offset:31744
    s_add_u32 m0, s22, 65536
    v_mfma_f32_16x16x32_bf16 v[188:191], a[220:223], v[84:87], v[188:191]
    s_waitcnt vmcnt(28) lgkmcnt(4)
    s_barrier
    v_mfma_f32_16x16x32_bf16 v[160:163], a[224:227], v[56:59], v[160:163]
    ds_read_b128 a[192:195], v5 offset:0
    v_xor_b32 v6, 0x8000, v6
    v_mfma_f32_16x16x32_bf16 v[164:167], a[224:227], v[88:91], v[164:167]
    buffer_load_dwordx4 v4, s[12:15], s27 offen offset:0 lds
    v_mfma_f32_16x16x32_bf16 v[168:171], a[228:231], v[56:59], v[168:171]
    ds_read_b128 a[196:199], v5 offset:1024
    v_cvt_pk_bf16_f32 v105, v148, v156
    v_mfma_f32_16x16x32_bf16 v[172:175], a[228:231], v[88:91], v[172:175]
    v_mul_f32 v133, v133, v27
    v_mul_f32 v141, v141, v27
    v_mfma_f32_16x16x32_bf16 v[176:179], a[232:235], v[56:59], v[176:179]
    ds_read_b128 a[200:203], v5 offset:2048
    v_cvt_pk_bf16_f32 v106, v133, v141
    v_mfma_f32_16x16x32_bf16 v[180:183], a[232:235], v[88:91], v[180:183]
    buffer_load_dwordx4 v4, s[12:15], s27 offen offset:1024 lds
    v_mfma_f32_16x16x32_bf16 v[184:187], a[236:239], v[56:59], v[184:187]
    ds_read_b128 a[204:207], v5 offset:3072
    v_mul_f32 v149, v149, v27
    v_mfma_f32_16x16x32_bf16 v[188:191], a[236:239], v[88:91], v[188:191]
    v_mul_f32 v157, v157, v27
    v_cvt_pk_bf16_f32 v107, v149, v157
    s_waitcnt lgkmcnt(4)
    buffer_store_dwordx4 v[104:107], v22, s[12:15], s36 offen offset:0 sc1
    v_mfma_f32_16x16x32_bf16 v[160:163], a[240:243], v[60:63], v[160:163]
    ds_read_b128 a[208:211], v5 offset:4096
    v_mul_f32 v134, v134, v27
    v_mfma_f32_16x16x32_bf16 v[164:167], a[240:243], v[92:95], v[164:167]
    buffer_load_dwordx4 v4, s[12:15], s27 offen offset:2048 lds
    v_mfma_f32_16x16x32_bf16 v[168:171], a[244:247], v[60:63], v[168:171]
    ds_read_b128 a[212:215], v5 offset:5120
    v_mul_f32 v142, v142, v27
    v_mfma_f32_16x16x32_bf16 v[172:175], a[244:247], v[92:95], v[172:175]
    v_cvt_pk_bf16_f32 v108, v134, v142
    v_mul_f32 v150, v150, v27
    v_mfma_f32_16x16x32_bf16 v[176:179], a[248:251], v[60:63], v[176:179]
    ds_read_b128 a[216:219], v5 offset:6144
    s_add_u32 s20, s20, 1
    v_mfma_f32_16x16x32_bf16 v[180:183], a[248:251], v[92:95], v[180:183]
    buffer_load_dwordx4 v4, s[12:15], s27 offen offset:3072 lds
    v_mfma_f32_16x16x32_bf16 v[184:187], a[252:255], v[60:63], v[184:187]
    ds_read_b128 a[220:223], v5 offset:7168
    v_mul_f32 v158, v158, v27
    v_mfma_f32_16x16x32_bf16 v[188:191], a[252:255], v[92:95], v[188:191]
    v_cvt_pk_bf16_f32 v109, v150, v158
    v_mul_f32 v135, v135, v27
    v_mul_f32 v143, v143, v27
    v_cvt_pk_bf16_f32 v110, v135, v143
    v_mul_f32 v151, v151, v27
    v_mul_f32 v159, v159, v27
    v_cvt_pk_bf16_f32 v111, v151, v159
    buffer_store_dwordx4 v[108:111], v22, s[12:15], s36 offen offset:1024 sc1
    s_waitcnt lgkmcnt(4)
    v_mfma_f32_16x16x32_bf16 v[128:131], a[192:195], v[32:35], 0
    ds_read_b128 a[224:227], v5 offset:8192
    v_readlane_b32 s23, v7, s20
    v_mfma_f32_16x16x32_bf16 v[132:135], a[192:195], v[64:67], 0
    s_waitcnt vmcnt(12)
    v_cmp_gt_u32 vcc, 2, v13
    v_mfma_f32_16x16x32_bf16 v[136:139], a[196:199], v[32:35], 0
    ds_read_b128 a[228:231], v5 offset:9216
    s_sub_u32 s36, s36, 12288
    v_mfma_f32_16x16x32_bf16 v[140:143], a[196:199], v[64:67], 0
    s_cmp_eq_u32 s92, 1
    s_cbranch_scc0 OP_x1
    s_cbranch_vccnz OP_x1
OP_xb1:
    v_mfma_f32_16x16x32_bf16 v[144:147], a[200:203], v[32:35], 0
    ds_read_b128 a[232:235], v5 offset:10240
    s_waitcnt vmcnt(13)
    v_lshlrev_b32 v96, 16, v192
    v_mfma_f32_16x16x32_bf16 v[148:151], a[200:203], v[64:67], 0
    buffer_load_dwordx4 v[208:211], v1, s[12:15], s81 offen offset:0 sc1
    v_mfma_f32_16x16x32_bf16 v[152:155], a[204:207], v[32:35], 0
    ds_read_b128 a[236:239], v5 offset:11264
    v_and_b32 v192, 0xffff0000, v192
    v_fma_f32 v160, v160, v26, v96
    v_mfma_f32_16x16x32_bf16 v[156:159], a[204:207], v[64:67], 0
    v_fma_f32 v168, v168, v26, v192
    s_waitcnt lgkmcnt(4)
    v_mfma_f32_16x16x32_bf16 v[128:131], a[208:211], v[36:39], v[128:131]
    ds_read_b128 a[240:243], v5 offset:12288
    v_cvt_pk_bf16_f32 v96, v160, v168
    v_lshlrev_b32 v97, 16, v193
    v_mfma_f32_16x16x32_bf16 v[132:135], a[208:211], v[68:71], v[132:135]
    buffer_load_dwordx4 v[212:215], v1, s[12:15], s81 offen offset:1024 sc1
    v_mfma_f32_16x16x32_bf16 v[136:139], a[212:215], v[36:39], v[136:139]
    ds_read_b128 a[244:247], v5 offset:13312
    v_and_b32 v193, 0xffff0000, v193
    v_fma_f32 v176, v176, v26, v97
    v_mfma_f32_16x16x32_bf16 v[140:143], a[212:215], v[68:71], v[140:143]
    v_fma_f32 v184, v184, v26, v193
    v_cvt_pk_bf16_f32 v97, v176, v184
    v_mfma_f32_16x16x32_bf16 v[144:147], a[216:219], v[36:39], v[144:147]
    ds_read_b128 a[248:251], v5 offset:14336
    v_lshlrev_b32 v98, 16, v194
    v_and_b32 v194, 0xffff0000, v194
    v_mfma_f32_16x16x32_bf16 v[148:151], a[216:219], v[68:71], v[148:151]
    buffer_load_dwordx4 v[216:219], v1, s[12:15], s81 offen offset:2048 sc1
    v_mfma_f32_16x16x32_bf16 v[152:155], a[220:223], v[36:39], v[152:155]
    ds_read_b128 a[252:255], v5 offset:15360
    v_fma_f32 v161, v161, v26, v98
    v_fma_f32 v169, v169, v26, v194
    v_mfma_f32_16x16x32_bf16 v[156:159], a[220:223], v[68:71], v[156:159]
    v_cvt_pk_bf16_f32 v98, v161, v169
    s_waitcnt lgkmcnt(4)
    v_mfma_f32_16x16x32_bf16 v[128:131], a[224:227], v[40:43], v[128:131]
    ds_read_b128 a[192:195], v6 offset:0
    v_lshlrev_b32 v99, 16, v195
    v_and_b32 v195, 0xffff0000, v195
    v_mfma_f32_16x16x32_bf16 v[132:135], a[224:227], v[72:75], v[132:135]
    buffer_load_dwordx4 v[220:223], v1, s[12:15], s81 offen offset:3072 sc1
    v_mfma_f32_16x16x32_bf16 v[136:139], a[228:231], v[40:43], v[136:139]
    ds_read_b128 a[196:199], v6 offset:1024
    v_fma_f32 v177, v177, v26, v99
    v_fma_f32 v185, v185, v26, v195
    v_mfma_f32_16x16x32_bf16 v[140:143], a[228:231], v[72:75], v[140:143]
    buffer_load_dword v13, off, s[12:15], s29 offset:64 sc1
    v_mfma_f32_16x16x32_bf16 v[144:147], a[232:235], v[40:43], v[144:147]
    ds_read_b128 a[200:203], v6 offset:2048
    v_cvt_pk_bf16_f32 v99, v177, v185
    v_lshlrev_b32 v100, 16, v196
    v_mfma_f32_16x16x32_bf16 v[148:151], a[232:235], v[72:75], v[148:151]
    buffer_store_dwordx4 v[96:99], v1, s[12:15], s36 offen offset:0 sc1
    v_mfma_f32_16x16x32_bf16 v[152:155], a[236:239], v[40:43], v[152:155]
    ds_read_b128 a[204:207], v6 offset:3072
    v_and_b32 v196, 0xffff0000, v196
    v_fma_f32 v162, v162, v26, v100
    v_mfma_f32_16x16x32_bf16 v[156:159], a[236:239], v[72:75], v[156:159]
    s_add_u32 s81, s81, 4096
    s_waitcnt lgkmcnt(4)
    v_mfma_f32_16x16x32_bf16 v[128:131], a[240:243], v[44:47], v[128:131]
    ds_read_b128 a[208:211], v6 offset:4096
    s_add_u32 m0, s22, 16384
    v_fma_f32 v170, v170, v26, v196
    v_mfma_f32_16x16x32_bf16 v[132:135], a[240:243], v[76:79], v[132:135]
    buffer_load_dwordx4 v4, s[12:15], s23 offen offset:0 lds
    v_mfma_f32_16x16x32_bf16 v[136:139], a[244:247], v[44:47], v[136:139]
    ds_read_b128 a[212:215], v6 offset:5120
    v_cvt_pk_bf16_f32 v100, v162, v170
    v_lshlrev_b32 v101, 16, v197
    v_mfma_f32_16x16x32_bf16 v[140:143], a[244:247], v[76:79], v[140:143]
    v_and_b32 v197, 0xffff0000, v197
    v_fma_f32 v178, v178, v26, v101
    v_mfma_f32_16x16x32_bf16 v[144:147], a[248:251], v[44:47], v[144:147]
    ds_read_b128 a[216:219], v6 offset:6144
    v_fma_f32 v186, v186, v26, v197
    v_cvt_pk_bf16_f32 v101, v178, v186
    v_mfma_f32_16x16x32_bf16 v[148:151], a[248:251], v[76:79], v[148:151]
    v_lshlrev_b32 v102, 16, v198
    v_and_b32 v198, 0xffff0000, v198
    v_mfma_f32_16x16x32_bf16 v[152:155], a[252:255], v[44:47], v[152:155]
    ds_read_b128 a[220:223], v6 offset:7168
    v_fma_f32 v163, v163, v26, v102
    v_fma_f32 v171, v171, v26, v198
    v_mfma_f32_16x16x32_bf16 v[156:159], a[252:255], v[76:79], v[156:159]
    v_cvt_pk_bf16_f32 v102, v163, v171
    s_waitcnt lgkmcnt(4)
    v_mfma_f32_16x16x32_bf16 v[128:131], a[192:195], v[48:51], v[128:131]
    ds_read_b128 a[224:227], v6 offset:8192
    v_lshlrev_b32 v103, 16, v199
    v_and_b32 v199, 0xffff0000, v199
    v_mfma_f32_16x16x32_bf16 v[132:135], a[192:195], v[80:83], v[132:135]
    buffer_load_dwordx4 v4, s[12:15], s23 offen offset:1024 lds
    v_mfma_f32_16x16x32_bf16 v[136:139], a[196:199], v[48:51], v[136:139]
    ds_read_b128 a[228:231], v6 offset:9216
    v_fma_f32 v179, v179, v26, v103
    v_fma_f32 v187, v187, v26, v199
    v_mfma_f32_16x16x32_bf16 v[140:143], a[196:199], v[80:83], v[140:143]
    v_cvt_pk_bf16_f32 v103, v179, v187
    v_lshlrev_b32 v104, 16, v200
    v_mfma_f32_16x16x32_bf16 v[144:147], a[200:203], v[48:51], v[144:147]
    ds_read_b128 a[232:235], v6 offset:10240
    v_readlane_b32 s27, v8, s20
    v_and_b32 v200, 0xffff0000, v200
    v_mfma_f32_16x16x32_bf16 v[148:151], a[200:203], v[80:83], v[148:151]
    buffer_store_dwordx4 v[100:103], v1, s[12:15], s36 offen offset:1024 sc1
    v_mfma_f32_16x16x32_bf16 v[152:155], a[204:207], v[48:51], v[152:155]
    ds_read_b128 a[236:239], v6 offset:11264
    v_fma_f32 v164, v164, v27, v104
    v_fma_f32 v172, v172, v27, v200
    v_mfma_f32_16x16x32_bf16 v[156:159], a[204:207], v[80:83], v[156:159]
    v_cvt_pk_bf16_f32 v104, v164, v172
    s_waitcnt lgkmcnt(4)
    v_mfma_f32_16x16x32_bf16 v[128:131], a[208:211], v[52:55], v[128:131]
    ds_read_b128 a[240:243], v6 offset:12288
    v_lshlrev_b32 v105, 16, v201
    v_and_b32 v201, 0xffff0000, v201
    v_mfma_f32_16x16x32_bf16 v[132:135], a[208:211], v[84:87], v[132:135]
    buffer_load_dwordx4 v4, s[12:15], s23 offen offset:2048 lds
    v_mfma_f32_16x16x32_bf16 v[136:139], a[212:215], v[52:55], v[136:139]
    ds_read_b128 a[244:247], v6 offset:13312
    v_fma_f32 v180, v180, v27, v105
    v_fma_f32 v188, v188, v27, v201
    v_mfma_f32_16x16x32_bf16 v[140:143], a[212:215], v[84:87], v[140:143]
    buffer_load_dwordx4 v4, s[12:15], s23 offen offset:3072 lds
    v_mfma_f32_16x16x32_bf16 v[144:147], a[216:219], v[52:55], v[144:147]
    ds_read_b128 a[248:251], v6 offset:14336
    v_cvt_pk_bf16_f32 v105, v180, v188
    v_lshlrev_b32 v106, 16, v202
    v_mfma_f32_16x16x32_bf16 v[148:151], a[216:219], v[84:87], v[148:151]
    v_and_b32 v202, 0xffff0000, v202
    v_fma_f32 v165, v165, v27, v106
    v_mfma_f32_16x16x32_bf16 v[152:155], a[220:223], v[52:55], v[152:155]
    ds_read_b128 a[252:255], v6 offset:15360
    s_add_u32 m0, s22, 81920
    v_fma_f32 v173, v173, v27, v202
    v_mfma_f32_16x16x32_bf16 v[156:159], a[220:223], v[84:87], v[156:159]
    s_waitcnt vmcnt(30) lgkmcnt(4)
    s_barrier
    v_mfma_f32_16x16x32_bf16 v[128:131], a[224:227], v[56:59], v[128:131]
    ds_read_b128 a[192:195], v5 offset:16384
    v_cvt_pk_bf16_f32 v106, v165, v173
    v_lshlrev_b32 v107, 16, v203
    v_mfma_f32_16x16x32_bf16 v[132:135], a[224:227], v[88:91], v[132:135]
    buffer_load_dwordx4 v4, s[12:15], s27 offen offset:0 lds
    v_mfma_f32_16x16x32_bf16 v[136:139], a[228:231], v[56:59], v[136:139]
    ds_read_b128 a[196:199], v5 offset:17408
    v_and_b32 v203, 0xffff0000, v203
    v_fma_f32 v181, v181, v27, v107
    v_mfma_f32_16x16x32_bf16 v[140:143], a[228:231], v[88:91], v[140:143]
    v_fma_f32 v189, v189, v27, v203
    v_cvt_pk_bf16_f32 v107, v181, v189
    buffer_store_dwordx4 v[104:107], v22, s[12:15], s36 offen offset:0 sc1
    v_mfma_f32_16x16x32_bf16 v[144:147], a[232:235], v[56:59], v[144:147]
    ds_read_b128 a[200:203], v5 offset:18432
    v_lshlrev_b32 v108, 16, v204
    v_and_b32 v204, 0xffff0000, v204
    v_mfma_f32_16x16x32_bf16 v[148:151], a[232:235], v[88:91], v[148:151]
    buffer_load_dwordx4 v4, s[12:15], s27 offen offset:1024 lds
    v_mfma_f32_16x16x32_bf16 v[152:155], a[236:239], v[56:59], v[152:155]
    ds_read_b128 a[204:207], v5 offset:19456
    v_fma_f32 v166, v166, v27, v108
    v_fma_f32 v174, v174, v27, v204
    v_mfma_f32_16x16x32_bf16 v[156:159], a[236:239], v[88:91], v[156:159]
    v_cvt_pk_bf16_f32 v108, v166, v174
    s_waitcnt lgkmcnt(4)
    v_mfma_f32_16x16x32_bf16 v[128:131], a[240:243], v[60:63], v[128:131]
    ds_read_b128 a[208:211], v5 offset:20480
    v_lshlrev_b32 v109, 16, v205
    v_and_b32 v205, 0xffff0000, v205
    v_mfma_f32_16x16x32_bf16 v[132:135], a[240:243], v[92:95], v[132:135]
    buffer_load_dwordx4 v4, s[12:15], s27 offen offset:2048 lds
    v_mfma_f32_16x16x32_bf16 v[136:139], a[244:247], v[60:63], v[136:139]
    ds_read_b128 a[212:215], v5 offset:21504
    v_fma_f32 v182, v182, v27, v109
    v_fma_f32 v190, v190, v27, v205
    v_mfma_f32_16x16x32_bf16 v[140:143], a[244:247], v[92:95], v[140:143]
    v_cvt_pk_bf16_f32 v109, v182, v190
    v_lshlrev_b32 v110, 16, v206
    v_mfma_f32_16x16x32_bf16 v[144:147], a[248:251], v[60:63], v[144:147]
    ds_read_b128 a[216:219], v5 offset:22528
    s_add_u32 s20, s20, 1
    v_and_b32 v206, 0xffff0000, v206
    v_mfma_f32_16x16x32_bf16 v[148:151], a[248:251], v[92:95], v[148:151]
    buffer_load_dwordx4 v4, s[12:15], s27 offen offset:3072 lds
    v_mfma_f32_16x16x32_bf16 v[152:155], a[252:255], v[60:63], v[152:155]
    ds_read_b128 a[220:223], v5 offset:23552
    v_fma_f32 v167, v167, v27, v110
    v_fma_f32 v175, v175, v27, v206
    v_mfma_f32_16x16x32_bf16 v[156:159], a[252:255], v[92:95], v[156:159]
    v_cvt_pk_bf16_f32 v110, v167, v175
    v_lshlrev_b32 v111, 16, v207
    v_and_b32 v207, 0xffff0000, v207
    v_fma_f32 v183, v183, v27, v111
    v_fma_f32 v191, v191, v27, v207
    v_cvt_pk_bf16_f32 v111, v183, v191
    buffer_store_dwordx4 v[108:111], v22, s[12:15], s36 offen offset:1024 sc1
    s_waitcnt lgkmcnt(4)
    v_mfma_f32_16x16x32_bf16 v[160:163], a[192:195], v[32:35], 0
    ds_read_b128 a[224:227], v5 offset:24576
    s_xor_b32 s22, s22, 0x8000
    v_mfma_f32_16x16x32_bf16 v[164:167], a[192:195], v[64:67], 0
    s_waitcnt vmcnt(12)
    v_cmp_gt_u32 vcc, 3, v13
    v_mfma_f32_16x16x32_bf16 v[168:171], a[196:199], v[32:35], 0
    ds_read_b128 a[228:231], v5 offset:25600
    s_add_u32 s36, s36, 4096
    v_mfma_f32_16x16x32_bf16 v[172:175], a[196:199], v[64:67], 0
    s_cmp_eq_u32 s92, 1
    s_cbranch_scc0 OP_x2
    s_cbranch_vccnz OP_x2
OP_xb2:
    v_mfma_f32_16x16x32_bf16 v[176:179], a[200:203], v[32:35], 0
    ds_read_b128 a[232:235], v5 offset:26624
    s_waitcnt vmcnt(13)
    v_lshlrev_b32 v96, 16, v208
    v_mfma_f32_16x16x32_bf16 v[180:183], a[200:203], v[64:67], 0
    buffer_load_dwordx4 v[192:195], v1, s[12:15], s81 offen offset:0 sc1
    v_mfma_f32_16x16x32_bf16 v[184:187], a[204:207], v[32:35], 0
    ds_read_b128 a[236:239], v5 offset:27648
    v_and_b32 v208, 0xffff0000, v208
    v_mfma_f32_16x16x32_bf16 v[188:191], a[204:207], v[64:67], 0
    v_fma_f32 v128, v128, v26, v96
    s_waitcnt lgkmcnt(4)
    v_mfma_f32_16x16x32_bf16 v[160:163], a[208:211], v[36:39], v[160:163]
    ds_read_b128 a[240:243], v5 offset:28672
    v_fma_f32 v136, v136, v26, v208
    v_cvt_pk_bf16_f32 v96, v128, v136
    v_mfma_f32_16x16x32_bf16 v[164:167], a[208:211], v[68:71], v[164:167]
    buffer_load_dwordx4 v[196:199], v1, s[12:15], s81 offen offset:1024 sc1
    v_mfma_f32_16x16x32_bf16 v[168:171], a[212:215], v[36:39], v[168:171]
    ds_read_b128 a[244:247], v5 offset:29696
    v_lshlrev_b32 v97, 16, v209
    v_mfma_f32_16x16x32_bf16 v[172:175], a[212:215], v[68:71], v[172:175]
    v_and_b32 v209, 0xffff0000, v209
    v_fma_f32 v144, v144, v26, v97
    v_mfma_f32_16x16x32_bf16 v[176:179], a[216:219], v[36:39], v[176:179]
    ds_read_b128 a[248:251], v5 offset:30720
    v_fma_f32 v152, v152, v26, v209
    v_cvt_pk_bf16_f32 v97, v144, v152
    v_mfma_f32_16x16x32_bf16 v[180:183], a[216:219], v[68:71], v[180:183]
    buffer_load_dwordx4 v[200:203], v1, s[12:15], s81 offen offset:2048 sc1
    v_mfma_f32_16x16x32_bf16 v[184:187], a[220:223], v[36:39], v[184:187]
    ds_read_b128 a[252:255], v5 offset:31744
    v_lshlrev_b32 v98, 16, v210
    v_mfma_f32_16x16x32_bf16 v[188:191], a[220:223], v[68:71], v[188:191]
    v_and_b32 v210, 0xffff0000, v210
    s_waitcnt lgkmcnt(4)
    v_mfma_f32_16x16x32_bf16 v[160:163], a[224:227], v[40:43], v[160:163]
    ds_read_b128 a[192:195], v6 offset:16384
    v_fma_f32 v129, v129, v26, v98
    v_fma_f32 v137, v137, v26, v210
    v_mfma_f32_16x16x32_bf16 v[164:167], a[224:227], v[72:75], v[164:167]
    buffer_load_dwordx4 v[204:207], v1, s[12:15], s81 offen offset:3072 sc1
    v_mfma_f32_16x16x32_bf16 v[168:171], a[228:231], v[40:43], v[168:171]
    ds_read_b128 a[196:199], v6 offset:17408
    v_cvt_pk_bf16_f32 v98, v129, v137
    v_mfma_f32_16x16x32_bf16 v[172:175], a[228:231], v[72:75], v[172:175]
    v_lshlrev_b32 v99, 16, v211
    v_and_b32 v211, 0xffff0000, v211
    v_mfma_f32_16x16x32_bf16 v[176:179], a[232:235], v[40:43], v[176:179]
    ds_read_b128 a[200:203], v6 offset:18432
    v_fma_f32 v145, v145, v26, v99
    v_fma_f32 v153, v153, v26, v211
    v_mfma_f32_16x16x32_bf16 v[180:183], a[232:235], v[72:75], v[180:183]
    v_cvt_pk_bf16_f32 v99, v145, v153
    buffer_store_dwordx4 v[96:99], v1, s[12:15], s36 offen offset:0 sc1
    v_mfma_f32_16x16x32_bf16 v[184:187], a[236:239], v[40:43], v[184:187]
    ds_read_b128 a[204:207], v6 offset:19456
    v_lshlrev_b32 v100, 16, v212
    v_mfma_f32_16x16x32_bf16 v[188:191], a[236:239], v[72:75], v[188:191]
    v_and_b32 v212, 0xffff0000, v212
    s_waitcnt lgkmcnt(4)
    v_mfma_f32_16x16x32_bf16 v[160:163], a[240:243], v[44:47], v[160:163]
    ds_read_b128 a[208:211], v6 offset:20480
    v_fma_f32 v130, v130, v26, v100
    v_fma_f32 v138, v138, v26, v212
    v_mfma_f32_16x16x32_bf16 v[164:167], a[240:243], v[76:79], v[164:167]
    v_cvt_pk_bf16_f32 v100, v130, v138
    v_lshlrev_b32 v101, 16, v213
    v_mfma_f32_16x16x32_bf16 v[168:171], a[244:247], v[44:47], v[168:171]
    ds_read_b128 a[212:215], v6 offset:21504
    v_and_b32 v213, 0xffff0000, v213
    v_mfma_f32_16x16x32_bf16 v[172:175], a[244:247], v[76:79], v[172:175]
    v_fma_f32 v146, v146, v26, v101
    v_fma_f32 v154, v154, v26, v213
    v_mfma_f32_16x16x32_bf16 v[176:179], a[248:251], v[44:47], v[176:179]
    ds_read_b128 a[216:219], v6 offset:22528
    v_cvt_pk_bf16_f32 v101, v146, v154
    v_lshlrev_b32 v102, 16, v214
    v_mfma_f32_16x16x32_bf16 v[180:183], a[248:251], v[76:79], v[180:183]
    v_and_b32 v214, 0xffff0000, v214
    v_fma_f32 v131, v131, v26, v102
    v_mfma_f32_16x16x32_bf16 v[184:187], a[252:255], v[44:47], v[184:187]
    ds_read_b128 a[220:223], v6 offset:23552
    v_xor_b32 v5, 0x8000, v5
    v_mfma_f32_16x16x32_bf16 v[188:191], a[252:255], v[76:79], v[188:191]
    v_fma_f32 v139, v139, v26, v214
    s_waitcnt lgkmcnt(4)
    v_mfma_f32_16x16x32_bf16 v[160:163], a[192:195], v[48:51], v[160:163]
    ds_read_b128 a[224:227], v6 offset:24576
    v_cvt_pk_bf16_f32 v102, v131, v139
    v_lshlrev_b32 v103, 16, v215
    v_mfma_f32_16x16x32_bf16 v[164:167], a[192:195], v[80:83], v[164:167]
    v_and_b32 v215, 0xffff0000, v215
    v_fma_f32 v147, v147, v26, v103
    v_mfma_f32_16x16x32_bf16 v[168:171], a[196:199], v[48:51], v[168:171]
    ds_read_b128 a[228:231], v6 offset:25600
    v_fma_f32 v155, v155, v26, v215
    v_mfma_f32_16x16x32_bf16 v[172:175], a[196:199], v[80:83], v[172:175]
    v_cvt_pk_bf16_f32 v103, v147, v155
    v_lshlrev_b32 v104, 16, v216
    v_mfma_f32_16x16x32_bf16 v[176:179], a[200:203], v[48:51], v[176:179]
    ds_read_b128 a[232:235], v6 offset:26624
    v_and_b32 v216, 0xffff0000, v216
    v_fma_f32 v132, v132, v27, v104
    v_mfma_f32_16x16x32_bf16 v[180:183], a[200:203], v[80:83], v[180:183]
    buffer_store_dwordx4 v[100:103], v1, s[12:15], s36 offen offset:1024 sc1
    v_mfma_f32_16x16x32_bf16 v[184:187], a[204:207], v[48:51], v[184:187]
    ds_read_b128 a[236:239], v6 offset:27648
    v_fma_f32 v140, v140, v27, v216
    v_mfma_f32_16x16x32_bf16 v[188:191], a[204:207], v[80:83], v[188:191]
    v_cvt_pk_bf16_f32 v104, v132, v140
    s_waitcnt lgkmcnt(4)
    v_mfma_f32_16x16x32_bf16 v[160:163], a[208:211], v[52:55], v[160:163]
    ds_read_b128 a[240:243], v6 offset:28672
    v_lshlrev_b32 v105, 16, v217
    v_and_b32 v217, 0xffff0000, v217
    v_mfma_f32_16x16x32_bf16 v[164:167], a[208:211], v[84:87], v[164:167]
    v_fma_f32 v148, v148, v27, v105
    v_fma_f32 v156, v156, v27, v217
    v_mfma_f32_16x16x32_bf16 v[168:171], a[212:215], v[52:55], v[168:171]
    ds_read_b128 a[244:247], v6 offset:29696
    v_cvt_pk_bf16_f32 v105, v148, v156
    v_mfma_f32_16x16x32_bf16 v[172:175], a[212:215], v[84:87], v[172:175]
    v_lshlrev_b32 v106, 16, v218
    v_and_b32 v218, 0xffff0000, v218
    v_mfma_f32_16x16x32_bf16 v[176:179], a[216:219], v[52:55], v[176:179]
    ds_read_b128 a[248:251], v6 offset:30720
    v_fma_f32 v133, v133, v27, v106
    v_fma_f32 v141, v141, v27, v218
    v_mfma_f32_16x16x32_bf16 v[180:183], a[216:219], v[84:87], v[180:183]
    v_cvt_pk_bf16_f32 v106, v133, v141
    v_lshlrev_b32 v107, 16, v219
    v_mfma_f32_16x16x32_bf16 v[184:187], a[220:223], v[52:55], v[184:187]
    ds_read_b128 a[252:255], v6 offset:31744
    v_and_b32 v219, 0xffff0000, v219
    v_mfma_f32_16x16x32_bf16 v[188:191], a[220:223], v[84:87], v[188:191]
    s_waitcnt vmcnt(23) lgkmcnt(4)
    s_barrier
    v_mfma_f32_16x16x32_bf16 v[160:163], a[224:227], v[56:59], v[160:163]
    v_xor_b32 v6, 0x8000, v6
    v_fma_f32 v149, v149, v27, v107
    v_fma_f32 v157, v157, v27, v219
    v_mfma_f32_16x16x32_bf16 v[164:167], a[224:227], v[88:91], v[164:167]
    v_cvt_pk_bf16_f32 v107, v149, v157
    v_lshlrev_b32 v108, 16, v220
    buffer_store_dword v14, v31, s[12:15], s93 offen offset:132 sc1
    v_mfma_f32_16x16x32_bf16 v[168:171], a[228:231], v[56:59], v[168:171]
    v_and_b32 v220, 0xffff0000, v220
    v_fma_f32 v134, v134, v27, v108
    v_mfma_f32_16x16x32_bf16 v[172:175], a[228:231], v[88:91], v[172:175]
    buffer_store_dwordx4 v[104:107], v22, s[12:15], s36 offen offset:0 sc1
    v_mfma_f32_16x16x32_bf16 v[176:179], a[232:235], v[56:59], v[176:179]
    v_fma_f32 v142, v142, v27, v220
    v_cvt_pk_bf16_f32 v108, v134, v142
    v_lshlrev_b32 v109, 16, v221
    v_mfma_f32_16x16x32_bf16 v[180:183], a[232:235], v[88:91], v[180:183]
    v_and_b32 v221, 0xffff0000, v221
    v_fma_f32 v150, v150, v27, v109
    v_mfma_f32_16x16x32_bf16 v[184:187], a[236:239], v[56:59], v[184:187]
    v_fma_f32 v158, v158, v27, v221
    v_cvt_pk_bf16_f32 v109, v150, v158
    v_mfma_f32_16x16x32_bf16 v[188:191], a[236:239], v[88:91], v[188:191]
    v_lshlrev_b32 v110, 16, v222
    s_waitcnt lgkmcnt(0)
    v_mfma_f32_16x16x32_bf16 v[160:163], a[240:243], v[60:63], v[160:163]
    v_and_b32 v222, 0xffff0000, v222
    v_fma_f32 v135, v135, v27, v110
    v_fma_f32 v143, v143, v27, v222
    v_mfma_f32_16x16x32_bf16 v[164:167], a[240:243], v[92:95], v[164:167]
    v_cvt_pk_bf16_f32 v110, v135, v143
    v_lshlrev_b32 v111, 16, v223
    v_mfma_f32_16x16x32_bf16 v[168:171], a[244:247], v[60:63], v[168:171]
    v_and_b32 v223, 0xffff0000, v223
    v_fma_f32 v151, v151, v27, v111
    v_mfma_f32_16x16x32_bf16 v[172:175], a[244:247], v[92:95], v[172:175]
    v_fma_f32 v159, v159, v27, v223
    v_cvt_pk_bf16_f32 v111, v151, v159
    v_mfma_f32_16x16x32_bf16 v[176:179], a[248:251], v[60:63], v[176:179]
    s_add_u32 s20, s20, 1
    v_mfma_f32_16x16x32_bf16 v[180:183], a[248:251], v[92:95], v[180:183]
    v_mfma_f32_16x16x32_bf16 v[184:187], a[252:255], v[60:63], v[184:187]
    v_mfma_f32_16x16x32_bf16 v[188:191], a[252:255], v[92:95], v[188:191]
    buffer_store_dwordx4 v[108:111], v22, s[12:15], s36 offen offset:1024 sc1
    s_nop 5
    s_add_u32 s36, s36, 4096
    s_waitcnt vmcnt(5)
    v_lshlrev_b32 v96, 16, v192
    v_and_b32 v192, 0xffff0000, v192
    v_fma_f32 v160, v160, v26, v96
    v_fma_f32 v168, v168, v26, v192
    v_cvt_pk_bf16_f32 v96, v160, v168
    v_lshlrev_b32 v97, 16, v193
    v_and_b32 v193, 0xffff0000, v193
    v_fma_f32 v176, v176, v26, v97
    v_fma_f32 v184, v184, v26, v193
    v_cvt_pk_bf16_f32 v97, v176, v184
    v_lshlrev_b32 v98, 16, v194
    v_and_b32 v194, 0xffff0000, v194
    v_fma_f32 v161, v161, v26, v98
    v_fma_f32 v169, v169, v26, v194
    v_cvt_pk_bf16_f32 v98, v161, v169
    v_lshlrev_b32 v99, 16, v195
    v_and_b32 v195, 0xffff0000, v195
    v_fma_f32 v177, v177, v26, v99
    v_fma_f32 v185, v185, v26, v195
    v_cvt_pk_bf16_f32 v99, v177, v185
    buffer_store_dwordx4 v[96:99], v1, s[12:15], s36 offen offset:0 sc1
    v_lshlrev_b32 v100, 16, v196
    v_and_b32 v196, 0xffff0000, v196
    v_fma_f32 v162, v162, v26, v100
    v_fma_f32 v170, v170, v26, v196
    v_cvt_pk_bf16_f32 v100, v162, v170
    v_lshlrev_b32 v101, 16, v197
    v_and_b32 v197, 0xffff0000, v197
    v_fma_f32 v178, v178, v26, v101
    v_fma_f32 v186, v186, v26, v197
    v_cvt_pk_bf16_f32 v101, v178, v186
    v_lshlrev_b32 v102, 16, v198
    v_and_b32 v198, 0xffff0000, v198
    v_fma_f32 v163, v163, v26, v102
    v_fma_f32 v171, v171, v26, v198
    v_cvt_pk_bf16_f32 v102, v163, v171
    v_lshlrev_b32 v103, 16, v199
    v_and_b32 v199, 0xffff0000, v199
    v_fma_f32 v179, v179, v26, v103
    v_fma_f32 v187, v187, v26, v199
    v_cvt_pk_bf16_f32 v103, v179, v187
    buffer_store_dwordx4 v[100:103], v1, s[12:15], s36 offen offset:1024 sc1
    v_lshlrev_b32 v104, 16, v200
    v_and_b32 v200, 0xffff0000, v200
    v_fma_f32 v164, v164, v27, v104
    v_fma_f32 v172, v172, v27, v200
    v_cvt_pk_bf16_f32 v104, v164, v172
    v_lshlrev_b32 v105, 16, v201
    v_and_b32 v201, 0xffff0000, v201
    v_fma_f32 v180, v180, v27, v105
    v_fma_f32 v188, v188, v27, v201
    v_cvt_pk_bf16_f32 v105, v180, v188
    v_lshlrev_b32 v106, 16, v202
    v_and_b32 v202, 0xffff0000, v202
    v_fma_f32 v165, v165, v27, v106
    v_fma_f32 v173, v173, v27, v202
    v_cvt_pk_bf16_f32 v106, v165, v173
    v_lshlrev_b32 v107, 16, v203
    v_and_b32 v203, 0xffff0000, v203
    v_fma_f32 v181, v181, v27, v107
    v_fma_f32 v189, v189, v27, v203
    v_cvt_pk_bf16_f32 v107, v181, v189
    buffer_store_dwordx4 v[104:107], v22, s[12:15], s36 offen offset:0 sc1
    v_lshlrev_b32 v108, 16, v204
    v_and_b32 v204, 0xffff0000, v204
    v_fma_f32 v166, v166, v27, v108
    v_fma_f32 v174, v174, v27, v204
    v_cvt_pk_bf16_f32 v108, v166, v174
    v_lshlrev_b32 v109, 16, v205
    v_and_b32 v205, 0xffff0000, v205
    v_fma_f32 v182, v182, v27, v109
    v_fma_f32 v190, v190, v27, v205
    v_cvt_pk_bf16_f32 v109, v182, v190
    v_lshlrev_b32 v110, 16, v206
    v_and_b32 v206, 0xffff0000, v206
    v_fma_f32 v167, v167, v27, v110
    v_fma_f32 v175, v175, v27, v206
    v_cvt_pk_bf16_f32 v110, v167, v175
    v_lshlrev_b32 v111, 16, v207
    v_and_b32 v207, 0xffff0000, v207
    v_fma_f32 v183, v183, v27, v111
    v_fma_f32 v191, v191, v27, v207
    v_cvt_pk_bf16_f32 v111, v183, v191
    buffer_store_dwordx4 v[108:111], v22, s[12:15], s36 offen offset:1024 sc1
    v_and_b32 v10, 60, v2
    v_and_b32 v11, 1, v2
    v_lshl_add_u32 v10, v11, 1, v10
    v_bfe_u32 v11, v2, 1, 1
    v_mul_u32_u24 v10, 144, v10
    v_lshl_add_u32 v10, v11, 3, v10
    s_lshl_b32 s3, s66, 5
    s_add_u32 s3, s3, 132096
    v_add_u32 v10, s3, v10
    s_waitcnt vmcnt(63)
    ds_write_b64 v10, v[112:113] offset:0
    ds_write_b64 v10, v[114:115] offset:144
    ds_write_b64 v10, v[116:117] offset:16
    ds_write_b64 v10, v[118:119] offset:160
    v_lshrrev_b32 v9, 3, v0
    v_lshlrev_b32 v9, 8, v9
    v_and_b32 v11, 7, v0
    v_lshl_add_u32 v9, v11, 4, v9
    s_lshr_b32 s38, s25, 1
    s_mul_i32 s38, s38, 16640
    s_and_b32 s3, s25, 1
    s_lshl_b32 s3, s3, 7
    s_add_u32 s38, s38, s3
    s_add_u32 s39, s38, 6144
    s_cmp_eq_u32 s66, 3
    s_cselect_b32 s38, s39, s38
    s_cselect_b32 s3, 2048, 0
    s_add_u32 s39, s39, s3
    s_mov_b32 s95, 88080384
    s_cmp_eq_u32 s92, 1
    s_cselect_b32 s95, 73468416, s95
    s_sub_u32 s3, 23, s78
    s_cmp_ge_u32 s78, 8
    s_cselect_b32 s28, s3, s78
    s_mul_i32 s28, s28, 6144
    s_add_u32 s28, s28, 111149056
    v_min_u32 v12, 15, v2
    v_mul_u32_u24 v12, 384, v12
    s_sub_u32 s3, s20, 1
    v_readlane_b32 s23, v7, s3
    v_readlane_b32 s27, v8, s3
    s_add_u32 m0, s24, 0
    s_nop 3
    buffer_load_dwordx4 v4, s[12:15], s23 offen offset:0 lds
    buffer_load_dwordx4 v4, s[12:15], s23 offen offset:1024 lds
    buffer_load_dwordx4 v4, s[12:15], s23 offen offset:2048 lds
    buffer_load_dwordx4 v4, s[12:15], s23 offen offset:3072 lds
    s_add_u32 m0, s24, 65536
    s_nop 0
    buffer_load_dwordx4 v4, s[12:15], s27 offen offset:0 lds
    buffer_load_dwordx4 v4, s[12:15], s27 offen offset:1024 lds
    buffer_load_dwordx4 v4, s[12:15], s27 offen offset:2048 lds
    buffer_load_dwordx4 v4, s[12:15], s27 offen offset:3072 lds
    s_waitcnt vmcnt(8) lgkmcnt(0)
    s_barrier
    buffer_store_dword v14, v31, s[12:15], s93 offen offset:128 sc1
    v_lshrrev_b32 v10, 3, v0
    v_add_lshl_u32 v10, v10, v0, 4
    s_cmp_eq_u32 s66, 3
    s_cselect_b32 s3, 3456, 0
    s_cselect_b32 s87, 1152, 0
    v_add_u32 v10, 132096, v10
    v_add_u32 v11, s87, v10
    v_add_u32 v10, s3, v10
    ds_read_b128 v[112:115], v10
    ds_read_b128 v[116:119], v11 offset:3456
    s_waitcnt lgkmcnt(0)
    v_lshlrev_b32 v32, 16, v112
    v_and_b32 v33, 0xffff0000, v112
    v_lshlrev_b32 v34, 16, v113
    v_and_b32 v35, 0xffff0000, v113
    v_lshlrev_b32 v36, 16, v114
    v_and_b32 v37, 0xffff0000, v114
    v_lshlrev_b32 v38, 16, v115
    v_and_b32 v39, 0xffff0000, v115
    v_lshlrev_b32 v40, 16, v116
    v_and_b32 v41, 0xffff0000, v116
    v_lshlrev_b32 v42, 16, v117
    v_and_b32 v43, 0xffff0000, v117
    v_lshlrev_b32 v44, 16, v118
    v_and_b32 v45, 0xffff0000, v118
    v_lshlrev_b32 v46, 16, v119
    v_and_b32 v47, 0xffff0000, v119
    s_cmp_eq_u32 s66, 3
    s_cselect_b32 s3, 4, 0
    s_add_u32 s28, s28, s3
    s_mov_b32 s3, 0x20000
fpo_poll_10:
    buffer_load_dword v13, v12, s[12:15], s28 offen offset:128 sc1
    s_waitcnt vmcnt(0)
    v_cmp_ne_u32 vcc, 1, v13
    s_sub_u32 s3, s3, 1
    s_cbranch_scc1 fpo_pdone_11
    s_nop 1
    s_cbranch_vccnz fpo_poll_10
fpo_pdone_11:
    s_add_u32 s34, s38, 69206016
    s_add_u32 s35, s39, 69206016
    buffer_load_dwordx4 v[128:131], v9, s[12:15], s34 offen sc1
    s_add_u32 s34, s34, 2131200
    buffer_load_dwordx4 v[132:135], v9, s[12:15], s35 offen sc1
    s_add_u32 s35, s35, 2131200
    buffer_load_dwordx4 v[136:139], v9, s[12:15], s34 offen sc1
    s_add_u32 s34, s34, 2131200
    buffer_load_dwordx4 v[140:143], v9, s[12:15], s35 offen sc1
    s_add_u32 s35, s35, 2131200
    buffer_load_dwordx4 v[144:147], v9, s[12:15], s34 offen sc1
    s_add_u32 s34, s34, 2131200
    buffer_load_dwordx4 v[148:151], v9, s[12:15], s35 offen sc1
    s_add_u32 s35, s35, 2131200
    buffer_load_dwordx4 v[152:155], v9, s[12:15], s34 offen sc1
    s_add_u32 s34, s34, 2131200
    buffer_load_dwordx4 v[156:159], v9, s[12:15], s35 offen sc1
    s_add_u32 s35, s35, 2131200
    buffer_load_dwordx4 v[160:163], v9, s[12:15], s34 offen sc1
    s_add_u32 s34, s34, 2131200
    buffer_load_dwordx4 v[164:167], v9, s[12:15], s35 offen sc1
    s_add_u32 s35, s35, 2131200
    buffer_load_dwordx4 v[168:171], v9, s[12:15], s34 offen sc1
    s_add_u32 s34, s34, 2131200
    buffer_load_dwordx4 v[172:175], v9, s[12:15], s35 offen sc1
    s_add_u32 s35, s35, 2131200
    buffer_load_dwordx4 v[176:179], v9, s[12:15], s34 offen sc1
    s_add_u32 s34, s34, 2131200
    buffer_load_dwordx4 v[180:183], v9, s[12:15], s35 offen sc1
    s_add_u32 s35, s35, 2131200
    buffer_load_dwordx4 v[184:187], v9, s[12:15], s34 offen sc1
    buffer_load_dwordx4 v[188:191], v9, s[12:15], s35 offen sc1
    s_add_u32 s38, s38, s95
    s_add_u32 s39, s39, s95
    s_add_u32 s38, s38, 8524800
    s_add_u32 s39, s39, 8524800
    s_cmp_eq_u32 s66, 3
    s_cselect_b32 s39, 268435456, s39
    s_waitcnt vmcnt(15)
    v_lshlrev_b32 v48, 16, v128
    v_and_b32 v49, 0xffff0000, v128
    v_lshlrev_b32 v50, 16, v129
    v_and_b32 v51, 0xffff0000, v129
    v_lshlrev_b32 v52, 16, v130
    v_and_b32 v53, 0xffff0000, v130
    v_lshlrev_b32 v54, 16, v131
    v_and_b32 v55, 0xffff0000, v131
    v_pk_add_f32 v[32:33], v[32:33], v[48:49]
    v_pk_add_f32 v[34:35], v[34:35], v[50:51]
    v_pk_add_f32 v[36:37], v[36:37], v[52:53]
    v_pk_add_f32 v[38:39], v[38:39], v[54:55]
    s_waitcnt vmcnt(14)
    v_lshlrev_b32 v48, 16, v132
    v_and_b32 v49, 0xffff0000, v132
    v_lshlrev_b32 v50, 16, v133
    v_and_b32 v51, 0xffff0000, v133
    v_lshlrev_b32 v52, 16, v134
    v_and_b32 v53, 0xffff0000, v134
    v_lshlrev_b32 v54, 16, v135
    v_and_b32 v55, 0xffff0000, v135
    v_pk_add_f32 v[40:41], v[40:41], v[48:49]
    v_pk_add_f32 v[42:43], v[42:43], v[50:51]
    v_pk_add_f32 v[44:45], v[44:45], v[52:53]
    v_pk_add_f32 v[46:47], v[46:47], v[54:55]
    s_waitcnt vmcnt(13)
    v_lshlrev_b32 v48, 16, v136
    v_and_b32 v49, 0xffff0000, v136
    v_lshlrev_b32 v50, 16, v137
    v_and_b32 v51, 0xffff0000, v137
    v_lshlrev_b32 v52, 16, v138
    v_and_b32 v53, 0xffff0000, v138
    v_lshlrev_b32 v54, 16, v139
    v_and_b32 v55, 0xffff0000, v139
    v_pk_add_f32 v[32:33], v[32:33], v[48:49]
    v_pk_add_f32 v[34:35], v[34:35], v[50:51]
    v_pk_add_f32 v[36:37], v[36:37], v[52:53]
    v_pk_add_f32 v[38:39], v[38:39], v[54:55]
    s_waitcnt vmcnt(12)
    v_lshlrev_b32 v48, 16, v140
    v_and_b32 v49, 0xffff0000, v140
    v_lshlrev_b32 v50, 16, v141
    v_and_b32 v51, 0xffff0000, v141
    v_lshlrev_b32 v52, 16, v142
    v_and_b32 v53, 0xffff0000, v142
    v_lshlrev_b32 v54, 16, v143
    v_and_b32 v55, 0xffff0000, v143
    v_pk_add_f32 v[40:41], v[40:41], v[48:49]
    v_pk_add_f32 v[42:43], v[42:43], v[50:51]
    v_pk_add_f32 v[44:45], v[44:45], v[52:53]
    v_pk_add_f32 v[46:47], v[46:47], v[54:55]
    s_waitcnt vmcnt(11)
    v_lshlrev_b32 v48, 16, v144
    v_and_b32 v49, 0xffff0000, v144
    v_lshlrev_b32 v50, 16, v145
    v_and_b32 v51, 0xffff0000, v145
    v_lshlrev_b32 v52, 16, v146
    v_and_b32 v53, 0xffff0000, v146
    v_lshlrev_b32 v54, 16, v147
    v_and_b32 v55, 0xffff0000, v147
    v_pk_add_f32 v[32:33], v[32:33], v[48:49]
    v_pk_add_f32 v[34:35], v[34:35], v[50:51]
    v_pk_add_f32 v[36:37], v[36:37], v[52:53]
    v_pk_add_f32 v[38:39], v[38:39], v[54:55]
    s_waitcnt vmcnt(10)
    v_lshlrev_b32 v48, 16, v148
    v_and_b32 v49, 0xffff0000, v148
    v_lshlrev_b32 v50, 16, v149
    v_and_b32 v51, 0xffff0000, v149
    v_lshlrev_b32 v52, 16, v150
    v_and_b32 v53, 0xffff0000, v150
    v_lshlrev_b32 v54, 16, v151
    v_and_b32 v55, 0xffff0000, v151
    v_pk_add_f32 v[40:41], v[40:41], v[48:49]
    v_pk_add_f32 v[42:43], v[42:43], v[50:51]
    v_pk_add_f32 v[44:45], v[44:45], v[52:53]
    v_pk_add_f32 v[46:47], v[46:47], v[54:55]
    s_waitcnt vmcnt(9)
    v_lshlrev_b32 v48, 16, v152
    v_and_b32 v49, 0xffff0000, v152
    v_lshlrev_b32 v50, 16, v153
    v_and_b32 v51, 0xffff0000, v153
    v_lshlrev_b32 v52, 16, v154
    v_and_b32 v53, 0xffff0000, v154
    v_lshlrev_b32 v54, 16, v155
    v_and_b32 v55, 0xffff0000, v155
    v_pk_add_f32 v[32:33], v[32:33], v[48:49]
    v_pk_add_f32 v[34:35], v[34:35], v[50:51]
    v_pk_add_f32 v[36:37], v[36:37], v[52:53]
    v_pk_add_f32 v[38:39], v[38:39], v[54:55]
    s_waitcnt vmcnt(8)
    v_lshlrev_b32 v48, 16, v156
    v_and_b32 v49, 0xffff0000, v156
    v_lshlrev_b32 v50, 16, v157
    v_and_b32 v51, 0xffff0000, v157
    v_lshlrev_b32 v52, 16, v158
    v_and_b32 v53, 0xffff0000, v158
    v_lshlrev_b32 v54, 16, v159
    v_and_b32 v55, 0xffff0000, v159
    v_pk_add_f32 v[40:41], v[40:41], v[48:49]
    v_pk_add_f32 v[42:43], v[42:43], v[50:51]
    v_pk_add_f32 v[44:45], v[44:45], v[52:53]
    v_pk_add_f32 v[46:47], v[46:47], v[54:55]
    s_waitcnt vmcnt(7)
    v_lshlrev_b32 v48, 16, v160
    v_and_b32 v49, 0xffff0000, v160
    v_lshlrev_b32 v50, 16, v161
    v_and_b32 v51, 0xffff0000, v161
    v_lshlrev_b32 v52, 16, v162
    v_and_b32 v53, 0xffff0000, v162
    v_lshlrev_b32 v54, 16, v163
    v_and_b32 v55, 0xffff0000, v163
    v_pk_add_f32 v[32:33], v[32:33], v[48:49]
    v_pk_add_f32 v[34:35], v[34:35], v[50:51]
    v_pk_add_f32 v[36:37], v[36:37], v[52:53]
    v_pk_add_f32 v[38:39], v[38:39], v[54:55]
    s_waitcnt vmcnt(6)
    v_lshlrev_b32 v48, 16, v164
    v_and_b32 v49, 0xffff0000, v164
    v_lshlrev_b32 v50, 16, v165
    v_and_b32 v51, 0xffff0000, v165
    v_lshlrev_b32 v52, 16, v166
    v_and_b32 v53, 0xffff0000, v166
    v_lshlrev_b32 v54, 16, v167
    v_and_b32 v55, 0xffff0000, v167
    v_pk_add_f32 v[40:41], v[40:41], v[48:49]
    v_pk_add_f32 v[42:43], v[42:43], v[50:51]
    v_pk_add_f32 v[44:45], v[44:45], v[52:53]
    v_pk_add_f32 v[46:47], v[46:47], v[54:55]
    s_waitcnt vmcnt(5)
    v_lshlrev_b32 v48, 16, v168
    v_and_b32 v49, 0xffff0000, v168
    v_lshlrev_b32 v50, 16, v169
    v_and_b32 v51, 0xffff0000, v169
    v_lshlrev_b32 v52, 16, v170
    v_and_b32 v53, 0xffff0000, v170
    v_lshlrev_b32 v54, 16, v171
    v_and_b32 v55, 0xffff0000, v171
    v_pk_add_f32 v[32:33], v[32:33], v[48:49]
    v_pk_add_f32 v[34:35], v[34:35], v[50:51]
    v_pk_add_f32 v[36:37], v[36:37], v[52:53]
    v_pk_add_f32 v[38:39], v[38:39], v[54:55]
    s_waitcnt vmcnt(4)
    v_lshlrev_b32 v48, 16, v172
    v_and_b32 v49, 0xffff0000, v172
    v_lshlrev_b32 v50, 16, v173
    v_and_b32 v51, 0xffff0000, v173
    v_lshlrev_b32 v52, 16, v174
    v_and_b32 v53, 0xffff0000, v174
    v_lshlrev_b32 v54, 16, v175
    v_and_b32 v55, 0xffff0000, v175
    v_pk_add_f32 v[40:41], v[40:41], v[48:49]
    v_pk_add_f32 v[42:43], v[42:43], v[50:51]
    v_pk_add_f32 v[44:45], v[44:45], v[52:53]
    v_pk_add_f32 v[46:47], v[46:47], v[54:55]
    s_waitcnt vmcnt(3)
    v_lshlrev_b32 v48, 16, v176
    v_and_b32 v49, 0xffff0000, v176
    v_lshlrev_b32 v50, 16, v177
    v_and_b32 v51, 0xffff0000, v177
    v_lshlrev_b32 v52, 16, v178
    v_and_b32 v53, 0xffff0000, v178
    v_lshlrev_b32 v54, 16, v179
    v_and_b32 v55, 0xffff0000, v179
    v_pk_add_f32 v[32:33], v[32:33], v[48:49]
    v_pk_add_f32 v[34:35], v[34:35], v[50:51]
    v_pk_add_f32 v[36:37], v[36:37], v[52:53]
    v_pk_add_f32 v[38:39], v[38:39], v[54:55]
    s_waitcnt vmcnt(2)
    v_lshlrev_b32 v48, 16, v180
    v_and_b32 v49, 0xffff0000, v180
    v_lshlrev_b32 v50, 16, v181
    v_and_b32 v51, 0xffff0000, v181
    v_lshlrev_b32 v52, 16, v182
    v_and_b32 v53, 0xffff0000, v182
    v_lshlrev_b32 v54, 16, v183
    v_and_b32 v55, 0xffff0000, v183
    v_pk_add_f32 v[40:41], v[40:41], v[48:49]
    v_pk_add_f32 v[42:43], v[42:43], v[50:51]
    v_pk_add_f32 v[44:45], v[44:45], v[52:53]
    v_pk_add_f32 v[46:47], v[46:47], v[54:55]
    s_waitcnt vmcnt(1)
    v_lshlrev_b32 v48, 16, v184
    v_and_b32 v49, 0xffff0000, v184
    v_lshlrev_b32 v50, 16, v185
    v_and_b32 v51, 0xffff0000, v185
    v_lshlrev_b32 v52, 16, v186
    v_and_b32 v53, 0xffff0000, v186
    v_lshlrev_b32 v54, 16, v187
    v_and_b32 v55, 0xffff0000, v187
    v_pk_add_f32 v[32:33], v[32:33], v[48:49]
    v_pk_add_f32 v[34:35], v[34:35], v[50:51]
    v_pk_add_f32 v[36:37], v[36:37], v[52:53]
    v_pk_add_f32 v[38:39], v[38:39], v[54:55]
    s_waitcnt vmcnt(0)
    v_lshlrev_b32 v48, 16, v188
    v_and_b32 v49, 0xffff0000, v188
    v_lshlrev_b32 v50, 16, v189
    v_and_b32 v51, 0xffff0000, v189
    v_lshlrev_b32 v52, 16, v190
    v_and_b32 v53, 0xffff0000, v190
    v_lshlrev_b32 v54, 16, v191
    v_and_b32 v55, 0xffff0000, v191
    v_pk_add_f32 v[40:41], v[40:41], v[48:49]
    v_pk_add_f32 v[42:43], v[42:43], v[50:51]
    v_pk_add_f32 v[44:45], v[44:45], v[52:53]
    v_pk_add_f32 v[46:47], v[46:47], v[54:55]
    s_cbranch_scc0 R1_nomerge
    v_pk_add_f32 v[32:33], v[32:33], v[40:41]
    v_mov_b64 v[40:41], 0
    v_pk_add_f32 v[34:35], v[34:35], v[42:43]
    v_mov_b64 v[42:43], 0
    v_pk_add_f32 v[36:37], v[36:37], v[44:45]
    v_mov_b64 v[44:45], 0
    v_pk_add_f32 v[38:39], v[38:39], v[46:47]
    v_mov_b64 v[46:47], 0
R1_nomerge:
    s_sub_u32 s3, s20, 0
    v_readlane_b32 s23, v7, s3
    v_readlane_b32 s27, v8, s3
    s_add_u32 m0, s24, 16384
    s_nop 3
    buffer_load_dwordx4 v4, s[12:15], s23 offen offset:0 lds
    buffer_load_dwordx4 v4, s[12:15], s23 offen offset:1024 lds
    buffer_load_dwordx4 v4, s[12:15], s23 offen offset:2048 lds
    buffer_load_dwordx4 v4, s[12:15], s23 offen offset:3072 lds
    s_add_u32 m0, s24, 81920
    s_nop 0
    buffer_load_dwordx4 v4, s[12:15], s27 offen offset:0 lds
    buffer_load_dwordx4 v4, s[12:15], s27 offen offset:1024 lds
    buffer_load_dwordx4 v4, s[12:15], s27 offen offset:2048 lds
    buffer_load_dwordx4 v4, s[12:15], s27 offen offset:3072 lds
    v_cvt_pk_bf16_f32 v16, v32, v33
    v_cvt_pk_bf16_f32 v17, v34, v35
    v_cvt_pk_bf16_f32 v18, v36, v37
    v_cvt_pk_bf16_f32 v19, v38, v39
    v_cvt_pk_bf16_f32 v20, v40, v41
    v_cvt_pk_bf16_f32 v21, v42, v43
    v_cvt_pk_bf16_f32 v22, v44, v45
    v_cvt_pk_bf16_f32 v23, v46, v47
    buffer_store_dwordx4 v[16:19], v9, s[12:15], s38 offen
    buffer_store_dwordx4 v[20:23], v9, s[12:15], s39 offen
    v_mov_b32 v58, 0x3f803f80
    v_mov_b32 v56, 0
    v_mov_b32 v57, 0
    v_dot2_f32_bf16 v56, v16, v58, v56
    v_dot2_f32_bf16 v57, v16, v16, v57
    v_dot2_f32_bf16 v56, v17, v58, v56
    v_dot2_f32_bf16 v57, v17, v17, v57
    v_dot2_f32_bf16 v56, v18, v58, v56
    v_dot2_f32_bf16 v57, v18, v18, v57
    v_dot2_f32_bf16 v56, v19, v58, v56
    v_dot2_f32_bf16 v57, v19, v19, v57
    v_dot2_f32_bf16 v56, v20, v58, v56
    v_dot2_f32_bf16 v57, v20, v20, v57
    v_dot2_f32_bf16 v56, v21, v58, v56
    v_dot2_f32_bf16 v57, v21, v21, v57
    v_dot2_f32_bf16 v56, v22, v58, v56
    v_dot2_f32_bf16 v57, v22, v22, v57
    v_dot2_f32_bf16 v56, v23, v58, v56
    v_dot2_f32_bf16 v57, v23, v23, v57
    v_and_b32 v10, 7, v2
    v_lshlrev_b32 v10, 3, v10
    s_lshl_b32 s3, s66, 6
    v_add_u32 v10, 131072, v10
    v_add_u32 v11, s3, v10
    v_add_f32_dpp v56, v56, v56 row_ror:8 row_mask:0xf bank_mask:0xf
    v_add_f32_dpp v57, v57, v57 row_ror:8 row_mask:0xf bank_mask:0xf
    v_mov_b32 v58, v56
    v_mov_b32 v59, v57
    s_nop 0
    v_permlane16_swap_b32 v56, v58
    v_permlane16_swap_b32 v57, v59
    s_nop 0
    v_add_f32 v56, v56, v58
    v_add_f32 v57, v57, v59
    v_mov_b32 v58, v56
    v_mov_b32 v59, v57
    s_nop 0
    v_permlane32_swap_b32 v56, v58
    v_permlane32_swap_b32 v57, v59
    s_nop 0
    v_add_f32 v56, v56, v58
    v_add_f32 v57, v57, v59
    ds_write_b64 v11, v[56:57]
    s_waitcnt lgkmcnt(0)
    s_barrier
    ds_read_b64 v[60:61], v10 offset:0
    ds_read_b64 v[62:63], v10 offset:64
    ds_read_b64 v[64:65], v10 offset:128
    ds_read_b64 v[66:67], v10 offset:192
    v_lshlrev_b32 v32, 16, v16
    v_and_b32 v33, 0xffff0000, v16
    v_lshlrev_b32 v34, 16, v17
    v_and_b32 v35, 0xffff0000, v17
    v_lshlrev_b32 v36, 16, v18
    v_and_b32 v37, 0xffff0000, v18
    v_lshlrev_b32 v38, 16, v19
    v_and_b32 v39, 0xffff0000, v19
    v_lshlrev_b32 v40, 16, v20
    v_and_b32 v41, 0xffff0000, v20
    v_lshlrev_b32 v42, 16, v21
    v_and_b32 v43, 0xffff0000, v21
    v_lshlrev_b32 v44, 16, v22
    v_and_b32 v45, 0xffff0000, v22
    v_lshlrev_b32 v46, 16, v23
    v_and_b32 v47, 0xffff0000, v23
    s_add_u32 s38, s38, 2131200
    s_cmp_eq_u32 s66, 3
    s_cselect_b32 s36, 0, 2131200
    s_add_u32 s39, s39, s36
    s_waitcnt lgkmcnt(0)
    v_add_f32 v56, v60, v62
    v_add_f32 v64, v64, v66
    v_add_f32 v56, v56, v64
    v_add_f32 v57, v61, v63
    v_add_f32 v65, v65, v67
    v_add_f32 v57, v57, v65
    v_mul_f32 v56, 0x3b124925, v56
    v_mul_f32 v57, 0x3b124925, v57
    v_fma_f32 v57, -v56, v56, v57
    v_max_f32 v57, 0, v57
    v_add_f32 v57, 0x3727c5ac, v57
    v_rsq_f32 v57, v57
    s_nop 0
    v_mul_f32 v56, v56, v57
    v_fma_f32 v32, v32, v57, -v56
    v_fma_f32 v33, v33, v57, -v56
    v_cvt_pk_bf16_f32 v72, v32, v33
    v_fma_f32 v34, v34, v57, -v56
    v_fma_f32 v35, v35, v57, -v56
    v_cvt_pk_bf16_f32 v73, v34, v35
    v_fma_f32 v36, v36, v57, -v56
    v_fma_f32 v37, v37, v57, -v56
    v_cvt_pk_bf16_f32 v74, v36, v37
    v_fma_f32 v38, v38, v57, -v56
    v_fma_f32 v39, v39, v57, -v56
    v_cvt_pk_bf16_f32 v75, v38, v39
    buffer_store_dwordx4 v[72:75], v9, s[12:15], s38 offen
    v_fma_f32 v40, v40, v57, -v56
    v_fma_f32 v41, v41, v57, -v56
    v_cvt_pk_bf16_f32 v76, v40, v41
    v_fma_f32 v42, v42, v57, -v56
    v_fma_f32 v43, v43, v57, -v56
    v_cvt_pk_bf16_f32 v77, v42, v43
    v_fma_f32 v44, v44, v57, -v56
    v_fma_f32 v45, v45, v57, -v56
    v_cvt_pk_bf16_f32 v78, v44, v45
    v_fma_f32 v46, v46, v57, -v56
    v_fma_f32 v47, v47, v57, -v56
    v_cvt_pk_bf16_f32 v79, v46, v47
    buffer_store_dwordx4 v[76:79], v9, s[12:15], s39 offen
    s_cmp_eq_u32 s92, 1
    s_waitcnt vmcnt(0)
    s_barrier
    s_cbranch_scc1 pub_12
    buffer_wbl2 sc1
    s_waitcnt vmcnt(0)
pub_12:
    buffer_store_dword v14, v30, s[12:15], s93 offen offset:20
    buffer_store_dword v14, v29, s[12:15], s93 offen offset:20 sc1
    s_cmp_ge_u32 s79, 14
    s_cbranch_scc1 M_fin
    ds_read_b128 a[192:195], v5 offset:0
    ds_read_b128 a[196:199], v5 offset:1024
    ds_read_b128 a[200:203], v5 offset:2048
    ds_read_b128 a[204:207], v5 offset:3072
    ds_read_b128 a[208:211], v5 offset:4096
    ds_read_b128 a[212:215], v5 offset:5120
    ds_read_b128 a[216:219], v5 offset:6144
    ds_read_b128 a[220:223], v5 offset:7168
    s_lshl_b32 s25, s78, 2
    s_add_u32 s25, s25, s66
    s_mul_i32 s25, s25, 33280
    s_add_u32 s25, s25, s95
    s_cmp_ge_u32 s79, 7
    s_cselect_b32 s3, 2116864, 0
    s_add_u32 s96, s25, s3
    s_lshl_b32 s3, s79, 11
    s_add_u32 s96, s96, s3
    s_add_u32 s97, s96, 4262400
    s_add_u32 s25, s25, 10656000
    s_add_u32 s35, s25, 4096
    s_add_u32 s36, s25, 8192
    s_add_u32 s37, s25, 12288
    v_add_u32 v11, 16640, v1
    s_mov_b32 s98, 0xbfb8aa3b
    s_and_b32 s3, s79, 1
    s_lshl_b32 s3, s3, 2
    s_lshl_b32 s87, s78, 3
    s_add_u32 s87, s87, s3
    s_add_u32 s88, s87, s66
    s_mul_i32 s39, s88, 16640
    s_lshr_b32 s3, s79, 1
    s_lshl_b32 s3, s3, 11
    s_add_u32 s39, s39, s3
    s_add_u32 s39, s39, s95
    s_add_u32 s39, s39, 8524800
    v_lshrrev_b32 v9, 5, v2
    v_lshlrev_b32 v9, 10, v9
    v_bfe_u32 v10, v2, 4, 1
    v_lshl_add_u32 v9, v10, 3, v9
    v_and_b32 v10, 15, v2
    v_lshl_add_u32 v9, v10, 4, v9
    s_mul_i32 s90, s87, 16640
    s_lshr_b32 s3, s66, 1
    s_mul_i32 s3, s3, 2131200
    s_add_u32 s90, s90, s3
    s_and_b32 s3, s66, 1
    s_mul_i32 s3, s3, 7168
    s_add_u32 s90, s90, s3
    s_add_u32 s90, s90, s95
    s_add_u32 s3, s66, 0
    s_and_b32 s3, s3, 3
    s_mul_i32 s3, s3, 16640
    v_add_u32 v24, s3, v1
    s_add_u32 s3, s66, 1
    s_and_b32 s3, s3, 3
    s_mul_i32 s70, s3, 12288
    s_mul_i32 s3, s3, 16640
    v_add_u32 v25, s3, v1
    s_add_u32 s3, s66, 2
    s_and_b32 s3, s3, 3
    s_mul_i32 s71, s3, 12288
    s_mul_i32 s3, s3, 16640
    v_add_u32 v26, s3, v1
    s_add_u32 s3, s66, 3
    s_and_b32 s3, s3, 3
    s_mul_i32 s72, s3, 12288
    s_mul_i32 s3, s3, 16640
    v_add_u32 v27, s3, v1
    s_mov_b32 s8, s64
    s_mov_b32 s9, s65
    s_mov_b32 s10, 1835008
    s_mov_b32 s11, 0x00020000
    s_mul_i32 s38, s88, 14336
    s_lshr_b32 s3, s79, 1
    s_lshl_b32 s3, s3, 7
    s_add_u32 s38, s38, s3
    v_and_b32 v10, 15, v2
    v_mul_u32_u24 v10, 896, v10
    v_lshrrev_b32 v15, 4, v2
    v_lshl_add_u32 v10, v15, 5, v10
    s_mul_i32 s3, s66, 12288
    v_add_u32 v15, s3, v1
    v_min_u32 v12, 15, v2
    v_mul_u32_u24 v12, 6144, v12
    s_mov_b32 s3, 0x20000
fh_poll_14:
    buffer_load_dword v13, v12, s[12:15], s94 offen offset:20 sc1
    s_waitcnt vmcnt(0)
    v_cmp_ne_u32 vcc, 1, v13
    s_sub_u32 s3, s3, 1
    s_cbranch_scc1 fh_pdone_15
    s_nop 1
    s_cbranch_vccnz fh_poll_14
fh_pdone_15:
    s_cmp_eq_u32 s92, 1
    s_cbranch_scc1 acq_13
    buffer_inv sc1
    s_waitcnt vmcnt(0)
acq_13:
    buffer_load_dwordx4 a[0:3], v1, s[12:15], s25 offen offset:0 sc1
    buffer_load_dwordx4 a[4:7], v11, s[12:15], s25 offen offset:0 sc1
    buffer_load_dwordx4 a[8:11], v1, s[12:15], s25 offen offset:1024 sc1
    buffer_load_dwordx4 a[12:15], v11, s[12:15], s25 offen offset:1024 sc1
    buffer_load_dwordx4 a[16:19], v1, s[12:15], s25 offen offset:2048 sc1
    buffer_load_dwordx4 a[20:23], v11, s[12:15], s25 offen offset:2048 sc1
    buffer_load_dwordx4 a[24:27], v1, s[12:15], s25 offen offset:3072 sc1
    buffer_load_dwordx4 a[28:31], v11, s[12:15], s25 offen offset:3072 sc1
    buffer_load_dwordx4 a[32:35], v1, s[12:15], s35 offen offset:0 sc1
    buffer_load_dwordx4 a[36:39], v11, s[12:15], s35 offen offset:0 sc1
    s_waitcnt lgkmcnt(4)
    s_waitcnt vmcnt(8)
    v_mfma_f32_16x16x32_bf16 v[128:131], a[192:195], a[0:3], 0
    ds_read_b128 a[224:227], v5 offset:8192
    v_mfma_f32_16x16x32_bf16 v[132:135], a[192:195], a[4:7], 0
    buffer_load_dwordx4 a[40:43], v1, s[12:15], s35 offen offset:1024 sc1
    v_mfma_f32_16x16x32_bf16 v[136:139], a[196:199], a[0:3], 0
    ds_read_b128 a[228:231], v5 offset:9216
    v_mfma_f32_16x16x32_bf16 v[140:143], a[196:199], a[4:7], 0
    v_mfma_f32_16x16x32_bf16 v[144:147], a[200:203], a[0:3], 0
    ds_read_b128 a[232:235], v5 offset:10240
    v_mfma_f32_16x16x32_bf16 v[148:151], a[200:203], a[4:7], 0
    buffer_load_dwordx4 a[44:47], v11, s[12:15], s35 offen offset:1024 sc1
    v_mfma_f32_16x16x32_bf16 v[152:155], a[204:207], a[0:3], 0
    ds_read_b128 a[236:239], v5 offset:11264
    v_mfma_f32_16x16x32_bf16 v[156:159], a[204:207], a[4:7], 0
    s_waitcnt lgkmcnt(4)
    v_mfma_f32_16x16x32_bf16 v[192:195], a[208:211], a[0:3], 0
    ds_read_b128 a[240:243], v5 offset:12288
    v_mfma_f32_16x16x32_bf16 v[196:199], a[208:211], a[4:7], 0
    buffer_load_dwordx4 a[48:51], v1, s[12:15], s35 offen offset:2048 sc1
    v_mfma_f32_16x16x32_bf16 v[200:203], a[212:215], a[0:3], 0
    ds_read_b128 a[244:247], v5 offset:13312
    v_mfma_f32_16x16x32_bf16 v[204:207], a[212:215], a[4:7], 0
    v_mfma_f32_16x16x32_bf16 v[208:211], a[216:219], a[0:3], 0
    ds_read_b128 a[248:251], v5 offset:14336
    v_mfma_f32_16x16x32_bf16 v[212:215], a[216:219], a[4:7], 0
    buffer_load_dwordx4 a[52:55], v11, s[12:15], s35 offen offset:2048 sc1
    v_mfma_f32_16x16x32_bf16 v[216:219], a[220:223], a[0:3], 0
    ds_read_b128 a[252:255], v5 offset:15360
    v_mfma_f32_16x16x32_bf16 v[220:223], a[220:223], a[4:7], 0
    s_waitcnt lgkmcnt(4)
    s_waitcnt vmcnt(10)
    v_mfma_f32_16x16x32_bf16 v[128:131], a[224:227], a[8:11], v[128:131]
    ds_read_b128 a[192:195], v6 offset:0
    v_mfma_f32_16x16x32_bf16 v[132:135], a[224:227], a[12:15], v[132:135]
    buffer_load_dwordx4 a[56:59], v1, s[12:15], s35 offen offset:3072 sc1
    v_mfma_f32_16x16x32_bf16 v[136:139], a[228:231], a[8:11], v[136:139]
    ds_read_b128 a[196:199], v6 offset:1024
    v_mfma_f32_16x16x32_bf16 v[140:143], a[228:231], a[12:15], v[140:143]
    v_mfma_f32_16x16x32_bf16 v[144:147], a[232:235], a[8:11], v[144:147]
    ds_read_b128 a[200:203], v6 offset:2048
    v_mfma_f32_16x16x32_bf16 v[148:151], a[232:235], a[12:15], v[148:151]
    buffer_load_dwordx4 a[60:63], v11, s[12:15], s35 offen offset:3072 sc1
    v_mfma_f32_16x16x32_bf16 v[152:155], a[236:239], a[8:11], v[152:155]
    ds_read_b128 a[204:207], v6 offset:3072
    v_mfma_f32_16x16x32_bf16 v[156:159], a[236:239], a[12:15], v[156:159]
    s_waitcnt lgkmcnt(4)
    v_mfma_f32_16x16x32_bf16 v[192:195], a[240:243], a[8:11], v[192:195]
    ds_read_b128 a[208:211], v6 offset:4096
    v_mfma_f32_16x16x32_bf16 v[196:199], a[240:243], a[12:15], v[196:199]
    buffer_load_dwordx4 a[64:67], v1, s[12:15], s36 offen offset:0 sc1
    v_mfma_f32_16x16x32_bf16 v[200:203], a[244:247], a[8:11], v[200:203]
    ds_read_b128 a[212:215], v6 offset:5120
    v_mfma_f32_16x16x32_bf16 v[204:207], a[244:247], a[12:15], v[204:207]
    v_mfma_f32_16x16x32_bf16 v[208:211], a[248:251], a[8:11], v[208:211]
    ds_read_b128 a[216:219], v6 offset:6144
    v_mfma_f32_16x16x32_bf16 v[212:215], a[248:251], a[12:15], v[212:215]
    buffer_load_dwordx4 a[68:71], v11, s[12:15], s36 offen offset:0 sc1
    v_mfma_f32_16x16x32_bf16 v[216:219], a[252:255], a[8:11], v[216:219]
    ds_read_b128 a[220:223], v6 offset:7168
    v_mfma_f32_16x16x32_bf16 v[220:223], a[252:255], a[12:15], v[220:223]
    s_waitcnt lgkmcnt(4)
    s_waitcnt vmcnt(12)
    v_mfma_f32_16x16x32_bf16 v[128:131], a[192:195], a[16:19], v[128:131]
    ds_read_b128 a[224:227], v6 offset:8192
    v_mfma_f32_16x16x32_bf16 v[132:135], a[192:195], a[20:23], v[132:135]
    buffer_load_dwordx4 a[72:75], v1, s[12:15], s36 offen offset:1024 sc1
    v_mfma_f32_16x16x32_bf16 v[136:139], a[196:199], a[16:19], v[136:139]
    ds_read_b128 a[228:231], v6 offset:9216
    v_mfma_f32_16x16x32_bf16 v[140:143], a[196:199], a[20:23], v[140:143]
    v_mfma_f32_16x16x32_bf16 v[144:147], a[200:203], a[16:19], v[144:147]
    ds_read_b128 a[232:235], v6 offset:10240
    v_mfma_f32_16x16x32_bf16 v[148:151], a[200:203], a[20:23], v[148:151]
    buffer_load_dwordx4 a[76:79], v11, s[12:15], s36 offen offset:1024 sc1
    v_mfma_f32_16x16x32_bf16 v[152:155], a[204:207], a[16:19], v[152:155]
    ds_read_b128 a[236:239], v6 offset:11264
    v_mfma_f32_16x16x32_bf16 v[156:159], a[204:207], a[20:23], v[156:159]
    s_waitcnt lgkmcnt(4)
    v_mfma_f32_16x16x32_bf16 v[192:195], a[208:211], a[16:19], v[192:195]
    ds_read_b128 a[240:243], v6 offset:12288
    v_mfma_f32_16x16x32_bf16 v[196:199], a[208:211], a[20:23], v[196:199]
    buffer_load_dwordx4 a[80:83], v1, s[12:15], s36 offen offset:2048 sc1
    v_mfma_f32_16x16x32_bf16 v[200:203], a[212:215], a[16:19], v[200:203]
    ds_read_b128 a[244:247], v6 offset:13312
    v_mfma_f32_16x16x32_bf16 v[204:207], a[212:215], a[20:23], v[204:207]
    v_mfma_f32_16x16x32_bf16 v[208:211], a[216:219], a[16:19], v[208:211]
    ds_read_b128 a[248:251], v6 offset:14336
    v_mfma_f32_16x16x32_bf16 v[212:215], a[216:219], a[20:23], v[212:215]
    buffer_load_dwordx4 a[84:87], v11, s[12:15], s36 offen offset:2048 sc1
    v_mfma_f32_16x16x32_bf16 v[216:219], a[220:223], a[16:19], v[216:219]
    ds_read_b128 a[252:255], v6 offset:15360
    v_mfma_f32_16x16x32_bf16 v[220:223], a[220:223], a[20:23], v[220:223]
    s_waitcnt lgkmcnt(4)
    s_barrier
    s_waitcnt vmcnt(14)
    v_mfma_f32_16x16x32_bf16 v[128:131], a[224:227], a[24:27], v[128:131]
    ds_read_b128 a[192:195], v5 offset:16384
    v_mfma_f32_16x16x32_bf16 v[132:135], a[224:227], a[28:31], v[132:135]
    buffer_load_dwordx4 a[88:91], v1, s[12:15], s36 offen offset:3072 sc1
    v_mfma_f32_16x16x32_bf16 v[136:139], a[228:231], a[24:27], v[136:139]
    ds_read_b128 a[196:199], v5 offset:17408
    v_mfma_f32_16x16x32_bf16 v[140:143], a[228:231], a[28:31], v[140:143]
    v_mfma_f32_16x16x32_bf16 v[144:147], a[232:235], a[24:27], v[144:147]
    ds_read_b128 a[200:203], v5 offset:18432
    v_mfma_f32_16x16x32_bf16 v[148:151], a[232:235], a[28:31], v[148:151]
    buffer_load_dwordx4 a[92:95], v11, s[12:15], s36 offen offset:3072 sc1
    v_mfma_f32_16x16x32_bf16 v[152:155], a[236:239], a[24:27], v[152:155]
    ds_read_b128 a[204:207], v5 offset:19456
    v_mfma_f32_16x16x32_bf16 v[156:159], a[236:239], a[28:31], v[156:159]
    s_waitcnt lgkmcnt(4)
    v_mfma_f32_16x16x32_bf16 v[192:195], a[240:243], a[24:27], v[192:195]
    ds_read_b128 a[208:211], v5 offset:20480
    v_mfma_f32_16x16x32_bf16 v[196:199], a[240:243], a[28:31], v[196:199]
    buffer_load_dwordx4 a[96:99], v1, s[12:15], s37 offen offset:0 sc1
    v_mfma_f32_16x16x32_bf16 v[200:203], a[244:247], a[24:27], v[200:203]
    ds_read_b128 a[212:215], v5 offset:21504
    v_mfma_f32_16x16x32_bf16 v[204:207], a[244:247], a[28:31], v[204:207]
    v_mfma_f32_16x16x32_bf16 v[208:211], a[248:251], a[24:27], v[208:211]
    ds_read_b128 a[216:219], v5 offset:22528
    s_add_u32 s20, s20, 1
    v_mfma_f32_16x16x32_bf16 v[212:215], a[248:251], a[28:31], v[212:215]
    buffer_load_dwordx4 a[100:103], v11, s[12:15], s37 offen offset:0 sc1
    v_mfma_f32_16x16x32_bf16 v[216:219], a[252:255], a[24:27], v[216:219]
    ds_read_b128 a[220:223], v5 offset:23552
    v_mfma_f32_16x16x32_bf16 v[220:223], a[252:255], a[28:31], v[220:223]
    s_waitcnt lgkmcnt(4)
    s_waitcnt vmcnt(16)
    v_mfma_f32_16x16x32_bf16 v[128:131], a[192:195], a[32:35], v[128:131]
    ds_read_b128 a[224:227], v5 offset:24576
    s_xor_b32 s22, s22, 0x8000
    v_mfma_f32_16x16x32_bf16 v[132:135], a[192:195], a[36:39], v[132:135]
    buffer_load_dwordx4 a[104:107], v1, s[12:15], s37 offen offset:1024 sc1
    v_mfma_f32_16x16x32_bf16 v[136:139], a[196:199], a[32:35], v[136:139]
    ds_read_b128 a[228:231], v5 offset:25600
    v_readlane_b32 s23, v7, s20
    v_mfma_f32_16x16x32_bf16 v[140:143], a[196:199], a[36:39], v[140:143]
    v_mfma_f32_16x16x32_bf16 v[144:147], a[200:203], a[32:35], v[144:147]
    ds_read_b128 a[232:235], v5 offset:26624
    s_add_u32 m0, s22, 0
    v_mfma_f32_16x16x32_bf16 v[148:151], a[200:203], a[36:39], v[148:151]
    buffer_load_dwordx4 v4, s[12:15], s23 offen offset:0 lds
    v_mfma_f32_16x16x32_bf16 v[152:155], a[204:207], a[32:35], v[152:155]
    ds_read_b128 a[236:239], v5 offset:27648
    v_mfma_f32_16x16x32_bf16 v[156:159], a[204:207], a[36:39], v[156:159]
    s_waitcnt lgkmcnt(4)
    v_mfma_f32_16x16x32_bf16 v[192:195], a[208:211], a[32:35], v[192:195]
    ds_read_b128 a[240:243], v5 offset:28672
    v_mfma_f32_16x16x32_bf16 v[196:199], a[208:211], a[36:39], v[196:199]
    buffer_load_dwordx4 a[108:111], v11, s[12:15], s37 offen offset:1024 sc1
    v_mfma_f32_16x16x32_bf16 v[200:203], a[212:215], a[32:35], v[200:203]
    ds_read_b128 a[244:247], v5 offset:29696
    v_mfma_f32_16x16x32_bf16 v[204:207], a[212:215], a[36:39], v[204:207]
    v_mfma_f32_16x16x32_bf16 v[208:211], a[216:219], a[32:35], v[208:211]
    ds_read_b128 a[248:251], v5 offset:30720
    v_mfma_f32_16x16x32_bf16 v[212:215], a[216:219], a[36:39], v[212:215]
    buffer_load_dwordx4 v4, s[12:15], s23 offen offset:1024 lds
    v_mfma_f32_16x16x32_bf16 v[216:219], a[220:223], a[32:35], v[216:219]
    ds_read_b128 a[252:255], v5 offset:31744
    v_mfma_f32_16x16x32_bf16 v[220:223], a[220:223], a[36:39], v[220:223]
    s_waitcnt lgkmcnt(4)
    s_waitcnt vmcnt(18)
    v_mfma_f32_16x16x32_bf16 v[128:131], a[224:227], a[40:43], v[128:131]
    ds_read_b128 a[192:195], v6 offset:16384
    s_add_u32 s89, s86, 8192
    v_mfma_f32_16x16x32_bf16 v[132:135], a[224:227], a[44:47], v[132:135]
    buffer_load_dwordx4 a[144:147], v1, s[12:15], s89 offen offset:0 sc1
    v_mfma_f32_16x16x32_bf16 v[136:139], a[228:231], a[40:43], v[136:139]
    ds_read_b128 a[196:199], v6 offset:17408
    v_mfma_f32_16x16x32_bf16 v[140:143], a[228:231], a[44:47], v[140:143]
    v_mfma_f32_16x16x32_bf16 v[144:147], a[232:235], a[40:43], v[144:147]
    ds_read_b128 a[200:203], v6 offset:18432
    v_mfma_f32_16x16x32_bf16 v[148:151], a[232:235], a[44:47], v[148:151]
    buffer_load_dwordx4 v4, s[12:15], s23 offen offset:2048 lds
    v_mfma_f32_16x16x32_bf16 v[152:155], a[236:239], a[40:43], v[152:155]
    ds_read_b128 a[204:207], v6 offset:19456
    v_mfma_f32_16x16x32_bf16 v[156:159], a[236:239], a[44:47], v[156:159]
    s_waitcnt lgkmcnt(4)
    v_mfma_f32_16x16x32_bf16 v[192:195], a[240:243], a[40:43], v[192:195]
    ds_read_b128 a[208:211], v6 offset:20480
    v_mfma_f32_16x16x32_bf16 v[196:199], a[240:243], a[44:47], v[196:199]
    buffer_load_dwordx4 a[148:151], v1, s[12:15], s89 offen offset:1024 sc1
    v_mfma_f32_16x16x32_bf16 v[200:203], a[244:247], a[40:43], v[200:203]
    ds_read_b128 a[212:215], v6 offset:21504
    v_mfma_f32_16x16x32_bf16 v[204:207], a[244:247], a[44:47], v[204:207]
    v_mfma_f32_16x16x32_bf16 v[208:211], a[248:251], a[40:43], v[208:211]
    ds_read_b128 a[216:219], v6 offset:22528
    v_mfma_f32_16x16x32_bf16 v[212:215], a[248:251], a[44:47], v[212:215]
    buffer_load_dwordx4 v4, s[12:15], s23 offen offset:3072 lds
    v_mfma_f32_16x16x32_bf16 v[216:219], a[252:255], a[40:43], v[216:219]
    ds_read_b128 a[220:223], v6 offset:23552
    v_xor_b32 v5, 0x8000, v5
    v_mfma_f32_16x16x32_bf16 v[220:223], a[252:255], a[44:47], v[220:223]
    s_waitcnt lgkmcnt(4)
    s_waitcnt vmcnt(20)
    v_mfma_f32_16x16x32_bf16 v[128:131], a[192:195], a[48:51], v[128:131]
    ds_read_b128 a[224:227], v6 offset:24576
    v_mfma_f32_16x16x32_bf16 v[132:135], a[192:195], a[52:55], v[132:135]
    buffer_load_dwordx4 a[152:155], v1, s[12:15], s89 offen offset:2048 sc1
    v_mfma_f32_16x16x32_bf16 v[136:139], a[196:199], a[48:51], v[136:139]
    ds_read_b128 a[228:231], v6 offset:25600
    v_mfma_f32_16x16x32_bf16 v[140:143], a[196:199], a[52:55], v[140:143]
    v_mfma_f32_16x16x32_bf16 v[144:147], a[200:203], a[48:51], v[144:147]
    ds_read_b128 a[232:235], v6 offset:26624
    v_readlane_b32 s27, v8, s20
    v_mfma_f32_16x16x32_bf16 v[148:151], a[200:203], a[52:55], v[148:151]
    buffer_load_dwordx4 a[156:159], v1, s[12:15], s89 offen offset:3072 sc1
    v_mfma_f32_16x16x32_bf16 v[152:155], a[204:207], a[48:51], v[152:155]
    ds_read_b128 a[236:239], v6 offset:27648
    v_mfma_f32_16x16x32_bf16 v[156:159], a[204:207], a[52:55], v[156:159]
    s_waitcnt lgkmcnt(4)
    v_mfma_f32_16x16x32_bf16 v[192:195], a[208:211], a[48:51], v[192:195]
    ds_read_b128 a[240:243], v6 offset:28672
    s_add_u32 s89, s86, 12288
    v_mfma_f32_16x16x32_bf16 v[196:199], a[208:211], a[52:55], v[196:199]
    buffer_load_dwordx4 a[160:163], v1, s[12:15], s89 offen offset:0 sc1
    v_mfma_f32_16x16x32_bf16 v[200:203], a[212:215], a[48:51], v[200:203]
    ds_read_b128 a[244:247], v6 offset:29696
    v_mfma_f32_16x16x32_bf16 v[204:207], a[212:215], a[52:55], v[204:207]
    v_mfma_f32_16x16x32_bf16 v[208:211], a[216:219], a[48:51], v[208:211]
    ds_read_b128 a[248:251], v6 offset:30720
    v_mfma_f32_16x16x32_bf16 v[212:215], a[216:219], a[52:55], v[212:215]
    buffer_load_dwordx4 a[164:167], v1, s[12:15], s89 offen offset:1024 sc1
    v_mfma_f32_16x16x32_bf16 v[216:219], a[220:223], a[48:51], v[216:219]
    ds_read_b128 a[252:255], v6 offset:31744
    s_add_u32 m0, s22, 65536
    v_mfma_f32_16x16x32_bf16 v[220:223], a[220:223], a[52:55], v[220:223]
    s_waitcnt lgkmcnt(4)
    s_barrier
    s_waitcnt vmcnt(22)
    v_mfma_f32_16x16x32_bf16 v[128:131], a[224:227], a[56:59], v[128:131]
    ds_read_b128 a[192:195], v5 offset:0
    v_xor_b32 v6, 0x8000, v6
    v_mfma_f32_16x16x32_bf16 v[132:135], a[224:227], a[60:63], v[132:135]
    buffer_load_dwordx4 v4, s[12:15], s27 offen offset:0 lds
    v_mfma_f32_16x16x32_bf16 v[136:139], a[228:231], a[56:59], v[136:139]
    ds_read_b128 a[196:199], v5 offset:1024
    v_mfma_f32_16x16x32_bf16 v[140:143], a[228:231], a[60:63], v[140:143]
    v_mfma_f32_16x16x32_bf16 v[144:147], a[232:235], a[56:59], v[144:147]
    ds_read_b128 a[200:203], v5 offset:2048
    v_mfma_f32_16x16x32_bf16 v[148:151], a[232:235], a[60:63], v[148:151]
    buffer_load_dwordx4 v4, s[12:15], s27 offen offset:1024 lds
    v_mfma_f32_16x16x32_bf16 v[152:155], a[236:239], a[56:59], v[152:155]
    ds_read_b128 a[204:207], v5 offset:3072
    v_mfma_f32_16x16x32_bf16 v[156:159], a[236:239], a[60:63], v[156:159]
    s_waitcnt lgkmcnt(4)
    v_mfma_f32_16x16x32_bf16 v[192:195], a[240:243], a[56:59], v[192:195]
    ds_read_b128 a[208:211], v5 offset:4096
    v_mfma_f32_16x16x32_bf16 v[196:199], a[240:243], a[60:63], v[196:199]
    buffer_load_dwordx4 v4, s[12:15], s27 offen offset:2048 lds
    v_mfma_f32_16x16x32_bf16 v[200:203], a[244:247], a[56:59], v[200:203]
    ds_read_b128 a[212:215], v5 offset:5120
    v_mfma_f32_16x16x32_bf16 v[204:207], a[244:247], a[60:63], v[204:207]
    v_mfma_f32_16x16x32_bf16 v[208:211], a[248:251], a[56:59], v[208:211]
    ds_read_b128 a[216:219], v5 offset:6144
    s_add_u32 s20, s20, 1
    v_mfma_f32_16x16x32_bf16 v[212:215], a[248:251], a[60:63], v[212:215]
    buffer_load_dwordx4 v4, s[12:15], s27 offen offset:3072 lds
    v_mfma_f32_16x16x32_bf16 v[216:219], a[252:255], a[56:59], v[216:219]
    ds_read_b128 a[220:223], v5 offset:7168
    v_mfma_f32_16x16x32_bf16 v[220:223], a[252:255], a[60:63], v[220:223]
    s_waitcnt lgkmcnt(4)
    s_waitcnt vmcnt(24)
    v_mfma_f32_16x16x32_bf16 v[128:131], a[192:195], a[64:67], v[128:131]
    ds_read_b128 a[224:227], v5 offset:8192
    v_readlane_b32 s23, v7, s20
    v_mfma_f32_16x16x32_bf16 v[132:135], a[192:195], a[68:71], v[132:135]
    buffer_load_dwordx4 a[168:171], v1, s[12:15], s89 offen offset:2048 sc1
    v_mfma_f32_16x16x32_bf16 v[136:139], a[196:199], a[64:67], v[136:139]
    ds_read_b128 a[228:231], v5 offset:9216
    v_mfma_f32_16x16x32_bf16 v[140:143], a[196:199], a[68:71], v[140:143]
    v_mfma_f32_16x16x32_bf16 v[144:147], a[200:203], a[64:67], v[144:147]
    ds_read_b128 a[232:235], v5 offset:10240
    s_add_u32 m0, s22, 16384
    v_mfma_f32_16x16x32_bf16 v[148:151], a[200:203], a[68:71], v[148:151]
    buffer_load_dwordx4 v4, s[12:15], s23 offen offset:0 lds
    v_mfma_f32_16x16x32_bf16 v[152:155], a[204:207], a[64:67], v[152:155]
    ds_read_b128 a[236:239], v5 offset:11264
    v_mfma_f32_16x16x32_bf16 v[156:159], a[204:207], a[68:71], v[156:159]
    s_waitcnt lgkmcnt(4)
    v_mfma_f32_16x16x32_bf16 v[192:195], a[208:211], a[64:67], v[192:195]
    ds_read_b128 a[240:243], v5 offset:12288
    v_mfma_f32_16x16x32_bf16 v[196:199], a[208:211], a[68:71], v[196:199]
    buffer_load_dwordx4 a[172:175], v1, s[12:15], s89 offen offset:3072 sc1
    v_mfma_f32_16x16x32_bf16 v[200:203], a[212:215], a[64:67], v[200:203]
    ds_read_b128 a[244:247], v5 offset:13312
    v_mfma_f32_16x16x32_bf16 v[204:207], a[212:215], a[68:71], v[204:207]
    v_mfma_f32_16x16x32_bf16 v[208:211], a[216:219], a[64:67], v[208:211]
    ds_read_b128 a[248:251], v5 offset:14336
    v_mfma_f32_16x16x32_bf16 v[212:215], a[216:219], a[68:71], v[212:215]
    buffer_load_dwordx4 v4, s[12:15], s23 offen offset:1024 lds
    v_mfma_f32_16x16x32_bf16 v[216:219], a[220:223], a[64:67], v[216:219]
    ds_read_b128 a[252:255], v5 offset:15360
    v_mfma_f32_16x16x32_bf16 v[220:223], a[220:223], a[68:71], v[220:223]
    s_waitcnt lgkmcnt(4)
    s_waitcnt vmcnt(26)
    v_mfma_f32_16x16x32_bf16 v[128:131], a[224:227], a[72:75], v[128:131]
    ds_read_b128 a[192:195], v6 offset:0
    s_add_u32 s89, s86, 16384
    v_mfma_f32_16x16x32_bf16 v[132:135], a[224:227], a[76:79], v[132:135]
    buffer_load_dwordx4 a[176:179], v1, s[12:15], s89 offen offset:0 sc1
    v_mfma_f32_16x16x32_bf16 v[136:139], a[228:231], a[72:75], v[136:139]
    ds_read_b128 a[196:199], v6 offset:1024
    v_mfma_f32_16x16x32_bf16 v[140:143], a[228:231], a[76:79], v[140:143]
    v_mfma_f32_16x16x32_bf16 v[144:147], a[232:235], a[72:75], v[144:147]
    ds_read_b128 a[200:203], v6 offset:2048
    v_mfma_f32_16x16x32_bf16 v[148:151], a[232:235], a[76:79], v[148:151]
    buffer_load_dwordx4 v4, s[12:15], s23 offen offset:2048 lds
    v_mfma_f32_16x16x32_bf16 v[152:155], a[236:239], a[72:75], v[152:155]
    ds_read_b128 a[204:207], v6 offset:3072
    v_mfma_f32_16x16x32_bf16 v[156:159], a[236:239], a[76:79], v[156:159]
    s_waitcnt lgkmcnt(4)
    v_mfma_f32_16x16x32_bf16 v[192:195], a[240:243], a[72:75], v[192:195]
    ds_read_b128 a[208:211], v6 offset:4096
    v_mfma_f32_16x16x32_bf16 v[196:199], a[240:243], a[76:79], v[196:199]
    buffer_load_dwordx4 a[180:183], v1, s[12:15], s89 offen offset:1024 sc1
    v_mfma_f32_16x16x32_bf16 v[200:203], a[244:247], a[72:75], v[200:203]
    ds_read_b128 a[212:215], v6 offset:5120
    v_mfma_f32_16x16x32_bf16 v[204:207], a[244:247], a[76:79], v[204:207]
    v_mfma_f32_16x16x32_bf16 v[208:211], a[248:251], a[72:75], v[208:211]
    ds_read_b128 a[216:219], v6 offset:6144
    v_mfma_f32_16x16x32_bf16 v[212:215], a[248:251], a[76:79], v[212:215]
    buffer_load_dwordx4 v4, s[12:15], s23 offen offset:3072 lds
    v_mfma_f32_16x16x32_bf16 v[216:219], a[252:255], a[72:75], v[216:219]
    ds_read_b128 a[220:223], v6 offset:7168
    v_mfma_f32_16x16x32_bf16 v[220:223], a[252:255], a[76:79], v[220:223]
    s_waitcnt lgkmcnt(4)
    s_waitcnt vmcnt(28)
    v_mfma_f32_16x16x32_bf16 v[128:131], a[192:195], a[80:83], v[128:131]
    ds_read_b128 a[224:227], v6 offset:8192
    v_mfma_f32_16x16x32_bf16 v[132:135], a[192:195], a[84:87], v[132:135]
    buffer_load_dwordx4 a[184:187], v1, s[12:15], s89 offen offset:2048 sc1
    v_mfma_f32_16x16x32_bf16 v[136:139], a[196:199], a[80:83], v[136:139]
    ds_read_b128 a[228:231], v6 offset:9216
    v_mfma_f32_16x16x32_bf16 v[140:143], a[196:199], a[84:87], v[140:143]
    v_mfma_f32_16x16x32_bf16 v[144:147], a[200:203], a[80:83], v[144:147]
    ds_read_b128 a[232:235], v6 offset:10240
    v_readlane_b32 s27, v8, s20
    v_mfma_f32_16x16x32_bf16 v[148:151], a[200:203], a[84:87], v[148:151]
    buffer_load_dwordx4 a[188:191], v1, s[12:15], s89 offen offset:3072 sc1
    v_mfma_f32_16x16x32_bf16 v[152:155], a[204:207], a[80:83], v[152:155]
    ds_read_b128 a[236:239], v6 offset:11264
    v_mfma_f32_16x16x32_bf16 v[156:159], a[204:207], a[84:87], v[156:159]
    s_waitcnt lgkmcnt(4)
    v_mfma_f32_16x16x32_bf16 v[192:195], a[208:211], a[80:83], v[192:195]
    ds_read_b128 a[240:243], v6 offset:12288
    s_add_u32 s89, s86, 20480
    v_mfma_f32_16x16x32_bf16 v[196:199], a[208:211], a[84:87], v[196:199]
    buffer_load_dwordx4 v[32:35], v1, s[12:15], s89 offen offset:0 sc1
    v_mfma_f32_16x16x32_bf16 v[200:203], a[212:215], a[80:83], v[200:203]
    ds_read_b128 a[244:247], v6 offset:13312
    v_mfma_f32_16x16x32_bf16 v[204:207], a[212:215], a[84:87], v[204:207]
    v_mfma_f32_16x16x32_bf16 v[208:211], a[216:219], a[80:83], v[208:211]
    ds_read_b128 a[248:251], v6 offset:14336
    v_mfma_f32_16x16x32_bf16 v[212:215], a[216:219], a[84:87], v[212:215]
    buffer_load_dwordx4 v[36:39], v1, s[12:15], s89 offen offset:1024 sc1
    v_mfma_f32_16x16x32_bf16 v[216:219], a[220:223], a[80:83], v[216:219]
    ds_read_b128 a[252:255], v6 offset:15360
    s_add_u32 m0, s22, 81920
    v_mfma_f32_16x16x32_bf16 v[220:223], a[220:223], a[84:87], v[220:223]
    s_waitcnt lgkmcnt(4)
    s_barrier
    s_waitcnt vmcnt(30)
    v_mfma_f32_16x16x32_bf16 v[128:131], a[224:227], a[88:91], v[128:131]
    ds_read_b128 a[192:195], v5 offset:16384
    v_mfma_f32_16x16x32_bf16 v[132:135], a[224:227], a[92:95], v[132:135]
    buffer_load_dwordx4 v4, s[12:15], s27 offen offset:0 lds
    v_mfma_f32_16x16x32_bf16 v[136:139], a[228:231], a[88:91], v[136:139]
    ds_read_b128 a[196:199], v5 offset:17408
    v_mfma_f32_16x16x32_bf16 v[140:143], a[228:231], a[92:95], v[140:143]
    v_mfma_f32_16x16x32_bf16 v[144:147], a[232:235], a[88:91], v[144:147]
    ds_read_b128 a[200:203], v5 offset:18432
    v_mfma_f32_16x16x32_bf16 v[148:151], a[232:235], a[92:95], v[148:151]
    buffer_load_dwordx4 v4, s[12:15], s27 offen offset:1024 lds
    v_mfma_f32_16x16x32_bf16 v[152:155], a[236:239], a[88:91], v[152:155]
    ds_read_b128 a[204:207], v5 offset:19456
    v_mfma_f32_16x16x32_bf16 v[156:159], a[236:239], a[92:95], v[156:159]
    s_waitcnt lgkmcnt(4)
    v_mfma_f32_16x16x32_bf16 v[192:195], a[240:243], a[88:91], v[192:195]
    ds_read_b128 a[208:211], v5 offset:20480
    v_mfma_f32_16x16x32_bf16 v[196:199], a[240:243], a[92:95], v[196:199]
    buffer_load_dwordx4 v4, s[12:15], s27 offen offset:2048 lds
    v_mfma_f32_16x16x32_bf16 v[200:203], a[244:247], a[88:91], v[200:203]
    ds_read_b128 a[212:215], v5 offset:21504
    v_mfma_f32_16x16x32_bf16 v[204:207], a[244:247], a[92:95], v[204:207]
    v_mfma_f32_16x16x32_bf16 v[208:211], a[248:251], a[88:91], v[208:211]
    ds_read_b128 a[216:219], v5 offset:22528
    s_add_u32 s20, s20, 1
    v_mfma_f32_16x16x32_bf16 v[212:215], a[248:251], a[92:95], v[212:215]
    buffer_load_dwordx4 v4, s[12:15], s27 offen offset:3072 lds
    v_mfma_f32_16x16x32_bf16 v[216:219], a[252:255], a[88:91], v[216:219]
    ds_read_b128 a[220:223], v5 offset:23552
    v_mfma_f32_16x16x32_bf16 v[220:223], a[252:255], a[92:95], v[220:223]
    s_waitcnt lgkmcnt(4)
    s_waitcnt vmcnt(32)
    v_mfma_f32_16x16x32_bf16 v[128:131], a[192:195], a[96:99], v[128:131]
    ds_read_b128 a[224:227], v5 offset:24576
    s_xor_b32 s22, s22, 0x8000
    v_mfma_f32_16x16x32_bf16 v[132:135], a[192:195], a[100:103], v[132:135]
    buffer_load_dwordx4 v[40:43], v1, s[12:15], s89 offen offset:2048 sc1
    v_mfma_f32_16x16x32_bf16 v[136:139], a[196:199], a[96:99], v[136:139]
    ds_read_b128 a[228:231], v5 offset:25600
    v_readlane_b32 s23, v7, s20
    v_mfma_f32_16x16x32_bf16 v[140:143], a[196:199], a[100:103], v[140:143]
    v_mfma_f32_16x16x32_bf16 v[144:147], a[200:203], a[96:99], v[144:147]
    ds_read_b128 a[232:235], v5 offset:26624
    s_add_u32 m0, s22, 0
    v_mfma_f32_16x16x32_bf16 v[148:151], a[200:203], a[100:103], v[148:151]
    buffer_load_dwordx4 v4, s[12:15], s23 offen offset:0 lds
    v_mfma_f32_16x16x32_bf16 v[152:155], a[204:207], a[96:99], v[152:155]
    ds_read_b128 a[236:239], v5 offset:27648
    v_mfma_f32_16x16x32_bf16 v[156:159], a[204:207], a[100:103], v[156:159]
    s_waitcnt lgkmcnt(4)
    v_mfma_f32_16x16x32_bf16 v[192:195], a[208:211], a[96:99], v[192:195]
    ds_read_b128 a[240:243], v5 offset:28672
    v_mfma_f32_16x16x32_bf16 v[196:199], a[208:211], a[100:103], v[196:199]
    buffer_load_dwordx4 v[44:47], v1, s[12:15], s89 offen offset:3072 sc1
    v_mfma_f32_16x16x32_bf16 v[200:203], a[212:215], a[96:99], v[200:203]
    ds_read_b128 a[244:247], v5 offset:29696
    v_mfma_f32_16x16x32_bf16 v[204:207], a[212:215], a[100:103], v[204:207]
    v_mfma_f32_16x16x32_bf16 v[208:211], a[216:219], a[96:99], v[208:211]
    ds_read_b128 a[248:251], v5 offset:30720
    v_mfma_f32_16x16x32_bf16 v[212:215], a[216:219], a[100:103], v[212:215]
    buffer_load_dwordx4 v4, s[12:15], s23 offen offset:1024 lds
    v_mfma_f32_16x16x32_bf16 v[216:219], a[220:223], a[96:99], v[216:219]
    ds_read_b128 a[252:255], v5 offset:31744
    v_mfma_f32_16x16x32_bf16 v[220:223], a[220:223], a[100:103], v[220:223]
    s_waitcnt lgkmcnt(4)
    s_waitcnt vmcnt(33)
    v_mfma_f32_16x16x32_bf16 v[128:131], a[224:227], a[104:107], v[128:131]
    ds_read_b128 a[192:195], v6 offset:16384
    s_add_u32 s89, s86, 24576
    v_mfma_f32_16x16x32_bf16 v[132:135], a[224:227], a[108:111], v[132:135]
    buffer_load_dwordx4 v[48:51], v1, s[12:15], s89 offen offset:0 sc1
    v_mfma_f32_16x16x32_bf16 v[136:139], a[228:231], a[104:107], v[136:139]
    ds_read_b128 a[196:199], v6 offset:17408
    v_mfma_f32_16x16x32_bf16 v[140:143], a[228:231], a[108:111], v[140:143]
    v_mfma_f32_16x16x32_bf16 v[144:147], a[232:235], a[104:107], v[144:147]
    ds_read_b128 a[200:203], v6 offset:18432
    v_mfma_f32_16x16x32_bf16 v[148:151], a[232:235], a[108:111], v[148:151]
    buffer_load_dwordx4 v4, s[12:15], s23 offen offset:2048 lds
    v_mfma_f32_16x16x32_bf16 v[152:155], a[236:239], a[104:107], v[152:155]
    ds_read_b128 a[204:207], v6 offset:19456
    v_mfma_f32_16x16x32_bf16 v[156:159], a[236:239], a[108:111], v[156:159]
    s_waitcnt lgkmcnt(4)
    v_mfma_f32_16x16x32_bf16 v[192:195], a[240:243], a[104:107], v[192:195]
    ds_read_b128 a[208:211], v6 offset:20480
    v_mfma_f32_16x16x32_bf16 v[196:199], a[240:243], a[108:111], v[196:199]
    buffer_load_dwordx4 v[52:55], v1, s[12:15], s89 offen offset:1024 sc1
    v_mfma_f32_16x16x32_bf16 v[200:203], a[244:247], a[104:107], v[200:203]
    ds_read_b128 a[212:215], v6 offset:21504
    v_mfma_f32_16x16x32_bf16 v[204:207], a[244:247], a[108:111], v[204:207]
    v_mfma_f32_16x16x32_bf16 v[208:211], a[248:251], a[104:107], v[208:211]
    ds_read_b128 a[216:219], v6 offset:22528
    v_mfma_f32_16x16x32_bf16 v[212:215], a[248:251], a[108:111], v[212:215]
    buffer_load_dwordx4 v4, s[12:15], s23 offen offset:3072 lds
    v_mfma_f32_16x16x32_bf16 v[216:219], a[252:255], a[104:107], v[216:219]
    ds_read_b128 a[220:223], v6 offset:23552
    v_xor_b32 v5, 0x8000, v5
    v_mfma_f32_16x16x32_bf16 v[220:223], a[252:255], a[108:111], v[220:223]
    s_waitcnt lgkmcnt(4)
    v_mfma_f32_16x16x32_bf16 v[160:163], a[192:195], a[0:3], 0
    ds_read_b128 a[224:227], v6 offset:24576
    v_mfma_f32_16x16x32_bf16 v[164:167], a[192:195], a[4:7], 0
    buffer_load_dwordx4 v[56:59], v1, s[12:15], s89 offen offset:2048 sc1
    v_mfma_f32_16x16x32_bf16 v[168:171], a[196:199], a[0:3], 0
    ds_read_b128 a[228:231], v6 offset:25600
    v_mfma_f32_16x16x32_bf16 v[172:175], a[196:199], a[4:7], 0
    v_mfma_f32_16x16x32_bf16 v[176:179], a[200:203], a[0:3], 0
    ds_read_b128 a[232:235], v6 offset:26624
    v_readlane_b32 s27, v8, s20
    v_mfma_f32_16x16x32_bf16 v[180:183], a[200:203], a[4:7], 0
    buffer_load_dwordx4 v[60:63], v1, s[12:15], s89 offen offset:3072 sc1
    v_mfma_f32_16x16x32_bf16 v[184:187], a[204:207], a[0:3], 0
    ds_read_b128 a[236:239], v6 offset:27648
    v_mul_f32 v192, v128, v192
    v_mfma_f32_16x16x32_bf16 v[188:191], a[204:207], a[4:7], 0
    v_mul_f32 v128, s98, v128
    s_waitcnt lgkmcnt(4)
    v_mfma_f32_16x16x32_bf16 v[224:227], a[208:211], a[0:3], 0
    ds_read_b128 a[240:243], v6 offset:28672
    s_add_u32 s89, s86, 114688
    v_mfma_f32_16x16x32_bf16 v[228:231], a[208:211], a[4:7], 0
    buffer_load_dwordx4 v[64:67], v1, s[12:15], s89 offen offset:0 sc1
    v_mfma_f32_16x16x32_bf16 v[232:235], a[212:215], a[0:3], 0
    ds_read_b128 a[244:247], v6 offset:29696
    v_mfma_f32_16x16x32_bf16 v[236:239], a[212:215], a[4:7], 0
    v_exp_f32 v128, v128
    v_mfma_f32_16x16x32_bf16 v[240:243], a[216:219], a[0:3], 0
    ds_read_b128 a[248:251], v6 offset:30720
    v_mul_f32 v193, v129, v193
    v_mfma_f32_16x16x32_bf16 v[244:247], a[216:219], a[4:7], 0
    buffer_load_dwordx4 v[68:71], v1, s[12:15], s89 offen offset:1024 sc1
    v_mfma_f32_16x16x32_bf16 v[248:251], a[220:223], a[0:3], 0
    ds_read_b128 a[252:255], v6 offset:31744
    s_add_u32 m0, s22, 65536
    v_mfma_f32_16x16x32_bf16 v[252:255], a[220:223], a[4:7], 0
    s_waitcnt vmcnt(28) lgkmcnt(4)
    s_barrier
    v_mfma_f32_16x16x32_bf16 v[160:163], a[224:227], a[8:11], v[160:163]
    ds_read_b128 a[192:195], v5 offset:0
    v_xor_b32 v6, 0x8000, v6
    v_mfma_f32_16x16x32_bf16 v[164:167], a[224:227], a[12:15], v[164:167]
    buffer_load_dwordx4 v4, s[12:15], s27 offen offset:0 lds
    v_mfma_f32_16x16x32_bf16 v[168:171], a[228:231], a[8:11], v[168:171]
    ds_read_b128 a[196:199], v5 offset:1024
    v_mul_f32 v129, s98, v129
    v_mfma_f32_16x16x32_bf16 v[172:175], a[228:231], a[12:15], v[172:175]
    v_exp_f32 v129, v129
    v_mfma_f32_16x16x32_bf16 v[176:179], a[232:235], a[8:11], v[176:179]
    ds_read_b128 a[200:203], v5 offset:2048
    v_mul_f32 v194, v130, v194
    v_mfma_f32_16x16x32_bf16 v[180:183], a[232:235], a[12:15], v[180:183]
    buffer_load_dwordx4 v4, s[12:15], s27 offen offset:1024 lds
    v_mfma_f32_16x16x32_bf16 v[184:187], a[236:239], a[8:11], v[184:187]
    ds_read_b128 a[204:207], v5 offset:3072
    v_mul_f32 v130, s98, v130
    v_mfma_f32_16x16x32_bf16 v[188:191], a[236:239], a[12:15], v[188:191]
    v_add_f32 v128, 1.0, v128
    s_waitcnt lgkmcnt(4)
    v_mfma_f32_16x16x32_bf16 v[224:227], a[240:243], a[8:11], v[224:227]
    ds_read_b128 a[208:211], v5 offset:4096
    v_mfma_f32_16x16x32_bf16 v[228:231], a[240:243], a[12:15], v[228:231]
    buffer_load_dwordx4 v4, s[12:15], s27 offen offset:2048 lds
    v_mfma_f32_16x16x32_bf16 v[232:235], a[244:247], a[8:11], v[232:235]
    ds_read_b128 a[212:215], v5 offset:5120
    v_mfma_f32_16x16x32_bf16 v[236:239], a[244:247], a[12:15], v[236:239]
    v_exp_f32 v130, v130
    v_mfma_f32_16x16x32_bf16 v[240:243], a[248:251], a[8:11], v[240:243]
    ds_read_b128 a[216:219], v5 offset:6144
    s_add_u32 s20, s20, 1
    v_mfma_f32_16x16x32_bf16 v[244:247], a[248:251], a[12:15], v[244:247]
    buffer_load_dwordx4 v4, s[12:15], s27 offen offset:3072 lds
    v_mfma_f32_16x16x32_bf16 v[248:251], a[252:255], a[8:11], v[248:251]
    ds_read_b128 a[220:223], v5 offset:7168
    v_mul_f32 v195, v131, v195
    v_mfma_f32_16x16x32_bf16 v[252:255], a[252:255], a[12:15], v[252:255]
    s_waitcnt lgkmcnt(4)
    v_mfma_f32_16x16x32_bf16 v[160:163], a[192:195], a[16:19], v[160:163]
    ds_read_b128 a[224:227], v5 offset:8192
    ds_read_b128 a[228:231], v5 offset:9216
    v_mul_f32 v131, s98, v131
    v_mfma_f32_16x16x32_bf16 v[164:167], a[192:195], a[20:23], v[164:167]
    buffer_load_dwordx4 v[72:75], v1, s[12:15], s89 offen offset:2048 sc1
    v_mfma_f32_16x16x32_bf16 v[168:171], a[196:199], a[16:19], v[168:171]
    v_rcp_f32 v128, v128
    v_mfma_f32_16x16x32_bf16 v[172:175], a[196:199], a[20:23], v[172:175]
    v_add_f32 v129, 1.0, v129
    v_mfma_f32_16x16x32_bf16 v[176:179], a[200:203], a[16:19], v[176:179]
    ds_read_b128 a[232:235], v5 offset:10240
    ds_read_b128 a[236:239], v5 offset:11264
    v_exp_f32 v131, v131
    v_mfma_f32_16x16x32_bf16 v[180:183], a[200:203], a[20:23], v[180:183]
    buffer_load_dwordx4 v[76:79], v1, s[12:15], s89 offen offset:3072 sc1
    v_mfma_f32_16x16x32_bf16 v[184:187], a[204:207], a[16:19], v[184:187]
    v_mul_f32 v200, v136, v200
    v_mul_f32 v136, s98, v136
    v_mfma_f32_16x16x32_bf16 v[188:191], a[204:207], a[20:23], v[188:191]
    v_rcp_f32 v129, v129
    s_waitcnt lgkmcnt(4)
    v_mfma_f32_16x16x32_bf16 v[224:227], a[208:211], a[16:19], v[224:227]
    ds_read_b128 a[240:243], v5 offset:12288
    ds_read_b128 a[244:247], v5 offset:13312
    v_add_f32 v130, 1.0, v130
    v_mul_f32 v192, v128, v192
    v_mfma_f32_16x16x32_bf16 v[228:231], a[208:211], a[20:23], v[228:231]
    s_add_u32 s89, s86, 118784
    buffer_load_dwordx4 v[80:83], v1, s[12:15], s89 offen offset:0 sc1
    v_mfma_f32_16x16x32_bf16 v[232:235], a[212:215], a[16:19], v[232:235]
    v_exp_f32 v136, v136
    v_mfma_f32_16x16x32_bf16 v[236:239], a[212:215], a[20:23], v[236:239]
    v_mul_f32 v201, v137, v201
    v_mul_f32 v137, s98, v137
    v_mfma_f32_16x16x32_bf16 v[240:243], a[216:219], a[16:19], v[240:243]
    ds_read_b128 a[248:251], v5 offset:14336
    ds_read_b128 a[252:255], v5 offset:15360
    v_rcp_f32 v130, v130
    v_mfma_f32_16x16x32_bf16 v[244:247], a[216:219], a[20:23], v[244:247]
    buffer_load_dwordx4 v[84:87], v1, s[12:15], s89 offen offset:1024 sc1
    v_mfma_f32_16x16x32_bf16 v[248:251], a[220:223], a[16:19], v[248:251]
    v_add_f32 v131, 1.0, v131
    v_mul_f32 v193, v129, v193
    v_mfma_f32_16x16x32_bf16 v[252:255], a[220:223], a[20:23], v[252:255]
    v_exp_f32 v137, v137
    s_waitcnt lgkmcnt(4)
    v_mfma_f32_16x16x32_bf16 v[160:163], a[224:227], a[24:27], v[160:163]
    ds_read_b128 a[192:195], v6 offset:0
    ds_read_b128 a[196:199], v6 offset:1024
    v_mul_f32 v202, v138, v202
    v_mul_f32 v138, s98, v138
    v_mfma_f32_16x16x32_bf16 v[164:167], a[224:227], a[28:31], v[164:167]
    buffer_load_dwordx4 v[88:91], v1, s[12:15], s89 offen offset:2048 sc1
    v_mfma_f32_16x16x32_bf16 v[168:171], a[228:231], a[24:27], v[168:171]
    v_rcp_f32 v131, v131
    v_mfma_f32_16x16x32_bf16 v[172:175], a[228:231], a[28:31], v[172:175]
    v_add_f32 v136, 1.0, v136
    v_mul_f32 v194, v130, v194
    v_mfma_f32_16x16x32_bf16 v[176:179], a[232:235], a[24:27], v[176:179]
    ds_read_b128 a[200:203], v6 offset:2048
    ds_read_b128 a[204:207], v6 offset:3072
    v_exp_f32 v138, v138
    v_mfma_f32_16x16x32_bf16 v[180:183], a[232:235], a[28:31], v[180:183]
    buffer_load_dwordx4 v[92:95], v1, s[12:15], s89 offen offset:3072 sc1
    v_mfma_f32_16x16x32_bf16 v[184:187], a[236:239], a[24:27], v[184:187]
    v_mul_f32 v203, v139, v203
    v_mul_f32 v139, s98, v139
    v_mfma_f32_16x16x32_bf16 v[188:191], a[236:239], a[28:31], v[188:191]
    v_rcp_f32 v136, v136
    s_waitcnt lgkmcnt(4)
    v_mfma_f32_16x16x32_bf16 v[224:227], a[240:243], a[24:27], v[224:227]
    ds_read_b128 a[208:211], v6 offset:4096
    ds_read_b128 a[212:215], v6 offset:5120
    v_add_f32 v137, 1.0, v137
    v_mul_f32 v195, v131, v195
    v_mfma_f32_16x16x32_bf16 v[228:231], a[240:243], a[28:31], v[228:231]
    s_add_u32 s89, s86, 122880
    buffer_load_dwordx4 v[96:99], v1, s[12:15], s89 offen offset:0 sc1
    v_mfma_f32_16x16x32_bf16 v[232:235], a[244:247], a[24:27], v[232:235]
    v_exp_f32 v139, v139
    v_mfma_f32_16x16x32_bf16 v[236:239], a[244:247], a[28:31], v[236:239]
    v_mul_f32 v208, v144, v208
    v_mul_f32 v144, s98, v144
    v_mfma_f32_16x16x32_bf16 v[240:243], a[248:251], a[24:27], v[240:243]
    ds_read_b128 a[216:219], v6 offset:6144
    ds_read_b128 a[220:223], v6 offset:7168
    v_rcp_f32 v137, v137
    v_mfma_f32_16x16x32_bf16 v[244:247], a[248:251], a[28:31], v[244:247]
    buffer_load_dwordx4 v[100:103], v1, s[12:15], s89 offen offset:1024 sc1
    v_mfma_f32_16x16x32_bf16 v[248:251], a[252:255], a[24:27], v[248:251]
    v_add_f32 v138, 1.0, v138
    v_mul_f32 v200, v136, v200
    v_mfma_f32_16x16x32_bf16 v[252:255], a[252:255], a[28:31], v[252:255]
    v_exp_f32 v144, v144
    s_waitcnt lgkmcnt(4)
    v_mfma_f32_16x16x32_bf16 v[160:163], a[192:195], a[32:35], v[160:163]
    ds_read_b128 a[224:227], v6 offset:8192
    ds_read_b128 a[228:231], v6 offset:9216
    v_mul_f32 v209, v145, v209
    v_mul_f32 v145, s98, v145
    v_mfma_f32_16x16x32_bf16 v[164:167], a[192:195], a[36:39], v[164:167]
    buffer_load_dwordx4 v[104:107], v1, s[12:15], s89 offen offset:2048 sc1
    v_mfma_f32_16x16x32_bf16 v[168:171], a[196:199], a[32:35], v[168:171]
    v_rcp_f32 v138, v138
    v_mfma_f32_16x16x32_bf16 v[172:175], a[196:199], a[36:39], v[172:175]
    v_add_f32 v139, 1.0, v139
    v_mul_f32 v201, v137, v201
    v_mfma_f32_16x16x32_bf16 v[176:179], a[200:203], a[32:35], v[176:179]
    ds_read_b128 a[232:235], v6 offset:10240
    ds_read_b128 a[236:239], v6 offset:11264
    v_exp_f32 v145, v145
    v_mfma_f32_16x16x32_bf16 v[180:183], a[200:203], a[36:39], v[180:183]
    buffer_load_dwordx4 v[108:111], v1, s[12:15], s89 offen offset:3072 sc1
    v_mfma_f32_16x16x32_bf16 v[184:187], a[204:207], a[32:35], v[184:187]
    v_mul_f32 v210, v146, v210
    v_mul_f32 v146, s98, v146
    v_mfma_f32_16x16x32_bf16 v[188:191], a[204:207], a[36:39], v[188:191]
    v_rcp_f32 v139, v139
    s_waitcnt lgkmcnt(4)
    v_mfma_f32_16x16x32_bf16 v[224:227], a[208:211], a[32:35], v[224:227]
    ds_read_b128 a[240:243], v6 offset:12288
    ds_read_b128 a[244:247], v6 offset:13312
    v_add_f32 v144, 1.0, v144
    v_mul_f32 v202, v138, v202
    v_mfma_f32_16x16x32_bf16 v[228:231], a[208:211], a[36:39], v[228:231]
    s_add_u32 s89, s86, 126976
    buffer_load_dwordx4 v[112:115], v1, s[12:15], s89 offen offset:0 sc1
    v_mfma_f32_16x16x32_bf16 v[232:235], a[212:215], a[32:35], v[232:235]
    v_exp_f32 v146, v146
    v_mfma_f32_16x16x32_bf16 v[236:239], a[212:215], a[36:39], v[236:239]
    v_mul_f32 v211, v147, v211
    v_mul_f32 v147, s98, v147
    v_mfma_f32_16x16x32_bf16 v[240:243], a[216:219], a[32:35], v[240:243]
    ds_read_b128 a[248:251], v6 offset:14336
    ds_read_b128 a[252:255], v6 offset:15360
    v_rcp_f32 v144, v144
    v_mfma_f32_16x16x32_bf16 v[244:247], a[216:219], a[36:39], v[244:247]
    buffer_load_dwordx4 v[116:119], v1, s[12:15], s89 offen offset:1024 sc1
    v_mfma_f32_16x16x32_bf16 v[248:251], a[220:223], a[32:35], v[248:251]
    v_add_f32 v145, 1.0, v145
    v_mul_f32 v203, v139, v203
    v_mfma_f32_16x16x32_bf16 v[252:255], a[220:223], a[36:39], v[252:255]
    s_waitcnt vmcnt(28) lgkmcnt(4)
    s_barrier
    v_mfma_f32_16x16x32_bf16 v[160:163], a[224:227], a[40:43], v[160:163]
    ds_read_b128 a[192:195], v5 offset:16384
    ds_read_b128 a[196:199], v5 offset:17408
    v_exp_f32 v147, v147
    v_mfma_f32_16x16x32_bf16 v[164:167], a[224:227], a[44:47], v[164:167]
    buffer_load_dwordx4 v[120:123], v1, s[12:15], s89 offen offset:2048 sc1
    v_mfma_f32_16x16x32_bf16 v[168:171], a[228:231], a[40:43], v[168:171]
    v_mul_f32 v216, v152, v216
    v_mul_f32 v152, s98, v152
    v_mfma_f32_16x16x32_bf16 v[172:175], a[228:231], a[44:47], v[172:175]
    v_rcp_f32 v145, v145
    v_mfma_f32_16x16x32_bf16 v[176:179], a[232:235], a[40:43], v[176:179]
    ds_read_b128 a[200:203], v5 offset:18432
    ds_read_b128 a[204:207], v5 offset:19456
    v_add_f32 v146, 1.0, v146
    v_mul_f32 v208, v144, v208
    v_mfma_f32_16x16x32_bf16 v[180:183], a[232:235], a[44:47], v[180:183]
    buffer_load_dwordx4 v[124:127], v1, s[12:15], s89 offen offset:3072 sc1
    v_mfma_f32_16x16x32_bf16 v[184:187], a[236:239], a[40:43], v[184:187]
    v_exp_f32 v152, v152
    v_mfma_f32_16x16x32_bf16 v[188:191], a[236:239], a[44:47], v[188:191]
    v_mul_f32 v217, v153, v217
    v_mul_f32 v153, s98, v153
    s_waitcnt lgkmcnt(4)
    v_mfma_f32_16x16x32_bf16 v[224:227], a[240:243], a[40:43], v[224:227]
    ds_read_b128 a[208:211], v5 offset:20480
    ds_read_b128 a[212:215], v5 offset:21504
    v_rcp_f32 v146, v146
    v_mfma_f32_16x16x32_bf16 v[228:231], a[240:243], a[44:47], v[228:231]
    buffer_load_dwordx2 v[16:17], v9, s[12:15], s39 offen offset:0 sc1
    v_mfma_f32_16x16x32_bf16 v[232:235], a[244:247], a[40:43], v[232:235]
    v_add_f32 v147, 1.0, v147
    v_mul_f32 v209, v145, v209
    v_mfma_f32_16x16x32_bf16 v[236:239], a[244:247], a[44:47], v[236:239]
    v_exp_f32 v153, v153
    v_mfma_f32_16x16x32_bf16 v[240:243], a[248:251], a[40:43], v[240:243]
    ds_read_b128 a[216:219], v5 offset:22528
    ds_read_b128 a[220:223], v5 offset:23552
    v_mul_f32 v218, v154, v218
    v_mul_f32 v154, s98, v154
    v_mfma_f32_16x16x32_bf16 v[244:247], a[248:251], a[44:47], v[244:247]
    buffer_load_dwordx2 v[18:19], v9, s[12:15], s39 offen offset:256 sc1
    v_mfma_f32_16x16x32_bf16 v[248:251], a[252:255], a[40:43], v[248:251]
    v_rcp_f32 v147, v147
    v_mfma_f32_16x16x32_bf16 v[252:255], a[252:255], a[44:47], v[252:255]
    s_waitcnt lgkmcnt(4)
    v_mfma_f32_16x16x32_bf16 v[160:163], a[192:195], a[48:51], v[160:163]
    ds_read_b128 a[224:227], v5 offset:24576
    ds_read_b128 a[228:231], v5 offset:25600
    v_add_f32 v152, 1.0, v152
    v_mul_f32 v210, v146, v210
    v_mfma_f32_16x16x32_bf16 v[164:167], a[192:195], a[52:55], v[164:167]
    buffer_load_dwordx2 v[20:21], v9, s[12:15], s39 offen offset:512 sc1
    v_mfma_f32_16x16x32_bf16 v[168:171], a[196:199], a[48:51], v[168:171]
    v_exp_f32 v154, v154
    v_mfma_f32_16x16x32_bf16 v[172:175], a[196:199], a[52:55], v[172:175]
    v_mul_f32 v219, v155, v219
    v_mul_f32 v155, s98, v155
    v_mfma_f32_16x16x32_bf16 v[176:179], a[200:203], a[48:51], v[176:179]
    ds_read_b128 a[232:235], v5 offset:26624
    ds_read_b128 a[236:239], v5 offset:27648
    v_rcp_f32 v152, v152
    v_mfma_f32_16x16x32_bf16 v[180:183], a[200:203], a[52:55], v[180:183]
    buffer_load_dwordx2 v[22:23], v9, s[12:15], s39 offen offset:768 sc1
    v_mfma_f32_16x16x32_bf16 v[184:187], a[204:207], a[48:51], v[184:187]
    v_add_f32 v153, 1.0, v153
    v_mul_f32 v211, v147, v211
    v_mfma_f32_16x16x32_bf16 v[188:191], a[204:207], a[52:55], v[188:191]
    v_exp_f32 v155, v155
    s_waitcnt lgkmcnt(4)
    v_mfma_f32_16x16x32_bf16 v[224:227], a[208:211], a[48:51], v[224:227]
    ds_read_b128 a[240:243], v5 offset:28672
    ds_read_b128 a[244:247], v5 offset:29696
    v_rcp_f32 v153, v153
    v_mfma_f32_16x16x32_bf16 v[228:231], a[208:211], a[52:55], v[228:231]
    s_add_u32 s89, s86, 131072
    buffer_load_dwordx4 a[0:3], v1, s[12:15], s89 offen offset:0 sc1
    v_mfma_f32_16x16x32_bf16 v[232:235], a[212:215], a[48:51], v[232:235]
    v_add_f32 v154, 1.0, v154
    v_mul_f32 v216, v152, v216
    v_mfma_f32_16x16x32_bf16 v[236:239], a[212:215], a[52:55], v[236:239]
    v_rcp_f32 v154, v154
    v_mfma_f32_16x16x32_bf16 v[240:243], a[216:219], a[48:51], v[240:243]
    ds_read_b128 a[248:251], v5 offset:30720
    ds_read_b128 a[252:255], v5 offset:31744
    v_add_f32 v155, 1.0, v155
    v_mul_f32 v217, v153, v217
    v_mfma_f32_16x16x32_bf16 v[244:247], a[216:219], a[52:55], v[244:247]
    buffer_load_dwordx4 a[4:7], v1, s[12:15], s89 offen offset:1024 sc1
    v_mfma_f32_16x16x32_bf16 v[248:251], a[220:223], a[48:51], v[248:251]
    v_rcp_f32 v155, v155
    v_mfma_f32_16x16x32_bf16 v[252:255], a[220:223], a[52:55], v[252:255]
    v_mul_f32 v218, v154, v218
    v_mul_f32 v219, v155, v219
    s_waitcnt lgkmcnt(4)
    v_mfma_f32_16x16x32_bf16 v[160:163], a[224:227], a[56:59], v[160:163]
    ds_read_b128 a[192:195], v6 offset:16384
    ds_read_b128 a[196:199], v6 offset:17408
    v_cvt_pk_bf16_f32 v128, v192, v200
    v_cvt_pk_bf16_f32 v129, v208, v216
    v_mfma_f32_16x16x32_bf16 v[164:167], a[224:227], a[60:63], v[164:167]
    buffer_load_dwordx4 a[8:11], v1, s[12:15], s89 offen offset:2048 sc1
    v_mfma_f32_16x16x32_bf16 v[168:171], a[228:231], a[56:59], v[168:171]
    v_cvt_pk_bf16_f32 v130, v193, v201
    v_cvt_pk_bf16_f32 v131, v209, v217
    v_mfma_f32_16x16x32_bf16 v[172:175], a[228:231], a[60:63], v[172:175]
    buffer_store_dwordx4 v[128:131], v1, s[12:15], s96 offen offset:0
    v_mfma_f32_16x16x32_bf16 v[176:179], a[232:235], a[56:59], v[176:179]
    ds_read_b128 a[200:203], v6 offset:18432
    ds_read_b128 a[204:207], v6 offset:19456
    v_cvt_pk_bf16_f32 v136, v194, v202
    v_cvt_pk_bf16_f32 v137, v210, v218
    v_mfma_f32_16x16x32_bf16 v[180:183], a[232:235], a[60:63], v[180:183]
    buffer_load_dwordx4 a[12:15], v1, s[12:15], s89 offen offset:3072 sc1
    v_mfma_f32_16x16x32_bf16 v[184:187], a[236:239], a[56:59], v[184:187]
    v_cvt_pk_bf16_f32 v138, v195, v203
    v_cvt_pk_bf16_f32 v139, v211, v219
    v_mfma_f32_16x16x32_bf16 v[188:191], a[236:239], a[60:63], v[188:191]
    buffer_store_dwordx4 v[136:139], v1, s[12:15], s96 offen offset:1024
    s_waitcnt lgkmcnt(4)
    v_mfma_f32_16x16x32_bf16 v[224:227], a[240:243], a[56:59], v[224:227]
    ds_read_b128 a[208:211], v6 offset:20480
    ds_read_b128 a[212:215], v6 offset:21504
    v_mul_f32 v196, v132, v196
    v_mul_f32 v132, s98, v132
    v_mfma_f32_16x16x32_bf16 v[228:231], a[240:243], a[60:63], v[228:231]
    s_add_u32 s89, s86, 135168
    buffer_load_dwordx4 a[16:19], v1, s[12:15], s89 offen offset:0 sc1
    v_mfma_f32_16x16x32_bf16 v[232:235], a[244:247], a[56:59], v[232:235]
    v_exp_f32 v132, v132
    v_mfma_f32_16x16x32_bf16 v[236:239], a[244:247], a[60:63], v[236:239]
    v_mul_f32 v197, v133, v197
    v_mul_f32 v133, s98, v133
    v_mfma_f32_16x16x32_bf16 v[240:243], a[248:251], a[56:59], v[240:243]
    ds_read_b128 a[216:219], v6 offset:22528
    ds_read_b128 a[220:223], v6 offset:23552
    v_exp_f32 v133, v133
    v_mfma_f32_16x16x32_bf16 v[244:247], a[248:251], a[60:63], v[244:247]
    buffer_load_dwordx4 a[20:23], v1, s[12:15], s89 offen offset:1024 sc1
    v_mfma_f32_16x16x32_bf16 v[248:251], a[252:255], a[56:59], v[248:251]
    v_mul_f32 v198, v134, v198
    v_mul_f32 v134, s98, v134
    v_mfma_f32_16x16x32_bf16 v[252:255], a[252:255], a[60:63], v[252:255]
    v_xor_b32 v5, 0x8000, v5
    v_add_f32 v132, 1.0, v132
    s_waitcnt lgkmcnt(4)
    v_mfma_f32_16x16x32_bf16 v[160:163], a[192:195], a[64:67], v[160:163]
    ds_read_b128 a[224:227], v6 offset:24576
    ds_read_b128 a[228:231], v6 offset:25600
    v_exp_f32 v134, v134
    v_mfma_f32_16x16x32_bf16 v[164:167], a[192:195], a[68:71], v[164:167]
    buffer_load_dwordx4 a[24:27], v1, s[12:15], s89 offen offset:2048 sc1
    v_mfma_f32_16x16x32_bf16 v[168:171], a[196:199], a[64:67], v[168:171]
    v_mul_f32 v199, v135, v199
    v_mul_f32 v135, s98, v135
    v_mfma_f32_16x16x32_bf16 v[172:175], a[196:199], a[68:71], v[172:175]
    v_rcp_f32 v132, v132
    v_mfma_f32_16x16x32_bf16 v[176:179], a[200:203], a[64:67], v[176:179]
    ds_read_b128 a[232:235], v6 offset:26624
    ds_read_b128 a[236:239], v6 offset:27648
    v_add_f32 v133, 1.0, v133
    v_mfma_f32_16x16x32_bf16 v[180:183], a[200:203], a[68:71], v[180:183]
    buffer_load_dwordx4 a[28:31], v1, s[12:15], s89 offen offset:3072 sc1
    v_mfma_f32_16x16x32_bf16 v[184:187], a[204:207], a[64:67], v[184:187]
    v_exp_f32 v135, v135
    v_mfma_f32_16x16x32_bf16 v[188:191], a[204:207], a[68:71], v[188:191]
    v_mul_f32 v204, v140, v204
    v_mul_f32 v140, s98, v140
    s_waitcnt lgkmcnt(4)
    v_mfma_f32_16x16x32_bf16 v[224:227], a[208:211], a[64:67], v[224:227]
    ds_read_b128 a[240:243], v6 offset:28672
    ds_read_b128 a[244:247], v6 offset:29696
    v_rcp_f32 v133, v133
    v_mfma_f32_16x16x32_bf16 v[228:231], a[208:211], a[68:71], v[228:231]
    v_add_f32 v134, 1.0, v134
    v_mul_f32 v196, v132, v196
    v_mfma_f32_16x16x32_bf16 v[232:235], a[212:215], a[64:67], v[232:235]
    v_exp_f32 v140, v140
    v_mfma_f32_16x16x32_bf16 v[236:239], a[212:215], a[68:71], v[236:239]
    v_mul_f32 v205, v141, v205
    v_mul_f32 v141, s98, v141
    v_mfma_f32_16x16x32_bf16 v[240:243], a[216:219], a[64:67], v[240:243]
    ds_read_b128 a[248:251], v6 offset:30720
    ds_read_b128 a[252:255], v6 offset:31744
    v_rcp_f32 v134, v134
    v_mfma_f32_16x16x32_bf16 v[244:247], a[216:219], a[68:71], v[244:247]
    v_add_f32 v135, 1.0, v135
    v_mul_f32 v197, v133, v197
    v_mfma_f32_16x16x32_bf16 v[248:251], a[220:223], a[64:67], v[248:251]
    v_exp_f32 v141, v141
    v_mfma_f32_16x16x32_bf16 v[252:255], a[220:223], a[68:71], v[252:255]
    v_mul_f32 v206, v142, v206
    s_waitcnt vmcnt(28) lgkmcnt(4)
    s_barrier
    v_mfma_f32_16x16x32_bf16 v[160:163], a[224:227], a[72:75], v[160:163]
    ds_read_b128 a[192:195], v5 offset:0
    ds_read_b128 a[196:199], v5 offset:1024
    v_mul_f32 v142, s98, v142
    v_mfma_f32_16x16x32_bf16 v[164:167], a[224:227], a[76:79], v[164:167]
    v_rcp_f32 v135, v135
    v_mfma_f32_16x16x32_bf16 v[168:171], a[228:231], a[72:75], v[168:171]
    v_add_f32 v140, 1.0, v140
    v_mul_f32 v198, v134, v198
    v_mfma_f32_16x16x32_bf16 v[172:175], a[228:231], a[76:79], v[172:175]
    v_exp_f32 v142, v142
    v_mfma_f32_16x16x32_bf16 v[176:179], a[232:235], a[72:75], v[176:179]
    ds_read_b128 a[200:203], v5 offset:2048
    ds_read_b128 a[204:207], v5 offset:3072
    v_mul_f32 v207, v143, v207
    v_mul_f32 v143, s98, v143
    v_mfma_f32_16x16x32_bf16 v[180:183], a[232:235], a[76:79], v[180:183]
    v_rcp_f32 v140, v140
    v_mfma_f32_16x16x32_bf16 v[184:187], a[236:239], a[72:75], v[184:187]
    v_add_f32 v141, 1.0, v141
    v_mul_f32 v199, v135, v199
    v_mfma_f32_16x16x32_bf16 v[188:191], a[236:239], a[76:79], v[188:191]
    v_xor_b32 v6, 0x8000, v6
    s_waitcnt lgkmcnt(4)
    v_mfma_f32_16x16x32_bf16 v[224:227], a[240:243], a[72:75], v[224:227]
    ds_read_b128 a[208:211], v5 offset:4096
    ds_read_b128 a[212:215], v5 offset:5120
    v_exp_f32 v143, v143
    v_mfma_f32_16x16x32_bf16 v[228:231], a[240:243], a[76:79], v[228:231]
    v_mul_f32 v212, v148, v212
    v_mul_f32 v148, s98, v148
    v_mfma_f32_16x16x32_bf16 v[232:235], a[244:247], a[72:75], v[232:235]
    v_rcp_f32 v141, v141
    v_mfma_f32_16x16x32_bf16 v[236:239], a[244:247], a[76:79], v[236:239]
    v_add_f32 v142, 1.0, v142
    v_mul_f32 v204, v140, v204
    v_mfma_f32_16x16x32_bf16 v[240:243], a[248:251], a[72:75], v[240:243]
    ds_read_b128 a[216:219], v5 offset:6144
    ds_read_b128 a[220:223], v5 offset:7168
    v_exp_f32 v148, v148
    v_mfma_f32_16x16x32_bf16 v[244:247], a[248:251], a[76:79], v[244:247]
    v_mul_f32 v213, v149, v213
    v_mul_f32 v149, s98, v149
    v_mfma_f32_16x16x32_bf16 v[248:251], a[252:255], a[72:75], v[248:251]
    v_rcp_f32 v142, v142
    v_mfma_f32_16x16x32_bf16 v[252:255], a[252:255], a[76:79], v[252:255]
    s_waitcnt lgkmcnt(4)
    v_mfma_f32_16x16x32_bf16 v[160:163], a[192:195], a[80:83], v[160:163]
    ds_read_b128 a[224:227], v5 offset:8192
    ds_read_b128 a[228:231], v5 offset:9216
    v_mfma_f32_16x16x32_bf16 v[164:167], a[192:195], a[84:87], v[164:167]
    v_add_f32 v143, 1.0, v143
    v_mul_f32 v205, v141, v205
    v_mfma_f32_16x16x32_bf16 v[168:171], a[196:199], a[80:83], v[168:171]
    v_exp_f32 v149, v149
    v_mfma_f32_16x16x32_bf16 v[172:175], a[196:199], a[84:87], v[172:175]
    v_mul_f32 v214, v150, v214
    v_mul_f32 v150, s98, v150
    v_mfma_f32_16x16x32_bf16 v[176:179], a[200:203], a[80:83], v[176:179]
    ds_read_b128 a[232:235], v5 offset:10240
    ds_read_b128 a[236:239], v5 offset:11264
    v_rcp_f32 v143, v143
    v_mfma_f32_16x16x32_bf16 v[180:183], a[200:203], a[84:87], v[180:183]
    v_add_f32 v148, 1.0, v148
    v_mul_f32 v206, v142, v206
    v_mfma_f32_16x16x32_bf16 v[184:187], a[204:207], a[80:83], v[184:187]
    v_exp_f32 v150, v150
    v_mfma_f32_16x16x32_bf16 v[188:191], a[204:207], a[84:87], v[188:191]
    v_mul_f32 v215, v151, v215
    v_mul_f32 v151, s98, v151
    s_waitcnt lgkmcnt(4)
    v_mfma_f32_16x16x32_bf16 v[224:227], a[208:211], a[80:83], v[224:227]
    ds_read_b128 a[240:243], v5 offset:12288
    ds_read_b128 a[244:247], v5 offset:13312
    v_mfma_f32_16x16x32_bf16 v[228:231], a[208:211], a[84:87], v[228:231]
    v_rcp_f32 v148, v148
    v_mfma_f32_16x16x32_bf16 v[232:235], a[212:215], a[80:83], v[232:235]
    v_add_f32 v149, 1.0, v149
    v_mul_f32 v207, v143, v207
    v_mfma_f32_16x16x32_bf16 v[236:239], a[212:215], a[84:87], v[236:239]
    v_exp_f32 v151, v151
    v_mfma_f32_16x16x32_bf16 v[240:243], a[216:219], a[80:83], v[240:243]
    ds_read_b128 a[248:251], v5 offset:14336
    ds_read_b128 a[252:255], v5 offset:15360
    v_mul_f32 v220, v156, v220
    v_mul_f32 v156, s98, v156
    v_mfma_f32_16x16x32_bf16 v[244:247], a[216:219], a[84:87], v[244:247]
    v_rcp_f32 v149, v149
    v_mfma_f32_16x16x32_bf16 v[248:251], a[220:223], a[80:83], v[248:251]
    v_add_f32 v150, 1.0, v150
    v_mul_f32 v212, v148, v212
    v_mfma_f32_16x16x32_bf16 v[252:255], a[220:223], a[84:87], v[252:255]
    v_exp_f32 v156, v156
    s_waitcnt lgkmcnt(4)
    v_mfma_f32_16x16x32_bf16 v[160:163], a[224:227], a[88:91], v[160:163]
    ds_read_b128 a[192:195], v6 offset:0
    ds_read_b128 a[196:199], v6 offset:1024
    v_mfma_f32_16x16x32_bf16 v[164:167], a[224:227], a[92:95], v[164:167]
    v_mul_f32 v221, v157, v221
    v_mul_f32 v157, s98, v157
    v_mfma_f32_16x16x32_bf16 v[168:171], a[228:231], a[88:91], v[168:171]
    v_rcp_f32 v150, v150
    v_mfma_f32_16x16x32_bf16 v[172:175], a[228:231], a[92:95], v[172:175]
    v_add_f32 v151, 1.0, v151
    v_mul_f32 v213, v149, v213
    v_mfma_f32_16x16x32_bf16 v[176:179], a[232:235], a[88:91], v[176:179]
    ds_read_b128 a[200:203], v6 offset:2048
    ds_read_b128 a[204:207], v6 offset:3072
    v_exp_f32 v157, v157
    v_mfma_f32_16x16x32_bf16 v[180:183], a[232:235], a[92:95], v[180:183]
    v_mul_f32 v222, v158, v222
    v_mul_f32 v158, s98, v158
    v_mfma_f32_16x16x32_bf16 v[184:187], a[236:239], a[88:91], v[184:187]
    v_rcp_f32 v151, v151
    v_mfma_f32_16x16x32_bf16 v[188:191], a[236:239], a[92:95], v[188:191]
    v_add_f32 v156, 1.0, v156
    v_mul_f32 v214, v150, v214
    s_waitcnt lgkmcnt(4)
    v_mfma_f32_16x16x32_bf16 v[224:227], a[240:243], a[88:91], v[224:227]
    ds_read_b128 a[208:211], v6 offset:4096
    ds_read_b128 a[212:215], v6 offset:5120
    v_mfma_f32_16x16x32_bf16 v[228:231], a[240:243], a[92:95], v[228:231]
    v_exp_f32 v158, v158
    v_mfma_f32_16x16x32_bf16 v[232:235], a[244:247], a[88:91], v[232:235]
    v_mul_f32 v223, v159, v223
    v_mul_f32 v159, s98, v159
    v_mfma_f32_16x16x32_bf16 v[236:239], a[244:247], a[92:95], v[236:239]
    v_rcp_f32 v156, v156
    v_mfma_f32_16x16x32_bf16 v[240:243], a[248:251], a[88:91], v[240:243]
    ds_read_b128 a[216:219], v6 offset:6144
    ds_read_b128 a[220:223], v6 offset:7168
    v_add_f32 v157, 1.0, v157
    v_mul_f32 v215, v151, v215
    v_mfma_f32_16x16x32_bf16 v[244:247], a[248:251], a[92:95], v[244:247]
    v_exp_f32 v159, v159
    v_mfma_f32_16x16x32_bf16 v[248:251], a[252:255], a[88:91], v[248:251]
    v_rcp_f32 v157, v157
    v_mfma_f32_16x16x32_bf16 v[252:255], a[252:255], a[92:95], v[252:255]
    v_add_f32 v158, 1.0, v158
    v_mul_f32 v220, v156, v220
    s_waitcnt lgkmcnt(4)
    v_mfma_f32_16x16x32_bf16 v[160:163], a[192:195], a[96:99], v[160:163]
    ds_read_b128 a[224:227], v6 offset:8192
    ds_read_b128 a[228:231], v6 offset:9216
    v_mfma_f32_16x16x32_bf16 v[164:167], a[192:195], a[100:103], v[164:167]
    v_rcp_f32 v158, v158
    v_mfma_f32_16x16x32_bf16 v[168:171], a[196:199], a[96:99], v[168:171]
    v_add_f32 v159, 1.0, v159
    v_mul_f32 v221, v157, v221
    v_mfma_f32_16x16x32_bf16 v[172:175], a[196:199], a[100:103], v[172:175]
    v_rcp_f32 v159, v159
    v_mfma_f32_16x16x32_bf16 v[176:179], a[200:203], a[96:99], v[176:179]
    ds_read_b128 a[232:235], v6 offset:10240
    ds_read_b128 a[236:239], v6 offset:11264
    v_mul_f32 v222, v158, v222
    v_mul_f32 v223, v159, v223
    v_mfma_f32_16x16x32_bf16 v[180:183], a[200:203], a[100:103], v[180:183]
    v_cvt_pk_bf16_f32 v132, v196, v204
    v_cvt_pk_bf16_f32 v133, v212, v220
    v_mfma_f32_16x16x32_bf16 v[184:187], a[204:207], a[96:99], v[184:187]
    v_cvt_pk_bf16_f32 v134, v197, v205
    v_cvt_pk_bf16_f32 v135, v213, v221
    v_mfma_f32_16x16x32_bf16 v[188:191], a[204:207], a[100:103], v[188:191]
    buffer_store_dwordx4 v[132:135], v11, s[12:15], s96 offen offset:0
    s_waitcnt lgkmcnt(4)
    v_mfma_f32_16x16x32_bf16 v[224:227], a[208:211], a[96:99], v[224:227]
    ds_read_b128 a[240:243], v6 offset:12288
    ds_read_b128 a[244:247], v6 offset:13312
    v_mfma_f32_16x16x32_bf16 v[228:231], a[208:211], a[100:103], v[228:231]
    v_cvt_pk_bf16_f32 v140, v198, v206
    v_cvt_pk_bf16_f32 v141, v214, v222
    v_mfma_f32_16x16x32_bf16 v[232:235], a[212:215], a[96:99], v[232:235]
    v_cvt_pk_bf16_f32 v142, v199, v207
    v_cvt_pk_bf16_f32 v143, v215, v223
    v_mfma_f32_16x16x32_bf16 v[236:239], a[212:215], a[100:103], v[236:239]
    buffer_store_dwordx4 v[140:143], v11, s[12:15], s96 offen offset:1024
    v_mfma_f32_16x16x32_bf16 v[240:243], a[216:219], a[96:99], v[240:243]
    ds_read_b128 a[248:251], v6 offset:14336
    ds_read_b128 a[252:255], v6 offset:15360
    v_mfma_f32_16x16x32_bf16 v[244:247], a[216:219], a[100:103], v[244:247]
    v_mfma_f32_16x16x32_bf16 v[248:251], a[220:223], a[96:99], v[248:251]
    v_mfma_f32_16x16x32_bf16 v[252:255], a[220:223], a[100:103], v[252:255]
    s_waitcnt vmcnt(0) lgkmcnt(4)
    s_barrier
    v_mfma_f32_16x16x32_bf16 v[160:163], a[224:227], a[104:107], v[160:163]
    s_cmp_eq_u32 s92, 1
    s_cbranch_scc0 GU_wb
GU_wbback:
    v_mfma_f32_16x16x32_bf16 v[164:167], a[224:227], a[108:111], v[164:167]
    buffer_store_dword v14, v30, s[12:15], s93 offen offset:28
    v_mfma_f32_16x16x32_bf16 v[168:171], a[228:231], a[104:107], v[168:171]
    buffer_store_dword v14, v29, s[12:15], s93 offen offset:28 sc1
    v_mfma_f32_16x16x32_bf16 v[172:175], a[228:231], a[108:111], v[172:175]
    v_mfma_f32_16x16x32_bf16 v[176:179], a[232:235], a[104:107], v[176:179]
    v_mfma_f32_16x16x32_bf16 v[180:183], a[232:235], a[108:111], v[180:183]
    s_add_u32 s89, s86, 139264
    buffer_load_dwordx4 a[32:35], v1, s[12:15], s89 offen offset:0 sc1
    v_mfma_f32_16x16x32_bf16 v[184:187], a[236:239], a[104:107], v[184:187]
    v_mfma_f32_16x16x32_bf16 v[188:191], a[236:239], a[108:111], v[188:191]
    s_waitcnt lgkmcnt(0)
    v_mfma_f32_16x16x32_bf16 v[224:227], a[240:243], a[104:107], v[224:227]
    v_mfma_f32_16x16x32_bf16 v[228:231], a[240:243], a[108:111], v[228:231]
    buffer_load_dwordx4 a[36:39], v1, s[12:15], s89 offen offset:1024 sc1
    v_mfma_f32_16x16x32_bf16 v[232:235], a[244:247], a[104:107], v[232:235]
    v_mfma_f32_16x16x32_bf16 v[236:239], a[244:247], a[108:111], v[236:239]
    v_mfma_f32_16x16x32_bf16 v[240:243], a[248:251], a[104:107], v[240:243]
    v_mfma_f32_16x16x32_bf16 v[244:247], a[248:251], a[108:111], v[244:247]
    buffer_load_dwordx4 a[40:43], v1, s[12:15], s89 offen offset:2048 sc1
    v_mfma_f32_16x16x32_bf16 v[248:251], a[252:255], a[104:107], v[248:251]
    v_mfma_f32_16x16x32_bf16 v[252:255], a[252:255], a[108:111], v[252:255]
    buffer_load_dwordx4 a[44:47], v1, s[12:15], s89 offen offset:3072 sc1
    s_nop 7
    v_min_u32 v12, 13, v2
    v_mul_u32_u24 v12, 6144, v12
    v_pk_mul_f32 v[224:225], v[160:161], v[224:225]
    v_pk_mul_f32 v[226:227], v[162:163], v[226:227]
    v_pk_mul_f32 v[232:233], v[168:169], v[232:233]
    v_pk_mul_f32 v[234:235], v[170:171], v[234:235]
    v_pk_mul_f32 v[240:241], v[176:177], v[240:241]
    v_pk_mul_f32 v[242:243], v[178:179], v[242:243]
    v_pk_mul_f32 v[248:249], v[184:185], v[248:249]
    v_pk_mul_f32 v[250:251], v[186:187], v[250:251]
    v_pk_mul_f32 v[160:161], v[160:161], s[98:99] op_sel_hi:[1,0]
    v_pk_mul_f32 v[162:163], v[162:163], s[98:99] op_sel_hi:[1,0]
    v_pk_mul_f32 v[168:169], v[168:169], s[98:99] op_sel_hi:[1,0]
    v_pk_mul_f32 v[170:171], v[170:171], s[98:99] op_sel_hi:[1,0]
    v_pk_mul_f32 v[176:177], v[176:177], s[98:99] op_sel_hi:[1,0]
    v_pk_mul_f32 v[178:179], v[178:179], s[98:99] op_sel_hi:[1,0]
    v_pk_mul_f32 v[184:185], v[184:185], s[98:99] op_sel_hi:[1,0]
    v_pk_mul_f32 v[186:187], v[186:187], s[98:99] op_sel_hi:[1,0]
    v_exp_f32 v160, v160
    v_exp_f32 v161, v161
    v_exp_f32 v162, v162
    v_exp_f32 v163, v163
    v_exp_f32 v168, v168
    v_exp_f32 v169, v169
    v_exp_f32 v170, v170
    v_exp_f32 v171, v171
    buffer_load_dword v13, v12, s[12:15], s94 offen offset:28 sc1
    v_exp_f32 v176, v176
    v_exp_f32 v177, v177
    v_exp_f32 v178, v178
    v_exp_f32 v179, v179
    v_exp_f32 v184, v184
    v_exp_f32 v185, v185
    v_exp_f32 v186, v186
    v_exp_f32 v187, v187
    v_pk_add_f32 v[160:161], v[160:161], 1.0 op_sel_hi:[1,0]
    v_pk_add_f32 v[162:163], v[162:163], 1.0 op_sel_hi:[1,0]
    v_pk_add_f32 v[168:169], v[168:169], 1.0 op_sel_hi:[1,0]
    v_pk_add_f32 v[170:171], v[170:171], 1.0 op_sel_hi:[1,0]
    v_pk_add_f32 v[176:177], v[176:177], 1.0 op_sel_hi:[1,0]
    v_pk_add_f32 v[178:179], v[178:179], 1.0 op_sel_hi:[1,0]
    v_pk_add_f32 v[184:185], v[184:185], 1.0 op_sel_hi:[1,0]
    v_pk_add_f32 v[186:187], v[186:187], 1.0 op_sel_hi:[1,0]
    v_rcp_f32 v160, v160
    v_rcp_f32 v161, v161
    v_rcp_f32 v162, v162
    v_rcp_f32 v163, v163
    v_rcp_f32 v168, v168
    v_rcp_f32 v169, v169
    v_rcp_f32 v170, v170
    v_rcp_f32 v171, v171
    v_rcp_f32 v176, v176
    v_rcp_f32 v177, v177
    v_rcp_f32 v178, v178
    v_rcp_f32 v179, v179
    v_rcp_f32 v184, v184
    v_rcp_f32 v185, v185
    v_rcp_f32 v186, v186
    v_rcp_f32 v187, v187
    v_pk_mul_f32 v[224:225], v[160:161], v[224:225]
    v_pk_mul_f32 v[226:227], v[162:163], v[226:227]
    v_pk_mul_f32 v[232:233], v[168:169], v[232:233]
    v_pk_mul_f32 v[234:235], v[170:171], v[234:235]
    v_pk_mul_f32 v[240:241], v[176:177], v[240:241]
    v_pk_mul_f32 v[242:243], v[178:179], v[242:243]
    v_pk_mul_f32 v[248:249], v[184:185], v[248:249]
    v_pk_mul_f32 v[250:251], v[186:187], v[250:251]
    v_cvt_pk_bf16_f32 v160, v224, v232
    v_cvt_pk_bf16_f32 v161, v240, v248
    v_cvt_pk_bf16_f32 v162, v225, v233
    v_cvt_pk_bf16_f32 v163, v241, v249
    buffer_store_dwordx4 v[160:163], v1, s[12:15], s97 offen offset:0
    v_cvt_pk_bf16_f32 v168, v226, v234
    v_cvt_pk_bf16_f32 v169, v242, v250
    v_cvt_pk_bf16_f32 v170, v227, v235
    v_cvt_pk_bf16_f32 v171, v243, v251
    buffer_store_dwordx4 v[168:171], v1, s[12:15], s97 offen offset:1024
    s_waitcnt vmcnt(2)
    v_cmp_ne_u32 vcc, 1, v13
    s_cmp_eq_u32 s92, 1
    s_cbranch_scc0 P4a0_slow
    s_cbranch_vccnz P4a0_slow
P4a0_back:
    s_add_u32 s91, s90, 0
    v_pk_mul_f32 v[228:229], v[164:165], v[228:229]
    v_pk_mul_f32 v[230:231], v[166:167], v[230:231]
    v_pk_mul_f32 v[236:237], v[172:173], v[236:237]
    v_pk_mul_f32 v[238:239], v[174:175], v[238:239]
    v_pk_mul_f32 v[244:245], v[180:181], v[244:245]
    v_pk_mul_f32 v[246:247], v[182:183], v[246:247]
    v_pk_mul_f32 v[252:253], v[188:189], v[252:253]
    v_pk_mul_f32 v[254:255], v[190:191], v[254:255]
    v_pk_mul_f32 v[164:165], v[164:165], s[98:99] op_sel_hi:[1,0]
    v_pk_mul_f32 v[166:167], v[166:167], s[98:99] op_sel_hi:[1,0]
    buffer_load_dwordx4 a[48:51], v24, s[12:15], s91 offen offset:0 sc1
    v_pk_mul_f32 v[172:173], v[172:173], s[98:99] op_sel_hi:[1,0]
    v_pk_mul_f32 v[174:175], v[174:175], s[98:99] op_sel_hi:[1,0]
    v_pk_mul_f32 v[180:181], v[180:181], s[98:99] op_sel_hi:[1,0]
    v_pk_mul_f32 v[182:183], v[182:183], s[98:99] op_sel_hi:[1,0]
    v_pk_mul_f32 v[188:189], v[188:189], s[98:99] op_sel_hi:[1,0]
    v_pk_mul_f32 v[190:191], v[190:191], s[98:99] op_sel_hi:[1,0]
    v_exp_f32 v164, v164
    v_exp_f32 v165, v165
    v_exp_f32 v166, v166
    v_exp_f32 v167, v167
    buffer_load_dwordx4 a[52:55], v25, s[12:15], s91 offen offset:0 sc1
    v_exp_f32 v172, v172
    v_exp_f32 v173, v173
    v_exp_f32 v174, v174
    v_exp_f32 v175, v175
    v_exp_f32 v180, v180
    v_exp_f32 v181, v181
    v_exp_f32 v182, v182
    v_exp_f32 v183, v183
    v_exp_f32 v188, v188
    v_exp_f32 v189, v189
    buffer_load_dwordx4 a[56:59], v26, s[12:15], s91 offen offset:0 sc1
    v_exp_f32 v190, v190
    v_exp_f32 v191, v191
    v_pk_add_f32 v[164:165], v[164:165], 1.0 op_sel_hi:[1,0]
    v_pk_add_f32 v[166:167], v[166:167], 1.0 op_sel_hi:[1,0]
    v_pk_add_f32 v[172:173], v[172:173], 1.0 op_sel_hi:[1,0]
    v_pk_add_f32 v[174:175], v[174:175], 1.0 op_sel_hi:[1,0]
    v_pk_add_f32 v[180:181], v[180:181], 1.0 op_sel_hi:[1,0]
    v_pk_add_f32 v[182:183], v[182:183], 1.0 op_sel_hi:[1,0]
    v_pk_add_f32 v[188:189], v[188:189], 1.0 op_sel_hi:[1,0]
    v_pk_add_f32 v[190:191], v[190:191], 1.0 op_sel_hi:[1,0]
    buffer_load_dwordx4 a[60:63], v27, s[12:15], s91 offen offset:0 sc1
    v_rcp_f32 v164, v164
    v_rcp_f32 v165, v165
    v_rcp_f32 v166, v166
    v_rcp_f32 v167, v167
    v_rcp_f32 v172, v172
    v_rcp_f32 v173, v173
    v_rcp_f32 v174, v174
    v_rcp_f32 v175, v175
    v_rcp_f32 v180, v180
    v_rcp_f32 v181, v181
    buffer_load_dwordx4 a[64:67], v24, s[12:15], s91 offen offset:1024 sc1
    v_rcp_f32 v182, v182
    v_rcp_f32 v183, v183
    v_rcp_f32 v188, v188
    v_rcp_f32 v189, v189
    v_rcp_f32 v190, v190
    v_rcp_f32 v191, v191
    v_pk_mul_f32 v[228:229], v[164:165], v[228:229]
    v_pk_mul_f32 v[230:231], v[166:167], v[230:231]
    v_pk_mul_f32 v[236:237], v[172:173], v[236:237]
    v_pk_mul_f32 v[238:239], v[174:175], v[238:239]
    v_pk_mul_f32 v[244:245], v[180:181], v[244:245]
    v_pk_mul_f32 v[246:247], v[182:183], v[246:247]
    v_pk_mul_f32 v[252:253], v[188:189], v[252:253]
    v_pk_mul_f32 v[254:255], v[190:191], v[254:255]
    v_cvt_pk_bf16_f32 v164, v228, v236
    v_cvt_pk_bf16_f32 v165, v244, v252
    v_cvt_pk_bf16_f32 v166, v229, v237
    v_cvt_pk_bf16_f32 v167, v245, v253
    buffer_store_dwordx4 v[164:167], v11, s[12:15], s97 offen offset:0
    v_cvt_pk_bf16_f32 v172, v230, v238
    v_cvt_pk_bf16_f32 v173, v246, v254
    v_cvt_pk_bf16_f32 v174, v231, v239
    v_cvt_pk_bf16_f32 v175, v247, v255
    buffer_store_dwordx4 v[172:175], v11, s[12:15], s97 offen offset:1024
    buffer_load_dwordx4 a[68:71], v25, s[12:15], s91 offen offset:1024 sc1
    buffer_load_dwordx4 a[72:75], v26, s[12:15], s91 offen offset:1024 sc1
    buffer_load_dwordx4 a[76:79], v27, s[12:15], s91 offen offset:1024 sc1
    buffer_load_dwordx4 a[80:83], v24, s[12:15], s91 offen offset:2048 sc1
    buffer_load_dwordx4 a[84:87], v25, s[12:15], s91 offen offset:2048 sc1
    buffer_load_dwordx4 a[88:91], v26, s[12:15], s91 offen offset:2048 sc1
    buffer_load_dwordx4 a[92:95], v27, s[12:15], s91 offen offset:2048 sc1
    buffer_load_dwordx4 a[96:99], v24, s[12:15], s91 offen offset:3072 sc1
    buffer_load_dwordx4 a[100:103], v25, s[12:15], s91 offen offset:3072 sc1
    buffer_load_dwordx4 a[104:107], v26, s[12:15], s91 offen offset:3072 sc1
    buffer_load_dwordx4 a[108:111], v27, s[12:15], s91 offen offset:3072 sc1
    s_cmp_eq_u32 s92, 1
    s_waitcnt vmcnt(11)
    s_barrier
    s_cbranch_scc0 P4_wb
P4_wbback:
    buffer_store_dword v14, v30, s[12:15], s93 offen offset:24
    buffer_store_dword v14, v29, s[12:15], s93 offen offset:24 sc1
    s_add_u32 s91, s90, 4096
    s_waitcnt vmcnt(16)
    v_mfma_f32_16x16x32_bf16 v[192:195], a[112:115], a[48:51], 0
    buffer_load_dwordx4 a[192:195], v24, s[12:15], s91 offen offset:0 sc1
    v_mfma_f32_16x16x32_bf16 v[208:211], a[112:115], a[52:55], 0
    v_mfma_f32_16x16x32_bf16 v[224:227], a[112:115], a[56:59], 0
    v_mfma_f32_16x16x32_bf16 v[240:243], a[112:115], a[60:63], 0
    v_mfma_f32_16x16x32_bf16 v[196:199], a[116:119], a[48:51], 0
    buffer_load_dwordx4 a[196:199], v25, s[12:15], s91 offen offset:0 sc1
    v_mfma_f32_16x16x32_bf16 v[212:215], a[116:119], a[52:55], 0
    v_mfma_f32_16x16x32_bf16 v[228:231], a[116:119], a[56:59], 0
    v_mfma_f32_16x16x32_bf16 v[244:247], a[116:119], a[60:63], 0
    v_mfma_f32_16x16x32_bf16 v[200:203], a[120:123], a[48:51], 0
    buffer_load_dwordx4 a[200:203], v26, s[12:15], s91 offen offset:0 sc1
    v_mfma_f32_16x16x32_bf16 v[216:219], a[120:123], a[52:55], 0
    v_mfma_f32_16x16x32_bf16 v[232:235], a[120:123], a[56:59], 0
    v_mfma_f32_16x16x32_bf16 v[248:251], a[120:123], a[60:63], 0
    v_mfma_f32_16x16x32_bf16 v[204:207], a[124:127], a[48:51], 0
    buffer_load_dwordx4 a[204:207], v27, s[12:15], s91 offen offset:0 sc1
    v_mfma_f32_16x16x32_bf16 v[220:223], a[124:127], a[52:55], 0
    v_mfma_f32_16x16x32_bf16 v[236:239], a[124:127], a[56:59], 0
    v_mfma_f32_16x16x32_bf16 v[252:255], a[124:127], a[60:63], 0
    s_waitcnt vmcnt(14)
    v_mfma_f32_16x16x32_bf16 v[192:195], a[128:131], a[64:67], v[192:195]
    buffer_load_dwordx4 a[208:211], v24, s[12:15], s91 offen offset:1024 sc1
    v_mfma_f32_16x16x32_bf16 v[208:211], a[128:131], a[68:71], v[208:211]
    v_mfma_f32_16x16x32_bf16 v[224:227], a[128:131], a[72:75], v[224:227]
    v_mfma_f32_16x16x32_bf16 v[240:243], a[128:131], a[76:79], v[240:243]
    buffer_load_dword v13, v12, s[12:15], s94 offen offset:24 sc1
    v_mfma_f32_16x16x32_bf16 v[196:199], a[132:135], a[64:67], v[196:199]
    buffer_load_dwordx4 a[212:215], v25, s[12:15], s91 offen offset:1024 sc1
    v_mfma_f32_16x16x32_bf16 v[212:215], a[132:135], a[68:71], v[212:215]
    v_mfma_f32_16x16x32_bf16 v[228:231], a[132:135], a[72:75], v[228:231]
    v_mfma_f32_16x16x32_bf16 v[244:247], a[132:135], a[76:79], v[244:247]
    v_mfma_f32_16x16x32_bf16 v[200:203], a[136:139], a[64:67], v[200:203]
    buffer_load_dwordx4 a[216:219], v26, s[12:15], s91 offen offset:1024 sc1
    v_mfma_f32_16x16x32_bf16 v[216:219], a[136:139], a[68:71], v[216:219]
    v_mfma_f32_16x16x32_bf16 v[232:235], a[136:139], a[72:75], v[232:235]
    v_mfma_f32_16x16x32_bf16 v[248:251], a[136:139], a[76:79], v[248:251]
    v_mfma_f32_16x16x32_bf16 v[204:207], a[140:143], a[64:67], v[204:207]
    buffer_load_dwordx4 a[220:223], v27, s[12:15], s91 offen offset:1024 sc1
    v_mfma_f32_16x16x32_bf16 v[220:223], a[140:143], a[68:71], v[220:223]
    v_mfma_f32_16x16x32_bf16 v[236:239], a[140:143], a[72:75], v[236:239]
    v_mfma_f32_16x16x32_bf16 v[252:255], a[140:143], a[76:79], v[252:255]
    s_waitcnt vmcnt(15)
    v_mfma_f32_16x16x32_bf16 v[192:195], a[144:147], a[80:83], v[192:195]
    buffer_load_dwordx4 a[224:227], v24, s[12:15], s91 offen offset:2048 sc1
    v_mfma_f32_16x16x32_bf16 v[208:211], a[144:147], a[84:87], v[208:211]
    v_mfma_f32_16x16x32_bf16 v[224:227], a[144:147], a[88:91], v[224:227]
    v_mfma_f32_16x16x32_bf16 v[240:243], a[144:147], a[92:95], v[240:243]
    v_mfma_f32_16x16x32_bf16 v[196:199], a[148:151], a[80:83], v[196:199]
    buffer_load_dwordx4 a[228:231], v25, s[12:15], s91 offen offset:2048 sc1
    v_mfma_f32_16x16x32_bf16 v[212:215], a[148:151], a[84:87], v[212:215]
    v_mfma_f32_16x16x32_bf16 v[228:231], a[148:151], a[88:91], v[228:231]
    v_mfma_f32_16x16x32_bf16 v[244:247], a[148:151], a[92:95], v[244:247]
    v_mfma_f32_16x16x32_bf16 v[200:203], a[152:155], a[80:83], v[200:203]
    buffer_load_dwordx4 a[232:235], v26, s[12:15], s91 offen offset:2048 sc1
    v_mfma_f32_16x16x32_bf16 v[216:219], a[152:155], a[84:87], v[216:219]
    v_mfma_f32_16x16x32_bf16 v[232:235], a[152:155], a[88:91], v[232:235]
    v_mfma_f32_16x16x32_bf16 v[248:251], a[152:155], a[92:95], v[248:251]
    v_mfma_f32_16x16x32_bf16 v[204:207], a[156:159], a[80:83], v[204:207]
    buffer_load_dwordx4 a[236:239], v27, s[12:15], s91 offen offset:2048 sc1
    v_mfma_f32_16x16x32_bf16 v[220:223], a[156:159], a[84:87], v[220:223]
    v_mfma_f32_16x16x32_bf16 v[236:239], a[156:159], a[88:91], v[236:239]
    v_mfma_f32_16x16x32_bf16 v[252:255], a[156:159], a[92:95], v[252:255]
    s_add_u32 s91, s90, 4262400
    s_waitcnt vmcnt(7)
    v_cmp_ne_u32 vcc, 1, v13
    s_cmp_eq_u32 s92, 1
    s_cbranch_scc0 P4a1_slow
    s_cbranch_vccnz P4a1_slow
P4a1_back:
    s_waitcnt vmcnt(15)
    v_mfma_f32_16x16x32_bf16 v[192:195], a[160:163], a[96:99], v[192:195]
    buffer_load_dwordx4 v[128:131], v24, s[12:15], s91 offen offset:0 sc1
    v_mfma_f32_16x16x32_bf16 v[208:211], a[160:163], a[100:103], v[208:211]
    v_mfma_f32_16x16x32_bf16 v[224:227], a[160:163], a[104:107], v[224:227]
    v_mfma_f32_16x16x32_bf16 v[240:243], a[160:163], a[108:111], v[240:243]
    v_mfma_f32_16x16x32_bf16 v[196:199], a[164:167], a[96:99], v[196:199]
    buffer_load_dwordx4 v[132:135], v25, s[12:15], s91 offen offset:0 sc1
    v_mfma_f32_16x16x32_bf16 v[212:215], a[164:167], a[100:103], v[212:215]
    v_mfma_f32_16x16x32_bf16 v[228:231], a[164:167], a[104:107], v[228:231]
    v_mfma_f32_16x16x32_bf16 v[244:247], a[164:167], a[108:111], v[244:247]
    v_mfma_f32_16x16x32_bf16 v[200:203], a[168:171], a[96:99], v[200:203]
    buffer_load_dwordx4 v[136:139], v26, s[12:15], s91 offen offset:0 sc1
    v_mfma_f32_16x16x32_bf16 v[216:219], a[168:171], a[100:103], v[216:219]
    v_mfma_f32_16x16x32_bf16 v[232:235], a[168:171], a[104:107], v[232:235]
    v_mfma_f32_16x16x32_bf16 v[248:251], a[168:171], a[108:111], v[248:251]
    v_mfma_f32_16x16x32_bf16 v[204:207], a[172:175], a[96:99], v[204:207]
    buffer_load_dwordx4 v[140:143], v27, s[12:15], s91 offen offset:0 sc1
    v_mfma_f32_16x16x32_bf16 v[220:223], a[172:175], a[100:103], v[220:223]
    v_mfma_f32_16x16x32_bf16 v[236:239], a[172:175], a[104:107], v[236:239]
    v_mfma_f32_16x16x32_bf16 v[252:255], a[172:175], a[108:111], v[252:255]
    s_waitcnt vmcnt(13)
    v_mfma_f32_16x16x32_bf16 v[192:195], a[176:179], a[192:195], v[192:195]
    buffer_load_dwordx4 v[144:147], v24, s[12:15], s91 offen offset:1024 sc1
    v_mfma_f32_16x16x32_bf16 v[208:211], a[176:179], a[196:199], v[208:211]
    v_mfma_f32_16x16x32_bf16 v[224:227], a[176:179], a[200:203], v[224:227]
    v_mfma_f32_16x16x32_bf16 v[240:243], a[176:179], a[204:207], v[240:243]
    v_mfma_f32_16x16x32_bf16 v[196:199], a[180:183], a[192:195], v[196:199]
    buffer_load_dwordx4 v[148:151], v25, s[12:15], s91 offen offset:1024 sc1
    v_mfma_f32_16x16x32_bf16 v[212:215], a[180:183], a[196:199], v[212:215]
    v_mfma_f32_16x16x32_bf16 v[228:231], a[180:183], a[200:203], v[228:231]
    v_mfma_f32_16x16x32_bf16 v[244:247], a[180:183], a[204:207], v[244:247]
    v_mfma_f32_16x16x32_bf16 v[200:203], a[184:187], a[192:195], v[200:203]
    buffer_load_dwordx4 v[152:155], v26, s[12:15], s91 offen offset:1024 sc1
    v_mfma_f32_16x16x32_bf16 v[216:219], a[184:187], a[196:199], v[216:219]
    v_mfma_f32_16x16x32_bf16 v[232:235], a[184:187], a[200:203], v[232:235]
    v_mfma_f32_16x16x32_bf16 v[248:251], a[184:187], a[204:207], v[248:251]
    v_mfma_f32_16x16x32_bf16 v[204:207], a[188:191], a[192:195], v[204:207]
    buffer_load_dwordx4 v[156:159], v27, s[12:15], s91 offen offset:1024 sc1
    v_mfma_f32_16x16x32_bf16 v[220:223], a[188:191], a[196:199], v[220:223]
    v_mfma_f32_16x16x32_bf16 v[236:239], a[188:191], a[200:203], v[236:239]
    v_mfma_f32_16x16x32_bf16 v[252:255], a[188:191], a[204:207], v[252:255]
    s_waitcnt vmcnt(12)
    v_mfma_f32_16x16x32_bf16 v[192:195], v[32:35], a[208:211], v[192:195]
    buffer_load_dwordx4 v[160:163], v24, s[12:15], s91 offen offset:2048 sc1
    v_mfma_f32_16x16x32_bf16 v[208:211], v[32:35], a[212:215], v[208:211]
    v_mfma_f32_16x16x32_bf16 v[224:227], v[32:35], a[216:219], v[224:227]
    v_mfma_f32_16x16x32_bf16 v[240:243], v[32:35], a[220:223], v[240:243]
    v_mfma_f32_16x16x32_bf16 v[196:199], v[36:39], a[208:211], v[196:199]
    buffer_load_dwordx4 v[164:167], v25, s[12:15], s91 offen offset:2048 sc1
    v_mfma_f32_16x16x32_bf16 v[212:215], v[36:39], a[212:215], v[212:215]
    v_mfma_f32_16x16x32_bf16 v[228:231], v[36:39], a[216:219], v[228:231]
    v_mfma_f32_16x16x32_bf16 v[244:247], v[36:39], a[220:223], v[244:247]
    v_mfma_f32_16x16x32_bf16 v[200:203], v[40:43], a[208:211], v[200:203]
    buffer_load_dwordx4 v[168:171], v26, s[12:15], s91 offen offset:2048 sc1
    v_mfma_f32_16x16x32_bf16 v[216:219], v[40:43], a[212:215], v[216:219]
    v_mfma_f32_16x16x32_bf16 v[232:235], v[40:43], a[216:219], v[232:235]
    v_mfma_f32_16x16x32_bf16 v[248:251], v[40:43], a[220:223], v[248:251]
    v_mfma_f32_16x16x32_bf16 v[204:207], v[44:47], a[208:211], v[204:207]
    buffer_load_dwordx4 v[172:175], v27, s[12:15], s91 offen offset:2048 sc1
    v_mfma_f32_16x16x32_bf16 v[220:223], v[44:47], a[212:215], v[220:223]
    v_mfma_f32_16x16x32_bf16 v[236:239], v[44:47], a[216:219], v[236:239]
    v_mfma_f32_16x16x32_bf16 v[252:255], v[44:47], a[220:223], v[252:255]
    s_waitcnt vmcnt(12)
    v_mfma_f32_16x16x32_bf16 v[192:195], v[48:51], a[224:227], v[192:195]
    buffer_load_dwordx4 v[176:179], v24, s[12:15], s91 offen offset:3072 sc1
    v_mfma_f32_16x16x32_bf16 v[208:211], v[48:51], a[228:231], v[208:211]
    v_mfma_f32_16x16x32_bf16 v[224:227], v[48:51], a[232:235], v[224:227]
    v_mfma_f32_16x16x32_bf16 v[240:243], v[48:51], a[236:239], v[240:243]
    v_mfma_f32_16x16x32_bf16 v[196:199], v[52:55], a[224:227], v[196:199]
    buffer_load_dwordx4 v[180:183], v25, s[12:15], s91 offen offset:3072 sc1
    v_mfma_f32_16x16x32_bf16 v[212:215], v[52:55], a[228:231], v[212:215]
    v_mfma_f32_16x16x32_bf16 v[228:231], v[52:55], a[232:235], v[228:231]
    v_mfma_f32_16x16x32_bf16 v[244:247], v[52:55], a[236:239], v[244:247]
    v_mfma_f32_16x16x32_bf16 v[200:203], v[56:59], a[224:227], v[200:203]
    buffer_load_dwordx4 v[184:187], v26, s[12:15], s91 offen offset:3072 sc1
    v_mfma_f32_16x16x32_bf16 v[216:219], v[56:59], a[228:231], v[216:219]
    v_mfma_f32_16x16x32_bf16 v[232:235], v[56:59], a[232:235], v[232:235]
    v_mfma_f32_16x16x32_bf16 v[248:251], v[56:59], a[236:239], v[248:251]
    v_mfma_f32_16x16x32_bf16 v[204:207], v[60:63], a[224:227], v[204:207]
    buffer_load_dwordx4 v[188:191], v27, s[12:15], s91 offen offset:3072 sc1
    v_mfma_f32_16x16x32_bf16 v[220:223], v[60:63], a[228:231], v[220:223]
    v_mfma_f32_16x16x32_bf16 v[236:239], v[60:63], a[232:235], v[236:239]
    v_mfma_f32_16x16x32_bf16 v[252:255], v[60:63], a[236:239], v[252:255]
    s_add_u32 s91, s90, 4266496
    s_waitcnt vmcnt(12)
    v_mfma_f32_16x16x32_bf16 v[192:195], v[64:67], v[128:131], v[192:195]
    buffer_load_dwordx4 a[240:243], v24, s[12:15], s91 offen offset:0 sc1
    v_mfma_f32_16x16x32_bf16 v[208:211], v[64:67], v[132:135], v[208:211]
    v_mfma_f32_16x16x32_bf16 v[224:227], v[64:67], v[136:139], v[224:227]
    v_mfma_f32_16x16x32_bf16 v[240:243], v[64:67], v[140:143], v[240:243]
    v_mfma_f32_16x16x32_bf16 v[196:199], v[68:71], v[128:131], v[196:199]
    buffer_load_dwordx4 a[244:247], v25, s[12:15], s91 offen offset:0 sc1
    v_mfma_f32_16x16x32_bf16 v[212:215], v[68:71], v[132:135], v[212:215]
    v_mfma_f32_16x16x32_bf16 v[228:231], v[68:71], v[136:139], v[228:231]
    v_mfma_f32_16x16x32_bf16 v[244:247], v[68:71], v[140:143], v[244:247]
    v_mfma_f32_16x16x32_bf16 v[200:203], v[72:75], v[128:131], v[200:203]
    buffer_load_dwordx4 a[248:251], v26, s[12:15], s91 offen offset:0 sc1
    v_mfma_f32_16x16x32_bf16 v[216:219], v[72:75], v[132:135], v[216:219]
    v_mfma_f32_16x16x32_bf16 v[232:235], v[72:75], v[136:139], v[232:235]
    v_mfma_f32_16x16x32_bf16 v[248:251], v[72:75], v[140:143], v[248:251]
    v_mfma_f32_16x16x32_bf16 v[204:207], v[76:79], v[128:131], v[204:207]
    buffer_load_dwordx4 a[252:255], v27, s[12:15], s91 offen offset:0 sc1
    v_mfma_f32_16x16x32_bf16 v[220:223], v[76:79], v[132:135], v[220:223]
    v_mfma_f32_16x16x32_bf16 v[236:239], v[76:79], v[136:139], v[236:239]
    v_mfma_f32_16x16x32_bf16 v[252:255], v[76:79], v[140:143], v[252:255]
    s_waitcnt vmcnt(12)
    v_mfma_f32_16x16x32_bf16 v[192:195], v[80:83], v[144:147], v[192:195]
    buffer_load_dwordx4 a[48:51], v24, s[12:15], s91 offen offset:1024 sc1
    v_mfma_f32_16x16x32_bf16 v[208:211], v[80:83], v[148:151], v[208:211]
    v_mfma_f32_16x16x32_bf16 v[224:227], v[80:83], v[152:155], v[224:227]
    v_mfma_f32_16x16x32_bf16 v[240:243], v[80:83], v[156:159], v[240:243]
    v_mfma_f32_16x16x32_bf16 v[196:199], v[84:87], v[144:147], v[196:199]
    buffer_load_dwordx4 a[52:55], v25, s[12:15], s91 offen offset:1024 sc1
    v_mfma_f32_16x16x32_bf16 v[212:215], v[84:87], v[148:151], v[212:215]
    v_mfma_f32_16x16x32_bf16 v[228:231], v[84:87], v[152:155], v[228:231]
    v_mfma_f32_16x16x32_bf16 v[244:247], v[84:87], v[156:159], v[244:247]
    v_mfma_f32_16x16x32_bf16 v[200:203], v[88:91], v[144:147], v[200:203]
    buffer_load_dwordx4 a[56:59], v26, s[12:15], s91 offen offset:1024 sc1
    v_mfma_f32_16x16x32_bf16 v[216:219], v[88:91], v[148:151], v[216:219]
    v_mfma_f32_16x16x32_bf16 v[232:235], v[88:91], v[152:155], v[232:235]
    v_mfma_f32_16x16x32_bf16 v[248:251], v[88:91], v[156:159], v[248:251]
    v_mfma_f32_16x16x32_bf16 v[204:207], v[92:95], v[144:147], v[204:207]
    buffer_load_dwordx4 a[60:63], v27, s[12:15], s91 offen offset:1024 sc1
    v_mfma_f32_16x16x32_bf16 v[220:223], v[92:95], v[148:151], v[220:223]
    v_mfma_f32_16x16x32_bf16 v[236:239], v[92:95], v[152:155], v[236:239]
    v_mfma_f32_16x16x32_bf16 v[252:255], v[92:95], v[156:159], v[252:255]
    s_waitcnt vmcnt(12)
    v_mfma_f32_16x16x32_bf16 v[192:195], v[96:99], v[160:163], v[192:195]
    buffer_load_dwordx4 a[64:67], v24, s[12:15], s91 offen offset:2048 sc1
    v_mfma_f32_16x16x32_bf16 v[208:211], v[96:99], v[164:167], v[208:211]
    v_mfma_f32_16x16x32_bf16 v[224:227], v[96:99], v[168:171], v[224:227]
    v_mfma_f32_16x16x32_bf16 v[240:243], v[96:99], v[172:175], v[240:243]
    v_mfma_f32_16x16x32_bf16 v[196:199], v[100:103], v[160:163], v[196:199]
    buffer_load_dwordx4 a[68:71], v25, s[12:15], s91 offen offset:2048 sc1
    v_mfma_f32_16x16x32_bf16 v[212:215], v[100:103], v[164:167], v[212:215]
    v_mfma_f32_16x16x32_bf16 v[228:231], v[100:103], v[168:171], v[228:231]
    v_mfma_f32_16x16x32_bf16 v[244:247], v[100:103], v[172:175], v[244:247]
    v_mfma_f32_16x16x32_bf16 v[200:203], v[104:107], v[160:163], v[200:203]
    buffer_load_dwordx4 a[72:75], v26, s[12:15], s91 offen offset:2048 sc1
    v_mfma_f32_16x16x32_bf16 v[216:219], v[104:107], v[164:167], v[216:219]
    v_mfma_f32_16x16x32_bf16 v[232:235], v[104:107], v[168:171], v[232:235]
    v_mfma_f32_16x16x32_bf16 v[248:251], v[104:107], v[172:175], v[248:251]
    v_mfma_f32_16x16x32_bf16 v[204:207], v[108:111], v[160:163], v[204:207]
    buffer_load_dwordx4 a[76:79], v27, s[12:15], s91 offen offset:2048 sc1
    v_mfma_f32_16x16x32_bf16 v[220:223], v[108:111], v[164:167], v[220:223]
    v_mfma_f32_16x16x32_bf16 v[236:239], v[108:111], v[168:171], v[236:239]
    v_mfma_f32_16x16x32_bf16 v[252:255], v[108:111], v[172:175], v[252:255]
    s_waitcnt vmcnt(12)
    v_mfma_f32_16x16x32_bf16 v[192:195], v[112:115], v[176:179], v[192:195]
    v_mfma_f32_16x16x32_bf16 v[208:211], v[112:115], v[180:183], v[208:211]
    v_mfma_f32_16x16x32_bf16 v[224:227], v[112:115], v[184:187], v[224:227]
    v_mfma_f32_16x16x32_bf16 v[240:243], v[112:115], v[188:191], v[240:243]
    v_mfma_f32_16x16x32_bf16 v[196:199], v[116:119], v[176:179], v[196:199]
    v_mfma_f32_16x16x32_bf16 v[212:215], v[116:119], v[180:183], v[212:215]
    v_mfma_f32_16x16x32_bf16 v[228:231], v[116:119], v[184:187], v[228:231]
    v_mfma_f32_16x16x32_bf16 v[244:247], v[116:119], v[188:191], v[244:247]
    v_mfma_f32_16x16x32_bf16 v[200:203], v[120:123], v[176:179], v[200:203]
    v_mfma_f32_16x16x32_bf16 v[216:219], v[120:123], v[180:183], v[216:219]
    v_mfma_f32_16x16x32_bf16 v[232:235], v[120:123], v[184:187], v[232:235]
    v_mfma_f32_16x16x32_bf16 v[248:251], v[120:123], v[188:191], v[248:251]
    v_mfma_f32_16x16x32_bf16 v[204:207], v[124:127], v[176:179], v[204:207]
    v_mfma_f32_16x16x32_bf16 v[220:223], v[124:127], v[180:183], v[220:223]
    v_mfma_f32_16x16x32_bf16 v[236:239], v[124:127], v[184:187], v[236:239]
    v_mfma_f32_16x16x32_bf16 v[252:255], v[124:127], v[188:191], v[252:255]
    s_waitcnt vmcnt(8)
    v_mfma_f32_16x16x32_bf16 v[192:195], a[0:3], a[240:243], v[192:195]
    v_add_u32 v25, s70, v1
    v_mfma_f32_16x16x32_bf16 v[208:211], a[0:3], a[244:247], v[208:211]
    v_add_u32 v26, s71, v1
    v_mfma_f32_16x16x32_bf16 v[224:227], a[0:3], a[248:251], v[224:227]
    v_add_u32 v27, s72, v1
    v_mfma_f32_16x16x32_bf16 v[240:243], a[0:3], a[252:255], v[240:243]
    v_lshlrev_b32 v32, 16, v16
    v_mfma_f32_16x16x32_bf16 v[196:199], a[4:7], a[240:243], v[196:199]
    v_and_b32 v36, 0xffff0000, v16
    v_mfma_f32_16x16x32_bf16 v[212:215], a[4:7], a[244:247], v[212:215]
    v_lshlrev_b32 v40, 16, v17
    v_mfma_f32_16x16x32_bf16 v[228:231], a[4:7], a[248:251], v[228:231]
    v_and_b32 v44, 0xffff0000, v17
    v_mfma_f32_16x16x32_bf16 v[244:247], a[4:7], a[252:255], v[244:247]
    v_lshlrev_b32 v33, 16, v18
    v_mfma_f32_16x16x32_bf16 v[200:203], a[8:11], a[240:243], v[200:203]
    v_and_b32 v37, 0xffff0000, v18
    v_mfma_f32_16x16x32_bf16 v[216:219], a[8:11], a[244:247], v[216:219]
    v_lshlrev_b32 v41, 16, v19
    v_mfma_f32_16x16x32_bf16 v[232:235], a[8:11], a[248:251], v[232:235]
    v_and_b32 v45, 0xffff0000, v19
    v_mfma_f32_16x16x32_bf16 v[248:251], a[8:11], a[252:255], v[248:251]
    v_lshlrev_b32 v34, 16, v20
    v_mfma_f32_16x16x32_bf16 v[204:207], a[12:15], a[240:243], v[204:207]
    v_and_b32 v38, 0xffff0000, v20
    v_mfma_f32_16x16x32_bf16 v[220:223], a[12:15], a[244:247], v[220:223]
    v_lshlrev_b32 v42, 16, v21
    v_mfma_f32_16x16x32_bf16 v[236:239], a[12:15], a[248:251], v[236:239]
    v_and_b32 v46, 0xffff0000, v21
    v_mfma_f32_16x16x32_bf16 v[252:255], a[12:15], a[252:255], v[252:255]
    v_lshlrev_b32 v35, 16, v22
    v_and_b32 v39, 0xffff0000, v22
    v_lshlrev_b32 v43, 16, v23
    v_and_b32 v47, 0xffff0000, v23
    s_waitcnt vmcnt(0)
    v_mfma_f32_16x16x32_bf16 v[208:211], a[16:19], a[52:55], v[208:211]
    v_mfma_f32_16x16x32_bf16 v[208:211], a[32:35], a[68:71], v[208:211]
    v_mfma_f32_16x16x32_bf16 v[212:215], a[20:23], a[52:55], v[212:215]
    v_mfma_f32_16x16x32_bf16 v[212:215], a[36:39], a[68:71], v[212:215]
    v_mfma_f32_16x16x32_bf16 v[216:219], a[24:27], a[52:55], v[216:219]
    v_mfma_f32_16x16x32_bf16 v[216:219], a[40:43], a[68:71], v[216:219]
    v_mfma_f32_16x16x32_bf16 v[220:223], a[28:31], a[52:55], v[220:223]
    v_mfma_f32_16x16x32_bf16 v[220:223], a[44:47], a[68:71], v[220:223]
    v_mfma_f32_16x16x32_bf16 v[224:227], a[16:19], a[56:59], v[224:227]
    v_mfma_f32_16x16x32_bf16 v[224:227], a[32:35], a[72:75], v[224:227]
    ds_write_b128 v25, v[208:211] offset:0
    v_mfma_f32_16x16x32_bf16 v[228:231], a[20:23], a[56:59], v[228:231]
    v_mfma_f32_16x16x32_bf16 v[228:231], a[36:39], a[72:75], v[228:231]
    ds_write_b128 v25, v[212:215] offset:1024
    v_mfma_f32_16x16x32_bf16 v[232:235], a[24:27], a[56:59], v[232:235]
    v_mfma_f32_16x16x32_bf16 v[232:235], a[40:43], a[72:75], v[232:235]
    ds_write_b128 v25, v[216:219] offset:2048
    v_mfma_f32_16x16x32_bf16 v[236:239], a[28:31], a[56:59], v[236:239]
    v_mfma_f32_16x16x32_bf16 v[236:239], a[44:47], a[72:75], v[236:239]
    ds_write_b128 v25, v[220:223] offset:3072
    v_mfma_f32_16x16x32_bf16 v[240:243], a[16:19], a[60:63], v[240:243]
    v_mfma_f32_16x16x32_bf16 v[240:243], a[32:35], a[76:79], v[240:243]
    ds_write_b128 v26, v[224:227] offset:4096
    v_mfma_f32_16x16x32_bf16 v[244:247], a[20:23], a[60:63], v[244:247]
    v_mfma_f32_16x16x32_bf16 v[244:247], a[36:39], a[76:79], v[244:247]
    ds_write_b128 v26, v[228:231] offset:5120
    v_mfma_f32_16x16x32_bf16 v[248:251], a[24:27], a[60:63], v[248:251]
    v_mfma_f32_16x16x32_bf16 v[248:251], a[40:43], a[76:79], v[248:251]
    ds_write_b128 v26, v[232:235] offset:6144
    v_mfma_f32_16x16x32_bf16 v[252:255], a[28:31], a[60:63], v[252:255]
    v_mfma_f32_16x16x32_bf16 v[252:255], a[44:47], a[76:79], v[252:255]
    ds_write_b128 v26, v[236:239] offset:7168
    v_mfma_f32_16x16x32_bf16 v[192:195], a[16:19], a[48:51], v[192:195]
    v_mfma_f32_16x16x32_bf16 v[192:195], a[32:35], a[64:67], v[192:195]
    ds_write_b128 v27, v[240:243] offset:8192
    v_mfma_f32_16x16x32_bf16 v[196:199], a[20:23], a[48:51], v[196:199]
    v_mfma_f32_16x16x32_bf16 v[196:199], a[36:39], a[64:67], v[196:199]
    ds_write_b128 v27, v[244:247] offset:9216
    v_mfma_f32_16x16x32_bf16 v[200:203], a[24:27], a[48:51], v[200:203]
    v_mfma_f32_16x16x32_bf16 v[200:203], a[40:43], a[64:67], v[200:203]
    ds_write_b128 v27, v[248:251] offset:10240
    v_mfma_f32_16x16x32_bf16 v[204:207], a[28:31], a[48:51], v[204:207]
    v_mfma_f32_16x16x32_bf16 v[204:207], a[44:47], a[64:67], v[204:207]
    ds_write_b128 v27, v[252:255] offset:11264
    s_nop 7
    v_pk_add_f32 v[32:33], v[32:33], v[192:193]
    v_pk_add_f32 v[34:35], v[34:35], v[194:195]
    v_pk_add_f32 v[36:37], v[36:37], v[196:197]
    v_pk_add_f32 v[38:39], v[38:39], v[198:199]
    v_pk_add_f32 v[40:41], v[40:41], v[200:201]
    v_pk_add_f32 v[42:43], v[42:43], v[202:203]
    v_pk_add_f32 v[44:45], v[44:45], v[204:205]
    v_pk_add_f32 v[46:47], v[46:47], v[206:207]
    s_waitcnt lgkmcnt(0)
    s_barrier
    ds_read_b128 v[48:51], v15 offset:0
    ds_read_b128 v[52:55], v15 offset:1024
    ds_read_b128 v[56:59], v15 offset:2048
    ds_read_b128 v[60:63], v15 offset:3072
    ds_read_b128 v[64:67], v15 offset:4096
    ds_read_b128 v[68:71], v15 offset:5120
    ds_read_b128 v[72:75], v15 offset:6144
    ds_read_b128 v[76:79], v15 offset:7168
    ds_read_b128 v[80:83], v15 offset:8192
    ds_read_b128 v[84:87], v15 offset:9216
    ds_read_b128 v[88:91], v15 offset:10240
    ds_read_b128 v[92:95], v15 offset:11264
    s_waitcnt lgkmcnt(8)
    v_pk_add_f32 v[32:33], v[32:33], v[48:49]
    v_pk_add_f32 v[34:35], v[34:35], v[50:51]
    v_pk_add_f32 v[36:37], v[36:37], v[52:53]
    v_pk_add_f32 v[38:39], v[38:39], v[54:55]
    v_pk_add_f32 v[40:41], v[40:41], v[56:57]
    v_pk_add_f32 v[42:43], v[42:43], v[58:59]
    v_pk_add_f32 v[44:45], v[44:45], v[60:61]
    v_pk_add_f32 v[46:47], v[46:47], v[62:63]
    s_waitcnt lgkmcnt(4)
    v_pk_add_f32 v[32:33], v[32:33], v[64:65]
    v_pk_add_f32 v[34:35], v[34:35], v[66:67]
    v_pk_add_f32 v[36:37], v[36:37], v[68:69]
    v_pk_add_f32 v[38:39], v[38:39], v[70:71]
    v_pk_add_f32 v[40:41], v[40:41], v[72:73]
    v_pk_add_f32 v[42:43], v[42:43], v[74:75]
    v_pk_add_f32 v[44:45], v[44:45], v[76:77]
    v_pk_add_f32 v[46:47], v[46:47], v[78:79]
    s_waitcnt lgkmcnt(0)
    v_pk_add_f32 v[32:33], v[32:33], v[80:81]
    v_pk_add_f32 v[34:35], v[34:35], v[82:83]
    v_pk_add_f32 v[36:37], v[36:37], v[84:85]
    v_pk_add_f32 v[38:39], v[38:39], v[86:87]
    v_pk_add_f32 v[40:41], v[40:41], v[88:89]
    v_pk_add_f32 v[42:43], v[42:43], v[90:91]
    v_pk_add_f32 v[44:45], v[44:45], v[92:93]
    v_pk_add_f32 v[46:47], v[46:47], v[94:95]
    v_cvt_pk_bf16_f32 v112, v32, v36
    v_cvt_pk_bf16_f32 v113, v40, v44
    v_cvt_pk_bf16_f32 v114, v33, v37
    v_cvt_pk_bf16_f32 v115, v41, v45
    buffer_store_dwordx4 v[112:115], v10, s[8:11], s38 offen
    v_cvt_pk_bf16_f32 v116, v34, v38
    v_cvt_pk_bf16_f32 v117, v42, v46
    v_cvt_pk_bf16_f32 v118, v35, v39
    v_cvt_pk_bf16_f32 v119, v43, v47
    buffer_store_dwordx4 v[116:119], v10, s[8:11], s38 offen offset:16
M_fin:
    s_waitcnt vmcnt(0) lgkmcnt(0)
M_end:
    s_endpgm
G_K_sig0:
    v_mov_b32 v24, 1
    buffer_atomic_add v24, v31, s[16:19], 0 offen sc1
    s_branch G_K_sigback0
G_K_sig1:
    v_mov_b32 v24, 1
    buffer_atomic_add v24, v31, s[16:19], 0 offen sc1
    s_branch G_K_sigback1
G_K_sig2:
    v_mov_b32 v24, 1
    buffer_atomic_add v24, v31, s[16:19], 0 offen sc1
    s_branch G_K_sigback2
G_K_sig3:
    v_mov_b32 v24, 1
    buffer_atomic_add v24, v31, s[16:19], 0 offen sc1
    s_branch G_K_sigback3
G_K_spin:
    s_mov_b32 s3, 0x20000
G_Kcnt_poll_1001:
    buffer_load_dword v9, off, s[16:19], 0 offset:0 sc1
    s_waitcnt vmcnt(0)
    v_cmp_gt_u32 vcc, 256, v9
    s_sub_u32 s3, s3, 1
    s_cbranch_scc1 G_Kcnt_pdone_1002
    s_nop 1
    s_cbranch_vccnz G_Kcnt_poll_1001
G_Kcnt_pdone_1002:
    s_branch G_K_spinback

QK_spin:
    s_mov_b32 s3, 0x20000
QKf1_poll_1:
    buffer_load_dword v12, v15, s[12:15], s94 offen offset:4 sc1
    s_waitcnt vmcnt(0)
    v_cmp_ne_u32 vcc, 1, v12
    s_sub_u32 s3, s3, 1
    s_cbranch_scc1 QKf1_pdone_2
    s_nop 1
    s_cbranch_vccnz QKf1_poll_1
QKf1_pdone_2:
    s_branch QK_spinback

G_V_sig0:
    v_mov_b32 v24, 1
    buffer_atomic_add v24, v31, s[16:19], 0 offen sc1
    s_branch G_V_sigback0
G_V_sig1:
    v_mov_b32 v24, 1
    buffer_atomic_add v24, v31, s[16:19], 0 offen sc1
    s_branch G_V_sigback1
G_V_sig2:
    v_mov_b32 v24, 1
    buffer_atomic_add v24, v31, s[16:19], 0 offen sc1
    s_branch G_V_sigback2
G_V_sig3:
    v_mov_b32 v24, 1
    buffer_atomic_add v24, v31, s[16:19], 0 offen sc1
    s_branch G_V_sigback3
G_V_spin:
    s_mov_b32 s3, 0x20000
G_Vcnt_poll_1051:
    buffer_load_dword v9, off, s[16:19], 0 offset:0 sc1
    s_waitcnt vmcnt(0)
    v_cmp_gt_u32 vcc, 256, v9
    s_sub_u32 s3, s3, 1
    s_cbranch_scc1 G_Vcnt_pdone_1052
    s_nop 1
    s_cbranch_vccnz G_Vcnt_poll_1051
G_Vcnt_pdone_1052:
    s_branch G_V_spinback

QV_spin:
    s_mov_b32 s3, 0x20000
QVf1_poll_1:
    buffer_load_dword v12, v15, s[12:15], s94 offen offset:4 sc1
    s_waitcnt vmcnt(0)
    v_cmp_ne_u32 vcc, 1, v12
    s_sub_u32 s3, s3, 1
    s_cbranch_scc1 QVf1_pdone_2
    s_nop 1
    s_cbranch_vccnz QVf1_poll_1
QVf1_pdone_2:
    s_branch QV_spinback

OP_pk:
    s_mov_b32 s3, 0x20000
    s_mov_b32 s29, 111280128
OP_pkl:
    buffer_load_dwordx4 v[124:127], v1, s[12:15], s29 offen sc1
    s_waitcnt vmcnt(0)
    v_and_b32 v124, v124, v125
    v_and_b32 v126, v126, v127
    v_and_b32 v124, v124, v126
    v_cmp_ne_u32 vcc, 1, v124
    s_sub_u32 s3, s3, 1
    s_cbranch_scc1 OP_pkback
    s_nop 1
    s_cbranch_vccnz OP_pkl
    s_branch OP_pkback
OP_w0:
    buffer_wbl2 sc1
    s_waitcnt vmcnt(0)
    s_branch OP_wb0
OP_w1:
    buffer_wbl2 sc1
    s_waitcnt vmcnt(0)
    s_branch OP_wb1
OP_x0:
    s_mov_b32 s87, s3
    s_mov_b32 s3, 0x20000
opx_poll_8001:
    buffer_load_dword v13, off, s[12:15], s29 offset:64 sc1
    s_waitcnt vmcnt(0)
    v_cmp_gt_u32 vcc, 1, v13
    s_sub_u32 s3, s3, 1
    s_cbranch_scc1 opx_pdone_8002
    s_nop 1
    s_cbranch_vccnz opx_poll_8001
opx_pdone_8002:
    s_mov_b32 s3, s87
    s_cmp_eq_u32 s92, 1
    s_cbranch_scc1 OP_xb0
    buffer_inv sc1
    s_waitcnt vmcnt(0)
    s_branch OP_xb0

OP_w2:
    buffer_wbl2 sc1
    s_waitcnt vmcnt(0)
    s_branch OP_wb2
OP_x1:
    s_mov_b32 s87, s3
    s_mov_b32 s3, 0x20000
opx_poll_8011:
    buffer_load_dword v13, off, s[12:15], s29 offset:64 sc1
    s_waitcnt vmcnt(0)
    v_cmp_gt_u32 vcc, 2, v13
    s_sub_u32 s3, s3, 1
    s_cbranch_scc1 opx_pdone_8012
    s_nop 1
    s_cbranch_vccnz opx_poll_8011
opx_pdone_8012:
    s_mov_b32 s3, s87
    s_cmp_eq_u32 s92, 1
    s_cbranch_scc1 OP_xb1
    buffer_inv sc1
    s_waitcnt vmcnt(0)
    s_branch OP_xb1

OP_x2:
    s_mov_b32 s87, s3
    s_mov_b32 s3, 0x20000
opx_poll_8021:
    buffer_load_dword v13, off, s[12:15], s29 offset:64 sc1
    s_waitcnt vmcnt(0)
    v_cmp_gt_u32 vcc, 3, v13
    s_sub_u32 s3, s3, 1
    s_cbranch_scc1 opx_pdone_8022
    s_nop 1
    s_cbranch_vccnz opx_poll_8021
opx_pdone_8022:
    s_mov_b32 s3, s87
    s_cmp_eq_u32 s92, 1
    s_cbranch_scc1 OP_xb2
    buffer_inv sc1
    s_waitcnt vmcnt(0)
    s_branch OP_xb2

GU_wb:
    buffer_wbl2 sc1
    s_waitcnt vmcnt(0)
    s_branch GU_wbback
P4a0_slow:
    v_min_u32 v12, 13, v2
    v_mul_u32_u24 v12, 6144, v12
    s_mov_b32 s3, 0x20000
P4a0_poll_7030:
    buffer_load_dword v13, v12, s[12:15], s94 offen offset:28 sc1
    s_waitcnt vmcnt(0)
    v_cmp_ne_u32 vcc, 1, v13
    s_sub_u32 s3, s3, 1
    s_cbranch_scc1 P4a0_pdone_7031
    s_nop 1
    s_cbranch_vccnz P4a0_poll_7030
P4a0_pdone_7031:
    s_cmp_eq_u32 s92, 1
    s_cbranch_scc1 acq_7029
    buffer_inv sc1
    s_waitcnt vmcnt(0)
acq_7029:
    s_branch P4a0_back

P4_wb:
    buffer_wbl2 sc1
    s_waitcnt vmcnt(0)
    s_branch P4_wbback
P4a1_slow:
    v_min_u32 v12, 13, v2
    v_mul_u32_u24 v12, 6144, v12
    s_mov_b32 s3, 0x20000
P4a1_poll_7026:
    buffer_load_dword v13, v12, s[12:15], s94 offen offset:24 sc1
    s_waitcnt vmcnt(0)
    v_cmp_ne_u32 vcc, 1, v13
    s_sub_u32 s3, s3, 1
    s_cbranch_scc1 P4a1_pdone_7027
    s_nop 1
    s_cbranch_vccnz P4a1_poll_7026
P4a1_pdone_7027:
    s_cmp_eq_u32 s92, 1
    s_cbranch_scc1 acq_7025
    buffer_inv sc1
    s_waitcnt vmcnt(0)
acq_7025:
    s_branch P4a1_back

AT_qkfirst:
    s_bitcmp1_b32 s20, 0
    s_cbranch_scc0 AT_qkfirst_odd
    s_waitcnt lgkmcnt(4)
    v_mfma_f32_16x16x32_bf16 v[32:35], a[192:195], a[128:131], v[96:99]
    ds_read_b128 a[224:227], v5 offset:8192
    v_readlane_b32 s23, v7, s20
    v_mfma_f32_16x16x32_bf16 v[32:35], a[196:199], a[132:135], v[32:35]
    v_mfma_f32_16x16x32_bf16 v[32:35], a[200:203], a[136:139], v[32:35]
    ds_read_b128 a[228:231], v5 offset:9216
    v_mfma_f32_16x16x32_bf16 v[32:35], a[204:207], a[140:143], v[32:35]
    v_mfma_f32_16x16x32_bf16 v[36:39], a[192:195], a[160:163], v[100:103]
    ds_read_b128 a[232:235], v5 offset:10240
    v_mfma_f32_16x16x32_bf16 v[36:39], a[196:199], a[164:167], v[36:39]
    v_mfma_f32_16x16x32_bf16 v[36:39], a[200:203], a[168:171], v[36:39]
    ds_read_b128 a[236:239], v5 offset:11264
    v_mfma_f32_16x16x32_bf16 v[36:39], a[204:207], a[172:175], v[36:39]
    s_waitcnt lgkmcnt(4)
    v_mfma_f32_16x16x32_bf16 v[36:39], a[208:211], a[176:179], v[36:39]
    ds_read_b128 a[240:243], v5 offset:12288
    v_mfma_f32_16x16x32_bf16 v[36:39], a[212:215], a[180:183], v[36:39]
    v_mfma_f32_16x16x32_bf16 v[36:39], a[216:219], a[184:187], v[36:39]
    ds_read_b128 a[244:247], v5 offset:13312
    v_mfma_f32_16x16x32_bf16 v[36:39], a[220:223], a[188:191], v[36:39]
    v_mfma_f32_16x16x32_bf16 v[32:35], a[208:211], a[144:147], v[32:35]
    ds_read_b128 a[248:251], v5 offset:14336
    v_mfma_f32_16x16x32_bf16 v[32:35], a[212:215], a[148:151], v[32:35]
    v_mfma_f32_16x16x32_bf16 v[32:35], a[216:219], a[152:155], v[32:35]
    ds_read_b128 a[252:255], v5 offset:15360
    v_mfma_f32_16x16x32_bf16 v[32:35], a[220:223], a[156:159], v[32:35]
    s_waitcnt lgkmcnt(4)
    v_mfma_f32_16x16x32_bf16 v[40:43], a[224:227], a[128:131], v[104:107]
    v_mfma_f32_16x16x32_bf16 v[40:43], a[228:231], a[132:135], v[40:43]
    v_mfma_f32_16x16x32_bf16 v[40:43], a[232:235], a[136:139], v[40:43]
    v_mfma_f32_16x16x32_bf16 v[40:43], a[236:239], a[140:143], v[40:43]
    v_mfma_f32_16x16x32_bf16 v[44:47], a[224:227], a[160:163], v[108:111]
    s_add_u32 m0, s22, 16384
    v_mfma_f32_16x16x32_bf16 v[44:47], a[228:231], a[164:167], v[44:47]
    buffer_load_dwordx4 v4, s[12:15], s23 offen offset:0 lds
    v_mfma_f32_16x16x32_bf16 v[44:47], a[232:235], a[168:171], v[44:47]
    v_mfma_f32_16x16x32_bf16 v[44:47], a[236:239], a[172:175], v[44:47]
    v_max3_f32 v9, v32, v33, v34
    v_max3_f32 v10, v36, v37, v38
    s_waitcnt lgkmcnt(0)
    v_mfma_f32_16x16x32_bf16 v[44:47], a[240:243], a[176:179], v[44:47]
    v_mov_b32 v18, 0
    v_mov_b32 v19, 0
    v_mfma_f32_16x16x32_bf16 v[44:47], a[244:247], a[180:183], v[44:47]
    buffer_load_dwordx4 v4, s[12:15], s23 offen offset:1024 lds
    v_mfma_f32_16x16x32_bf16 v[44:47], a[248:251], a[184:187], v[44:47]
    v_mfma_f32_16x16x32_bf16 v[44:47], a[252:255], a[188:191], v[44:47]
    buffer_load_dwordx4 v4, s[12:15], s23 offen offset:2048 lds
    v_mfma_f32_16x16x32_bf16 v[40:43], a[240:243], a[144:147], v[40:43]
    v_mfma_f32_16x16x32_bf16 v[40:43], a[244:247], a[148:151], v[40:43]
    buffer_load_dwordx4 v4, s[12:15], s23 offen offset:3072 lds
    v_mfma_f32_16x16x32_bf16 v[40:43], a[248:251], a[152:155], v[40:43]
    v_mfma_f32_16x16x32_bf16 v[40:43], a[252:255], a[156:159], v[40:43]
    v_readlane_b32 s27, v8, s20
    s_nop 6
    v_max3_f32 v9, v9, v35, v40
    v_max3_f32 v9, v9, v41, v42
    v_max_f32 v9, v9, v43
    v_max3_f32 v10, v10, v39, v44
    v_max3_f32 v10, v10, v45, v46
    v_max_f32 v10, v10, v47
    v_mov_b32 v11, v9
    v_mov_b32 v12, v10
    s_nop 0
    v_permlane16_swap_b32 v9, v11
    v_permlane16_swap_b32 v10, v12
    s_nop 0
    v_max_f32 v9, v9, v11
    v_max_f32 v10, v10, v12
    v_mov_b32 v11, v9
    v_mov_b32 v12, v10
    s_nop 0
    v_permlane32_swap_b32 v9, v11
    v_permlane32_swap_b32 v10, v12
    s_nop 0
    v_max_f32 v9, v9, v11
    v_max_f32 v10, v10, v12
    v_sub_f32 v16, 0, v9
    v_sub_f32 v32, v32, v9
    v_sub_f32 v33, v33, v9
    v_sub_f32 v34, v34, v9
    v_sub_f32 v35, v35, v9
    v_sub_f32 v17, 0, v10
    v_sub_f32 v36, v36, v10
    v_sub_f32 v37, v37, v10
    v_sub_f32 v38, v38, v10
    v_sub_f32 v39, v39, v10
    v_exp_f32 v80, v32
    v_exp_f32 v81, v33
    v_exp_f32 v82, v34
    v_exp_f32 v83, v35
    v_exp_f32 v84, v36
    v_exp_f32 v85, v37
    v_exp_f32 v86, v38
    v_exp_f32 v87, v39
    v_add_f32 v20, v80, v81
    v_cvt_pk_bf16_f32 v64, v80, v81
    v_add_f32 v20, v20, v82
    v_add_f32 v20, v20, v83
    v_cvt_pk_bf16_f32 v65, v82, v83
    v_add_f32 v21, v84, v85
    v_cvt_pk_bf16_f32 v68, v84, v85
    v_add_f32 v21, v21, v86
    v_add_f32 v21, v21, v87
    v_cvt_pk_bf16_f32 v69, v86, v87
    v_sub_f32 v40, v40, v9
    v_sub_f32 v41, v41, v9
    v_sub_f32 v42, v42, v9
    v_sub_f32 v43, v43, v9
    s_waitcnt vmcnt(12)
    s_barrier
    ds_read_b128 a[192:195], v5 offset:16384
    ds_read_b128 a[196:199], v5 offset:17408
    ds_read_b128 a[200:203], v5 offset:18432
    s_add_u32 m0, s22, 81920
    s_nop 3
    buffer_load_dwordx4 v4, s[12:15], s27 offen offset:0 lds
    ds_read_b128 a[204:207], v5 offset:19456
    ds_read_b128 a[208:211], v5 offset:20480
    buffer_load_dwordx4 v4, s[12:15], s27 offen offset:1024 lds
    ds_read_b128 a[212:215], v5 offset:21504
    buffer_load_dwordx4 v4, s[12:15], s27 offen offset:2048 lds
    ds_read_b128 a[216:219], v5 offset:22528
    s_add_u32 s20, s20, 1
    buffer_load_dwordx4 v4, s[12:15], s27 offen offset:3072 lds
    ds_read_b128 a[220:223], v5 offset:23552
    v_mov_b32 v96, v16
    v_mov_b32 v97, v16
    v_mov_b32 v98, v16
    v_mov_b32 v99, v16
    v_mov_b32 v104, v16
    v_mov_b32 v105, v16
    v_mov_b32 v106, v16
    v_mov_b32 v107, v16
    v_sub_f32 v44, v44, v10
    v_sub_f32 v45, v45, v10
    v_sub_f32 v46, v46, v10
    v_sub_f32 v47, v47, v10
    v_mov_b32 v100, v17
    v_mov_b32 v101, v17
    v_mov_b32 v102, v17
    v_mov_b32 v103, v17
    v_mov_b32 v108, v17
    v_mov_b32 v109, v17
    v_mov_b32 v110, v17
    v_mov_b32 v111, v17
    v_exp_f32 v88, v40
    s_setpc_b64 s[82:83]
AT_qkfirst_odd:
    s_waitcnt lgkmcnt(4)
    v_mfma_f32_16x16x32_bf16 v[48:51], a[192:195], a[128:131], v[96:99]
    ds_read_b128 a[224:227], v5 offset:24576
    s_xor_b32 s22, s22, 0x8000
    v_mfma_f32_16x16x32_bf16 v[48:51], a[196:199], a[132:135], v[48:51]
    v_mfma_f32_16x16x32_bf16 v[48:51], a[200:203], a[136:139], v[48:51]
    ds_read_b128 a[228:231], v5 offset:25600
    v_readlane_b32 s23, v7, s20
    v_mfma_f32_16x16x32_bf16 v[48:51], a[204:207], a[140:143], v[48:51]
    v_mfma_f32_16x16x32_bf16 v[52:55], a[192:195], a[160:163], v[100:103]
    ds_read_b128 a[232:235], v5 offset:26624
    v_mfma_f32_16x16x32_bf16 v[52:55], a[196:199], a[164:167], v[52:55]
    v_mfma_f32_16x16x32_bf16 v[52:55], a[200:203], a[168:171], v[52:55]
    ds_read_b128 a[236:239], v5 offset:27648
    v_mfma_f32_16x16x32_bf16 v[52:55], a[204:207], a[172:175], v[52:55]
    s_waitcnt lgkmcnt(4)
    v_mfma_f32_16x16x32_bf16 v[52:55], a[208:211], a[176:179], v[52:55]
    ds_read_b128 a[240:243], v5 offset:28672
    v_mfma_f32_16x16x32_bf16 v[52:55], a[212:215], a[180:183], v[52:55]
    v_mfma_f32_16x16x32_bf16 v[52:55], a[216:219], a[184:187], v[52:55]
    ds_read_b128 a[244:247], v5 offset:29696
    v_mfma_f32_16x16x32_bf16 v[52:55], a[220:223], a[188:191], v[52:55]
    v_mfma_f32_16x16x32_bf16 v[48:51], a[208:211], a[144:147], v[48:51]
    ds_read_b128 a[248:251], v5 offset:30720
    v_mfma_f32_16x16x32_bf16 v[48:51], a[212:215], a[148:151], v[48:51]
    v_mfma_f32_16x16x32_bf16 v[48:51], a[216:219], a[152:155], v[48:51]
    ds_read_b128 a[252:255], v5 offset:31744
    v_mfma_f32_16x16x32_bf16 v[48:51], a[220:223], a[156:159], v[48:51]
    s_waitcnt lgkmcnt(4)
    v_mfma_f32_16x16x32_bf16 v[56:59], a[224:227], a[128:131], v[104:107]
    v_mfma_f32_16x16x32_bf16 v[56:59], a[228:231], a[132:135], v[56:59]
    v_mfma_f32_16x16x32_bf16 v[56:59], a[232:235], a[136:139], v[56:59]
    v_mfma_f32_16x16x32_bf16 v[56:59], a[236:239], a[140:143], v[56:59]
    v_mfma_f32_16x16x32_bf16 v[60:63], a[224:227], a[160:163], v[108:111]
    s_add_u32 m0, s22, 0
    v_mfma_f32_16x16x32_bf16 v[60:63], a[228:231], a[164:167], v[60:63]
    buffer_load_dwordx4 v4, s[12:15], s23 offen offset:0 lds
    v_mfma_f32_16x16x32_bf16 v[60:63], a[232:235], a[168:171], v[60:63]
    v_mfma_f32_16x16x32_bf16 v[60:63], a[236:239], a[172:175], v[60:63]
    v_max3_f32 v9, v48, v49, v50
    v_max3_f32 v10, v52, v53, v54
    s_waitcnt lgkmcnt(0)
    v_mfma_f32_16x16x32_bf16 v[60:63], a[240:243], a[176:179], v[60:63]
    v_mov_b32 v18, 0
    v_mov_b32 v19, 0
    v_mfma_f32_16x16x32_bf16 v[60:63], a[244:247], a[180:183], v[60:63]
    buffer_load_dwordx4 v4, s[12:15], s23 offen offset:1024 lds
    v_mfma_f32_16x16x32_bf16 v[60:63], a[248:251], a[184:187], v[60:63]
    v_mfma_f32_16x16x32_bf16 v[60:63], a[252:255], a[188:191], v[60:63]
    buffer_load_dwordx4 v4, s[12:15], s23 offen offset:2048 lds
    v_mfma_f32_16x16x32_bf16 v[56:59], a[240:243], a[144:147], v[56:59]
    v_mfma_f32_16x16x32_bf16 v[56:59], a[244:247], a[148:151], v[56:59]
    buffer_load_dwordx4 v4, s[12:15], s23 offen offset:3072 lds
    v_mfma_f32_16x16x32_bf16 v[56:59], a[248:251], a[152:155], v[56:59]
    v_xor_b32 v5, 0x8000, v5
    v_mfma_f32_16x16x32_bf16 v[56:59], a[252:255], a[156:159], v[56:59]
    v_readlane_b32 s27, v8, s20
    s_nop 6
    v_max3_f32 v9, v9, v51, v56
    v_max3_f32 v9, v9, v57, v58
    v_max_f32 v9, v9, v59
    v_max3_f32 v10, v10, v55, v60
    v_max3_f32 v10, v10, v61, v62
    v_max_f32 v10, v10, v63
    v_mov_b32 v11, v9
    v_mov_b32 v12, v10
    s_nop 0
    v_permlane16_swap_b32 v9, v11
    v_permlane16_swap_b32 v10, v12
    s_nop 0
    v_max_f32 v9, v9, v11
    v_max_f32 v10, v10, v12
    v_mov_b32 v11, v9
    v_mov_b32 v12, v10
    s_nop 0
    v_permlane32_swap_b32 v9, v11
    v_permlane32_swap_b32 v10, v12
    s_nop 0
    v_max_f32 v9, v9, v11
    v_max_f32 v10, v10, v12
    v_sub_f32 v16, 0, v9
    v_sub_f32 v48, v48, v9
    v_sub_f32 v49, v49, v9
    v_sub_f32 v50, v50, v9
    v_sub_f32 v51, v51, v9
    v_sub_f32 v17, 0, v10
    v_sub_f32 v52, v52, v10
    v_sub_f32 v53, v53, v10
    v_sub_f32 v54, v54, v10
    v_sub_f32 v55, v55, v10
    v_exp_f32 v80, v48
    v_exp_f32 v81, v49
    v_exp_f32 v82, v50
    v_exp_f32 v83, v51
    v_exp_f32 v84, v52
    v_exp_f32 v85, v53
    v_exp_f32 v86, v54
    v_exp_f32 v87, v55
    v_add_f32 v20, v80, v81
    v_cvt_pk_bf16_f32 v72, v80, v81
    v_add_f32 v20, v20, v82
    v_add_f32 v20, v20, v83
    v_cvt_pk_bf16_f32 v73, v82, v83
    v_add_f32 v21, v84, v85
    v_cvt_pk_bf16_f32 v76, v84, v85
    v_add_f32 v21, v21, v86
    v_add_f32 v21, v21, v87
    v_cvt_pk_bf16_f32 v77, v86, v87
    v_sub_f32 v56, v56, v9
    v_sub_f32 v57, v57, v9
    v_sub_f32 v58, v58, v9
    v_sub_f32 v59, v59, v9
    s_waitcnt vmcnt(12)
    s_barrier
    ds_read_b128 a[192:195], v5 offset:0
    v_xor_b32 v6, 0x8000, v6
    ds_read_b128 a[196:199], v5 offset:1024
    ds_read_b128 a[200:203], v5 offset:2048
    s_add_u32 m0, s22, 65536
    s_nop 3
    buffer_load_dwordx4 v4, s[12:15], s27 offen offset:0 lds
    ds_read_b128 a[204:207], v5 offset:3072
    ds_read_b128 a[208:211], v5 offset:4096
    buffer_load_dwordx4 v4, s[12:15], s27 offen offset:1024 lds
    ds_read_b128 a[212:215], v5 offset:5120
    buffer_load_dwordx4 v4, s[12:15], s27 offen offset:2048 lds
    ds_read_b128 a[216:219], v5 offset:6144
    s_add_u32 s20, s20, 1
    buffer_load_dwordx4 v4, s[12:15], s27 offen offset:3072 lds
    ds_read_b128 a[220:223], v5 offset:7168
    v_mov_b32 v96, v16
    v_mov_b32 v97, v16
    v_mov_b32 v98, v16
    v_mov_b32 v99, v16
    v_mov_b32 v104, v16
    v_mov_b32 v105, v16
    v_mov_b32 v106, v16
    v_mov_b32 v107, v16
    v_sub_f32 v60, v60, v10
    v_sub_f32 v61, v61, v10
    v_sub_f32 v62, v62, v10
    v_sub_f32 v63, v63, v10
    v_mov_b32 v100, v17
    v_mov_b32 v101, v17
    v_mov_b32 v102, v17
    v_mov_b32 v103, v17
    v_mov_b32 v108, v17
    v_mov_b32 v109, v17
    v_mov_b32 v110, v17
    v_mov_b32 v111, v17
    v_exp_f32 v88, v56
    s_setpc_b64 s[82:83]
AT_full:
    s_bitcmp1_b32 s20, 0
    s_cbranch_scc0 AT_full_odd
    .p2align 4
AT_full_even:
    s_waitcnt lgkmcnt(4)
    v_mfma_f32_16x16x32_bf16 v[32:35], a[192:195], a[128:131], v[96:99]
    ds_read_b128 a[224:227], v5 offset:8192
    v_readlane_b32 s23, v7, s20
    v_mfma_f32_16x16x32_bf16 v[32:35], a[196:199], a[132:135], v[32:35]
    v_exp_f32 v88, v56
    v_mfma_f32_16x16x32_bf16 v[32:35], a[200:203], a[136:139], v[32:35]
    ds_read_b128 a[228:231], v5 offset:9216
    v_add_f32 v20, v20, v88
    v_mfma_f32_16x16x32_bf16 v[32:35], a[204:207], a[140:143], v[32:35]
    v_exp_f32 v89, v57
    v_mfma_f32_16x16x32_bf16 v[36:39], a[192:195], a[160:163], v[100:103]
    ds_read_b128 a[232:235], v5 offset:10240
    v_add_f32 v20, v20, v89
    v_mfma_f32_16x16x32_bf16 v[36:39], a[196:199], a[164:167], v[36:39]
    v_exp_f32 v90, v58
    v_mfma_f32_16x16x32_bf16 v[36:39], a[200:203], a[168:171], v[36:39]
    ds_read_b128 a[236:239], v5 offset:11264
    v_cvt_pk_bf16_f32 v74, v88, v89
    v_mfma_f32_16x16x32_bf16 v[36:39], a[204:207], a[172:175], v[36:39]
    v_add_f32 v20, v20, v90
    s_waitcnt lgkmcnt(4)
    v_mfma_f32_16x16x32_bf16 v[36:39], a[208:211], a[176:179], v[36:39]
    ds_read_b128 a[240:243], v5 offset:12288
    v_mfma_f32_16x16x32_bf16 v[36:39], a[212:215], a[180:183], v[36:39]
    v_exp_f32 v91, v59
    v_mfma_f32_16x16x32_bf16 v[36:39], a[216:219], a[184:187], v[36:39]
    ds_read_b128 a[244:247], v5 offset:13312
    v_add_f32 v20, v20, v91
    v_mfma_f32_16x16x32_bf16 v[36:39], a[220:223], a[188:191], v[36:39]
    v_exp_f32 v92, v60
    v_mfma_f32_16x16x32_bf16 v[32:35], a[208:211], a[144:147], v[32:35]
    ds_read_b128 a[248:251], v5 offset:14336
    v_cvt_pk_bf16_f32 v75, v90, v91
    v_mfma_f32_16x16x32_bf16 v[32:35], a[212:215], a[148:151], v[32:35]
    v_exp_f32 v93, v61
    v_mfma_f32_16x16x32_bf16 v[32:35], a[216:219], a[152:155], v[32:35]
    ds_read_b128 a[252:255], v5 offset:15360
    v_add_f32 v21, v21, v92
    v_mfma_f32_16x16x32_bf16 v[32:35], a[220:223], a[156:159], v[32:35]
    v_add_f32 v21, v21, v93
    s_waitcnt lgkmcnt(4)
    v_mfma_f32_16x16x32_bf16 v[40:43], a[224:227], a[128:131], v[104:107]
    ds_read_b128 a[192:195], v6 offset:0
    v_cvt_pk_bf16_f32 v78, v92, v93
    v_mfma_f32_16x16x32_bf16 v[40:43], a[228:231], a[132:135], v[40:43]
    v_exp_f32 v94, v62
    v_mfma_f32_16x16x32_bf16 v[40:43], a[232:235], a[136:139], v[40:43]
    ds_read_b128 a[196:199], v6 offset:1024
    v_add_f32 v21, v21, v94
    v_mfma_f32_16x16x32_bf16 v[40:43], a[236:239], a[140:143], v[40:43]
    v_exp_f32 v95, v63
    v_mfma_f32_16x16x32_bf16 v[44:47], a[224:227], a[160:163], v[108:111]
    ds_read_b128 a[200:203], v6 offset:2048
    s_add_u32 m0, s22, 16384
    v_mfma_f32_16x16x32_bf16 v[44:47], a[228:231], a[164:167], v[44:47]
    buffer_load_dwordx4 v4, s[12:15], s23 offen offset:0 lds
    v_mfma_f32_16x16x32_bf16 v[44:47], a[232:235], a[168:171], v[44:47]
    ds_read_b128 a[204:207], v6 offset:3072
    v_add_f32 v21, v21, v95
    v_mfma_f32_16x16x32_bf16 v[44:47], a[236:239], a[172:175], v[44:47]
    v_cvt_pk_bf16_f32 v79, v94, v95
    s_waitcnt lgkmcnt(4)
    v_mfma_f32_16x16x32_bf16 v[44:47], a[240:243], a[176:179], v[44:47]
    ds_read_b128 a[208:211], v6 offset:4096
    v_max_f32 v9, v20, v21
    v_mfma_f32_16x16x32_bf16 v[44:47], a[244:247], a[180:183], v[44:47]
    buffer_load_dwordx4 v4, s[12:15], s23 offen offset:1024 lds
    v_mfma_f32_16x16x32_bf16 v[44:47], a[248:251], a[184:187], v[44:47]
    ds_read_b128 a[212:215], v6 offset:5120
    v_cmp_lt_f32 vcc, s37, v9
    v_mfma_f32_16x16x32_bf16 v[44:47], a[252:255], a[188:191], v[44:47]
    buffer_load_dwordx4 v4, s[12:15], s23 offen offset:2048 lds
    v_mfma_f32_16x16x32_bf16 v[40:43], a[240:243], a[144:147], v[40:43]
    ds_read_b128 a[216:219], v6 offset:6144
    v_mfma_f32_16x16x32_bf16 v[40:43], a[244:247], a[148:151], v[40:43]
    buffer_load_dwordx4 v4, s[12:15], s23 offen offset:3072 lds
    v_mfma_f32_16x16x32_bf16 v[40:43], a[248:251], a[152:155], v[40:43]
    ds_read_b128 a[220:223], v6 offset:7168
    v_mfma_f32_16x16x32_bf16 v[40:43], a[252:255], a[156:159], v[40:43]
    s_cbranch_vccnz AT_full0_stub
AT_full0_back:
    s_waitcnt lgkmcnt(4)
    v_mfma_f32_16x16x32_bf16 v[128:131], a[192:195], v[72:75], v[128:131]
    ds_read_b128 a[224:227], v6 offset:8192
    v_add_f32 v18, v18, v20
    v_mfma_f32_16x16x32_bf16 v[132:135], a[192:195], v[76:79], v[132:135]
    v_exp_f32 v80, v32
    v_mfma_f32_16x16x32_bf16 v[140:143], a[196:199], v[76:79], v[140:143]
    ds_read_b128 a[228:231], v6 offset:9216
    v_add_f32 v19, v19, v21
    v_mfma_f32_16x16x32_bf16 v[136:139], a[196:199], v[72:75], v[136:139]
    v_exp_f32 v81, v33
    v_mfma_f32_16x16x32_bf16 v[144:147], a[200:203], v[72:75], v[144:147]
    ds_read_b128 a[232:235], v6 offset:10240
    v_readlane_b32 s27, v8, s20
    v_mfma_f32_16x16x32_bf16 v[148:151], a[200:203], v[76:79], v[148:151]
    v_exp_f32 v82, v34
    v_mfma_f32_16x16x32_bf16 v[156:159], a[204:207], v[76:79], v[156:159]
    ds_read_b128 a[236:239], v6 offset:11264
    v_add_f32 v20, v80, v81
    v_mfma_f32_16x16x32_bf16 v[152:155], a[204:207], v[72:75], v[152:155]
    v_cvt_pk_bf16_f32 v64, v80, v81
    s_waitcnt lgkmcnt(4)
    v_mfma_f32_16x16x32_bf16 v[160:163], a[208:211], v[72:75], v[160:163]
    ds_read_b128 a[240:243], v6 offset:12288
    v_add_f32 v20, v20, v82
    v_mfma_f32_16x16x32_bf16 v[164:167], a[208:211], v[76:79], v[164:167]
    v_exp_f32 v83, v35
    v_mfma_f32_16x16x32_bf16 v[172:175], a[212:215], v[76:79], v[172:175]
    ds_read_b128 a[244:247], v6 offset:13312
    v_add_f32 v20, v20, v83
    v_mfma_f32_16x16x32_bf16 v[168:171], a[212:215], v[72:75], v[168:171]
    v_exp_f32 v84, v36
    v_mfma_f32_16x16x32_bf16 v[176:179], a[216:219], v[72:75], v[176:179]
    ds_read_b128 a[248:251], v6 offset:14336
    v_cvt_pk_bf16_f32 v65, v82, v83
    v_mfma_f32_16x16x32_bf16 v[180:183], a[216:219], v[76:79], v[180:183]
    v_exp_f32 v85, v37
    v_mfma_f32_16x16x32_bf16 v[188:191], a[220:223], v[76:79], v[188:191]
    ds_read_b128 a[252:255], v6 offset:15360
    v_add_f32 v21, v84, v85
    v_mfma_f32_16x16x32_bf16 v[184:187], a[220:223], v[72:75], v[184:187]
    s_waitcnt vmcnt(12) lgkmcnt(4)
    s_barrier
    v_mfma_f32_16x16x32_bf16 v[192:195], a[224:227], v[72:75], v[192:195]
    ds_read_b128 a[192:195], v5 offset:16384
    v_cvt_pk_bf16_f32 v68, v84, v85
    v_mfma_f32_16x16x32_bf16 v[196:199], a[224:227], v[76:79], v[196:199]
    v_exp_f32 v86, v38
    v_mfma_f32_16x16x32_bf16 v[204:207], a[228:231], v[76:79], v[204:207]
    ds_read_b128 a[196:199], v5 offset:17408
    v_add_f32 v21, v21, v86
    v_mfma_f32_16x16x32_bf16 v[200:203], a[228:231], v[72:75], v[200:203]
    v_exp_f32 v87, v39
    v_mfma_f32_16x16x32_bf16 v[208:211], a[232:235], v[72:75], v[208:211]
    ds_read_b128 a[200:203], v5 offset:18432
    s_add_u32 m0, s22, 81920
    v_mfma_f32_16x16x32_bf16 v[212:215], a[232:235], v[76:79], v[212:215]
    buffer_load_dwordx4 v4, s[12:15], s27 offen offset:0 lds
    v_mfma_f32_16x16x32_bf16 v[220:223], a[236:239], v[76:79], v[220:223]
    ds_read_b128 a[204:207], v5 offset:19456
    v_add_f32 v21, v21, v87
    v_mfma_f32_16x16x32_bf16 v[216:219], a[236:239], v[72:75], v[216:219]
    v_cvt_pk_bf16_f32 v69, v86, v87
    s_waitcnt lgkmcnt(4)
    v_mfma_f32_16x16x32_bf16 v[224:227], a[240:243], v[72:75], v[224:227]
    ds_read_b128 a[208:211], v5 offset:20480
    v_mfma_f32_16x16x32_bf16 v[228:231], a[240:243], v[76:79], v[228:231]
    buffer_load_dwordx4 v4, s[12:15], s27 offen offset:1024 lds
    v_mfma_f32_16x16x32_bf16 v[236:239], a[244:247], v[76:79], v[236:239]
    ds_read_b128 a[212:215], v5 offset:21504
    v_mfma_f32_16x16x32_bf16 v[232:235], a[244:247], v[72:75], v[232:235]
    buffer_load_dwordx4 v4, s[12:15], s27 offen offset:2048 lds
    v_mfma_f32_16x16x32_bf16 v[240:243], a[248:251], v[72:75], v[240:243]
    ds_read_b128 a[216:219], v5 offset:22528
    s_add_u32 s20, s20, 1
    v_mfma_f32_16x16x32_bf16 v[244:247], a[248:251], v[76:79], v[244:247]
    buffer_load_dwordx4 v4, s[12:15], s27 offen offset:3072 lds
    v_mfma_f32_16x16x32_bf16 v[252:255], a[252:255], v[76:79], v[252:255]
    ds_read_b128 a[220:223], v5 offset:23552
    s_cmp_eq_u32 s20, s21
    v_mfma_f32_16x16x32_bf16 v[248:251], a[252:255], v[72:75], v[248:251]
    s_cbranch_scc1 AT_full_ret
AT_full_odd:
    s_waitcnt lgkmcnt(4)
    v_mfma_f32_16x16x32_bf16 v[48:51], a[192:195], a[128:131], v[96:99]
    ds_read_b128 a[224:227], v5 offset:24576
    s_xor_b32 s22, s22, 0x8000
    v_mfma_f32_16x16x32_bf16 v[48:51], a[196:199], a[132:135], v[48:51]
    v_exp_f32 v88, v40
    v_mfma_f32_16x16x32_bf16 v[48:51], a[200:203], a[136:139], v[48:51]
    ds_read_b128 a[228:231], v5 offset:25600
    v_readlane_b32 s23, v7, s20
    v_mfma_f32_16x16x32_bf16 v[48:51], a[204:207], a[140:143], v[48:51]
    v_exp_f32 v89, v41
    v_mfma_f32_16x16x32_bf16 v[52:55], a[192:195], a[160:163], v[100:103]
    ds_read_b128 a[232:235], v5 offset:26624
    v_add_f32 v20, v20, v88
    v_mfma_f32_16x16x32_bf16 v[52:55], a[196:199], a[164:167], v[52:55]
    v_exp_f32 v90, v42
    v_mfma_f32_16x16x32_bf16 v[52:55], a[200:203], a[168:171], v[52:55]
    ds_read_b128 a[236:239], v5 offset:27648
    v_add_f32 v20, v20, v89
    v_mfma_f32_16x16x32_bf16 v[52:55], a[204:207], a[172:175], v[52:55]
    v_cvt_pk_bf16_f32 v66, v88, v89
    s_waitcnt lgkmcnt(4)
    v_mfma_f32_16x16x32_bf16 v[52:55], a[208:211], a[176:179], v[52:55]
    ds_read_b128 a[240:243], v5 offset:28672
    v_add_f32 v20, v20, v90
    v_mfma_f32_16x16x32_bf16 v[52:55], a[212:215], a[180:183], v[52:55]
    v_exp_f32 v91, v43
    v_mfma_f32_16x16x32_bf16 v[52:55], a[216:219], a[184:187], v[52:55]
    ds_read_b128 a[244:247], v5 offset:29696
    v_add_f32 v20, v20, v91
    v_mfma_f32_16x16x32_bf16 v[52:55], a[220:223], a[188:191], v[52:55]
    v_exp_f32 v92, v44
    v_mfma_f32_16x16x32_bf16 v[48:51], a[208:211], a[144:147], v[48:51]
    ds_read_b128 a[248:251], v5 offset:30720
    v_cvt_pk_bf16_f32 v67, v90, v91
    v_mfma_f32_16x16x32_bf16 v[48:51], a[212:215], a[148:151], v[48:51]
    v_exp_f32 v93, v45
    v_mfma_f32_16x16x32_bf16 v[48:51], a[216:219], a[152:155], v[48:51]
    ds_read_b128 a[252:255], v5 offset:31744
    v_add_f32 v21, v21, v92
    v_mfma_f32_16x16x32_bf16 v[48:51], a[220:223], a[156:159], v[48:51]
    v_add_f32 v21, v21, v93
    s_waitcnt lgkmcnt(4)
    v_mfma_f32_16x16x32_bf16 v[56:59], a[224:227], a[128:131], v[104:107]
    ds_read_b128 a[192:195], v6 offset:16384
    v_cvt_pk_bf16_f32 v70, v92, v93
    v_mfma_f32_16x16x32_bf16 v[56:59], a[228:231], a[132:135], v[56:59]
    v_exp_f32 v94, v46
    v_mfma_f32_16x16x32_bf16 v[56:59], a[232:235], a[136:139], v[56:59]
    ds_read_b128 a[196:199], v6 offset:17408
    v_add_f32 v21, v21, v94
    v_mfma_f32_16x16x32_bf16 v[56:59], a[236:239], a[140:143], v[56:59]
    v_exp_f32 v95, v47
    v_mfma_f32_16x16x32_bf16 v[60:63], a[224:227], a[160:163], v[108:111]
    ds_read_b128 a[200:203], v6 offset:18432
    s_add_u32 m0, s22, 0
    v_mfma_f32_16x16x32_bf16 v[60:63], a[228:231], a[164:167], v[60:63]
    buffer_load_dwordx4 v4, s[12:15], s23 offen offset:0 lds
    v_mfma_f32_16x16x32_bf16 v[60:63], a[232:235], a[168:171], v[60:63]
    ds_read_b128 a[204:207], v6 offset:19456
    v_add_f32 v21, v21, v95
    v_mfma_f32_16x16x32_bf16 v[60:63], a[236:239], a[172:175], v[60:63]
    v_cvt_pk_bf16_f32 v71, v94, v95
    s_waitcnt lgkmcnt(4)
    v_mfma_f32_16x16x32_bf16 v[60:63], a[240:243], a[176:179], v[60:63]
    ds_read_b128 a[208:211], v6 offset:20480
    v_max_f32 v9, v20, v21
    v_mfma_f32_16x16x32_bf16 v[60:63], a[244:247], a[180:183], v[60:63]
    buffer_load_dwordx4 v4, s[12:15], s23 offen offset:1024 lds
    v_mfma_f32_16x16x32_bf16 v[60:63], a[248:251], a[184:187], v[60:63]
    ds_read_b128 a[212:215], v6 offset:21504
    v_cmp_lt_f32 vcc, s37, v9
    v_mfma_f32_16x16x32_bf16 v[60:63], a[252:255], a[188:191], v[60:63]
    buffer_load_dwordx4 v4, s[12:15], s23 offen offset:2048 lds
    v_mfma_f32_16x16x32_bf16 v[56:59], a[240:243], a[144:147], v[56:59]
    ds_read_b128 a[216:219], v6 offset:22528
    v_mfma_f32_16x16x32_bf16 v[56:59], a[244:247], a[148:151], v[56:59]
    buffer_load_dwordx4 v4, s[12:15], s23 offen offset:3072 lds
    v_mfma_f32_16x16x32_bf16 v[56:59], a[248:251], a[152:155], v[56:59]
    ds_read_b128 a[220:223], v6 offset:23552
    v_xor_b32 v5, 0x8000, v5
    v_mfma_f32_16x16x32_bf16 v[56:59], a[252:255], a[156:159], v[56:59]
    s_cbranch_vccnz AT_full1_stub
AT_full1_back:
    s_waitcnt lgkmcnt(4)
    v_mfma_f32_16x16x32_bf16 v[128:131], a[192:195], v[64:67], v[128:131]
    ds_read_b128 a[224:227], v6 offset:24576
    v_add_f32 v18, v18, v20
    v_mfma_f32_16x16x32_bf16 v[132:135], a[192:195], v[68:71], v[132:135]
    v_exp_f32 v80, v48
    v_mfma_f32_16x16x32_bf16 v[140:143], a[196:199], v[68:71], v[140:143]
    ds_read_b128 a[228:231], v6 offset:25600
    v_add_f32 v19, v19, v21
    v_mfma_f32_16x16x32_bf16 v[136:139], a[196:199], v[64:67], v[136:139]
    v_exp_f32 v81, v49
    v_mfma_f32_16x16x32_bf16 v[144:147], a[200:203], v[64:67], v[144:147]
    ds_read_b128 a[232:235], v6 offset:26624
    v_readlane_b32 s27, v8, s20
    v_mfma_f32_16x16x32_bf16 v[148:151], a[200:203], v[68:71], v[148:151]
    v_exp_f32 v82, v50
    v_mfma_f32_16x16x32_bf16 v[156:159], a[204:207], v[68:71], v[156:159]
    ds_read_b128 a[236:239], v6 offset:27648
    v_add_f32 v20, v80, v81
    v_mfma_f32_16x16x32_bf16 v[152:155], a[204:207], v[64:67], v[152:155]
    v_cvt_pk_bf16_f32 v72, v80, v81
    s_waitcnt lgkmcnt(4)
    v_mfma_f32_16x16x32_bf16 v[160:163], a[208:211], v[64:67], v[160:163]
    ds_read_b128 a[240:243], v6 offset:28672
    v_add_f32 v20, v20, v82
    v_mfma_f32_16x16x32_bf16 v[164:167], a[208:211], v[68:71], v[164:167]
    v_exp_f32 v83, v51
    v_mfma_f32_16x16x32_bf16 v[172:175], a[212:215], v[68:71], v[172:175]
    ds_read_b128 a[244:247], v6 offset:29696
    v_add_f32 v20, v20, v83
    v_mfma_f32_16x16x32_bf16 v[168:171], a[212:215], v[64:67], v[168:171]
    v_exp_f32 v84, v52
    v_mfma_f32_16x16x32_bf16 v[176:179], a[216:219], v[64:67], v[176:179]
    ds_read_b128 a[248:251], v6 offset:30720
    v_cvt_pk_bf16_f32 v73, v82, v83
    v_mfma_f32_16x16x32_bf16 v[180:183], a[216:219], v[68:71], v[180:183]
    v_exp_f32 v85, v53
    v_mfma_f32_16x16x32_bf16 v[188:191], a[220:223], v[68:71], v[188:191]
    ds_read_b128 a[252:255], v6 offset:31744
    v_add_f32 v21, v84, v85
    v_mfma_f32_16x16x32_bf16 v[184:187], a[220:223], v[64:67], v[184:187]
    s_waitcnt vmcnt(12) lgkmcnt(4)
    s_barrier
    v_mfma_f32_16x16x32_bf16 v[192:195], a[224:227], v[64:67], v[192:195]
    ds_read_b128 a[192:195], v5 offset:0
    v_xor_b32 v6, 0x8000, v6
    v_mfma_f32_16x16x32_bf16 v[196:199], a[224:227], v[68:71], v[196:199]
    v_exp_f32 v86, v54
    v_mfma_f32_16x16x32_bf16 v[204:207], a[228:231], v[68:71], v[204:207]
    ds_read_b128 a[196:199], v5 offset:1024
    v_cvt_pk_bf16_f32 v76, v84, v85
    v_mfma_f32_16x16x32_bf16 v[200:203], a[228:231], v[64:67], v[200:203]
    v_exp_f32 v87, v55
    v_mfma_f32_16x16x32_bf16 v[208:211], a[232:235], v[64:67], v[208:211]
    ds_read_b128 a[200:203], v5 offset:2048
    s_add_u32 m0, s22, 65536
    v_mfma_f32_16x16x32_bf16 v[212:215], a[232:235], v[68:71], v[212:215]
    buffer_load_dwordx4 v4, s[12:15], s27 offen offset:0 lds
    v_mfma_f32_16x16x32_bf16 v[220:223], a[236:239], v[68:71], v[220:223]
    ds_read_b128 a[204:207], v5 offset:3072
    v_add_f32 v21, v21, v86
    v_mfma_f32_16x16x32_bf16 v[216:219], a[236:239], v[64:67], v[216:219]
    v_add_f32 v21, v21, v87
    s_waitcnt lgkmcnt(4)
    v_mfma_f32_16x16x32_bf16 v[224:227], a[240:243], v[64:67], v[224:227]
    ds_read_b128 a[208:211], v5 offset:4096
    v_cvt_pk_bf16_f32 v77, v86, v87
    v_mfma_f32_16x16x32_bf16 v[228:231], a[240:243], v[68:71], v[228:231]
    buffer_load_dwordx4 v4, s[12:15], s27 offen offset:1024 lds
    v_mfma_f32_16x16x32_bf16 v[236:239], a[244:247], v[68:71], v[236:239]
    ds_read_b128 a[212:215], v5 offset:5120
    v_mfma_f32_16x16x32_bf16 v[232:235], a[244:247], v[64:67], v[232:235]
    buffer_load_dwordx4 v4, s[12:15], s27 offen offset:2048 lds
    v_mfma_f32_16x16x32_bf16 v[240:243], a[248:251], v[64:67], v[240:243]
    ds_read_b128 a[216:219], v5 offset:6144
    s_add_u32 s20, s20, 1
    v_mfma_f32_16x16x32_bf16 v[244:247], a[248:251], v[68:71], v[244:247]
    buffer_load_dwordx4 v4, s[12:15], s27 offen offset:3072 lds
    v_mfma_f32_16x16x32_bf16 v[252:255], a[252:255], v[68:71], v[252:255]
    ds_read_b128 a[220:223], v5 offset:7168
    s_cmp_eq_u32 s20, s21
    v_mfma_f32_16x16x32_bf16 v[248:251], a[252:255], v[64:67], v[248:251]
    s_cbranch_scc0 AT_full_even
AT_full_ret:
    s_setpc_b64 s[82:83]
AT_pvlast:
    s_bitcmp1_b32 s20, 0
    s_cbranch_scc0 AT_pvlast_odd
    s_waitcnt lgkmcnt(0)
    ds_read_b128 a[192:195], v6 offset:0
    ds_read_b128 a[196:199], v6 offset:1024
    ds_read_b128 a[200:203], v6 offset:2048
    ds_read_b128 a[204:207], v6 offset:3072
    ds_read_b128 a[208:211], v6 offset:4096
    ds_read_b128 a[212:215], v6 offset:5120
    ds_read_b128 a[216:219], v6 offset:6144
    ds_read_b128 a[220:223], v6 offset:7168
    v_readlane_b32 s23, v7, s20
    v_exp_f32 v88, v56
    v_exp_f32 v89, v57
    v_exp_f32 v90, v58
    v_exp_f32 v91, v59
    v_exp_f32 v92, v60
    v_exp_f32 v93, v61
    v_exp_f32 v94, v62
    v_exp_f32 v95, v63
    v_add_f32 v20, v20, v88
    v_add_f32 v20, v20, v89
    v_cvt_pk_bf16_f32 v74, v88, v89
    v_add_f32 v20, v20, v90
    v_add_f32 v20, v20, v91
    v_cvt_pk_bf16_f32 v75, v90, v91
    v_add_f32 v21, v21, v92
    v_add_f32 v21, v21, v93
    v_cvt_pk_bf16_f32 v78, v92, v93
    v_add_f32 v21, v21, v94
    v_add_f32 v21, v21, v95
    v_cvt_pk_bf16_f32 v79, v94, v95
    v_max_f32 v9, v20, v21
    v_cmp_lt_f32 vcc, s37, v9
    s_add_u32 m0, s22, 16384
    s_nop 3
    buffer_load_dwordx4 v4, s[12:15], s23 offen offset:0 lds
    buffer_load_dwordx4 v4, s[12:15], s23 offen offset:1024 lds
    buffer_load_dwordx4 v4, s[12:15], s23 offen offset:2048 lds
    buffer_load_dwordx4 v4, s[12:15], s23 offen offset:3072 lds
    s_cbranch_vccnz AT_pv0_stub
AT_pv0_back:
    s_waitcnt lgkmcnt(4)
    v_mfma_f32_16x16x32_bf16 v[128:131], a[192:195], v[72:75], v[128:131]
    ds_read_b128 a[224:227], v6 offset:8192
    v_mfma_f32_16x16x32_bf16 v[132:135], a[192:195], v[76:79], v[132:135]
    v_add_f32 v18, v18, v20
    v_add_f32 v19, v19, v21
    v_mfma_f32_16x16x32_bf16 v[140:143], a[196:199], v[76:79], v[140:143]
    ds_read_b128 a[228:231], v6 offset:9216
    v_mfma_f32_16x16x32_bf16 v[136:139], a[196:199], v[72:75], v[136:139]
    v_mfma_f32_16x16x32_bf16 v[144:147], a[200:203], v[72:75], v[144:147]
    ds_read_b128 a[232:235], v6 offset:10240
    v_readlane_b32 s27, v8, s20
    v_mfma_f32_16x16x32_bf16 v[148:151], a[200:203], v[76:79], v[148:151]
    v_mfma_f32_16x16x32_bf16 v[156:159], a[204:207], v[76:79], v[156:159]
    ds_read_b128 a[236:239], v6 offset:11264
    v_mfma_f32_16x16x32_bf16 v[152:155], a[204:207], v[72:75], v[152:155]
    s_waitcnt lgkmcnt(4)
    v_mfma_f32_16x16x32_bf16 v[160:163], a[208:211], v[72:75], v[160:163]
    ds_read_b128 a[240:243], v6 offset:12288
    v_mfma_f32_16x16x32_bf16 v[164:167], a[208:211], v[76:79], v[164:167]
    v_mfma_f32_16x16x32_bf16 v[172:175], a[212:215], v[76:79], v[172:175]
    ds_read_b128 a[244:247], v6 offset:13312
    v_mfma_f32_16x16x32_bf16 v[168:171], a[212:215], v[72:75], v[168:171]
    v_mfma_f32_16x16x32_bf16 v[176:179], a[216:219], v[72:75], v[176:179]
    ds_read_b128 a[248:251], v6 offset:14336
    v_mfma_f32_16x16x32_bf16 v[180:183], a[216:219], v[76:79], v[180:183]
    v_mfma_f32_16x16x32_bf16 v[188:191], a[220:223], v[76:79], v[188:191]
    ds_read_b128 a[252:255], v6 offset:15360
    v_mfma_f32_16x16x32_bf16 v[184:187], a[220:223], v[72:75], v[184:187]
    s_waitcnt vmcnt(12) lgkmcnt(4)
    s_barrier
    v_mfma_f32_16x16x32_bf16 v[192:195], a[224:227], v[72:75], v[192:195]
    ds_read_b128 a[192:195], v5 offset:16384
    v_mfma_f32_16x16x32_bf16 v[196:199], a[224:227], v[76:79], v[196:199]
    v_mfma_f32_16x16x32_bf16 v[204:207], a[228:231], v[76:79], v[204:207]
    ds_read_b128 a[196:199], v5 offset:17408
    v_mfma_f32_16x16x32_bf16 v[200:203], a[228:231], v[72:75], v[200:203]
    v_mfma_f32_16x16x32_bf16 v[208:211], a[232:235], v[72:75], v[208:211]
    ds_read_b128 a[200:203], v5 offset:18432
    s_add_u32 m0, s22, 81920
    v_mfma_f32_16x16x32_bf16 v[212:215], a[232:235], v[76:79], v[212:215]
    buffer_load_dwordx4 v4, s[12:15], s27 offen offset:0 lds
    v_mfma_f32_16x16x32_bf16 v[220:223], a[236:239], v[76:79], v[220:223]
    ds_read_b128 a[204:207], v5 offset:19456
    v_mfma_f32_16x16x32_bf16 v[216:219], a[236:239], v[72:75], v[216:219]
    s_waitcnt lgkmcnt(4)
    v_mfma_f32_16x16x32_bf16 v[224:227], a[240:243], v[72:75], v[224:227]
    ds_read_b128 a[208:211], v5 offset:20480
    v_mfma_f32_16x16x32_bf16 v[228:231], a[240:243], v[76:79], v[228:231]
    buffer_load_dwordx4 v4, s[12:15], s27 offen offset:1024 lds
    v_mfma_f32_16x16x32_bf16 v[236:239], a[244:247], v[76:79], v[236:239]
    ds_read_b128 a[212:215], v5 offset:21504
    v_mfma_f32_16x16x32_bf16 v[232:235], a[244:247], v[72:75], v[232:235]
    buffer_load_dwordx4 v4, s[12:15], s27 offen offset:2048 lds
    v_mfma_f32_16x16x32_bf16 v[240:243], a[248:251], v[72:75], v[240:243]
    ds_read_b128 a[216:219], v5 offset:22528
    s_add_u32 s20, s20, 1
    v_mfma_f32_16x16x32_bf16 v[244:247], a[248:251], v[76:79], v[244:247]
    buffer_load_dwordx4 v4, s[12:15], s27 offen offset:3072 lds
    v_mfma_f32_16x16x32_bf16 v[252:255], a[252:255], v[76:79], v[252:255]
    ds_read_b128 a[220:223], v5 offset:23552
    v_mfma_f32_16x16x32_bf16 v[248:251], a[252:255], v[72:75], v[248:251]
    s_setpc_b64 s[82:83]
AT_pvlast_odd:
    s_waitcnt lgkmcnt(0)
    ds_read_b128 a[192:195], v6 offset:16384
    ds_read_b128 a[196:199], v6 offset:17408
    ds_read_b128 a[200:203], v6 offset:18432
    ds_read_b128 a[204:207], v6 offset:19456
    ds_read_b128 a[208:211], v6 offset:20480
    ds_read_b128 a[212:215], v6 offset:21504
    ds_read_b128 a[216:219], v6 offset:22528
    ds_read_b128 a[220:223], v6 offset:23552
    s_xor_b32 s22, s22, 0x8000
    v_readlane_b32 s23, v7, s20
    v_exp_f32 v88, v40
    v_exp_f32 v89, v41
    v_exp_f32 v90, v42
    v_exp_f32 v91, v43
    v_exp_f32 v92, v44
    v_exp_f32 v93, v45
    v_exp_f32 v94, v46
    v_exp_f32 v95, v47
    v_add_f32 v20, v20, v88
    v_add_f32 v20, v20, v89
    v_cvt_pk_bf16_f32 v66, v88, v89
    v_add_f32 v20, v20, v90
    v_add_f32 v20, v20, v91
    v_cvt_pk_bf16_f32 v67, v90, v91
    v_add_f32 v21, v21, v92
    v_add_f32 v21, v21, v93
    v_cvt_pk_bf16_f32 v70, v92, v93
    v_add_f32 v21, v21, v94
    v_add_f32 v21, v21, v95
    v_cvt_pk_bf16_f32 v71, v94, v95
    v_max_f32 v9, v20, v21
    v_cmp_lt_f32 vcc, s37, v9
    s_add_u32 m0, s22, 0
    s_nop 3
    buffer_load_dwordx4 v4, s[12:15], s23 offen offset:0 lds
    buffer_load_dwordx4 v4, s[12:15], s23 offen offset:1024 lds
    buffer_load_dwordx4 v4, s[12:15], s23 offen offset:2048 lds
    buffer_load_dwordx4 v4, s[12:15], s23 offen offset:3072 lds
    v_xor_b32 v5, 0x8000, v5
    s_cbranch_vccnz AT_pv1_stub
AT_pv1_back:
    s_waitcnt lgkmcnt(4)
    v_mfma_f32_16x16x32_bf16 v[128:131], a[192:195], v[64:67], v[128:131]
    ds_read_b128 a[224:227], v6 offset:24576
    v_mfma_f32_16x16x32_bf16 v[132:135], a[192:195], v[68:71], v[132:135]
    v_add_f32 v18, v18, v20
    v_add_f32 v19, v19, v21
    v_mfma_f32_16x16x32_bf16 v[140:143], a[196:199], v[68:71], v[140:143]
    ds_read_b128 a[228:231], v6 offset:25600
    v_mfma_f32_16x16x32_bf16 v[136:139], a[196:199], v[64:67], v[136:139]
    v_mfma_f32_16x16x32_bf16 v[144:147], a[200:203], v[64:67], v[144:147]
    ds_read_b128 a[232:235], v6 offset:26624
    v_readlane_b32 s27, v8, s20
    v_mfma_f32_16x16x32_bf16 v[148:151], a[200:203], v[68:71], v[148:151]
    v_mfma_f32_16x16x32_bf16 v[156:159], a[204:207], v[68:71], v[156:159]
    ds_read_b128 a[236:239], v6 offset:27648
    v_mfma_f32_16x16x32_bf16 v[152:155], a[204:207], v[64:67], v[152:155]
    s_waitcnt lgkmcnt(4)
    v_mfma_f32_16x16x32_bf16 v[160:163], a[208:211], v[64:67], v[160:163]
    ds_read_b128 a[240:243], v6 offset:28672
    v_mfma_f32_16x16x32_bf16 v[164:167], a[208:211], v[68:71], v[164:167]
    v_mfma_f32_16x16x32_bf16 v[172:175], a[212:215], v[68:71], v[172:175]
    ds_read_b128 a[244:247], v6 offset:29696
    v_mfma_f32_16x16x32_bf16 v[168:171], a[212:215], v[64:67], v[168:171]
    v_mfma_f32_16x16x32_bf16 v[176:179], a[216:219], v[64:67], v[176:179]
    ds_read_b128 a[248:251], v6 offset:30720
    v_mfma_f32_16x16x32_bf16 v[180:183], a[216:219], v[68:71], v[180:183]
    v_mfma_f32_16x16x32_bf16 v[188:191], a[220:223], v[68:71], v[188:191]
    ds_read_b128 a[252:255], v6 offset:31744
    v_mfma_f32_16x16x32_bf16 v[184:187], a[220:223], v[64:67], v[184:187]
    s_waitcnt vmcnt(12) lgkmcnt(4)
    s_barrier
    v_mfma_f32_16x16x32_bf16 v[192:195], a[224:227], v[64:67], v[192:195]
    ds_read_b128 a[192:195], v5 offset:0
    v_xor_b32 v6, 0x8000, v6
    v_mfma_f32_16x16x32_bf16 v[196:199], a[224:227], v[68:71], v[196:199]
    v_mfma_f32_16x16x32_bf16 v[204:207], a[228:231], v[68:71], v[204:207]
    ds_read_b128 a[196:199], v5 offset:1024
    v_mfma_f32_16x16x32_bf16 v[200:203], a[228:231], v[64:67], v[200:203]
    v_mfma_f32_16x16x32_bf16 v[208:211], a[232:235], v[64:67], v[208:211]
    ds_read_b128 a[200:203], v5 offset:2048
    s_add_u32 m0, s22, 65536
    v_mfma_f32_16x16x32_bf16 v[212:215], a[232:235], v[68:71], v[212:215]
    buffer_load_dwordx4 v4, s[12:15], s27 offen offset:0 lds
    v_mfma_f32_16x16x32_bf16 v[220:223], a[236:239], v[68:71], v[220:223]
    ds_read_b128 a[204:207], v5 offset:3072
    v_mfma_f32_16x16x32_bf16 v[216:219], a[236:239], v[64:67], v[216:219]
    s_waitcnt lgkmcnt(4)
    v_mfma_f32_16x16x32_bf16 v[224:227], a[240:243], v[64:67], v[224:227]
    ds_read_b128 a[208:211], v5 offset:4096
    v_mfma_f32_16x16x32_bf16 v[228:231], a[240:243], v[68:71], v[228:231]
    buffer_load_dwordx4 v4, s[12:15], s27 offen offset:1024 lds
    v_mfma_f32_16x16x32_bf16 v[236:239], a[244:247], v[68:71], v[236:239]
    ds_read_b128 a[212:215], v5 offset:5120
    v_mfma_f32_16x16x32_bf16 v[232:235], a[244:247], v[64:67], v[232:235]
    buffer_load_dwordx4 v4, s[12:15], s27 offen offset:2048 lds
    v_mfma_f32_16x16x32_bf16 v[240:243], a[248:251], v[64:67], v[240:243]
    ds_read_b128 a[216:219], v5 offset:6144
    s_add_u32 s20, s20, 1
    v_mfma_f32_16x16x32_bf16 v[244:247], a[248:251], v[68:71], v[244:247]
    buffer_load_dwordx4 v4, s[12:15], s27 offen offset:3072 lds
    v_mfma_f32_16x16x32_bf16 v[252:255], a[252:255], v[68:71], v[252:255]
    ds_read_b128 a[220:223], v5 offset:7168
    v_mfma_f32_16x16x32_bf16 v[248:251], a[252:255], v[64:67], v[248:251]
    s_setpc_b64 s[82:83]
AT_idle:
    s_bitcmp1_b32 s20, 0
    s_cbranch_scc0 AT_idle_odd
    .p2align 4
AT_idle_even:
    s_waitcnt lgkmcnt(0)
    v_readlane_b32 s23, v7, s20
    s_add_u32 m0, s22, 16384
    s_nop 3
    buffer_load_dwordx4 v4, s[12:15], s23 offen offset:0 lds
    buffer_load_dwordx4 v4, s[12:15], s23 offen offset:1024 lds
    buffer_load_dwordx4 v4, s[12:15], s23 offen offset:2048 lds
    buffer_load_dwordx4 v4, s[12:15], s23 offen offset:3072 lds
    v_readlane_b32 s27, v8, s20
    s_waitcnt vmcnt(12)
    s_barrier
    ds_read_b128 a[192:195], v5 offset:16384
    ds_read_b128 a[196:199], v5 offset:17408
    ds_read_b128 a[200:203], v5 offset:18432
    s_add_u32 m0, s22, 81920
    s_nop 3
    buffer_load_dwordx4 v4, s[12:15], s27 offen offset:0 lds
    ds_read_b128 a[204:207], v5 offset:19456
    ds_read_b128 a[208:211], v5 offset:20480
    buffer_load_dwordx4 v4, s[12:15], s27 offen offset:1024 lds
    ds_read_b128 a[212:215], v5 offset:21504
    buffer_load_dwordx4 v4, s[12:15], s27 offen offset:2048 lds
    ds_read_b128 a[216:219], v5 offset:22528
    s_add_u32 s20, s20, 1
    buffer_load_dwordx4 v4, s[12:15], s27 offen offset:3072 lds
    ds_read_b128 a[220:223], v5 offset:23552
    s_cmp_eq_u32 s20, s21
    s_cbranch_scc1 AT_idle_ret
AT_idle_odd:
    s_waitcnt lgkmcnt(0)
    s_xor_b32 s22, s22, 0x8000
    v_readlane_b32 s23, v7, s20
    s_add_u32 m0, s22, 0
    s_nop 3
    buffer_load_dwordx4 v4, s[12:15], s23 offen offset:0 lds
    buffer_load_dwordx4 v4, s[12:15], s23 offen offset:1024 lds
    buffer_load_dwordx4 v4, s[12:15], s23 offen offset:2048 lds
    buffer_load_dwordx4 v4, s[12:15], s23 offen offset:3072 lds
    v_xor_b32 v5, 0x8000, v5
    v_readlane_b32 s27, v8, s20
    s_waitcnt vmcnt(12)
    s_barrier
    ds_read_b128 a[192:195], v5 offset:0
    v_xor_b32 v6, 0x8000, v6
    ds_read_b128 a[196:199], v5 offset:1024
    ds_read_b128 a[200:203], v5 offset:2048
    s_add_u32 m0, s22, 65536
    s_nop 3
    buffer_load_dwordx4 v4, s[12:15], s27 offen offset:0 lds
    ds_read_b128 a[204:207], v5 offset:3072
    ds_read_b128 a[208:211], v5 offset:4096
    buffer_load_dwordx4 v4, s[12:15], s27 offen offset:1024 lds
    ds_read_b128 a[212:215], v5 offset:5120
    buffer_load_dwordx4 v4, s[12:15], s27 offen offset:2048 lds
    ds_read_b128 a[216:219], v5 offset:6144
    s_add_u32 s20, s20, 1
    buffer_load_dwordx4 v4, s[12:15], s27 offen offset:3072 lds
    ds_read_b128 a[220:223], v5 offset:7168
    s_cmp_eq_u32 s20, s21
    s_cbranch_scc0 AT_idle_even
AT_idle_ret:
    s_setpc_b64 s[82:83]
AT_full0_stub:
    s_call_b64 s[84:85], AT_rescale0
    s_branch AT_full0_back
AT_full1_stub:
    s_call_b64 s[84:85], AT_rescale1
    s_branch AT_full1_back
AT_pv0_stub:
    s_call_b64 s[84:85], AT_rescale0
    s_branch AT_pv0_back
AT_pv1_stub:
    s_call_b64 s[84:85], AT_rescale1
    s_branch AT_pv1_back
AT_rescale0:
    s_nop 7
    v_max3_f32 v9, v48, v49, v50
    v_max3_f32 v9, v9, v51, v56
    v_max3_f32 v9, v9, v57, v58
    v_max3_f32 v9, v9, v59, 0
    v_mov_b32 v11, v9
    s_nop 1
    v_permlane16_swap_b32 v9, v11
    s_nop 1
    v_max_f32 v9, v9, v11
    v_mov_b32 v11, v9
    s_nop 1
    v_permlane32_swap_b32 v9, v11
    s_nop 1
    v_max_f32 v9, v9, v11
    v_exp_f32 v10, -v9
    v_sub_f32 v16, v16, v9
    v_mul_f32 v18, v18, v10
    v_sub_f32 v48, v48, v9
    v_sub_f32 v32, v32, v9
    v_sub_f32 v96, v96, v9
    v_sub_f32 v49, v49, v9
    v_sub_f32 v33, v33, v9
    v_sub_f32 v97, v97, v9
    v_sub_f32 v50, v50, v9
    v_sub_f32 v34, v34, v9
    v_sub_f32 v98, v98, v9
    v_sub_f32 v51, v51, v9
    v_sub_f32 v35, v35, v9
    v_sub_f32 v99, v99, v9
    v_sub_f32 v56, v56, v9
    v_sub_f32 v40, v40, v9
    v_sub_f32 v104, v104, v9
    v_sub_f32 v57, v57, v9
    v_sub_f32 v41, v41, v9
    v_sub_f32 v105, v105, v9
    v_sub_f32 v58, v58, v9
    v_sub_f32 v42, v42, v9
    v_sub_f32 v106, v106, v9
    v_sub_f32 v59, v59, v9
    v_sub_f32 v43, v43, v9
    v_sub_f32 v107, v107, v9
    v_mul_f32 v128, v128, v10
    v_mul_f32 v129, v129, v10
    v_mul_f32 v130, v130, v10
    v_mul_f32 v131, v131, v10
    v_mul_f32 v136, v136, v10
    v_mul_f32 v137, v137, v10
    v_mul_f32 v138, v138, v10
    v_mul_f32 v139, v139, v10
    v_mul_f32 v144, v144, v10
    v_mul_f32 v145, v145, v10
    v_mul_f32 v146, v146, v10
    v_mul_f32 v147, v147, v10
    v_mul_f32 v152, v152, v10
    v_mul_f32 v153, v153, v10
    v_mul_f32 v154, v154, v10
    v_mul_f32 v155, v155, v10
    v_mul_f32 v160, v160, v10
    v_mul_f32 v161, v161, v10
    v_mul_f32 v162, v162, v10
    v_mul_f32 v163, v163, v10
    v_mul_f32 v168, v168, v10
    v_mul_f32 v169, v169, v10
    v_mul_f32 v170, v170, v10
    v_mul_f32 v171, v171, v10
    v_mul_f32 v176, v176, v10
    v_mul_f32 v177, v177, v10
    v_mul_f32 v178, v178, v10
    v_mul_f32 v179, v179, v10
    v_mul_f32 v184, v184, v10
    v_mul_f32 v185, v185, v10
    v_mul_f32 v186, v186, v10
    v_mul_f32 v187, v187, v10
    v_mul_f32 v192, v192, v10
    v_mul_f32 v193, v193, v10
    v_mul_f32 v194, v194, v10
    v_mul_f32 v195, v195, v10
    v_mul_f32 v200, v200, v10
    v_mul_f32 v201, v201, v10
    v_mul_f32 v202, v202, v10
    v_mul_f32 v203, v203, v10
    v_mul_f32 v208, v208, v10
    v_mul_f32 v209, v209, v10
    v_mul_f32 v210, v210, v10
    v_mul_f32 v211, v211, v10
    v_mul_f32 v216, v216, v10
    v_mul_f32 v217, v217, v10
    v_mul_f32 v218, v218, v10
    v_mul_f32 v219, v219, v10
    v_mul_f32 v224, v224, v10
    v_mul_f32 v225, v225, v10
    v_mul_f32 v226, v226, v10
    v_mul_f32 v227, v227, v10
    v_mul_f32 v232, v232, v10
    v_mul_f32 v233, v233, v10
    v_mul_f32 v234, v234, v10
    v_mul_f32 v235, v235, v10
    v_mul_f32 v240, v240, v10
    v_mul_f32 v241, v241, v10
    v_mul_f32 v242, v242, v10
    v_mul_f32 v243, v243, v10
    v_mul_f32 v248, v248, v10
    v_mul_f32 v249, v249, v10
    v_mul_f32 v250, v250, v10
    v_mul_f32 v251, v251, v10
    v_max3_f32 v9, v52, v53, v54
    v_max3_f32 v9, v9, v55, v60
    v_max3_f32 v9, v9, v61, v62
    v_max3_f32 v9, v9, v63, 0
    v_mov_b32 v11, v9
    s_nop 1
    v_permlane16_swap_b32 v9, v11
    s_nop 1
    v_max_f32 v9, v9, v11
    v_mov_b32 v11, v9
    s_nop 1
    v_permlane32_swap_b32 v9, v11
    s_nop 1
    v_max_f32 v9, v9, v11
    v_exp_f32 v10, -v9
    v_sub_f32 v17, v17, v9
    v_mul_f32 v19, v19, v10
    v_sub_f32 v52, v52, v9
    v_sub_f32 v36, v36, v9
    v_sub_f32 v100, v100, v9
    v_sub_f32 v53, v53, v9
    v_sub_f32 v37, v37, v9
    v_sub_f32 v101, v101, v9
    v_sub_f32 v54, v54, v9
    v_sub_f32 v38, v38, v9
    v_sub_f32 v102, v102, v9
    v_sub_f32 v55, v55, v9
    v_sub_f32 v39, v39, v9
    v_sub_f32 v103, v103, v9
    v_sub_f32 v60, v60, v9
    v_sub_f32 v44, v44, v9
    v_sub_f32 v108, v108, v9
    v_sub_f32 v61, v61, v9
    v_sub_f32 v45, v45, v9
    v_sub_f32 v109, v109, v9
    v_sub_f32 v62, v62, v9
    v_sub_f32 v46, v46, v9
    v_sub_f32 v110, v110, v9
    v_sub_f32 v63, v63, v9
    v_sub_f32 v47, v47, v9
    v_sub_f32 v111, v111, v9
    v_mul_f32 v132, v132, v10
    v_mul_f32 v133, v133, v10
    v_mul_f32 v134, v134, v10
    v_mul_f32 v135, v135, v10
    v_mul_f32 v140, v140, v10
    v_mul_f32 v141, v141, v10
    v_mul_f32 v142, v142, v10
    v_mul_f32 v143, v143, v10
    v_mul_f32 v148, v148, v10
    v_mul_f32 v149, v149, v10
    v_mul_f32 v150, v150, v10
    v_mul_f32 v151, v151, v10
    v_mul_f32 v156, v156, v10
    v_mul_f32 v157, v157, v10
    v_mul_f32 v158, v158, v10
    v_mul_f32 v159, v159, v10
    v_mul_f32 v164, v164, v10
    v_mul_f32 v165, v165, v10
    v_mul_f32 v166, v166, v10
    v_mul_f32 v167, v167, v10
    v_mul_f32 v172, v172, v10
    v_mul_f32 v173, v173, v10
    v_mul_f32 v174, v174, v10
    v_mul_f32 v175, v175, v10
    v_mul_f32 v180, v180, v10
    v_mul_f32 v181, v181, v10
    v_mul_f32 v182, v182, v10
    v_mul_f32 v183, v183, v10
    v_mul_f32 v188, v188, v10
    v_mul_f32 v189, v189, v10
    v_mul_f32 v190, v190, v10
    v_mul_f32 v191, v191, v10
    v_mul_f32 v196, v196, v10
    v_mul_f32 v197, v197, v10
    v_mul_f32 v198, v198, v10
    v_mul_f32 v199, v199, v10
    v_mul_f32 v204, v204, v10
    v_mul_f32 v205, v205, v10
    v_mul_f32 v206, v206, v10
    v_mul_f32 v207, v207, v10
    v_mul_f32 v212, v212, v10
    v_mul_f32 v213, v213, v10
    v_mul_f32 v214, v214, v10
    v_mul_f32 v215, v215, v10
    v_mul_f32 v220, v220, v10
    v_mul_f32 v221, v221, v10
    v_mul_f32 v222, v222, v10
    v_mul_f32 v223, v223, v10
    v_mul_f32 v228, v228, v10
    v_mul_f32 v229, v229, v10
    v_mul_f32 v230, v230, v10
    v_mul_f32 v231, v231, v10
    v_mul_f32 v236, v236, v10
    v_mul_f32 v237, v237, v10
    v_mul_f32 v238, v238, v10
    v_mul_f32 v239, v239, v10
    v_mul_f32 v244, v244, v10
    v_mul_f32 v245, v245, v10
    v_mul_f32 v246, v246, v10
    v_mul_f32 v247, v247, v10
    v_mul_f32 v252, v252, v10
    v_mul_f32 v253, v253, v10
    v_mul_f32 v254, v254, v10
    v_mul_f32 v255, v255, v10
    v_exp_f32 v80, v48
    v_exp_f32 v81, v49
    v_exp_f32 v82, v50
    v_exp_f32 v83, v51
    v_exp_f32 v84, v52
    v_exp_f32 v85, v53
    v_exp_f32 v86, v54
    v_exp_f32 v87, v55
    v_add_f32 v20, v80, v81
    v_cvt_pk_bf16_f32 v72, v80, v81
    v_add_f32 v20, v20, v82
    v_add_f32 v20, v20, v83
    v_cvt_pk_bf16_f32 v73, v82, v83
    v_add_f32 v21, v84, v85
    v_cvt_pk_bf16_f32 v76, v84, v85
    v_add_f32 v21, v21, v86
    v_add_f32 v21, v21, v87
    v_cvt_pk_bf16_f32 v77, v86, v87
    v_exp_f32 v88, v56
    v_exp_f32 v89, v57
    v_exp_f32 v90, v58
    v_exp_f32 v91, v59
    v_exp_f32 v92, v60
    v_exp_f32 v93, v61
    v_exp_f32 v94, v62
    v_exp_f32 v95, v63
    v_add_f32 v20, v20, v88
    v_add_f32 v20, v20, v89
    v_cvt_pk_bf16_f32 v74, v88, v89
    v_add_f32 v20, v20, v90
    v_add_f32 v20, v20, v91
    v_cvt_pk_bf16_f32 v75, v90, v91
    v_add_f32 v21, v21, v92
    v_add_f32 v21, v21, v93
    v_cvt_pk_bf16_f32 v78, v92, v93
    v_add_f32 v21, v21, v94
    v_add_f32 v21, v21, v95
    v_cvt_pk_bf16_f32 v79, v94, v95
    v_exp_f32 v80, v32
    s_nop 1
    s_setpc_b64 s[84:85]
AT_rescale1:
    s_nop 7
    v_max3_f32 v9, v32, v33, v34
    v_max3_f32 v9, v9, v35, v40
    v_max3_f32 v9, v9, v41, v42
    v_max3_f32 v9, v9, v43, 0
    v_mov_b32 v11, v9
    s_nop 1
    v_permlane16_swap_b32 v9, v11
    s_nop 1
    v_max_f32 v9, v9, v11
    v_mov_b32 v11, v9
    s_nop 1
    v_permlane32_swap_b32 v9, v11
    s_nop 1
    v_max_f32 v9, v9, v11
    v_exp_f32 v10, -v9
    v_sub_f32 v16, v16, v9
    v_mul_f32 v18, v18, v10
    v_sub_f32 v32, v32, v9
    v_sub_f32 v48, v48, v9
    v_sub_f32 v96, v96, v9
    v_sub_f32 v33, v33, v9
    v_sub_f32 v49, v49, v9
    v_sub_f32 v97, v97, v9
    v_sub_f32 v34, v34, v9
    v_sub_f32 v50, v50, v9
    v_sub_f32 v98, v98, v9
    v_sub_f32 v35, v35, v9
    v_sub_f32 v51, v51, v9
    v_sub_f32 v99, v99, v9
    v_sub_f32 v40, v40, v9
    v_sub_f32 v56, v56, v9
    v_sub_f32 v104, v104, v9
    v_sub_f32 v41, v41, v9
    v_sub_f32 v57, v57, v9
    v_sub_f32 v105, v105, v9
    v_sub_f32 v42, v42, v9
    v_sub_f32 v58, v58, v9
    v_sub_f32 v106, v106, v9
    v_sub_f32 v43, v43, v9
    v_sub_f32 v59, v59, v9
    v_sub_f32 v107, v107, v9
    v_mul_f32 v128, v128, v10
    v_mul_f32 v129, v129, v10
    v_mul_f32 v130, v130, v10
    v_mul_f32 v131, v131, v10
    v_mul_f32 v136, v136, v10
    v_mul_f32 v137, v137, v10
    v_mul_f32 v138, v138, v10
    v_mul_f32 v139, v139, v10
    v_mul_f32 v144, v144, v10
    v_mul_f32 v145, v145, v10
    v_mul_f32 v146, v146, v10
    v_mul_f32 v147, v147, v10
    v_mul_f32 v152, v152, v10
    v_mul_f32 v153, v153, v10
    v_mul_f32 v154, v154, v10
    v_mul_f32 v155, v155, v10
    v_mul_f32 v160, v160, v10
    v_mul_f32 v161, v161, v10
    v_mul_f32 v162, v162, v10
    v_mul_f32 v163, v163, v10
    v_mul_f32 v168, v168, v10
    v_mul_f32 v169, v169, v10
    v_mul_f32 v170, v170, v10
    v_mul_f32 v171, v171, v10
    v_mul_f32 v176, v176, v10
    v_mul_f32 v177, v177, v10
    v_mul_f32 v178, v178, v10
    v_mul_f32 v179, v179, v10
    v_mul_f32 v184, v184, v10
    v_mul_f32 v185, v185, v10
    v_mul_f32 v186, v186, v10
    v_mul_f32 v187, v187, v10
    v_mul_f32 v192, v192, v10
    v_mul_f32 v193, v193, v10
    v_mul_f32 v194, v194, v10
    v_mul_f32 v195, v195, v10
    v_mul_f32 v200, v200, v10
    v_mul_f32 v201, v201, v10
    v_mul_f32 v202, v202, v10
    v_mul_f32 v203, v203, v10
    v_mul_f32 v208, v208, v10
    v_mul_f32 v209, v209, v10
    v_mul_f32 v210, v210, v10
    v_mul_f32 v211, v211, v10
    v_mul_f32 v216, v216, v10
    v_mul_f32 v217, v217, v10
    v_mul_f32 v218, v218, v10
    v_mul_f32 v219, v219, v10
    v_mul_f32 v224, v224, v10
    v_mul_f32 v225, v225, v10
    v_mul_f32 v226, v226, v10
    v_mul_f32 v227, v227, v10
    v_mul_f32 v232, v232, v10
    v_mul_f32 v233, v233, v10
    v_mul_f32 v234, v234, v10
    v_mul_f32 v235, v235, v10
    v_mul_f32 v240, v240, v10
    v_mul_f32 v241, v241, v10
    v_mul_f32 v242, v242, v10
    v_mul_f32 v243, v243, v10
    v_mul_f32 v248, v248, v10
    v_mul_f32 v249, v249, v10
    v_mul_f32 v250, v250, v10
    v_mul_f32 v251, v251, v10
    v_max3_f32 v9, v36, v37, v38
    v_max3_f32 v9, v9, v39, v44
    v_max3_f32 v9, v9, v45, v46
    v_max3_f32 v9, v9, v47, 0
    v_mov_b32 v11, v9
    s_nop 1
    v_permlane16_swap_b32 v9, v11
    s_nop 1
    v_max_f32 v9, v9, v11
    v_mov_b32 v11, v9
    s_nop 1
    v_permlane32_swap_b32 v9, v11
    s_nop 1
    v_max_f32 v9, v9, v11
    v_exp_f32 v10, -v9
    v_sub_f32 v17, v17, v9
    v_mul_f32 v19, v19, v10
    v_sub_f32 v36, v36, v9
    v_sub_f32 v52, v52, v9
    v_sub_f32 v100, v100, v9
    v_sub_f32 v37, v37, v9
    v_sub_f32 v53, v53, v9
    v_sub_f32 v101, v101, v9
    v_sub_f32 v38, v38, v9
    v_sub_f32 v54, v54, v9
    v_sub_f32 v102, v102, v9
    v_sub_f32 v39, v39, v9
    v_sub_f32 v55, v55, v9
    v_sub_f32 v103, v103, v9
    v_sub_f32 v44, v44, v9
    v_sub_f32 v60, v60, v9
    v_sub_f32 v108, v108, v9
    v_sub_f32 v45, v45, v9
    v_sub_f32 v61, v61, v9
    v_sub_f32 v109, v109, v9
    v_sub_f32 v46, v46, v9
    v_sub_f32 v62, v62, v9
    v_sub_f32 v110, v110, v9
    v_sub_f32 v47, v47, v9
    v_sub_f32 v63, v63, v9
    v_sub_f32 v111, v111, v9
    v_mul_f32 v132, v132, v10
    v_mul_f32 v133, v133, v10
    v_mul_f32 v134, v134, v10
    v_mul_f32 v135, v135, v10
    v_mul_f32 v140, v140, v10
    v_mul_f32 v141, v141, v10
    v_mul_f32 v142, v142, v10
    v_mul_f32 v143, v143, v10
    v_mul_f32 v148, v148, v10
    v_mul_f32 v149, v149, v10
    v_mul_f32 v150, v150, v10
    v_mul_f32 v151, v151, v10
    v_mul_f32 v156, v156, v10
    v_mul_f32 v157, v157, v10
    v_mul_f32 v158, v158, v10
    v_mul_f32 v159, v159, v10
    v_mul_f32 v164, v164, v10
    v_mul_f32 v165, v165, v10
    v_mul_f32 v166, v166, v10
    v_mul_f32 v167, v167, v10
    v_mul_f32 v172, v172, v10
    v_mul_f32 v173, v173, v10
    v_mul_f32 v174, v174, v10
    v_mul_f32 v175, v175, v10
    v_mul_f32 v180, v180, v10
    v_mul_f32 v181, v181, v10
    v_mul_f32 v182, v182, v10
    v_mul_f32 v183, v183, v10
    v_mul_f32 v188, v188, v10
    v_mul_f32 v189, v189, v10
    v_mul_f32 v190, v190, v10
    v_mul_f32 v191, v191, v10
    v_mul_f32 v196, v196, v10
    v_mul_f32 v197, v197, v10
    v_mul_f32 v198, v198, v10
    v_mul_f32 v199, v199, v10
    v_mul_f32 v204, v204, v10
    v_mul_f32 v205, v205, v10
    v_mul_f32 v206, v206, v10
    v_mul_f32 v207, v207, v10
    v_mul_f32 v212, v212, v10
    v_mul_f32 v213, v213, v10
    v_mul_f32 v214, v214, v10
    v_mul_f32 v215, v215, v10
    v_mul_f32 v220, v220, v10
    v_mul_f32 v221, v221, v10
    v_mul_f32 v222, v222, v10
    v_mul_f32 v223, v223, v10
    v_mul_f32 v228, v228, v10
    v_mul_f32 v229, v229, v10
    v_mul_f32 v230, v230, v10
    v_mul_f32 v231, v231, v10
    v_mul_f32 v236, v236, v10
    v_mul_f32 v237, v237, v10
    v_mul_f32 v238, v238, v10
    v_mul_f32 v239, v239, v10
    v_mul_f32 v244, v244, v10
    v_mul_f32 v245, v245, v10
    v_mul_f32 v246, v246, v10
    v_mul_f32 v247, v247, v10
    v_mul_f32 v252, v252, v10
    v_mul_f32 v253, v253, v10
    v_mul_f32 v254, v254, v10
    v_mul_f32 v255, v255, v10
    v_exp_f32 v80, v32
    v_exp_f32 v81, v33
    v_exp_f32 v82, v34
    v_exp_f32 v83, v35
    v_exp_f32 v84, v36
    v_exp_f32 v85, v37
    v_exp_f32 v86, v38
    v_exp_f32 v87, v39
    v_add_f32 v20, v80, v81
    v_cvt_pk_bf16_f32 v64, v80, v81
    v_add_f32 v20, v20, v82
    v_add_f32 v20, v20, v83
    v_cvt_pk_bf16_f32 v65, v82, v83
    v_add_f32 v21, v84, v85
    v_cvt_pk_bf16_f32 v68, v84, v85
    v_add_f32 v21, v21, v86
    v_add_f32 v21, v21, v87
    v_cvt_pk_bf16_f32 v69, v86, v87
    v_exp_f32 v88, v40
    v_exp_f32 v89, v41
    v_exp_f32 v90, v42
    v_exp_f32 v91, v43
    v_exp_f32 v92, v44
    v_exp_f32 v93, v45
    v_exp_f32 v94, v46
    v_exp_f32 v95, v47
    v_add_f32 v20, v20, v88
    v_add_f32 v20, v20, v89
    v_cvt_pk_bf16_f32 v66, v88, v89
    v_add_f32 v20, v20, v90
    v_add_f32 v20, v20, v91
    v_cvt_pk_bf16_f32 v67, v90, v91
    v_add_f32 v21, v21, v92
    v_add_f32 v21, v21, v93
    v_cvt_pk_bf16_f32 v70, v92, v93
    v_add_f32 v21, v21, v94
    v_add_f32 v21, v21, v95
    v_cvt_pk_bf16_f32 v71, v94, v95
    v_exp_f32 v80, v48
    s_nop 1
    s_setpc_b64 s[84:85]
M_codeend:
.section .rodata,"a"
.p2align 6
.amdhsa_kernel sequential_preLN__compressed_kv_cla__glu_gated_swiglu__prompt_kernel
  .amdhsa_next_free_vgpr 512
  .amdhsa_next_free_sgpr 102
  .amdhsa_accum_offset 256
  .amdhsa_group_segment_fixed_size 0
  .amdhsa_kernarg_size 104
  .amdhsa_user_sgpr_count 2
  .amdhsa_user_sgpr_kernarg_segment_ptr 1
  .amdhsa_system_sgpr_workgroup_id_x 1
  .amdhsa_float_denorm_mode_32 3
  .amdhsa_float_denorm_mode_16_64 3
.end_amdhsa_kernel
```
